```python
import torch

def _softmax(x, axis=-1):
    return torch.softmax(x, dim=axis)
def _gelu(x):
    return torch.nn.functional.gelu(x, approximate="tanh")
def _silu(x):
    return torch.nn.functional.silu(x)
def _sigmoid(x):
    return torch.sigmoid(x)
def _layernorm(x, axis=-1, eps=1e-5):
    m = x.mean(dim=axis, keepdim=True)
    v = x.var(dim=axis, keepdim=True, unbiased=False)
    return (x - m) / torch.sqrt(v + eps)
def _scatter_add(tgt, idx, src, axis=0):
    return tgt.clone().index_add_(axis, idx, src)
def _segment_sum(src, seg, n):
    out = torch.zeros((n,) + src.shape[1:], dtype=src.dtype)
    return out.index_add_(0, seg, src)
def _pad(x, pw):
    flat = tuple(v for pair in reversed(pw) for v in pair)
    return torch.nn.functional.pad(x, flat)

kernel_name = 'gated_mix__compressed_kv_cla__sliding_local_dilated__prompt'

def setup_inputs():

    _w = (lambda a: (lambda t: t.to(torch.bfloat16) if t.is_floating_point() else t)(torch.as_tensor(a)))
    def _A_setup():
        B, H, Sq, Sk, D, M = 1, 16, 2048, 2048, 256, 448
        Dc = 4 * D
        return {
            "x": _w((lambda *s: torch.randn(*s, dtype=torch.bfloat16) * 0.05)(B, Sq, M)),
            "c_kv": _w((lambda *s: torch.randn(*s, dtype=torch.bfloat16) * 1.6)(B, Sk, Dc)),
            "w_q": _w((lambda *s: torch.randn(*s, dtype=torch.bfloat16) * 3.2)(M, H, D) * (M ** -0.5)),
            "w_uk": _w((lambda *s: torch.randn(*s, dtype=torch.bfloat16) * 3.2)(Dc, H, D) * (Dc ** -0.5)),
            "w_uv": _w((lambda *s: torch.randn(*s, dtype=torch.bfloat16) * 1.6)(Dc, H, D) * (Dc ** -0.5)),
            "w_o": _w((lambda *s: torch.randn(*s, dtype=torch.bfloat16) * 1.6)(H, D, M) * ((H * D) ** -0.5)),
        }
    _A_in = _A_setup()

    def _B_setup():
        B, S, D = 1, 2048, 448
        return {
            "x": _w((lambda *s: torch.randn(*s, dtype=torch.bfloat16) * 0.05)(B, S, D)),
            "wqkv": _w((lambda *s: torch.randn(*s, dtype=torch.bfloat16) * 1.6)(D, 3 * D)),
            "wo": _w((lambda *s: torch.randn(*s, dtype=torch.bfloat16) * 0.05)(D, D)),
        }
    _B_in = _B_setup()

    return {
        "A_x": _A_in["x"],
        "A_c_kv": _A_in["c_kv"],
        "A_w_q": _A_in["w_q"],
        "A_w_uk": _A_in["w_uk"],
        "A_w_uv": _A_in["w_uv"],
        "A_w_o": _A_in["w_o"],
        "B_x": _B_in["x"],
        "B_wqkv": _B_in["wqkv"],
        "B_wo": _B_in["wo"],
        "gate_w": _w((lambda *s: torch.randn(*s, dtype=torch.bfloat16) * 0.05)(448) * 16.0),
    }

def reference(A_x, A_c_kv, A_w_q, A_w_uk, A_w_uv, A_w_o, B_x, B_wqkv, B_wo, gate_w):
    def _A_ref(x, c_kv, w_q, w_uk, w_uv, w_o):
        B, Sq, M = x.shape[0], x.shape[1], x.shape[2]
        Sk = c_kv.shape[1]
        H, D = w_q.shape[1], w_q.shape[2]
        q = torch.einsum("bqm,mhd->bhqd", x, w_q)
        k = torch.einsum("bkc,chd->bhkd", c_kv, w_uk)
        v = torch.einsum("bkc,chd->bhkd", c_kv, w_uv)
        scores = torch.einsum("bhqd,bhkd->bhqk", q, k) * (D ** -0.5)
        off = Sk - Sq
        qi = torch.arange(Sq)[:, None]
        kj = torch.arange(Sk)[None, :]
        cmask = kj <= (qi + off)
        scores = torch.where(cmask[None, None], scores, -1e9)
        p = _softmax(scores, axis=-1)
        ctx = torch.einsum("bhqk,bhkd->bhqd", p, v)
        return torch.einsum("bhqd,hdm->bqm", ctx, w_o)

    def _B_ref(x, wqkv, wo):
        B, S, D = x.shape
        H = 16; Dh = D // H
        W, dil = 8, 2
        qkv = (lambda x, *d: x.permute(*d))((x @ wqkv).reshape(B, S, 3, H, Dh), 2, 0, 3, 1, 4)
        q, k, v = qkv[0], qkv[1], qkv[2]
        scale = Dh ** -0.5
        pos = torch.arange(S)
        off = torch.arange(W) * dil
        idx = pos[:, None] - off[None, :]
        mask = idx >= 0
        idx_c = torch.where(mask, idx, 0).reshape(-1)
        kg = k[:, :, idx_c, :].reshape(B, H, S, W, Dh)
        vg = v[:, :, idx_c, :].reshape(B, H, S, W, Dh)
        logits = torch.einsum("bhsd,bhswd->bhsw", q, kg) * scale
        logits = torch.where(mask[None, None, :, :], logits, -1e9)
        attn = _softmax(logits, axis=-1)
        o = torch.einsum("bhsw,bhswd->bhsd", attn, vg)
        return (lambda x, *d: x.permute(*d))(o, 0, 2, 1, 3).reshape(B, S, D) @ wo

    x = A_x
    g = _sigmoid((x * gate_w).sum(-1, keepdims=True))
    a = _A_ref(x, A_c_kv, A_w_q, A_w_uk, A_w_uv, A_w_o)
    b = _B_ref(x, B_wqkv, B_wo)
    return g * a + (1 - g) * b
```

```asm
; @launch grid=(256,1,1) block=(256,1,1) lds=163840
.amdgcn_target "amdgcn-amd-amdhsa--gfx950"
.text
.globl gated_mix__compressed_kv_cla__sliding_local_dilated__prompt_kernel
.p2align 8
.type gated_mix__compressed_kv_cla__sliding_local_dilated__prompt_kernel,@function
gated_mix__compressed_kv_cla__sliding_local_dilated__prompt_kernel:
    s_cmp_ge_u32 s2, 256
    s_cbranch_scc1 F_end_1
    s_load_dwordx16 s[4:19], s[0:1], 0
    s_load_dwordx4 s[20:23], s[0:1], 64
    s_load_dwordx4 s[24:27], s[0:1], 88
    s_load_dwordx2 s[98:99], s[0:1], 80
    s_getpc_b64 s[72:73]
PC_2:
    s_sub_u32 s72, s72, PC_2 - gated_mix__compressed_kv_cla__sliding_local_dilated__prompt_kernel
    s_subb_u32 s73, s73, 0
    s_bfe_u32 s74, s2, 131075
    s_lshl_b32 s74, s74, 15
    v_lshlrev_b32 v14, 7, v0
    v_add_u32 v14, s74, v14
    v_min_u32 v14, CODE_END - gated_mix__compressed_kv_cla__sliding_local_dilated__prompt_kernel - 4, v14
    global_load_dword v15, v14, s[72:73]
    v_lshrrev_b32 v26, 6, v0
    s_nop 0
    v_readfirstlane_b32 s60, v26
    v_cmp_eq_u32 vcc, 0, v0
    v_and_b32 v0, 63, v0
    s_and_b32 s81, s2, 7
    s_bfe_u32 s63, s2, 196611
    s_bfe_u32 s65, s2, 65542
    s_lshr_b32 s82, s2, 7
    s_lshl_b32 s64, s81, 1
    s_add_u32 s64, s64, s82
    v_mov_b32 v24, 0x40000000
    v_cndmask_b32 v24, v24, 0, vcc
    s_lshr_b32 s61, s60, 1
    s_and_b32 s62, s60, 1
    v_lshrrev_b32 v26, 4, v0
    s_lshl_b32 s81, s62, 2
    v_add_u32 v26, s81, v26
    v_and_b32 v27, 7, v0
    v_xor_b32 v26, v26, v27
    v_lshlrev_b32 v26, 4, v26
    v_lshrrev_b32 v27, 3, v0
    s_lshl_b32 s81, s60, 3
    v_add_u32 v27, s81, v27
    v_lshl_add_u32 v2, v27, 11, v26
    v_mul_u32_u24 v4, 896, v27
    v_add_u32 v4, v4, v26
    v_lshrrev_b32 v26, 5, v0
    s_lshl_b32 s81, s62, 1
    v_add_u32 v26, s81, v26
    s_lshl_b32 s81, s61, 2
    v_or_b32 v27, s81, v26
    v_lshlrev_b32 v27, 1, v27
    v_and_b32 v28, 31, v0
    v_xor_b32 v27, v27, v28
    v_lshlrev_b32 v27, 4, v27
    s_lshl_b32 s81, s61, 3
    v_add_u32 v26, s81, v26
    v_lshl_add_u32 v3, v26, 13, v27
    s_lshl_b32 s66, s63, 19
    s_lshl_b32 s67, s64, 9
    s_mov_b32 s90, 0x8000
    s_lshl_b32 s76, s60, 10
    s_lshl_b32 s85, s61, 2
    s_add_u32 s85, s85, s62
    s_lshl_b32 s85, s85, 10
    s_mov_b32 s86, 65536
    s_mov_b32 s31, 0x00020000
    s_mov_b32 s35, 0x00020000
    s_mov_b32 s30, 4194304
    s_mov_b32 s34, 8388608
    s_cmp_eq_u32 s65, 0
    s_waitcnt lgkmcnt(0)
    s_mov_b64 s[28:29], s[6:7]
    s_cselect_b64 s[32:33], s[10:11], s[12:13]
    s_add_u32 m0, s76, 0
    s_add_u32 s81, s66, 0
    buffer_load_dwordx4 v2, s[28:31], s81 offen lds
    s_add_u32 m0, s76, 4096
    s_add_u32 s81, s66, 65536
    buffer_load_dwordx4 v2, s[28:31], s81 offen lds
    s_add_u32 m0, s76, 8192
    s_add_u32 s81, s66, 131072
    buffer_load_dwordx4 v2, s[28:31], s81 offen lds
    s_add_u32 m0, s76, 12288
    s_add_u32 s81, s66, 196608
    buffer_load_dwordx4 v2, s[28:31], s81 offen lds
    s_add_u32 m0, s76, 16384
    s_add_u32 s81, s66, 262144
    buffer_load_dwordx4 v2, s[28:31], s81 offen lds
    s_add_u32 m0, s76, 20480
    s_add_u32 s81, s66, 327680
    buffer_load_dwordx4 v2, s[28:31], s81 offen lds
    s_add_u32 m0, s76, 24576
    s_add_u32 s81, s66, 393216
    buffer_load_dwordx4 v2, s[28:31], s81 offen lds
    s_add_u32 m0, s76, 28672
    s_add_u32 s81, s66, 458752
    buffer_load_dwordx4 v2, s[28:31], s81 offen lds
    s_add_u32 s66, s66, 128
    s_xor_b32 s76, s76, s90
    s_add_u32 s77, s86, s85
    s_add_u32 m0, s77, 0
    s_add_u32 s82, s67, 0
    buffer_load_dwordx4 v3, s[32:35], s82 offen lds
    s_add_u32 m0, s77, 8192
    s_add_u32 s82, s67, 131072
    buffer_load_dwordx4 v3, s[32:35], s82 offen lds
    s_add_u32 m0, s77, 16384
    s_add_u32 s82, s67, 262144
    buffer_load_dwordx4 v3, s[32:35], s82 offen lds
    s_add_u32 m0, s77, 24576
    s_add_u32 s82, s67, 393216
    buffer_load_dwordx4 v3, s[32:35], s82 offen lds
    s_add_u32 m0, s77, 2048
    s_add_u32 s82, s67, 32768
    buffer_load_dwordx4 v3, s[32:35], s82 offen lds
    s_add_u32 m0, s77, 10240
    s_add_u32 s82, s67, 163840
    buffer_load_dwordx4 v3, s[32:35], s82 offen lds
    s_add_u32 m0, s77, 18432
    s_add_u32 s82, s67, 294912
    buffer_load_dwordx4 v3, s[32:35], s82 offen lds
    s_add_u32 m0, s77, 26624
    s_add_u32 s82, s67, 425984
    buffer_load_dwordx4 v3, s[32:35], s82 offen lds
    s_add_u32 s67, s67, 524288
    s_add_u32 s86, s86, s90
    s_cmp_eq_u32 s86, 163840
    s_cselect_b32 s86, 65536, s86
    s_lshr_b32 s75, s2, 3
    s_lshl_b32 s75, s75, 2
    s_add_u32 s75, s75, s60
    s_mov_b32 s83, s75
    s_add_u32 m0, s76, 0
    s_add_u32 s81, s66, 0
    buffer_load_dwordx4 v2, s[28:31], s81 offen lds
    s_add_u32 m0, s76, 4096
    s_add_u32 s81, s66, 65536
    buffer_load_dwordx4 v2, s[28:31], s81 offen lds
    s_add_u32 m0, s76, 8192
    s_add_u32 s81, s66, 131072
    buffer_load_dwordx4 v2, s[28:31], s81 offen lds
    s_add_u32 m0, s76, 12288
    s_add_u32 s81, s66, 196608
    buffer_load_dwordx4 v2, s[28:31], s81 offen lds
    s_add_u32 m0, s76, 16384
    s_add_u32 s81, s66, 262144
    buffer_load_dwordx4 v2, s[28:31], s81 offen lds
    s_add_u32 m0, s76, 20480
    s_add_u32 s81, s66, 327680
    buffer_load_dwordx4 v2, s[28:31], s81 offen lds
    s_add_u32 m0, s76, 24576
    s_add_u32 s81, s66, 393216
    buffer_load_dwordx4 v2, s[28:31], s81 offen lds
    s_add_u32 m0, s76, 28672
    s_add_u32 s81, s66, 458752
    buffer_load_dwordx4 v2, s[28:31], s81 offen lds
    s_add_u32 s66, s66, 128
    s_xor_b32 s76, s76, s90
    s_add_u32 s77, s86, s85
    s_add_u32 m0, s77, 0
    s_add_u32 s82, s67, 0
    buffer_load_dwordx4 v3, s[32:35], s82 offen lds
    s_add_u32 m0, s77, 8192
    s_add_u32 s82, s67, 131072
    buffer_load_dwordx4 v3, s[32:35], s82 offen lds
    s_add_u32 m0, s77, 16384
    s_add_u32 s82, s67, 262144
    buffer_load_dwordx4 v3, s[32:35], s82 offen lds
    s_add_u32 m0, s77, 24576
    s_add_u32 s82, s67, 393216
    buffer_load_dwordx4 v3, s[32:35], s82 offen lds
    s_add_u32 m0, s77, 2048
    s_add_u32 s82, s67, 32768
    buffer_load_dwordx4 v3, s[32:35], s82 offen lds
    s_add_u32 m0, s77, 10240
    s_add_u32 s82, s67, 163840
    buffer_load_dwordx4 v3, s[32:35], s82 offen lds
    s_add_u32 m0, s77, 18432
    s_add_u32 s82, s67, 294912
    buffer_load_dwordx4 v3, s[32:35], s82 offen lds
    s_add_u32 m0, s77, 26624
    s_add_u32 s82, s67, 425984
    buffer_load_dwordx4 v3, s[32:35], s82 offen lds
    s_add_u32 s67, s67, 524288
    s_add_u32 s86, s86, s90
    s_cmp_eq_u32 s86, 163840
    s_cselect_b32 s86, 65536, s86
    v_and_b32 v26, 15, v0
    v_lshrrev_b32 v27, 4, v0
    v_lshrrev_b32 v28, 1, v26
    v_xor_b32 v28, v28, v27
    v_lshlrev_b32 v28, 4, v28
    v_lshl_add_u32 v30, v26, 7, v28
    v_lshrrev_b32 v28, 2, v26
    v_and_b32 v29, 1, v27
    v_lshl_or_b32 v29, v29, 2, v28
    v_lshl_add_u32 v28, v27, 3, v28
    v_and_b32 v26, 3, v0
    v_lshlrev_b32 v26, 3, v26
    v_lshl_add_u32 v26, v29, 5, v26
    v_lshl_add_u32 v7, v28, 9, v26
    v_lshl_add_u32 v31, v28, 8, v26
    s_lshl_b32 s83, s61, 14
    v_add_u32 v8, s83, v30
    v_xor_b32 v9, 64, v8
    s_lshl_b32 s83, s62, 8
    s_add_u32 s83, s83, 65536
    v_add_u32 v16, s83, v7
    s_mov_b32 s80, 0
    s_mov_b32 s78, 1
    v_xor_b32 v17, 32, v16
    v_xor_b32 v18, 64, v16
    v_xor_b32 v19, 96, v16
    v_xor_b32 v20, 128, v16
    v_xor_b32 v21, 160, v16
    v_xor_b32 v22, 192, v16
    v_xor_b32 v23, 224, v16
    s_waitcnt vmcnt(16)
    s_barrier
    ds_read_b128 a[160:163], v8 offset:0
    ds_read_b128 a[164:167], v9 offset:0
    ds_read_b64_tr_b16 a[0:1], v16 offset:0
    ds_read_b64_tr_b16 a[2:3], v16 offset:2048
    ds_read_b64_tr_b16 a[32:33], v16 offset:16384
    ds_read_b64_tr_b16 a[34:35], v16 offset:18432
    ds_read_b64_tr_b16 a[4:5], v17 offset:0
    ds_read_b64_tr_b16 a[6:7], v17 offset:2048
    ds_read_b64_tr_b16 a[36:37], v17 offset:16384
    ds_read_b64_tr_b16 a[38:39], v17 offset:18432
    ds_read_b64_tr_b16 a[8:9], v18 offset:0
    ds_read_b64_tr_b16 a[10:11], v18 offset:2048
    ds_read_b64_tr_b16 a[40:41], v18 offset:16384
    ds_read_b64_tr_b16 a[42:43], v18 offset:18432
    ds_read_b64_tr_b16 a[12:13], v19 offset:0
    ds_read_b64_tr_b16 a[14:15], v19 offset:2048
    ds_read_b64_tr_b16 a[44:45], v19 offset:16384
    ds_read_b64_tr_b16 a[46:47], v19 offset:18432
    ds_read_b64_tr_b16 a[16:17], v20 offset:0
    ds_read_b64_tr_b16 a[18:19], v20 offset:2048
    ds_read_b64_tr_b16 a[48:49], v20 offset:16384
    ds_read_b64_tr_b16 a[50:51], v20 offset:18432
    ds_read_b64_tr_b16 a[20:21], v21 offset:0
    ds_read_b64_tr_b16 a[22:23], v21 offset:2048
    ds_read_b64_tr_b16 a[52:53], v21 offset:16384
    ds_read_b64_tr_b16 a[54:55], v21 offset:18432
    ds_read_b64_tr_b16 a[24:25], v22 offset:0
    ds_read_b64_tr_b16 a[26:27], v22 offset:2048
    ds_read_b64_tr_b16 a[56:57], v22 offset:16384
    ds_read_b64_tr_b16 a[58:59], v22 offset:18432
    ds_read_b64_tr_b16 a[28:29], v23 offset:0
    ds_read_b64_tr_b16 a[30:31], v23 offset:2048
    ds_read_b64_tr_b16 a[60:61], v23 offset:16384
    ds_read_b64_tr_b16 a[62:63], v23 offset:18432
    ds_read_b128 a[168:171], v8 offset:2048
    ds_read_b128 a[172:175], v9 offset:2048
    ds_read_b128 a[176:179], v8 offset:4096
    ds_read_b128 a[180:183], v9 offset:4096
    ds_read_b128 a[184:187], v8 offset:6144
    ds_read_b128 a[188:191], v9 offset:6144
    s_cmp_eq_u32 s65, 1
    s_cbranch_scc1 F_Ve_3
    s_waitcnt lgkmcnt(0)
    v_mfma_f32_16x16x32_bf16 v[128:131], a[0:3], a[160:163], 0
    s_mov_b32 s39, 0x00020000
    v_mfma_f32_16x16x32_bf16 v[128:131], a[32:35], a[164:167], v[128:131]
    s_add_u32 s77, s86, s85
    s_mov_b32 s43, 0x00020000
    ds_read_b128 a[192:195], v8 offset:8192
    v_mfma_f32_16x16x32_bf16 a[128:131], a[36:39], a[164:167], 0
    s_mov_b32 s47, 0x00020000
    v_mfma_f32_16x16x32_bf16 a[128:131], a[4:7], a[160:163], a[128:131]
    s_add_u32 m0, s77, 0
    s_mov_b32 s51, 0x00020000
    ds_read_b128 a[196:199], v9 offset:8192
    v_mfma_f32_16x16x32_bf16 v[132:135], a[8:11], a[160:163], 0
    s_mov_b32 s71, 0x00020000
    v_mfma_f32_16x16x32_bf16 v[132:135], a[40:43], a[164:167], v[132:135]
    s_add_u32 s82, s67, 0
    s_mov_b32 s38, 1835008
    v_mfma_f32_16x16x32_bf16 a[132:135], a[44:47], a[164:167], 0
    s_mov_b32 s42, 3670016
    ds_read_b128 a[200:203], v8 offset:10240
    v_mfma_f32_16x16x32_bf16 a[132:135], a[12:15], a[160:163], a[132:135]
    s_mov_b32 s46, 1204224
    s_mov_b32 s50, 268435456
    v_mfma_f32_16x16x32_bf16 v[136:139], a[16:19], a[160:163], 0
    buffer_load_dwordx4 v3, s[32:35], s82 offen lds
    v_mfma_f32_16x16x32_bf16 v[136:139], a[48:51], a[164:167], v[136:139]
    s_add_u32 m0, s77, 8192
    s_mov_b32 s70, 896
    ds_read_b128 a[204:207], v9 offset:10240
    v_mfma_f32_16x16x32_bf16 a[136:139], a[52:55], a[164:167], 0
    s_mov_b64 s[36:37], s[4:5]
    s_mov_b64 s[40:41], s[8:9]
    v_mfma_f32_16x16x32_bf16 a[136:139], a[20:23], a[160:163], a[136:139]
    s_add_u32 s82, s67, 131072
    s_mov_b64 s[44:45], s[18:19]
    ds_read_b128 a[208:211], v8 offset:12288
    v_mfma_f32_16x16x32_bf16 v[140:143], a[24:27], a[160:163], 0
    s_mov_b64 s[48:49], s[26:27]
    v_mfma_f32_16x16x32_bf16 v[140:143], a[56:59], a[164:167], v[140:143]
    s_mov_b64 s[68:69], s[22:23]
    v_mfma_f32_16x16x32_bf16 a[140:143], a[60:63], a[164:167], 0
    s_mov_b64 s[18:19], s[14:15]
    ds_read_b128 a[212:215], v9 offset:12288
    v_mfma_f32_16x16x32_bf16 a[140:143], a[28:31], a[160:163], a[140:143]
    buffer_load_dwordx4 v3, s[32:35], s82 offen lds
    v_mfma_f32_16x16x32_bf16 a[156:159], a[28:31], a[168:171], 0
    s_add_u32 m0, s77, 16384
    s_mov_b64 s[0:1], s[20:21]
    ds_read_b128 a[216:219], v8 offset:14336
    v_mfma_f32_16x16x32_bf16 a[156:159], a[60:63], a[172:175], a[156:159]
    s_lshl_b32 s83, s75, 2
    v_and_b32 v26, 3, v0
    v_mfma_f32_16x16x32_bf16 v[156:159], a[56:59], a[172:175], 0
    s_add_u32 s82, s67, 262144
    v_add_u32 v26, s83, v26
    v_mfma_f32_16x16x32_bf16 v[156:159], a[24:27], a[168:171], v[156:159]
    ds_read_b128 a[220:223], v9 offset:14336
    v_min_u32 v26, 447, v26
    v_mfma_f32_16x16x32_bf16 a[152:155], a[20:23], a[168:171], 0
    v_lshrrev_b32 v27, 3, v26
    v_and_b32 v26, 7, v26
    v_mfma_f32_16x16x32_bf16 a[152:155], a[52:55], a[172:175], a[152:155]
    buffer_load_dwordx4 v3, s[32:35], s82 offen lds
    v_mfma_f32_16x16x32_bf16 v[152:155], a[48:51], a[172:175], 0
    s_add_u32 m0, s77, 24576
    v_xor_b32 v8, 0x8000, v8
    v_lshlrev_b32 v26, 7, v26
    v_mfma_f32_16x16x32_bf16 v[152:155], a[16:19], a[168:171], v[152:155]
    v_lshl_add_u32 v11, v27, 13, v26
    v_mfma_f32_16x16x32_bf16 a[148:151], a[12:15], a[168:171], 0
    s_and_b32 s84, s2, 7
    v_xor_b32 v9, 0x8000, v9
    v_mfma_f32_16x16x32_bf16 a[148:151], a[44:47], a[172:175], a[148:151]
    s_add_u32 s82, s67, 393216
    s_lshl_b32 s5, s84, 10
    v_mfma_f32_16x16x32_bf16 v[148:151], a[40:43], a[172:175], 0
    s_add_u32 s80, s80, 1
    s_mul_i32 s6, s84, 112
    v_mfma_f32_16x16x32_bf16 v[148:151], a[8:11], a[168:171], v[148:151]
    s_lshl_b32 s4, s2, 2
    s_add_u32 s4, s4, s60
    v_mfma_f32_16x16x32_bf16 a[144:147], a[4:7], a[168:171], 0
    buffer_load_dwordx4 v3, s[32:35], s82 offen lds
    v_mfma_f32_16x16x32_bf16 a[144:147], a[36:39], a[172:175], a[144:147]
    s_add_u32 m0, s77, 2048
    s_mul_i32 s4, s4, 1792
    v_min_u32 v10, 13, v0
    v_mfma_f32_16x16x32_bf16 v[144:147], a[32:35], a[172:175], 0
    s_cmp_eq_u32 s80, 3
    s_cselect_b32 s80, 0, s80
    s_cselect_b32 s79, 4294901760, s90
    v_mfma_f32_16x16x32_bf16 v[144:147], a[0:3], a[168:171], v[144:147]
    s_add_u32 s82, s67, 32768
    v_add_u32 v16, s79, v16
    v_lshlrev_b32 v10, 7, v10
    v_mfma_f32_16x16x32_bf16 v[160:163], a[0:3], a[176:179], 0
    s_sub_u32 s4, s4, 0
    v_mul_u32_u24 v12, 2688, v27
    v_mfma_f32_16x16x32_bf16 v[160:163], a[32:35], a[180:183], v[160:163]
    buffer_load_dwordx4 v3, s[32:35], s82 offen lds
    v_mfma_f32_16x16x32_bf16 v[32:35], a[36:39], a[180:183], 0
    v_add_u32 v17, s79, v17
    v_lshrrev_b32 v27, 8, v26
    v_mfma_f32_16x16x32_bf16 v[32:35], a[4:7], a[176:179], v[32:35]
    s_add_u32 m0, s77, 10240
    v_min_u32 v27, 2, v27
    v_mul_u32_u24 v27, 896, v27
    v_mfma_f32_16x16x32_bf16 v[164:167], a[8:11], a[176:179], 0
    v_add_u32 v18, s79, v18
    v_add_u32 v12, v12, v27
    v_mfma_f32_16x16x32_bf16 v[164:167], a[40:43], a[180:183], v[164:167]
    v_bfe_u32 v27, v26, 7, 1
    v_mfma_f32_16x16x32_bf16 v[36:39], a[44:47], a[180:183], 0
    s_add_u32 s82, s67, 163840
    v_mul_u32_u24 v27, 116, v27
    v_mfma_f32_16x16x32_bf16 v[36:39], a[12:15], a[176:179], v[36:39]
    v_add_u32 v19, s79, v19
    v_add_u32 v12, v12, v27
    v_mfma_f32_16x16x32_bf16 v[168:171], a[16:19], a[176:179], 0
    buffer_load_dwordx4 v3, s[32:35], s82 offen lds
    v_mfma_f32_16x16x32_bf16 v[168:171], a[48:51], a[180:183], v[168:171]
    s_mov_b64 s[8:9], s[36:37]
    s_mov_b32 s10, 0
    v_mfma_f32_16x16x32_bf16 v[40:43], a[52:55], a[180:183], 0
    s_add_u32 m0, s77, 18432
    s_mov_b32 s11, 0x00020000
    v_add_u32 v20, s79, v20
    v_mfma_f32_16x16x32_bf16 v[40:43], a[20:23], a[176:179], v[40:43]
    s_sub_u32 s4, s4, 67108864
    v_mfma_f32_16x16x32_bf16 v[172:175], a[24:27], a[176:179], 0
    s_add_u32 s82, s67, 294912
    s_mov_b64 s[12:13], s[40:41]
    v_add_u32 v21, s79, v21
    v_mfma_f32_16x16x32_bf16 v[172:175], a[56:59], a[180:183], v[172:175]
    s_mov_b32 s14, 0
    v_mfma_f32_16x16x32_bf16 v[44:47], a[60:63], a[180:183], 0
    s_mov_b32 s15, 0x00020000
    s_sub_u32 s5, s5, 1835008
    v_add_u32 v22, s79, v22
    v_mfma_f32_16x16x32_bf16 v[44:47], a[28:31], a[176:179], v[44:47]
    buffer_load_dwordx4 v3, s[32:35], s82 offen lds
    v_mfma_f32_16x16x32_bf16 v[60:63], a[28:31], a[184:187], 0
    s_mov_b64 s[20:21], s[44:45]
    v_mfma_f32_16x16x32_bf16 v[60:63], a[60:63], a[188:191], v[60:63]
    s_add_u32 m0, s77, 26624
    s_mov_b32 s22, 0
    v_add_u32 v23, s79, v23
    v_mfma_f32_16x16x32_bf16 v[188:191], a[56:59], a[188:191], 0
    s_mov_b32 s23, 0x00020000
    s_sub_u32 s6, s6, 602112
    v_mfma_f32_16x16x32_bf16 v[188:191], a[24:27], a[184:187], v[188:191]
    s_add_u32 s82, s67, 425984
    s_lshl_b32 s100, s2, 7
    v_mfma_f32_16x16x32_bf16 v[56:59], a[20:23], a[184:187], 0
    s_add_u32 s100, s100, 57671680
    v_mfma_f32_16x16x32_bf16 v[56:59], a[52:55], a[188:191], v[56:59]
    buffer_load_dwordx4 v3, s[32:35], s82 offen lds
    v_mfma_f32_16x16x32_bf16 v[184:187], a[48:51], a[188:191], 0
    s_and_b32 s101, s2, 0x87
    s_lshl_b32 s101, s101, 7
    v_mfma_f32_16x16x32_bf16 v[184:187], a[16:19], a[184:187], v[184:187]
    s_add_u32 s67, s67, 524288
    s_add_u32 s101, s101, 57671692
    v_mfma_f32_16x16x32_bf16 v[52:55], a[12:15], a[184:187], 0
    v_mov_b64 v[26:27], 0
    v_mfma_f32_16x16x32_bf16 v[52:55], a[44:47], a[188:191], v[52:55]
    s_add_u32 s86, s86, s90
    v_mov_b64 v[28:29], 0
    v_mfma_f32_16x16x32_bf16 v[180:183], a[40:43], a[188:191], 0
    v_lshlrev_b32 v1, 4, v0
    v_mfma_f32_16x16x32_bf16 v[180:183], a[8:11], a[184:187], v[180:183]
    s_cmp_eq_u32 s86, 163840
    s_cselect_b32 s86, 65536, s86
    v_mfma_f32_16x16x32_bf16 v[48:51], a[4:7], a[184:187], 0
    v_mfma_f32_16x16x32_bf16 v[48:51], a[36:39], a[188:191], v[48:51]
    buffer_store_dwordx4 v[26:29], v24, s[48:51], s100 offen sc1
    v_mfma_f32_16x16x32_bf16 v[176:179], a[32:35], a[188:191], 0
    buffer_store_dwordx4 v[26:29], v24, s[48:51], s100 offen offset:16 sc1
    v_mfma_f32_16x16x32_bf16 v[176:179], a[0:3], a[184:187], v[176:179]
    buffer_load_dword v13, v1, s[68:71], 0 offen
    s_waitcnt vmcnt(11) lgkmcnt(0)
    s_barrier
    v_mfma_f32_16x16x32_bf16 v[192:195], a[0:3], a[192:195], 0
    ds_read_b128 a[160:163], v8 offset:0
    v_mfma_f32_16x16x32_bf16 v[192:195], a[32:35], a[196:199], v[192:195]
    s_add_u32 m0, s76, 0
    ds_read_b128 a[164:167], v9 offset:0
    v_mfma_f32_16x16x32_bf16 v[64:67], a[36:39], a[196:199], 0
    v_mfma_f32_16x16x32_bf16 v[64:67], a[4:7], a[192:195], v[64:67]
    s_add_u32 s81, s66, 0
    ds_read_b64_tr_b16 a[64:65], v16 offset:0
    v_mfma_f32_16x16x32_bf16 v[196:199], a[8:11], a[192:195], 0
    ds_read_b64_tr_b16 a[66:67], v16 offset:2048
    v_mfma_f32_16x16x32_bf16 v[196:199], a[40:43], a[196:199], v[196:199]
    ds_read_b64_tr_b16 a[96:97], v16 offset:16384
    v_mfma_f32_16x16x32_bf16 v[68:71], a[44:47], a[196:199], 0
    buffer_load_dwordx4 v2, s[28:31], s81 offen lds
    v_mfma_f32_16x16x32_bf16 v[68:71], a[12:15], a[192:195], v[68:71]
    ds_read_b64_tr_b16 a[98:99], v16 offset:18432
    v_mfma_f32_16x16x32_bf16 v[200:203], a[16:19], a[192:195], 0
    s_add_u32 m0, s76, 4096
    ds_read_b64_tr_b16 a[68:69], v17 offset:0
    v_mfma_f32_16x16x32_bf16 v[200:203], a[48:51], a[196:199], v[200:203]
    ds_read_b64_tr_b16 a[70:71], v17 offset:2048
    v_mfma_f32_16x16x32_bf16 v[72:75], a[52:55], a[196:199], 0
    s_add_u32 s81, s66, 65536
    ds_read_b64_tr_b16 a[100:101], v17 offset:16384
    v_mfma_f32_16x16x32_bf16 v[72:75], a[20:23], a[192:195], v[72:75]
    v_mfma_f32_16x16x32_bf16 v[204:207], a[24:27], a[192:195], 0
    ds_read_b64_tr_b16 a[102:103], v17 offset:18432
    ds_read_b64_tr_b16 a[72:73], v18 offset:0
    v_mfma_f32_16x16x32_bf16 v[204:207], a[56:59], a[196:199], v[204:207]
    buffer_load_dwordx4 v2, s[28:31], s81 offen lds
    v_mfma_f32_16x16x32_bf16 v[76:79], a[60:63], a[196:199], 0
    ds_read_b64_tr_b16 a[74:75], v18 offset:2048
    v_mfma_f32_16x16x32_bf16 v[76:79], a[28:31], a[192:195], v[76:79]
    s_add_u32 m0, s76, 8192
    ds_read_b64_tr_b16 a[104:105], v18 offset:16384
    v_mfma_f32_16x16x32_bf16 v[92:95], a[28:31], a[200:203], 0
    v_mfma_f32_16x16x32_bf16 v[92:95], a[60:63], a[204:207], v[92:95]
    s_add_u32 s81, s66, 131072
    ds_read_b64_tr_b16 a[106:107], v18 offset:18432
    v_mfma_f32_16x16x32_bf16 v[220:223], a[56:59], a[204:207], 0
    ds_read_b64_tr_b16 a[76:77], v19 offset:0
    v_mfma_f32_16x16x32_bf16 v[220:223], a[24:27], a[200:203], v[220:223]
    ds_read_b64_tr_b16 a[78:79], v19 offset:2048
    v_mfma_f32_16x16x32_bf16 v[88:91], a[20:23], a[200:203], 0
    buffer_load_dwordx4 v2, s[28:31], s81 offen lds
    v_mfma_f32_16x16x32_bf16 v[88:91], a[52:55], a[204:207], v[88:91]
    ds_read_b64_tr_b16 a[108:109], v19 offset:16384
    v_mfma_f32_16x16x32_bf16 v[216:219], a[48:51], a[204:207], 0
    s_add_u32 m0, s76, 12288
    ds_read_b64_tr_b16 a[110:111], v19 offset:18432
    v_mfma_f32_16x16x32_bf16 v[216:219], a[16:19], a[200:203], v[216:219]
    ds_read_b64_tr_b16 a[80:81], v20 offset:0
    v_mfma_f32_16x16x32_bf16 v[84:87], a[12:15], a[200:203], 0
    s_add_u32 s81, s66, 196608
    ds_read_b64_tr_b16 a[82:83], v20 offset:2048
    v_mfma_f32_16x16x32_bf16 v[84:87], a[44:47], a[204:207], v[84:87]
    v_mfma_f32_16x16x32_bf16 v[212:215], a[40:43], a[204:207], 0
    ds_read_b64_tr_b16 a[112:113], v20 offset:16384
    ds_read_b64_tr_b16 a[114:115], v20 offset:18432
    v_mfma_f32_16x16x32_bf16 v[212:215], a[8:11], a[200:203], v[212:215]
    buffer_load_dwordx4 v2, s[28:31], s81 offen lds
    v_mfma_f32_16x16x32_bf16 v[80:83], a[4:7], a[200:203], 0
    ds_read_b64_tr_b16 a[84:85], v21 offset:0
    v_mfma_f32_16x16x32_bf16 v[80:83], a[36:39], a[204:207], v[80:83]
    s_add_u32 m0, s76, 16384
    ds_read_b64_tr_b16 a[86:87], v21 offset:2048
    v_mfma_f32_16x16x32_bf16 v[208:211], a[32:35], a[204:207], 0
    v_mfma_f32_16x16x32_bf16 v[208:211], a[0:3], a[200:203], v[208:211]
    s_add_u32 s81, s66, 262144
    ds_read_b64_tr_b16 a[116:117], v21 offset:16384
    v_mfma_f32_16x16x32_bf16 v[224:227], a[0:3], a[208:211], 0
    ds_read_b64_tr_b16 a[118:119], v21 offset:18432
    v_mfma_f32_16x16x32_bf16 v[224:227], a[32:35], a[212:215], v[224:227]
    ds_read_b64_tr_b16 a[88:89], v22 offset:0
    v_mfma_f32_16x16x32_bf16 v[96:99], a[36:39], a[212:215], 0
    buffer_load_dwordx4 v2, s[28:31], s81 offen lds
    v_mfma_f32_16x16x32_bf16 v[96:99], a[4:7], a[208:211], v[96:99]
    ds_read_b64_tr_b16 a[90:91], v22 offset:2048
    v_mfma_f32_16x16x32_bf16 v[228:231], a[8:11], a[208:211], 0
    s_add_u32 m0, s76, 20480
    ds_read_b64_tr_b16 a[120:121], v22 offset:16384
    v_mfma_f32_16x16x32_bf16 v[228:231], a[40:43], a[212:215], v[228:231]
    ds_read_b64_tr_b16 a[122:123], v22 offset:18432
    v_mfma_f32_16x16x32_bf16 v[100:103], a[44:47], a[212:215], 0
    s_add_u32 s81, s66, 327680
    ds_read_b64_tr_b16 a[92:93], v23 offset:0
    v_mfma_f32_16x16x32_bf16 v[100:103], a[12:15], a[208:211], v[100:103]
    v_mfma_f32_16x16x32_bf16 v[232:235], a[16:19], a[208:211], 0
    ds_read_b64_tr_b16 a[94:95], v23 offset:2048
    ds_read_b64_tr_b16 a[124:125], v23 offset:16384
    v_mfma_f32_16x16x32_bf16 v[232:235], a[48:51], a[212:215], v[232:235]
    buffer_load_dwordx4 v2, s[28:31], s81 offen lds
    v_mfma_f32_16x16x32_bf16 v[104:107], a[52:55], a[212:215], 0
    ds_read_b64_tr_b16 a[126:127], v23 offset:18432
    v_mfma_f32_16x16x32_bf16 v[104:107], a[20:23], a[208:211], v[104:107]
    s_add_u32 m0, s76, 24576
    ds_read_b128 a[168:171], v8 offset:2048
    v_mfma_f32_16x16x32_bf16 v[236:239], a[24:27], a[208:211], 0
    v_mfma_f32_16x16x32_bf16 v[236:239], a[56:59], a[212:215], v[236:239]
    s_add_u32 s81, s66, 393216
    ds_read_b128 a[172:175], v9 offset:2048
    v_mfma_f32_16x16x32_bf16 v[108:111], a[60:63], a[212:215], 0
    ds_read_b128 a[176:179], v8 offset:4096
    v_mfma_f32_16x16x32_bf16 v[108:111], a[28:31], a[208:211], v[108:111]
    ds_read_b128 a[180:183], v9 offset:4096
    v_mfma_f32_16x16x32_bf16 v[124:127], a[28:31], a[216:219], 0
    buffer_load_dwordx4 v2, s[28:31], s81 offen lds
    v_mfma_f32_16x16x32_bf16 v[124:127], a[60:63], a[220:223], v[124:127]
    ds_read_b128 a[184:187], v8 offset:6144
    v_mfma_f32_16x16x32_bf16 v[252:255], a[56:59], a[220:223], 0
    s_add_u32 m0, s76, 28672
    ds_read_b128 a[188:191], v9 offset:6144
    v_mfma_f32_16x16x32_bf16 v[252:255], a[24:27], a[216:219], v[252:255]
    v_mfma_f32_16x16x32_bf16 v[120:123], a[20:23], a[216:219], 0
    s_add_u32 s81, s66, 458752
    v_mfma_f32_16x16x32_bf16 v[120:123], a[52:55], a[220:223], v[120:123]
    v_mfma_f32_16x16x32_bf16 v[248:251], a[48:51], a[220:223], 0
    v_mfma_f32_16x16x32_bf16 v[248:251], a[16:19], a[216:219], v[248:251]
    buffer_load_dwordx4 v2, s[28:31], s81 offen lds
    v_mfma_f32_16x16x32_bf16 v[116:119], a[12:15], a[216:219], 0
    v_mfma_f32_16x16x32_bf16 v[116:119], a[44:47], a[220:223], v[116:119]
    s_add_u32 s66, s66, 128
    v_mfma_f32_16x16x32_bf16 v[244:247], a[40:43], a[220:223], 0
    v_mfma_f32_16x16x32_bf16 v[244:247], a[8:11], a[216:219], v[244:247]
    s_xor_b32 s76, s76, s90
    v_mfma_f32_16x16x32_bf16 v[112:115], a[4:7], a[216:219], 0
    v_mfma_f32_16x16x32_bf16 v[112:115], a[36:39], a[220:223], v[112:115]
    v_mfma_f32_16x16x32_bf16 v[240:243], a[32:35], a[220:223], 0
    v_mfma_f32_16x16x32_bf16 v[240:243], a[0:3], a[216:219], v[240:243]
    s_waitcnt lgkmcnt(0)
    v_mfma_f32_16x16x32_bf16 v[128:131], a[64:67], a[160:163], v[128:131]
    v_mfma_f32_16x16x32_bf16 v[128:131], a[96:99], a[164:167], v[128:131]
    s_add_u32 s77, s86, s85
    ds_read_b128 a[192:195], v8 offset:8192
    v_mfma_f32_16x16x32_bf16 a[128:131], a[100:103], a[164:167], a[128:131]
    v_mfma_f32_16x16x32_bf16 a[128:131], a[68:71], a[160:163], a[128:131]
    s_add_u32 m0, s77, 0
    ds_read_b128 a[196:199], v9 offset:8192
    v_mfma_f32_16x16x32_bf16 v[132:135], a[72:75], a[160:163], v[132:135]
    v_mfma_f32_16x16x32_bf16 v[132:135], a[104:107], a[164:167], v[132:135]
    s_add_u32 s82, s67, 0
    v_mfma_f32_16x16x32_bf16 a[132:135], a[108:111], a[164:167], a[132:135]
    ds_read_b128 a[200:203], v8 offset:10240
    v_mfma_f32_16x16x32_bf16 a[132:135], a[76:79], a[160:163], a[132:135]
    buffer_load_dwordx4 v3, s[32:35], s82 offen lds
    v_mfma_f32_16x16x32_bf16 v[136:139], a[80:83], a[160:163], v[136:139]
    ds_read_b128 a[204:207], v9 offset:10240
    v_mfma_f32_16x16x32_bf16 v[136:139], a[112:115], a[164:167], v[136:139]
    s_add_u32 m0, s77, 8192
    v_mfma_f32_16x16x32_bf16 a[136:139], a[116:119], a[164:167], a[136:139]
    v_mfma_f32_16x16x32_bf16 a[136:139], a[84:87], a[160:163], a[136:139]
    s_add_u32 s82, s67, 131072
    ds_read_b128 a[208:211], v8 offset:12288
    v_mfma_f32_16x16x32_bf16 v[140:143], a[88:91], a[160:163], v[140:143]
    v_mfma_f32_16x16x32_bf16 v[140:143], a[120:123], a[164:167], v[140:143]
    buffer_load_dwordx4 v3, s[32:35], s82 offen lds
    v_mfma_f32_16x16x32_bf16 a[140:143], a[124:127], a[164:167], a[140:143]
    ds_read_b128 a[212:215], v9 offset:12288
    v_mfma_f32_16x16x32_bf16 a[140:143], a[92:95], a[160:163], a[140:143]
    v_mfma_f32_16x16x32_bf16 a[156:159], a[92:95], a[168:171], a[156:159]
    s_add_u32 m0, s77, 16384
    ds_read_b128 a[216:219], v8 offset:14336
    v_mfma_f32_16x16x32_bf16 a[156:159], a[124:127], a[172:175], a[156:159]
    v_mfma_f32_16x16x32_bf16 v[156:159], a[120:123], a[172:175], v[156:159]
    s_add_u32 s82, s67, 262144
    v_mfma_f32_16x16x32_bf16 v[156:159], a[88:91], a[168:171], v[156:159]
    ds_read_b128 a[220:223], v9 offset:14336
    v_mfma_f32_16x16x32_bf16 a[152:155], a[84:87], a[168:171], a[152:155]
    buffer_load_dwordx4 v3, s[32:35], s82 offen lds
    v_mfma_f32_16x16x32_bf16 a[152:155], a[116:119], a[172:175], a[152:155]
    v_xor_b32 v8, 0x8000, v8
    v_mfma_f32_16x16x32_bf16 v[152:155], a[112:115], a[172:175], v[152:155]
    s_add_u32 m0, s77, 24576
    v_mfma_f32_16x16x32_bf16 v[152:155], a[80:83], a[168:171], v[152:155]
    v_mfma_f32_16x16x32_bf16 a[148:151], a[76:79], a[168:171], a[148:151]
    v_xor_b32 v9, 0x8000, v9
    v_mfma_f32_16x16x32_bf16 a[148:151], a[108:111], a[172:175], a[148:151]
    s_add_u32 s82, s67, 393216
    v_mfma_f32_16x16x32_bf16 v[148:151], a[104:107], a[172:175], v[148:151]
    s_add_u32 s80, s80, 1
    v_mfma_f32_16x16x32_bf16 v[148:151], a[72:75], a[168:171], v[148:151]
    buffer_load_dwordx4 v3, s[32:35], s82 offen lds
    v_mfma_f32_16x16x32_bf16 a[144:147], a[68:71], a[168:171], a[144:147]
    s_add_u32 m0, s77, 2048
    v_mfma_f32_16x16x32_bf16 a[144:147], a[100:103], a[172:175], a[144:147]
    s_cmp_eq_u32 s80, 3
    s_cselect_b32 s80, 0, s80
    s_cselect_b32 s79, 4294901760, s90
    v_mfma_f32_16x16x32_bf16 v[144:147], a[96:99], a[172:175], v[144:147]
    v_mfma_f32_16x16x32_bf16 v[144:147], a[64:67], a[168:171], v[144:147]
    s_add_u32 s82, s67, 32768
    v_add_u32 v16, s79, v16
    v_mfma_f32_16x16x32_bf16 v[160:163], a[64:67], a[176:179], v[160:163]
    v_mfma_f32_16x16x32_bf16 v[160:163], a[96:99], a[180:183], v[160:163]
    buffer_load_dwordx4 v3, s[32:35], s82 offen lds
    v_mfma_f32_16x16x32_bf16 v[32:35], a[100:103], a[180:183], v[32:35]
    v_add_u32 v17, s79, v17
    v_mfma_f32_16x16x32_bf16 v[32:35], a[68:71], a[176:179], v[32:35]
    s_add_u32 m0, s77, 10240
    v_mfma_f32_16x16x32_bf16 v[164:167], a[72:75], a[176:179], v[164:167]
    v_add_u32 v18, s79, v18
    v_mfma_f32_16x16x32_bf16 v[164:167], a[104:107], a[180:183], v[164:167]
    v_mfma_f32_16x16x32_bf16 v[36:39], a[108:111], a[180:183], v[36:39]
    s_add_u32 s82, s67, 163840
    v_mfma_f32_16x16x32_bf16 v[36:39], a[76:79], a[176:179], v[36:39]
    v_add_u32 v19, s79, v19
    v_mfma_f32_16x16x32_bf16 v[168:171], a[80:83], a[176:179], v[168:171]
    buffer_load_dwordx4 v3, s[32:35], s82 offen lds
    v_mfma_f32_16x16x32_bf16 v[168:171], a[112:115], a[180:183], v[168:171]
    v_mfma_f32_16x16x32_bf16 v[40:43], a[116:119], a[180:183], v[40:43]
    s_add_u32 m0, s77, 18432
    v_add_u32 v20, s79, v20
    v_mfma_f32_16x16x32_bf16 v[40:43], a[84:87], a[176:179], v[40:43]
    v_mfma_f32_16x16x32_bf16 v[172:175], a[88:91], a[176:179], v[172:175]
    s_add_u32 s82, s67, 294912
    v_add_u32 v21, s79, v21
    v_mfma_f32_16x16x32_bf16 v[172:175], a[120:123], a[180:183], v[172:175]
    v_mfma_f32_16x16x32_bf16 v[44:47], a[124:127], a[180:183], v[44:47]
    buffer_load_dwordx4 v3, s[32:35], s82 offen lds
    v_mfma_f32_16x16x32_bf16 v[44:47], a[92:95], a[176:179], v[44:47]
    v_add_u32 v22, s79, v22
    v_mfma_f32_16x16x32_bf16 v[60:63], a[92:95], a[184:187], v[60:63]
    v_mfma_f32_16x16x32_bf16 v[60:63], a[124:127], a[188:191], v[60:63]
    s_add_u32 m0, s77, 26624
    v_add_u32 v23, s79, v23
    v_mfma_f32_16x16x32_bf16 v[188:191], a[120:123], a[188:191], v[188:191]
    v_mfma_f32_16x16x32_bf16 v[188:191], a[88:91], a[184:187], v[188:191]
    s_add_u32 s82, s67, 425984
    v_mfma_f32_16x16x32_bf16 v[56:59], a[84:87], a[184:187], v[56:59]
    v_mfma_f32_16x16x32_bf16 v[56:59], a[116:119], a[188:191], v[56:59]
    buffer_load_dwordx4 v3, s[32:35], s82 offen lds
    v_mfma_f32_16x16x32_bf16 v[184:187], a[112:115], a[188:191], v[184:187]
    v_mfma_f32_16x16x32_bf16 v[184:187], a[80:83], a[184:187], v[184:187]
    s_add_u32 s67, s67, 524288
    v_mfma_f32_16x16x32_bf16 v[52:55], a[76:79], a[184:187], v[52:55]
    v_mfma_f32_16x16x32_bf16 v[52:55], a[108:111], a[188:191], v[52:55]
    s_add_u32 s86, s86, s90
    v_mfma_f32_16x16x32_bf16 v[180:183], a[104:107], a[188:191], v[180:183]
    v_mfma_f32_16x16x32_bf16 v[180:183], a[72:75], a[184:187], v[180:183]
    s_cmp_eq_u32 s86, 163840
    s_cselect_b32 s86, 65536, s86
    v_mfma_f32_16x16x32_bf16 v[48:51], a[68:71], a[184:187], v[48:51]
    v_mfma_f32_16x16x32_bf16 v[48:51], a[100:103], a[188:191], v[48:51]
    v_mfma_f32_16x16x32_bf16 v[176:179], a[96:99], a[188:191], v[176:179]
    v_mfma_f32_16x16x32_bf16 v[176:179], a[64:67], a[184:187], v[176:179]
    s_mov_b32 s78, 2
    s_waitcnt vmcnt(8) lgkmcnt(0)
    s_barrier
.p2align 6
F_loop_5:
    v_mfma_f32_16x16x32_bf16 v[192:195], a[64:67], a[192:195], v[192:195]
    s_add_u32 m0, s76, 0
    ds_read_b128 a[160:163], v8 offset:0
    v_mfma_f32_16x16x32_bf16 v[192:195], a[96:99], a[196:199], v[192:195]
    ds_read_b128 a[164:167], v9 offset:0
    v_mfma_f32_16x16x32_bf16 v[64:67], a[100:103], a[196:199], v[64:67]
    s_add_u32 s81, s66, 0
    v_mfma_f32_16x16x32_bf16 v[64:67], a[68:71], a[192:195], v[64:67]
    ds_read_b64_tr_b16 a[0:1], v16 offset:0
    v_mfma_f32_16x16x32_bf16 v[196:199], a[72:75], a[192:195], v[196:199]
    ds_read_b64_tr_b16 a[2:3], v16 offset:2048
    v_mfma_f32_16x16x32_bf16 v[196:199], a[104:107], a[196:199], v[196:199]
    buffer_load_dwordx4 v2, s[28:31], s81 offen lds
    v_mfma_f32_16x16x32_bf16 v[68:71], a[108:111], a[196:199], v[68:71]
    s_add_u32 m0, s76, 4096
    ds_read_b64_tr_b16 a[32:33], v16 offset:16384
    v_mfma_f32_16x16x32_bf16 v[68:71], a[76:79], a[192:195], v[68:71]
    ds_read_b64_tr_b16 a[34:35], v16 offset:18432
    v_mfma_f32_16x16x32_bf16 v[200:203], a[80:83], a[192:195], v[200:203]
    s_add_u32 s81, s66, 65536
    ds_read_b64_tr_b16 a[4:5], v17 offset:0
    v_mfma_f32_16x16x32_bf16 v[200:203], a[112:115], a[196:199], v[200:203]
    ds_read_b64_tr_b16 a[6:7], v17 offset:2048
    v_mfma_f32_16x16x32_bf16 v[72:75], a[116:119], a[196:199], v[72:75]
    buffer_load_dwordx4 v2, s[28:31], s81 offen lds
    v_mfma_f32_16x16x32_bf16 v[72:75], a[84:87], a[192:195], v[72:75]
    ds_read_b64_tr_b16 a[36:37], v17 offset:16384
    v_mfma_f32_16x16x32_bf16 v[204:207], a[88:91], a[192:195], v[204:207]
    s_add_u32 m0, s76, 8192
    ds_read_b64_tr_b16 a[38:39], v17 offset:18432
    v_mfma_f32_16x16x32_bf16 v[204:207], a[120:123], a[196:199], v[204:207]
    ds_read_b64_tr_b16 a[8:9], v18 offset:0
    v_mfma_f32_16x16x32_bf16 v[76:79], a[124:127], a[196:199], v[76:79]
    s_add_u32 s81, s66, 131072
    ds_read_b64_tr_b16 a[10:11], v18 offset:2048
    v_mfma_f32_16x16x32_bf16 v[76:79], a[92:95], a[192:195], v[76:79]
    ds_read_b64_tr_b16 a[40:41], v18 offset:16384
    v_mfma_f32_16x16x32_bf16 v[92:95], a[92:95], a[200:203], v[92:95]
    buffer_load_dwordx4 v2, s[28:31], s81 offen lds
    v_mfma_f32_16x16x32_bf16 v[92:95], a[124:127], a[204:207], v[92:95]
    ds_read_b64_tr_b16 a[42:43], v18 offset:18432
    v_mfma_f32_16x16x32_bf16 v[220:223], a[120:123], a[204:207], v[220:223]
    s_add_u32 m0, s76, 12288
    ds_read_b64_tr_b16 a[12:13], v19 offset:0
    v_mfma_f32_16x16x32_bf16 v[220:223], a[88:91], a[200:203], v[220:223]
    ds_read_b64_tr_b16 a[14:15], v19 offset:2048
    v_mfma_f32_16x16x32_bf16 v[88:91], a[84:87], a[200:203], v[88:91]
    s_add_u32 s81, s66, 196608
    v_mfma_f32_16x16x32_bf16 v[88:91], a[116:119], a[204:207], v[88:91]
    ds_read_b64_tr_b16 a[44:45], v19 offset:16384
    ds_read_b64_tr_b16 a[46:47], v19 offset:18432
    v_mfma_f32_16x16x32_bf16 v[216:219], a[112:115], a[204:207], v[216:219]
    buffer_load_dwordx4 v2, s[28:31], s81 offen lds
    v_mfma_f32_16x16x32_bf16 v[216:219], a[80:83], a[200:203], v[216:219]
    ds_read_b64_tr_b16 a[16:17], v20 offset:0
    v_mfma_f32_16x16x32_bf16 v[84:87], a[76:79], a[200:203], v[84:87]
    s_add_u32 m0, s76, 16384
    ds_read_b64_tr_b16 a[18:19], v20 offset:2048
    v_mfma_f32_16x16x32_bf16 v[84:87], a[108:111], a[204:207], v[84:87]
    v_mfma_f32_16x16x32_bf16 v[212:215], a[104:107], a[204:207], v[212:215]
    s_add_u32 s81, s66, 262144
    ds_read_b64_tr_b16 a[48:49], v20 offset:16384
    v_mfma_f32_16x16x32_bf16 v[212:215], a[72:75], a[200:203], v[212:215]
    ds_read_b64_tr_b16 a[50:51], v20 offset:18432
    v_mfma_f32_16x16x32_bf16 v[80:83], a[68:71], a[200:203], v[80:83]
    buffer_load_dwordx4 v2, s[28:31], s81 offen lds
    v_mfma_f32_16x16x32_bf16 v[80:83], a[100:103], a[204:207], v[80:83]
    ds_read_b64_tr_b16 a[20:21], v21 offset:0
    ds_read_b64_tr_b16 a[22:23], v21 offset:2048
    v_mfma_f32_16x16x32_bf16 v[208:211], a[96:99], a[204:207], v[208:211]
    s_add_u32 m0, s76, 20480
    v_mfma_f32_16x16x32_bf16 v[208:211], a[64:67], a[200:203], v[208:211]
    s_add_u32 s81, s66, 327680
    ds_read_b64_tr_b16 a[52:53], v21 offset:16384
    v_mfma_f32_16x16x32_bf16 v[224:227], a[64:67], a[208:211], v[224:227]
    ds_read_b64_tr_b16 a[54:55], v21 offset:18432
    v_mfma_f32_16x16x32_bf16 v[224:227], a[96:99], a[212:215], v[224:227]
    ds_read_b64_tr_b16 a[24:25], v22 offset:0
    v_mfma_f32_16x16x32_bf16 v[96:99], a[100:103], a[212:215], v[96:99]
    buffer_load_dwordx4 v2, s[28:31], s81 offen lds
    v_mfma_f32_16x16x32_bf16 v[96:99], a[68:71], a[208:211], v[96:99]
    s_add_u32 m0, s76, 24576
    ds_read_b64_tr_b16 a[26:27], v22 offset:2048
    v_mfma_f32_16x16x32_bf16 v[228:231], a[72:75], a[208:211], v[228:231]
    ds_read_b64_tr_b16 a[56:57], v22 offset:16384
    v_mfma_f32_16x16x32_bf16 v[228:231], a[104:107], a[212:215], v[228:231]
    s_add_u32 s81, s66, 393216
    ds_read_b64_tr_b16 a[58:59], v22 offset:18432
    v_mfma_f32_16x16x32_bf16 v[100:103], a[108:111], a[212:215], v[100:103]
    ds_read_b64_tr_b16 a[28:29], v23 offset:0
    v_mfma_f32_16x16x32_bf16 v[100:103], a[76:79], a[208:211], v[100:103]
    buffer_load_dwordx4 v2, s[28:31], s81 offen lds
    v_mfma_f32_16x16x32_bf16 v[232:235], a[80:83], a[208:211], v[232:235]
    ds_read_b64_tr_b16 a[30:31], v23 offset:2048
    v_mfma_f32_16x16x32_bf16 v[232:235], a[112:115], a[212:215], v[232:235]
    s_add_u32 m0, s76, 28672
    ds_read_b64_tr_b16 a[60:61], v23 offset:16384
    v_mfma_f32_16x16x32_bf16 v[104:107], a[116:119], a[212:215], v[104:107]
    ds_read_b64_tr_b16 a[62:63], v23 offset:18432
    v_mfma_f32_16x16x32_bf16 v[104:107], a[84:87], a[208:211], v[104:107]
    s_add_u32 s81, s66, 458752
    ds_read_b128 a[168:171], v8 offset:2048
    v_mfma_f32_16x16x32_bf16 v[236:239], a[88:91], a[208:211], v[236:239]
    v_mfma_f32_16x16x32_bf16 v[236:239], a[120:123], a[212:215], v[236:239]
    ds_read_b128 a[172:175], v9 offset:2048
    v_mfma_f32_16x16x32_bf16 v[108:111], a[124:127], a[212:215], v[108:111]
    buffer_load_dwordx4 v2, s[28:31], s81 offen lds
    v_mfma_f32_16x16x32_bf16 v[108:111], a[92:95], a[208:211], v[108:111]
    s_add_u32 s66, s66, 128
    ds_read_b128 a[176:179], v8 offset:4096
    ds_read_b128 a[180:183], v9 offset:4096
    v_mfma_f32_16x16x32_bf16 v[124:127], a[92:95], a[216:219], v[124:127]
    v_mfma_f32_16x16x32_bf16 v[124:127], a[124:127], a[220:223], v[124:127]
    s_xor_b32 s76, s76, s90
    ds_read_b128 a[184:187], v8 offset:6144
    v_mfma_f32_16x16x32_bf16 v[252:255], a[120:123], a[220:223], v[252:255]
    ds_read_b128 a[188:191], v9 offset:6144
    v_mfma_f32_16x16x32_bf16 v[252:255], a[88:91], a[216:219], v[252:255]
    s_cmp_eq_u32 s78, 6
    s_cselect_b32 s10, s38, s10
    s_cselect_b32 s14, s42, s14
    s_cselect_b32 s22, s46, s22
    v_mfma_f32_16x16x32_bf16 v[120:123], a[84:87], a[216:219], v[120:123]
    v_mfma_f32_16x16x32_bf16 v[120:123], a[116:119], a[220:223], v[120:123]
    buffer_load_dword v13, v10, s[8:11], s4 offen
    v_mfma_f32_16x16x32_bf16 v[248:251], a[112:115], a[220:223], v[248:251]
    v_mfma_f32_16x16x32_bf16 v[248:251], a[80:83], a[216:219], v[248:251]
    s_add_u32 s4, s4, 16777216
    v_mfma_f32_16x16x32_bf16 v[116:119], a[76:79], a[216:219], v[116:119]
    v_mfma_f32_16x16x32_bf16 v[116:119], a[108:111], a[220:223], v[116:119]
    buffer_load_dword v13, v11, s[12:15], s5 offen
    v_mfma_f32_16x16x32_bf16 v[244:247], a[104:107], a[220:223], v[244:247]
    v_mfma_f32_16x16x32_bf16 v[244:247], a[72:75], a[216:219], v[244:247]
    s_add_u32 s5, s5, 458752
    v_mfma_f32_16x16x32_bf16 v[112:115], a[68:71], a[216:219], v[112:115]
    v_mfma_f32_16x16x32_bf16 v[112:115], a[100:103], a[220:223], v[112:115]
    buffer_load_dword v13, v12, s[20:23], s6 offen
    v_mfma_f32_16x16x32_bf16 v[240:243], a[96:99], a[220:223], v[240:243]
    v_mfma_f32_16x16x32_bf16 v[240:243], a[64:67], a[216:219], v[240:243]
    s_add_u32 s6, s6, 150528
    s_waitcnt lgkmcnt(0)
    v_mfma_f32_16x16x32_bf16 v[128:131], a[0:3], a[160:163], v[128:131]
    v_mfma_f32_16x16x32_bf16 v[128:131], a[32:35], a[164:167], v[128:131]
    s_add_u32 s77, s86, s85
    ds_read_b128 a[192:195], v8 offset:8192
    v_mfma_f32_16x16x32_bf16 a[128:131], a[36:39], a[164:167], a[128:131]
    v_mfma_f32_16x16x32_bf16 a[128:131], a[4:7], a[160:163], a[128:131]
    s_add_u32 m0, s77, 0
    ds_read_b128 a[196:199], v9 offset:8192
    v_mfma_f32_16x16x32_bf16 v[132:135], a[8:11], a[160:163], v[132:135]
    v_mfma_f32_16x16x32_bf16 v[132:135], a[40:43], a[164:167], v[132:135]
    s_add_u32 s82, s67, 0
    v_mfma_f32_16x16x32_bf16 a[132:135], a[44:47], a[164:167], a[132:135]
    ds_read_b128 a[200:203], v8 offset:10240
    v_mfma_f32_16x16x32_bf16 a[132:135], a[12:15], a[160:163], a[132:135]
    buffer_load_dwordx4 v3, s[32:35], s82 offen lds
    v_mfma_f32_16x16x32_bf16 v[136:139], a[16:19], a[160:163], v[136:139]
    ds_read_b128 a[204:207], v9 offset:10240
    v_mfma_f32_16x16x32_bf16 v[136:139], a[48:51], a[164:167], v[136:139]
    s_add_u32 m0, s77, 8192
    v_mfma_f32_16x16x32_bf16 a[136:139], a[52:55], a[164:167], a[136:139]
    v_mfma_f32_16x16x32_bf16 a[136:139], a[20:23], a[160:163], a[136:139]
    s_add_u32 s82, s67, 131072
    ds_read_b128 a[208:211], v8 offset:12288
    v_mfma_f32_16x16x32_bf16 v[140:143], a[24:27], a[160:163], v[140:143]
    v_mfma_f32_16x16x32_bf16 v[140:143], a[56:59], a[164:167], v[140:143]
    buffer_load_dwordx4 v3, s[32:35], s82 offen lds
    v_mfma_f32_16x16x32_bf16 a[140:143], a[60:63], a[164:167], a[140:143]
    ds_read_b128 a[212:215], v9 offset:12288
    v_mfma_f32_16x16x32_bf16 a[140:143], a[28:31], a[160:163], a[140:143]
    v_mfma_f32_16x16x32_bf16 a[156:159], a[28:31], a[168:171], a[156:159]
    s_add_u32 m0, s77, 16384
    ds_read_b128 a[216:219], v8 offset:14336
    v_mfma_f32_16x16x32_bf16 a[156:159], a[60:63], a[172:175], a[156:159]
    v_mfma_f32_16x16x32_bf16 v[156:159], a[56:59], a[172:175], v[156:159]
    s_add_u32 s82, s67, 262144
    v_mfma_f32_16x16x32_bf16 v[156:159], a[24:27], a[168:171], v[156:159]
    ds_read_b128 a[220:223], v9 offset:14336
    v_mfma_f32_16x16x32_bf16 a[152:155], a[20:23], a[168:171], a[152:155]
    buffer_load_dwordx4 v3, s[32:35], s82 offen lds
    v_mfma_f32_16x16x32_bf16 a[152:155], a[52:55], a[172:175], a[152:155]
    v_xor_b32 v8, 0x8000, v8
    v_mfma_f32_16x16x32_bf16 v[152:155], a[48:51], a[172:175], v[152:155]
    s_add_u32 m0, s77, 24576
    v_mfma_f32_16x16x32_bf16 v[152:155], a[16:19], a[168:171], v[152:155]
    v_mfma_f32_16x16x32_bf16 a[148:151], a[12:15], a[168:171], a[148:151]
    v_xor_b32 v9, 0x8000, v9
    v_mfma_f32_16x16x32_bf16 a[148:151], a[44:47], a[172:175], a[148:151]
    s_add_u32 s82, s67, 393216
    v_mfma_f32_16x16x32_bf16 v[148:151], a[40:43], a[172:175], v[148:151]
    s_add_u32 s80, s80, 1
    v_mfma_f32_16x16x32_bf16 v[148:151], a[8:11], a[168:171], v[148:151]
    buffer_load_dwordx4 v3, s[32:35], s82 offen lds
    v_mfma_f32_16x16x32_bf16 a[144:147], a[4:7], a[168:171], a[144:147]
    s_add_u32 m0, s77, 2048
    v_mfma_f32_16x16x32_bf16 a[144:147], a[36:39], a[172:175], a[144:147]
    s_cmp_eq_u32 s80, 3
    s_cselect_b32 s80, 0, s80
    s_cselect_b32 s79, 4294901760, s90
    v_mfma_f32_16x16x32_bf16 v[144:147], a[32:35], a[172:175], v[144:147]
    v_mfma_f32_16x16x32_bf16 v[144:147], a[0:3], a[168:171], v[144:147]
    s_add_u32 s82, s67, 32768
    v_add_u32 v16, s79, v16
    v_mfma_f32_16x16x32_bf16 v[160:163], a[0:3], a[176:179], v[160:163]
    v_mfma_f32_16x16x32_bf16 v[160:163], a[32:35], a[180:183], v[160:163]
    buffer_load_dwordx4 v3, s[32:35], s82 offen lds
    v_mfma_f32_16x16x32_bf16 v[32:35], a[36:39], a[180:183], v[32:35]
    v_add_u32 v17, s79, v17
    v_mfma_f32_16x16x32_bf16 v[32:35], a[4:7], a[176:179], v[32:35]
    s_add_u32 m0, s77, 10240
    v_mfma_f32_16x16x32_bf16 v[164:167], a[8:11], a[176:179], v[164:167]
    v_add_u32 v18, s79, v18
    v_mfma_f32_16x16x32_bf16 v[164:167], a[40:43], a[180:183], v[164:167]
    v_mfma_f32_16x16x32_bf16 v[36:39], a[44:47], a[180:183], v[36:39]
    s_add_u32 s82, s67, 163840
    v_mfma_f32_16x16x32_bf16 v[36:39], a[12:15], a[176:179], v[36:39]
    v_add_u32 v19, s79, v19
    v_mfma_f32_16x16x32_bf16 v[168:171], a[16:19], a[176:179], v[168:171]
    buffer_load_dwordx4 v3, s[32:35], s82 offen lds
    v_mfma_f32_16x16x32_bf16 v[168:171], a[48:51], a[180:183], v[168:171]
    v_mfma_f32_16x16x32_bf16 v[40:43], a[52:55], a[180:183], v[40:43]
    s_add_u32 m0, s77, 18432
    v_add_u32 v20, s79, v20
    v_mfma_f32_16x16x32_bf16 v[40:43], a[20:23], a[176:179], v[40:43]
    v_mfma_f32_16x16x32_bf16 v[172:175], a[24:27], a[176:179], v[172:175]
    s_add_u32 s82, s67, 294912
    v_add_u32 v21, s79, v21
    v_mfma_f32_16x16x32_bf16 v[172:175], a[56:59], a[180:183], v[172:175]
    v_mfma_f32_16x16x32_bf16 v[44:47], a[60:63], a[180:183], v[44:47]
    buffer_load_dwordx4 v3, s[32:35], s82 offen lds
    v_mfma_f32_16x16x32_bf16 v[44:47], a[28:31], a[176:179], v[44:47]
    v_add_u32 v22, s79, v22
    v_mfma_f32_16x16x32_bf16 v[60:63], a[28:31], a[184:187], v[60:63]
    v_mfma_f32_16x16x32_bf16 v[60:63], a[60:63], a[188:191], v[60:63]
    s_add_u32 m0, s77, 26624
    v_add_u32 v23, s79, v23
    v_mfma_f32_16x16x32_bf16 v[188:191], a[56:59], a[188:191], v[188:191]
    v_mfma_f32_16x16x32_bf16 v[188:191], a[24:27], a[184:187], v[188:191]
    s_add_u32 s82, s67, 425984
    v_mfma_f32_16x16x32_bf16 v[56:59], a[20:23], a[184:187], v[56:59]
    v_mfma_f32_16x16x32_bf16 v[56:59], a[52:55], a[188:191], v[56:59]
    buffer_load_dwordx4 v3, s[32:35], s82 offen lds
    v_mfma_f32_16x16x32_bf16 v[184:187], a[48:51], a[188:191], v[184:187]
    v_mfma_f32_16x16x32_bf16 v[184:187], a[16:19], a[184:187], v[184:187]
    s_add_u32 s67, s67, 524288
    v_mfma_f32_16x16x32_bf16 v[52:55], a[12:15], a[184:187], v[52:55]
    v_mfma_f32_16x16x32_bf16 v[52:55], a[44:47], a[188:191], v[52:55]
    s_add_u32 s86, s86, s90
    v_mfma_f32_16x16x32_bf16 v[180:183], a[40:43], a[188:191], v[180:183]
    v_mfma_f32_16x16x32_bf16 v[180:183], a[8:11], a[184:187], v[180:183]
    s_cmp_eq_u32 s86, 163840
    s_cselect_b32 s86, 65536, s86
    v_mfma_f32_16x16x32_bf16 v[48:51], a[4:7], a[184:187], v[48:51]
    v_mfma_f32_16x16x32_bf16 v[48:51], a[36:39], a[188:191], v[48:51]
    v_mfma_f32_16x16x32_bf16 v[176:179], a[32:35], a[188:191], v[176:179]
    v_mfma_f32_16x16x32_bf16 v[176:179], a[0:3], a[184:187], v[176:179]
    s_add_u32 s78, s78, 1
    s_cmp_lt_u32 s78, 14
    s_waitcnt vmcnt(11) lgkmcnt(0)
    s_barrier
    v_mfma_f32_16x16x32_bf16 v[192:195], a[0:3], a[192:195], v[192:195]
    s_add_u32 m0, s76, 0
    ds_read_b128 a[160:163], v8 offset:0
    v_mfma_f32_16x16x32_bf16 v[192:195], a[32:35], a[196:199], v[192:195]
    ds_read_b128 a[164:167], v9 offset:0
    v_mfma_f32_16x16x32_bf16 v[64:67], a[36:39], a[196:199], v[64:67]
    s_add_u32 s81, s66, 0
    v_mfma_f32_16x16x32_bf16 v[64:67], a[4:7], a[192:195], v[64:67]
    ds_read_b64_tr_b16 a[64:65], v16 offset:0
    v_mfma_f32_16x16x32_bf16 v[196:199], a[8:11], a[192:195], v[196:199]
    ds_read_b64_tr_b16 a[66:67], v16 offset:2048
    v_mfma_f32_16x16x32_bf16 v[196:199], a[40:43], a[196:199], v[196:199]
    buffer_load_dwordx4 v2, s[28:31], s81 offen lds
    v_mfma_f32_16x16x32_bf16 v[68:71], a[44:47], a[196:199], v[68:71]
    s_add_u32 m0, s76, 4096
    ds_read_b64_tr_b16 a[96:97], v16 offset:16384
    v_mfma_f32_16x16x32_bf16 v[68:71], a[12:15], a[192:195], v[68:71]
    ds_read_b64_tr_b16 a[98:99], v16 offset:18432
    v_mfma_f32_16x16x32_bf16 v[200:203], a[16:19], a[192:195], v[200:203]
    s_add_u32 s81, s66, 65536
    ds_read_b64_tr_b16 a[68:69], v17 offset:0
    v_mfma_f32_16x16x32_bf16 v[200:203], a[48:51], a[196:199], v[200:203]
    ds_read_b64_tr_b16 a[70:71], v17 offset:2048
    v_mfma_f32_16x16x32_bf16 v[72:75], a[52:55], a[196:199], v[72:75]
    buffer_load_dwordx4 v2, s[28:31], s81 offen lds
    v_mfma_f32_16x16x32_bf16 v[72:75], a[20:23], a[192:195], v[72:75]
    ds_read_b64_tr_b16 a[100:101], v17 offset:16384
    v_mfma_f32_16x16x32_bf16 v[204:207], a[24:27], a[192:195], v[204:207]
    s_add_u32 m0, s76, 8192
    ds_read_b64_tr_b16 a[102:103], v17 offset:18432
    v_mfma_f32_16x16x32_bf16 v[204:207], a[56:59], a[196:199], v[204:207]
    ds_read_b64_tr_b16 a[72:73], v18 offset:0
    v_mfma_f32_16x16x32_bf16 v[76:79], a[60:63], a[196:199], v[76:79]
    s_add_u32 s81, s66, 131072
    ds_read_b64_tr_b16 a[74:75], v18 offset:2048
    v_mfma_f32_16x16x32_bf16 v[76:79], a[28:31], a[192:195], v[76:79]
    ds_read_b64_tr_b16 a[104:105], v18 offset:16384
    v_mfma_f32_16x16x32_bf16 v[92:95], a[28:31], a[200:203], v[92:95]
    buffer_load_dwordx4 v2, s[28:31], s81 offen lds
    v_mfma_f32_16x16x32_bf16 v[92:95], a[60:63], a[204:207], v[92:95]
    ds_read_b64_tr_b16 a[106:107], v18 offset:18432
    v_mfma_f32_16x16x32_bf16 v[220:223], a[56:59], a[204:207], v[220:223]
    s_add_u32 m0, s76, 12288
    ds_read_b64_tr_b16 a[76:77], v19 offset:0
    v_mfma_f32_16x16x32_bf16 v[220:223], a[24:27], a[200:203], v[220:223]
    ds_read_b64_tr_b16 a[78:79], v19 offset:2048
    v_mfma_f32_16x16x32_bf16 v[88:91], a[20:23], a[200:203], v[88:91]
    s_add_u32 s81, s66, 196608
    v_mfma_f32_16x16x32_bf16 v[88:91], a[52:55], a[204:207], v[88:91]
    ds_read_b64_tr_b16 a[108:109], v19 offset:16384
    ds_read_b64_tr_b16 a[110:111], v19 offset:18432
    v_mfma_f32_16x16x32_bf16 v[216:219], a[48:51], a[204:207], v[216:219]
    buffer_load_dwordx4 v2, s[28:31], s81 offen lds
    v_mfma_f32_16x16x32_bf16 v[216:219], a[16:19], a[200:203], v[216:219]
    ds_read_b64_tr_b16 a[80:81], v20 offset:0
    v_mfma_f32_16x16x32_bf16 v[84:87], a[12:15], a[200:203], v[84:87]
    s_add_u32 m0, s76, 16384
    ds_read_b64_tr_b16 a[82:83], v20 offset:2048
    v_mfma_f32_16x16x32_bf16 v[84:87], a[44:47], a[204:207], v[84:87]
    v_mfma_f32_16x16x32_bf16 v[212:215], a[40:43], a[204:207], v[212:215]
    s_add_u32 s81, s66, 262144
    ds_read_b64_tr_b16 a[112:113], v20 offset:16384
    v_mfma_f32_16x16x32_bf16 v[212:215], a[8:11], a[200:203], v[212:215]
    ds_read_b64_tr_b16 a[114:115], v20 offset:18432
    v_mfma_f32_16x16x32_bf16 v[80:83], a[4:7], a[200:203], v[80:83]
    buffer_load_dwordx4 v2, s[28:31], s81 offen lds
    v_mfma_f32_16x16x32_bf16 v[80:83], a[36:39], a[204:207], v[80:83]
    ds_read_b64_tr_b16 a[84:85], v21 offset:0
    ds_read_b64_tr_b16 a[86:87], v21 offset:2048
    v_mfma_f32_16x16x32_bf16 v[208:211], a[32:35], a[204:207], v[208:211]
    s_add_u32 m0, s76, 20480
    v_mfma_f32_16x16x32_bf16 v[208:211], a[0:3], a[200:203], v[208:211]
    s_add_u32 s81, s66, 327680
    ds_read_b64_tr_b16 a[116:117], v21 offset:16384
    v_mfma_f32_16x16x32_bf16 v[224:227], a[0:3], a[208:211], v[224:227]
    ds_read_b64_tr_b16 a[118:119], v21 offset:18432
    v_mfma_f32_16x16x32_bf16 v[224:227], a[32:35], a[212:215], v[224:227]
    ds_read_b64_tr_b16 a[88:89], v22 offset:0
    v_mfma_f32_16x16x32_bf16 v[96:99], a[36:39], a[212:215], v[96:99]
    buffer_load_dwordx4 v2, s[28:31], s81 offen lds
    v_mfma_f32_16x16x32_bf16 v[96:99], a[4:7], a[208:211], v[96:99]
    s_add_u32 m0, s76, 24576
    ds_read_b64_tr_b16 a[90:91], v22 offset:2048
    v_mfma_f32_16x16x32_bf16 v[228:231], a[8:11], a[208:211], v[228:231]
    ds_read_b64_tr_b16 a[120:121], v22 offset:16384
    v_mfma_f32_16x16x32_bf16 v[228:231], a[40:43], a[212:215], v[228:231]
    s_add_u32 s81, s66, 393216
    ds_read_b64_tr_b16 a[122:123], v22 offset:18432
    v_mfma_f32_16x16x32_bf16 v[100:103], a[44:47], a[212:215], v[100:103]
    ds_read_b64_tr_b16 a[92:93], v23 offset:0
    v_mfma_f32_16x16x32_bf16 v[100:103], a[12:15], a[208:211], v[100:103]
    buffer_load_dwordx4 v2, s[28:31], s81 offen lds
    v_mfma_f32_16x16x32_bf16 v[232:235], a[16:19], a[208:211], v[232:235]
    ds_read_b64_tr_b16 a[94:95], v23 offset:2048
    v_mfma_f32_16x16x32_bf16 v[232:235], a[48:51], a[212:215], v[232:235]
    s_add_u32 m0, s76, 28672
    ds_read_b64_tr_b16 a[124:125], v23 offset:16384
    v_mfma_f32_16x16x32_bf16 v[104:107], a[52:55], a[212:215], v[104:107]
    ds_read_b64_tr_b16 a[126:127], v23 offset:18432
    v_mfma_f32_16x16x32_bf16 v[104:107], a[20:23], a[208:211], v[104:107]
    s_add_u32 s81, s66, 458752
    ds_read_b128 a[168:171], v8 offset:2048
    v_mfma_f32_16x16x32_bf16 v[236:239], a[24:27], a[208:211], v[236:239]
    v_mfma_f32_16x16x32_bf16 v[236:239], a[56:59], a[212:215], v[236:239]
    ds_read_b128 a[172:175], v9 offset:2048
    v_mfma_f32_16x16x32_bf16 v[108:111], a[60:63], a[212:215], v[108:111]
    buffer_load_dwordx4 v2, s[28:31], s81 offen lds
    v_mfma_f32_16x16x32_bf16 v[108:111], a[28:31], a[208:211], v[108:111]
    s_add_u32 s66, s66, 128
    ds_read_b128 a[176:179], v8 offset:4096
    ds_read_b128 a[180:183], v9 offset:4096
    v_mfma_f32_16x16x32_bf16 v[124:127], a[28:31], a[216:219], v[124:127]
    v_mfma_f32_16x16x32_bf16 v[124:127], a[60:63], a[220:223], v[124:127]
    s_xor_b32 s76, s76, s90
    ds_read_b128 a[184:187], v8 offset:6144
    v_mfma_f32_16x16x32_bf16 v[252:255], a[56:59], a[220:223], v[252:255]
    ds_read_b128 a[188:191], v9 offset:6144
    v_mfma_f32_16x16x32_bf16 v[252:255], a[24:27], a[216:219], v[252:255]
    s_cmp_eq_u32 s78, 6
    s_cselect_b32 s10, s38, s10
    s_cselect_b32 s14, s42, s14
    s_cselect_b32 s22, s46, s22
    v_mfma_f32_16x16x32_bf16 v[120:123], a[20:23], a[216:219], v[120:123]
    v_mfma_f32_16x16x32_bf16 v[120:123], a[52:55], a[220:223], v[120:123]
    buffer_load_dword v13, v10, s[8:11], s4 offen
    v_mfma_f32_16x16x32_bf16 v[248:251], a[48:51], a[220:223], v[248:251]
    v_mfma_f32_16x16x32_bf16 v[248:251], a[16:19], a[216:219], v[248:251]
    s_add_u32 s4, s4, 16777216
    v_mfma_f32_16x16x32_bf16 v[116:119], a[12:15], a[216:219], v[116:119]
    v_mfma_f32_16x16x32_bf16 v[116:119], a[44:47], a[220:223], v[116:119]
    buffer_load_dword v13, v11, s[12:15], s5 offen
    v_mfma_f32_16x16x32_bf16 v[244:247], a[40:43], a[220:223], v[244:247]
    v_mfma_f32_16x16x32_bf16 v[244:247], a[8:11], a[216:219], v[244:247]
    s_add_u32 s5, s5, 458752
    v_mfma_f32_16x16x32_bf16 v[112:115], a[4:7], a[216:219], v[112:115]
    v_mfma_f32_16x16x32_bf16 v[112:115], a[36:39], a[220:223], v[112:115]
    buffer_load_dword v13, v12, s[20:23], s6 offen
    v_mfma_f32_16x16x32_bf16 v[240:243], a[32:35], a[220:223], v[240:243]
    v_mfma_f32_16x16x32_bf16 v[240:243], a[0:3], a[216:219], v[240:243]
    s_add_u32 s6, s6, 150528
    s_waitcnt lgkmcnt(0)
    v_mfma_f32_16x16x32_bf16 v[128:131], a[64:67], a[160:163], v[128:131]
    v_mfma_f32_16x16x32_bf16 v[128:131], a[96:99], a[164:167], v[128:131]
    s_add_u32 s77, s86, s85
    ds_read_b128 a[192:195], v8 offset:8192
    v_mfma_f32_16x16x32_bf16 a[128:131], a[100:103], a[164:167], a[128:131]
    v_mfma_f32_16x16x32_bf16 a[128:131], a[68:71], a[160:163], a[128:131]
    s_add_u32 m0, s77, 0
    ds_read_b128 a[196:199], v9 offset:8192
    v_mfma_f32_16x16x32_bf16 v[132:135], a[72:75], a[160:163], v[132:135]
    v_mfma_f32_16x16x32_bf16 v[132:135], a[104:107], a[164:167], v[132:135]
    s_add_u32 s82, s67, 0
    v_mfma_f32_16x16x32_bf16 a[132:135], a[108:111], a[164:167], a[132:135]
    ds_read_b128 a[200:203], v8 offset:10240
    v_mfma_f32_16x16x32_bf16 a[132:135], a[76:79], a[160:163], a[132:135]
    buffer_load_dwordx4 v3, s[32:35], s82 offen lds
    v_mfma_f32_16x16x32_bf16 v[136:139], a[80:83], a[160:163], v[136:139]
    ds_read_b128 a[204:207], v9 offset:10240
    v_mfma_f32_16x16x32_bf16 v[136:139], a[112:115], a[164:167], v[136:139]
    s_add_u32 m0, s77, 8192
    v_mfma_f32_16x16x32_bf16 a[136:139], a[116:119], a[164:167], a[136:139]
    v_mfma_f32_16x16x32_bf16 a[136:139], a[84:87], a[160:163], a[136:139]
    s_add_u32 s82, s67, 131072
    ds_read_b128 a[208:211], v8 offset:12288
    v_mfma_f32_16x16x32_bf16 v[140:143], a[88:91], a[160:163], v[140:143]
    v_mfma_f32_16x16x32_bf16 v[140:143], a[120:123], a[164:167], v[140:143]
    buffer_load_dwordx4 v3, s[32:35], s82 offen lds
    v_mfma_f32_16x16x32_bf16 a[140:143], a[124:127], a[164:167], a[140:143]
    ds_read_b128 a[212:215], v9 offset:12288
    v_mfma_f32_16x16x32_bf16 a[140:143], a[92:95], a[160:163], a[140:143]
    v_mfma_f32_16x16x32_bf16 a[156:159], a[92:95], a[168:171], a[156:159]
    s_add_u32 m0, s77, 16384
    ds_read_b128 a[216:219], v8 offset:14336
    v_mfma_f32_16x16x32_bf16 a[156:159], a[124:127], a[172:175], a[156:159]
    v_mfma_f32_16x16x32_bf16 v[156:159], a[120:123], a[172:175], v[156:159]
    s_add_u32 s82, s67, 262144
    v_mfma_f32_16x16x32_bf16 v[156:159], a[88:91], a[168:171], v[156:159]
    ds_read_b128 a[220:223], v9 offset:14336
    v_mfma_f32_16x16x32_bf16 a[152:155], a[84:87], a[168:171], a[152:155]
    buffer_load_dwordx4 v3, s[32:35], s82 offen lds
    v_mfma_f32_16x16x32_bf16 a[152:155], a[116:119], a[172:175], a[152:155]
    v_xor_b32 v8, 0x8000, v8
    v_mfma_f32_16x16x32_bf16 v[152:155], a[112:115], a[172:175], v[152:155]
    s_add_u32 m0, s77, 24576
    v_mfma_f32_16x16x32_bf16 v[152:155], a[80:83], a[168:171], v[152:155]
    v_mfma_f32_16x16x32_bf16 a[148:151], a[76:79], a[168:171], a[148:151]
    v_xor_b32 v9, 0x8000, v9
    v_mfma_f32_16x16x32_bf16 a[148:151], a[108:111], a[172:175], a[148:151]
    s_add_u32 s82, s67, 393216
    v_mfma_f32_16x16x32_bf16 v[148:151], a[104:107], a[172:175], v[148:151]
    s_add_u32 s80, s80, 1
    v_mfma_f32_16x16x32_bf16 v[148:151], a[72:75], a[168:171], v[148:151]
    buffer_load_dwordx4 v3, s[32:35], s82 offen lds
    v_mfma_f32_16x16x32_bf16 a[144:147], a[68:71], a[168:171], a[144:147]
    s_add_u32 m0, s77, 2048
    v_mfma_f32_16x16x32_bf16 a[144:147], a[100:103], a[172:175], a[144:147]
    s_cmp_eq_u32 s80, 3
    s_cselect_b32 s80, 0, s80
    s_cselect_b32 s79, 4294901760, s90
    v_mfma_f32_16x16x32_bf16 v[144:147], a[96:99], a[172:175], v[144:147]
    v_mfma_f32_16x16x32_bf16 v[144:147], a[64:67], a[168:171], v[144:147]
    s_add_u32 s82, s67, 32768
    v_add_u32 v16, s79, v16
    v_mfma_f32_16x16x32_bf16 v[160:163], a[64:67], a[176:179], v[160:163]
    v_mfma_f32_16x16x32_bf16 v[160:163], a[96:99], a[180:183], v[160:163]
    buffer_load_dwordx4 v3, s[32:35], s82 offen lds
    v_mfma_f32_16x16x32_bf16 v[32:35], a[100:103], a[180:183], v[32:35]
    v_add_u32 v17, s79, v17
    v_mfma_f32_16x16x32_bf16 v[32:35], a[68:71], a[176:179], v[32:35]
    s_add_u32 m0, s77, 10240
    v_mfma_f32_16x16x32_bf16 v[164:167], a[72:75], a[176:179], v[164:167]
    v_add_u32 v18, s79, v18
    v_mfma_f32_16x16x32_bf16 v[164:167], a[104:107], a[180:183], v[164:167]
    v_mfma_f32_16x16x32_bf16 v[36:39], a[108:111], a[180:183], v[36:39]
    s_add_u32 s82, s67, 163840
    v_mfma_f32_16x16x32_bf16 v[36:39], a[76:79], a[176:179], v[36:39]
    v_add_u32 v19, s79, v19
    v_mfma_f32_16x16x32_bf16 v[168:171], a[80:83], a[176:179], v[168:171]
    buffer_load_dwordx4 v3, s[32:35], s82 offen lds
    v_mfma_f32_16x16x32_bf16 v[168:171], a[112:115], a[180:183], v[168:171]
    v_mfma_f32_16x16x32_bf16 v[40:43], a[116:119], a[180:183], v[40:43]
    s_add_u32 m0, s77, 18432
    v_add_u32 v20, s79, v20
    v_mfma_f32_16x16x32_bf16 v[40:43], a[84:87], a[176:179], v[40:43]
    v_mfma_f32_16x16x32_bf16 v[172:175], a[88:91], a[176:179], v[172:175]
    s_add_u32 s82, s67, 294912
    v_add_u32 v21, s79, v21
    v_mfma_f32_16x16x32_bf16 v[172:175], a[120:123], a[180:183], v[172:175]
    v_mfma_f32_16x16x32_bf16 v[44:47], a[124:127], a[180:183], v[44:47]
    buffer_load_dwordx4 v3, s[32:35], s82 offen lds
    v_mfma_f32_16x16x32_bf16 v[44:47], a[92:95], a[176:179], v[44:47]
    v_add_u32 v22, s79, v22
    v_mfma_f32_16x16x32_bf16 v[60:63], a[92:95], a[184:187], v[60:63]
    v_mfma_f32_16x16x32_bf16 v[60:63], a[124:127], a[188:191], v[60:63]
    s_add_u32 m0, s77, 26624
    v_add_u32 v23, s79, v23
    v_mfma_f32_16x16x32_bf16 v[188:191], a[120:123], a[188:191], v[188:191]
    v_mfma_f32_16x16x32_bf16 v[188:191], a[88:91], a[184:187], v[188:191]
    s_add_u32 s82, s67, 425984
    v_mfma_f32_16x16x32_bf16 v[56:59], a[84:87], a[184:187], v[56:59]
    v_mfma_f32_16x16x32_bf16 v[56:59], a[116:119], a[188:191], v[56:59]
    buffer_load_dwordx4 v3, s[32:35], s82 offen lds
    v_mfma_f32_16x16x32_bf16 v[184:187], a[112:115], a[188:191], v[184:187]
    v_mfma_f32_16x16x32_bf16 v[184:187], a[80:83], a[184:187], v[184:187]
    s_add_u32 s67, s67, 524288
    v_mfma_f32_16x16x32_bf16 v[52:55], a[76:79], a[184:187], v[52:55]
    v_mfma_f32_16x16x32_bf16 v[52:55], a[108:111], a[188:191], v[52:55]
    s_add_u32 s86, s86, s90
    v_mfma_f32_16x16x32_bf16 v[180:183], a[104:107], a[188:191], v[180:183]
    v_mfma_f32_16x16x32_bf16 v[180:183], a[72:75], a[184:187], v[180:183]
    s_cmp_eq_u32 s86, 163840
    s_cselect_b32 s86, 65536, s86
    v_mfma_f32_16x16x32_bf16 v[48:51], a[68:71], a[184:187], v[48:51]
    v_mfma_f32_16x16x32_bf16 v[48:51], a[100:103], a[188:191], v[48:51]
    v_mfma_f32_16x16x32_bf16 v[176:179], a[96:99], a[188:191], v[176:179]
    v_mfma_f32_16x16x32_bf16 v[176:179], a[64:67], a[184:187], v[176:179]
    s_add_u32 s78, s78, 1
    s_cmp_lt_u32 s78, 14
    s_waitcnt vmcnt(11) lgkmcnt(0)
    s_barrier
    s_cbranch_scc1 F_loop_5
    v_mfma_f32_16x16x32_bf16 v[192:195], a[64:67], a[192:195], v[192:195]
    s_add_u32 m0, s76, 0
    s_lshl_b32 s73, s64, 9
    ds_read_b128 a[160:163], v8 offset:0
    v_mfma_f32_16x16x32_bf16 v[192:195], a[96:99], a[196:199], v[192:195]
    ds_read_b128 a[164:167], v9 offset:0
    v_mfma_f32_16x16x32_bf16 v[64:67], a[100:103], a[196:199], v[64:67]
    s_add_u32 s81, s66, 0
    v_lshrrev_b32 v26, 4, v0
    v_mfma_f32_16x16x32_bf16 v[64:67], a[68:71], a[192:195], v[64:67]
    s_lshl_b32 s83, s62, 2
    ds_read_b64_tr_b16 a[0:1], v16 offset:0
    ds_read_b64_tr_b16 a[2:3], v16 offset:2048
    v_mfma_f32_16x16x32_bf16 v[196:199], a[72:75], a[192:195], v[196:199]
    buffer_load_dwordx4 v2, s[28:31], s81 offen lds
    v_mfma_f32_16x16x32_bf16 v[196:199], a[104:107], a[196:199], v[196:199]
    s_add_u32 m0, s76, 4096
    ds_read_b64_tr_b16 a[32:33], v16 offset:16384
    v_or_b32 v27, s83, v26
    v_mfma_f32_16x16x32_bf16 v[68:71], a[108:111], a[196:199], v[68:71]
    v_lshlrev_b32 v27, 1, v27
    v_mfma_f32_16x16x32_bf16 v[68:71], a[76:79], a[192:195], v[68:71]
    s_add_u32 s81, s66, 65536
    ds_read_b64_tr_b16 a[34:35], v16 offset:18432
    v_and_b32 v28, 15, v0
    v_mfma_f32_16x16x32_bf16 v[200:203], a[80:83], a[192:195], v[200:203]
    ds_read_b64_tr_b16 a[4:5], v17 offset:0
    v_xor_b32 v27, v27, v28
    v_mfma_f32_16x16x32_bf16 v[200:203], a[112:115], a[196:199], v[200:203]
    buffer_load_dwordx4 v2, s[28:31], s81 offen lds
    v_mfma_f32_16x16x32_bf16 v[72:75], a[116:119], a[196:199], v[72:75]
    s_lshl_b32 s83, s62, 1
    ds_read_b64_tr_b16 a[6:7], v17 offset:2048
    ds_read_b64_tr_b16 a[36:37], v17 offset:16384
    v_mfma_f32_16x16x32_bf16 v[72:75], a[84:87], a[192:195], v[72:75]
    s_add_u32 m0, s76, 8192
    v_mfma_f32_16x16x32_bf16 v[204:207], a[88:91], a[192:195], v[204:207]
    s_add_u32 s81, s66, 131072
    s_add_u32 s83, s83, s61
    ds_read_b64_tr_b16 a[38:39], v17 offset:18432
    v_mfma_f32_16x16x32_bf16 v[204:207], a[120:123], a[196:199], v[204:207]
    s_lshl_b32 s84, s83, 2
    ds_read_b64_tr_b16 a[8:9], v18 offset:0
    v_mfma_f32_16x16x32_bf16 v[76:79], a[124:127], a[196:199], v[76:79]
    buffer_load_dwordx4 v2, s[28:31], s81 offen lds
    v_mfma_f32_16x16x32_bf16 v[76:79], a[92:95], a[192:195], v[76:79]
    s_add_u32 m0, s76, 12288
    ds_read_b64_tr_b16 a[10:11], v18 offset:2048
    v_add_u32 v26, s84, v26
    v_mfma_f32_16x16x32_bf16 v[92:95], a[92:95], a[200:203], v[92:95]
    s_lshl_b32 s89, s83, 10
    ds_read_b64_tr_b16 a[40:41], v18 offset:16384
    v_mfma_f32_16x16x32_bf16 v[92:95], a[124:127], a[204:207], v[92:95]
    s_add_u32 s81, s66, 196608
    ds_read_b64_tr_b16 a[42:43], v18 offset:18432
    v_mfma_f32_16x16x32_bf16 v[220:223], a[120:123], a[204:207], v[220:223]
    ds_read_b64_tr_b16 a[12:13], v19 offset:0
    v_lshrrev_b32 v28, 2, v27
    v_mfma_f32_16x16x32_bf16 v[220:223], a[88:91], a[200:203], v[220:223]
    buffer_load_dwordx4 v2, s[28:31], s81 offen lds
    v_mfma_f32_16x16x32_bf16 v[88:91], a[84:87], a[200:203], v[88:91]
    ds_read_b64_tr_b16 a[14:15], v19 offset:2048
    v_add_u32 v29, 1, v28
    v_mfma_f32_16x16x32_bf16 v[88:91], a[116:119], a[204:207], v[88:91]
    s_add_u32 m0, s76, 16384
    ds_read_b64_tr_b16 a[44:45], v19 offset:16384
    v_and_b32 v29, 4, v29
    v_mfma_f32_16x16x32_bf16 v[216:219], a[112:115], a[204:207], v[216:219]
    s_add_u32 s81, s66, 262144
    ds_read_b64_tr_b16 a[46:47], v19 offset:18432
    v_mul_u32_u24 v28, 896, v28
    v_mfma_f32_16x16x32_bf16 v[216:219], a[80:83], a[200:203], v[216:219]
    ds_read_b64_tr_b16 a[16:17], v20 offset:0
    v_lshl_add_u32 v28, v29, 28, v28
    v_mfma_f32_16x16x32_bf16 v[84:87], a[76:79], a[200:203], v[84:87]
    buffer_load_dwordx4 v2, s[28:31], s81 offen lds
    v_mfma_f32_16x16x32_bf16 v[84:87], a[108:111], a[204:207], v[84:87]
    ds_read_b64_tr_b16 a[18:19], v20 offset:2048
    v_and_b32 v27, 3, v27
    v_mfma_f32_16x16x32_bf16 v[212:215], a[104:107], a[204:207], v[212:215]
    s_add_u32 m0, s76, 20480
    ds_read_b64_tr_b16 a[48:49], v20 offset:16384
    v_lshl_add_u32 v28, v27, 4, v28
    v_mfma_f32_16x16x32_bf16 v[212:215], a[72:75], a[200:203], v[212:215]
    s_add_u32 s81, s66, 327680
    ds_read_b64_tr_b16 a[50:51], v20 offset:18432
    v_mfma_f32_16x16x32_bf16 v[80:83], a[68:71], a[200:203], v[80:83]
    ds_read_b64_tr_b16 a[20:21], v21 offset:0
    v_mul_u32_u24 v6, 2688, v26
    v_mfma_f32_16x16x32_bf16 v[80:83], a[100:103], a[204:207], v[80:83]
    buffer_load_dwordx4 v2, s[28:31], s81 offen lds
    v_mfma_f32_16x16x32_bf16 v[208:211], a[96:99], a[204:207], v[208:211]
    ds_read_b64_tr_b16 a[22:23], v21 offset:2048
    v_add_u32 v6, v6, v28
    v_mfma_f32_16x16x32_bf16 v[208:211], a[64:67], a[200:203], v[208:211]
    s_add_u32 m0, s76, 24576
    s_sub_u32 s83, 15, s63
    ds_read_b64_tr_b16 a[52:53], v21 offset:16384
    v_mfma_f32_16x16x32_bf16 v[224:227], a[64:67], a[208:211], v[224:227]
    s_cmp_eq_u32 s65, 1
    s_cselect_b32 s88, s83, s63
    ds_read_b64_tr_b16 a[54:55], v21 offset:18432
    v_mfma_f32_16x16x32_bf16 v[224:227], a[96:99], a[212:215], v[224:227]
    s_add_u32 s81, s66, 393216
    ds_read_b64_tr_b16 a[24:25], v22 offset:0
    v_mfma_f32_16x16x32_bf16 v[96:99], a[100:103], a[212:215], v[96:99]
    s_mul_i32 s72, s88, 114688
    ds_read_b64_tr_b16 a[26:27], v22 offset:2048
    v_mfma_f32_16x16x32_bf16 v[96:99], a[68:71], a[208:211], v[96:99]
    buffer_load_dwordx4 v2, s[28:31], s81 offen lds
    v_mfma_f32_16x16x32_bf16 v[228:231], a[72:75], a[208:211], v[228:231]
    s_add_u32 m0, s76, 28672
    s_mul_i32 s74, s64, 56
    ds_read_b64_tr_b16 a[56:57], v22 offset:16384
    v_mfma_f32_16x16x32_bf16 v[228:231], a[104:107], a[212:215], v[228:231]
    s_add_u32 s81, s66, 458752
    s_lshl_b32 s87, s64, 7
    ds_read_b64_tr_b16 a[58:59], v22 offset:18432
    v_mfma_f32_16x16x32_bf16 v[100:103], a[108:111], a[212:215], v[100:103]
    s_lshl_b32 s84, s63, 4
    ds_read_b64_tr_b16 a[28:29], v23 offset:0
    v_mfma_f32_16x16x32_bf16 v[100:103], a[76:79], a[208:211], v[100:103]
    buffer_load_dwordx4 v2, s[28:31], s81 offen lds
    v_mfma_f32_16x16x32_bf16 v[232:235], a[80:83], a[208:211], v[232:235]
    s_add_u32 s87, s87, s84
    ds_read_b64_tr_b16 a[30:31], v23 offset:2048
    v_mfma_f32_16x16x32_bf16 v[232:235], a[112:115], a[212:215], v[232:235]
    s_add_u32 s66, s66, 128
    s_lshl_b32 s84, s61, 3
    ds_read_b64_tr_b16 a[60:61], v23 offset:16384
    v_mfma_f32_16x16x32_bf16 v[104:107], a[116:119], a[212:215], v[104:107]
    s_xor_b32 s76, s76, s90
    s_add_u32 s87, s87, s84
    ds_read_b64_tr_b16 a[62:63], v23 offset:18432
    v_mfma_f32_16x16x32_bf16 v[104:107], a[84:87], a[208:211], v[104:107]
    ds_read_b128 a[168:171], v8 offset:2048
    v_mfma_f32_16x16x32_bf16 v[236:239], a[88:91], a[208:211], v[236:239]
    s_lshl_b32 s87, s87, 13
    v_and_b32 v25, 48, v0
    v_mfma_f32_16x16x32_bf16 v[236:239], a[120:123], a[212:215], v[236:239]
    s_add_u32 s83, s65, 12
    ds_read_b128 a[172:175], v9 offset:2048
    v_mfma_f32_16x16x32_bf16 v[108:111], a[124:127], a[212:215], v[108:111]
    s_mov_b64 s[8:9], s[68:69]
    ds_read_b128 a[176:179], v8 offset:4096
    v_mfma_f32_16x16x32_bf16 v[108:111], a[92:95], a[208:211], v[108:111]
    s_movk_i32 s10, 896
    s_lshl_b32 s84, s62, s83
    ds_read_b128 a[180:183], v9 offset:4096
    v_mfma_f32_16x16x32_bf16 v[124:127], a[92:95], a[216:219], v[124:127]
    s_add_u32 s87, s87, s84
    v_mfma_f32_16x16x32_bf16 v[124:127], a[124:127], a[220:223], v[124:127]
    s_mov_b32 s11, 0x00020000
    ds_read_b128 a[184:187], v8 offset:6144
    v_mfma_f32_16x16x32_bf16 v[252:255], a[120:123], a[220:223], v[252:255]
    s_lshl_b32 s84, s65, 24
    ds_read_b128 a[188:191], v9 offset:6144
    v_mfma_f32_16x16x32_bf16 v[252:255], a[88:91], a[216:219], v[252:255]
    buffer_load_dwordx4 a[252:255], v25, s[8:11], 0 offen offset:0
    v_mfma_f32_16x16x32_bf16 v[120:123], a[84:87], a[216:219], v[120:123]
    s_add_u32 s87, s87, s84
    s_lshl_b32 s84, s65, 12
    v_mfma_f32_16x16x32_bf16 v[120:123], a[116:119], a[220:223], v[120:123]
    buffer_load_dwordx4 a[248:251], v25, s[8:11], 0 offen offset:64
    v_mfma_f32_16x16x32_bf16 v[248:251], a[112:115], a[220:223], v[248:251]
    s_sub_u32 s16, 8192, s84
    v_mfma_f32_16x16x32_bf16 v[248:251], a[80:83], a[216:219], v[248:251]
    buffer_load_dwordx4 a[244:247], v25, s[8:11], 0 offen offset:128
    v_mfma_f32_16x16x32_bf16 v[116:119], a[76:79], a[216:219], v[116:119]
    s_add_u32 s17, 8192, s84
    s_lshl_b32 s91, s64, 7
    v_mfma_f32_16x16x32_bf16 v[116:119], a[108:111], a[220:223], v[116:119]
    buffer_load_dwordx4 a[240:243], v25, s[8:11], 0 offen offset:192
    v_mfma_f32_16x16x32_bf16 v[244:247], a[104:107], a[220:223], v[244:247]
    buffer_load_dwordx4 a[236:239], v25, s[8:11], 0 offen offset:256
    v_mfma_f32_16x16x32_bf16 v[244:247], a[72:75], a[216:219], v[244:247]
    s_lshl_b32 s84, s88, 3
    s_add_u32 s91, s91, s84
    v_mfma_f32_16x16x32_bf16 v[112:115], a[68:71], a[216:219], v[112:115]
    buffer_load_dwordx4 a[232:235], v25, s[8:11], 0 offen offset:320
    v_mfma_f32_16x16x32_bf16 v[112:115], a[100:103], a[220:223], v[112:115]
    buffer_load_dwordx4 a[228:231], v25, s[8:11], 0 offen offset:384
    v_mfma_f32_16x16x32_bf16 v[240:243], a[96:99], a[220:223], v[240:243]
    s_lshl_b32 s84, s60, 1
    s_add_u32 s91, s91, s84
    v_mfma_f32_16x16x32_bf16 v[240:243], a[64:67], a[216:219], v[240:243]
    buffer_load_dwordx4 a[224:227], v25, s[8:11], 0 offen offset:448
    s_waitcnt lgkmcnt(0)
    v_mfma_f32_16x16x32_bf16 v[128:131], a[0:3], a[160:163], v[128:131]
    v_mfma_f32_16x16x32_bf16 v[128:131], a[32:35], a[164:167], v[128:131]
    s_add_u32 s77, s86, s85
    ds_read_b128 a[192:195], v8 offset:8192
    v_mfma_f32_16x16x32_bf16 a[128:131], a[36:39], a[164:167], a[128:131]
    v_mfma_f32_16x16x32_bf16 a[128:131], a[4:7], a[160:163], a[128:131]
    s_add_u32 m0, s77, 0
    ds_read_b128 a[196:199], v9 offset:8192
    v_mfma_f32_16x16x32_bf16 v[132:135], a[8:11], a[160:163], v[132:135]
    v_mfma_f32_16x16x32_bf16 v[132:135], a[40:43], a[164:167], v[132:135]
    s_add_u32 s82, s73, 0
    v_mfma_f32_16x16x32_bf16 a[132:135], a[44:47], a[164:167], a[132:135]
    ds_read_b128 a[200:203], v8 offset:10240
    v_mfma_f32_16x16x32_bf16 a[132:135], a[12:15], a[160:163], a[132:135]
    buffer_load_dwordx4 v3, s[40:43], s82 offen lds
    v_mfma_f32_16x16x32_bf16 v[136:139], a[16:19], a[160:163], v[136:139]
    ds_read_b128 a[204:207], v9 offset:10240
    v_mfma_f32_16x16x32_bf16 v[136:139], a[48:51], a[164:167], v[136:139]
    s_add_u32 m0, s77, 8192
    v_mfma_f32_16x16x32_bf16 a[136:139], a[52:55], a[164:167], a[136:139]
    v_mfma_f32_16x16x32_bf16 a[136:139], a[20:23], a[160:163], a[136:139]
    s_add_u32 s82, s73, 131072
    ds_read_b128 a[208:211], v8 offset:12288
    v_mfma_f32_16x16x32_bf16 v[140:143], a[24:27], a[160:163], v[140:143]
    v_mfma_f32_16x16x32_bf16 v[140:143], a[56:59], a[164:167], v[140:143]
    buffer_load_dwordx4 v3, s[40:43], s82 offen lds
    v_mfma_f32_16x16x32_bf16 a[140:143], a[60:63], a[164:167], a[140:143]
    ds_read_b128 a[212:215], v9 offset:12288
    v_mfma_f32_16x16x32_bf16 a[140:143], a[28:31], a[160:163], a[140:143]
    v_mfma_f32_16x16x32_bf16 a[156:159], a[28:31], a[168:171], a[156:159]
    s_add_u32 m0, s77, 16384
    ds_read_b128 a[216:219], v8 offset:14336
    v_mfma_f32_16x16x32_bf16 a[156:159], a[60:63], a[172:175], a[156:159]
    v_mfma_f32_16x16x32_bf16 v[156:159], a[56:59], a[172:175], v[156:159]
    s_add_u32 s82, s73, 262144
    v_mfma_f32_16x16x32_bf16 v[156:159], a[24:27], a[168:171], v[156:159]
    ds_read_b128 a[220:223], v9 offset:14336
    v_mfma_f32_16x16x32_bf16 a[152:155], a[20:23], a[168:171], a[152:155]
    buffer_load_dwordx4 v3, s[40:43], s82 offen lds
    v_mfma_f32_16x16x32_bf16 a[152:155], a[52:55], a[172:175], a[152:155]
    v_xor_b32 v8, 0x8000, v8
    v_mfma_f32_16x16x32_bf16 v[152:155], a[48:51], a[172:175], v[152:155]
    s_add_u32 m0, s77, 24576
    v_mfma_f32_16x16x32_bf16 v[152:155], a[16:19], a[168:171], v[152:155]
    v_mfma_f32_16x16x32_bf16 a[148:151], a[12:15], a[168:171], a[148:151]
    v_xor_b32 v9, 0x8000, v9
    v_mfma_f32_16x16x32_bf16 a[148:151], a[44:47], a[172:175], a[148:151]
    s_add_u32 s82, s73, 393216
    v_mfma_f32_16x16x32_bf16 v[148:151], a[40:43], a[172:175], v[148:151]
    s_add_u32 s80, s80, 1
    v_mfma_f32_16x16x32_bf16 v[148:151], a[8:11], a[168:171], v[148:151]
    buffer_load_dwordx4 v3, s[40:43], s82 offen lds
    v_mfma_f32_16x16x32_bf16 a[144:147], a[4:7], a[168:171], a[144:147]
    s_add_u32 m0, s77, 2048
    v_mfma_f32_16x16x32_bf16 a[144:147], a[36:39], a[172:175], a[144:147]
    s_cmp_eq_u32 s80, 3
    s_cselect_b32 s80, 0, s80
    s_cselect_b32 s79, 4294901760, s90
    v_mfma_f32_16x16x32_bf16 v[144:147], a[32:35], a[172:175], v[144:147]
    v_mfma_f32_16x16x32_bf16 v[144:147], a[0:3], a[168:171], v[144:147]
    s_add_u32 s82, s73, 32768
    v_add_u32 v16, s79, v16
    v_mfma_f32_16x16x32_bf16 v[160:163], a[0:3], a[176:179], v[160:163]
    v_mfma_f32_16x16x32_bf16 v[160:163], a[32:35], a[180:183], v[160:163]
    buffer_load_dwordx4 v3, s[40:43], s82 offen lds
    v_mfma_f32_16x16x32_bf16 v[32:35], a[36:39], a[180:183], v[32:35]
    v_add_u32 v17, s79, v17
    v_mfma_f32_16x16x32_bf16 v[32:35], a[4:7], a[176:179], v[32:35]
    s_add_u32 m0, s77, 10240
    v_mfma_f32_16x16x32_bf16 v[164:167], a[8:11], a[176:179], v[164:167]
    v_add_u32 v18, s79, v18
    v_mfma_f32_16x16x32_bf16 v[164:167], a[40:43], a[180:183], v[164:167]
    v_mfma_f32_16x16x32_bf16 v[36:39], a[44:47], a[180:183], v[36:39]
    s_add_u32 s82, s73, 163840
    v_mfma_f32_16x16x32_bf16 v[36:39], a[12:15], a[176:179], v[36:39]
    v_add_u32 v19, s79, v19
    v_mfma_f32_16x16x32_bf16 v[168:171], a[16:19], a[176:179], v[168:171]
    buffer_load_dwordx4 v3, s[40:43], s82 offen lds
    v_mfma_f32_16x16x32_bf16 v[168:171], a[48:51], a[180:183], v[168:171]
    v_mfma_f32_16x16x32_bf16 v[40:43], a[52:55], a[180:183], v[40:43]
    s_add_u32 m0, s77, 18432
    v_add_u32 v20, s79, v20
    v_mfma_f32_16x16x32_bf16 v[40:43], a[20:23], a[176:179], v[40:43]
    v_mfma_f32_16x16x32_bf16 v[172:175], a[24:27], a[176:179], v[172:175]
    s_add_u32 s82, s73, 294912
    v_add_u32 v21, s79, v21
    v_mfma_f32_16x16x32_bf16 v[172:175], a[56:59], a[180:183], v[172:175]
    v_mfma_f32_16x16x32_bf16 v[44:47], a[60:63], a[180:183], v[44:47]
    buffer_load_dwordx4 v3, s[40:43], s82 offen lds
    v_mfma_f32_16x16x32_bf16 v[44:47], a[28:31], a[176:179], v[44:47]
    v_add_u32 v22, s79, v22
    v_mfma_f32_16x16x32_bf16 v[60:63], a[28:31], a[184:187], v[60:63]
    v_mfma_f32_16x16x32_bf16 v[60:63], a[60:63], a[188:191], v[60:63]
    s_add_u32 m0, s77, 26624
    v_add_u32 v23, s79, v23
    v_mfma_f32_16x16x32_bf16 v[188:191], a[56:59], a[188:191], v[188:191]
    v_mfma_f32_16x16x32_bf16 v[188:191], a[24:27], a[184:187], v[188:191]
    s_add_u32 s82, s73, 425984
    v_mfma_f32_16x16x32_bf16 v[56:59], a[20:23], a[184:187], v[56:59]
    v_mfma_f32_16x16x32_bf16 v[56:59], a[52:55], a[188:191], v[56:59]
    buffer_load_dwordx4 v3, s[40:43], s82 offen lds
    v_mfma_f32_16x16x32_bf16 v[184:187], a[48:51], a[188:191], v[184:187]
    v_mfma_f32_16x16x32_bf16 v[184:187], a[16:19], a[184:187], v[184:187]
    s_add_u32 s73, s73, 524288
    v_mfma_f32_16x16x32_bf16 v[52:55], a[12:15], a[184:187], v[52:55]
    v_mfma_f32_16x16x32_bf16 v[52:55], a[44:47], a[188:191], v[52:55]
    s_add_u32 s86, s86, s90
    v_mfma_f32_16x16x32_bf16 v[180:183], a[40:43], a[188:191], v[180:183]
    v_mfma_f32_16x16x32_bf16 v[180:183], a[8:11], a[184:187], v[180:183]
    s_cmp_eq_u32 s86, 163840
    s_cselect_b32 s86, 65536, s86
    v_mfma_f32_16x16x32_bf16 v[48:51], a[4:7], a[184:187], v[48:51]
    v_mfma_f32_16x16x32_bf16 v[48:51], a[36:39], a[188:191], v[48:51]
    v_mfma_f32_16x16x32_bf16 v[176:179], a[32:35], a[188:191], v[176:179]
    v_mfma_f32_16x16x32_bf16 v[176:179], a[0:3], a[184:187], v[176:179]
    s_waitcnt vmcnt(16) lgkmcnt(0)
    s_barrier
    v_mfma_f32_16x16x32_bf16 v[192:195], a[0:3], a[192:195], v[192:195]
    s_add_u32 m0, s76, 0
    ds_read_b128 a[160:163], v8 offset:0
    v_mfma_f32_16x16x32_bf16 v[192:195], a[32:35], a[196:199], v[192:195]
    ds_read_b128 a[164:167], v9 offset:0
    v_mfma_f32_16x16x32_bf16 v[64:67], a[36:39], a[196:199], v[64:67]
    s_add_u32 s81, s72, 0
    v_mfma_f32_16x16x32_bf16 v[64:67], a[4:7], a[192:195], v[64:67]
    ds_read_b64_tr_b16 a[64:65], v16 offset:0
    v_mfma_f32_16x16x32_bf16 v[196:199], a[8:11], a[192:195], v[196:199]
    ds_read_b64_tr_b16 a[66:67], v16 offset:2048
    v_mfma_f32_16x16x32_bf16 v[196:199], a[40:43], a[196:199], v[196:199]
    buffer_load_dwordx4 v4, s[36:39], s81 offen lds
    v_mfma_f32_16x16x32_bf16 v[68:71], a[44:47], a[196:199], v[68:71]
    s_add_u32 m0, s76, 4096
    ds_read_b64_tr_b16 a[96:97], v16 offset:16384
    v_mfma_f32_16x16x32_bf16 v[68:71], a[12:15], a[192:195], v[68:71]
    ds_read_b64_tr_b16 a[98:99], v16 offset:18432
    v_mfma_f32_16x16x32_bf16 v[200:203], a[16:19], a[192:195], v[200:203]
    s_add_u32 s81, s72, 28672
    ds_read_b64_tr_b16 a[68:69], v17 offset:0
    v_mfma_f32_16x16x32_bf16 v[200:203], a[48:51], a[196:199], v[200:203]
    ds_read_b64_tr_b16 a[70:71], v17 offset:2048
    v_mfma_f32_16x16x32_bf16 v[72:75], a[52:55], a[196:199], v[72:75]
    buffer_load_dwordx4 v4, s[36:39], s81 offen lds
    v_mfma_f32_16x16x32_bf16 v[72:75], a[20:23], a[192:195], v[72:75]
    ds_read_b64_tr_b16 a[100:101], v17 offset:16384
    v_mfma_f32_16x16x32_bf16 v[204:207], a[24:27], a[192:195], v[204:207]
    s_add_u32 m0, s76, 8192
    ds_read_b64_tr_b16 a[102:103], v17 offset:18432
    v_mfma_f32_16x16x32_bf16 v[204:207], a[56:59], a[196:199], v[204:207]
    ds_read_b64_tr_b16 a[72:73], v18 offset:0
    v_mfma_f32_16x16x32_bf16 v[76:79], a[60:63], a[196:199], v[76:79]
    s_add_u32 s81, s72, 57344
    ds_read_b64_tr_b16 a[74:75], v18 offset:2048
    v_mfma_f32_16x16x32_bf16 v[76:79], a[28:31], a[192:195], v[76:79]
    ds_read_b64_tr_b16 a[104:105], v18 offset:16384
    v_mfma_f32_16x16x32_bf16 v[92:95], a[28:31], a[200:203], v[92:95]
    buffer_load_dwordx4 v4, s[36:39], s81 offen lds
    v_mfma_f32_16x16x32_bf16 v[92:95], a[60:63], a[204:207], v[92:95]
    ds_read_b64_tr_b16 a[106:107], v18 offset:18432
    v_mfma_f32_16x16x32_bf16 v[220:223], a[56:59], a[204:207], v[220:223]
    s_add_u32 m0, s76, 12288
    ds_read_b64_tr_b16 a[76:77], v19 offset:0
    v_mfma_f32_16x16x32_bf16 v[220:223], a[24:27], a[200:203], v[220:223]
    ds_read_b64_tr_b16 a[78:79], v19 offset:2048
    v_mfma_f32_16x16x32_bf16 v[88:91], a[20:23], a[200:203], v[88:91]
    s_add_u32 s81, s72, 86016
    v_mfma_f32_16x16x32_bf16 v[88:91], a[52:55], a[204:207], v[88:91]
    ds_read_b64_tr_b16 a[108:109], v19 offset:16384
    ds_read_b64_tr_b16 a[110:111], v19 offset:18432
    v_mfma_f32_16x16x32_bf16 v[216:219], a[48:51], a[204:207], v[216:219]
    buffer_load_dwordx4 v4, s[36:39], s81 offen lds
    v_mfma_f32_16x16x32_bf16 v[216:219], a[16:19], a[200:203], v[216:219]
    ds_read_b64_tr_b16 a[80:81], v20 offset:0
    v_mfma_f32_16x16x32_bf16 v[84:87], a[12:15], a[200:203], v[84:87]
    s_add_u32 m0, s89, 16384
    ds_read_b64_tr_b16 a[82:83], v20 offset:2048
    v_mfma_f32_16x16x32_bf16 v[84:87], a[44:47], a[204:207], v[84:87]
    v_mfma_f32_16x16x32_bf16 v[212:215], a[40:43], a[204:207], v[212:215]
    s_add_u32 s81, s74, 0
    ds_read_b64_tr_b16 a[112:113], v20 offset:16384
    v_mfma_f32_16x16x32_bf16 v[212:215], a[8:11], a[200:203], v[212:215]
    ds_read_b64_tr_b16 a[114:115], v20 offset:18432
    v_mfma_f32_16x16x32_bf16 v[80:83], a[4:7], a[200:203], v[80:83]
    buffer_load_dwordx4 v6, s[44:47], s81 offen lds
    v_mfma_f32_16x16x32_bf16 v[80:83], a[36:39], a[204:207], v[80:83]
    ds_read_b64_tr_b16 a[84:85], v21 offset:0
    ds_read_b64_tr_b16 a[86:87], v21 offset:2048
    v_mfma_f32_16x16x32_bf16 v[208:211], a[32:35], a[204:207], v[208:211]
    s_add_u32 m0, s89, 20480
    v_mfma_f32_16x16x32_bf16 v[208:211], a[0:3], a[200:203], v[208:211]
    s_add_u32 s81, s74, 43008
    ds_read_b64_tr_b16 a[116:117], v21 offset:16384
    v_mfma_f32_16x16x32_bf16 v[224:227], a[0:3], a[208:211], v[224:227]
    ds_read_b64_tr_b16 a[118:119], v21 offset:18432
    v_mfma_f32_16x16x32_bf16 v[224:227], a[32:35], a[212:215], v[224:227]
    ds_read_b64_tr_b16 a[88:89], v22 offset:0
    v_mfma_f32_16x16x32_bf16 v[96:99], a[36:39], a[212:215], v[96:99]
    buffer_load_dwordx4 v6, s[44:47], s81 offen lds
    v_mfma_f32_16x16x32_bf16 v[96:99], a[4:7], a[208:211], v[96:99]
    s_add_u32 m0, s89, 24576
    ds_read_b64_tr_b16 a[90:91], v22 offset:2048
    v_mfma_f32_16x16x32_bf16 v[228:231], a[8:11], a[208:211], v[228:231]
    ds_read_b64_tr_b16 a[120:121], v22 offset:16384
    v_mfma_f32_16x16x32_bf16 v[228:231], a[40:43], a[212:215], v[228:231]
    s_add_u32 s81, s74, 86016
    ds_read_b64_tr_b16 a[122:123], v22 offset:18432
    v_mfma_f32_16x16x32_bf16 v[100:103], a[44:47], a[212:215], v[100:103]
    ds_read_b64_tr_b16 a[92:93], v23 offset:0
    v_mfma_f32_16x16x32_bf16 v[100:103], a[12:15], a[208:211], v[100:103]
    buffer_load_dwordx4 v6, s[44:47], s81 offen lds
    v_mfma_f32_16x16x32_bf16 v[232:235], a[16:19], a[208:211], v[232:235]
    ds_read_b64_tr_b16 a[94:95], v23 offset:2048
    v_mfma_f32_16x16x32_bf16 v[232:235], a[48:51], a[212:215], v[232:235]
    s_add_u32 m0, s89, 28672
    ds_read_b64_tr_b16 a[124:125], v23 offset:16384
    v_mfma_f32_16x16x32_bf16 v[104:107], a[52:55], a[212:215], v[104:107]
    ds_read_b64_tr_b16 a[126:127], v23 offset:18432
    v_mfma_f32_16x16x32_bf16 v[104:107], a[20:23], a[208:211], v[104:107]
    s_add_u32 s81, s74, 129024
    ds_read_b128 a[168:171], v8 offset:2048
    v_mfma_f32_16x16x32_bf16 v[236:239], a[24:27], a[208:211], v[236:239]
    v_mfma_f32_16x16x32_bf16 v[236:239], a[56:59], a[212:215], v[236:239]
    ds_read_b128 a[172:175], v9 offset:2048
    v_mfma_f32_16x16x32_bf16 v[108:111], a[60:63], a[212:215], v[108:111]
    buffer_load_dwordx4 v6, s[44:47], s81 offen lds
    v_mfma_f32_16x16x32_bf16 v[108:111], a[28:31], a[208:211], v[108:111]
    s_add_u32 s72, s72, 128
    ds_read_b128 a[176:179], v8 offset:4096
    ds_read_b128 a[180:183], v9 offset:4096
    v_mfma_f32_16x16x32_bf16 v[124:127], a[28:31], a[216:219], v[124:127]
    v_mfma_f32_16x16x32_bf16 v[124:127], a[60:63], a[220:223], v[124:127]
    s_add_u32 s74, s74, 172032
    ds_read_b128 a[184:187], v8 offset:6144
    v_mfma_f32_16x16x32_bf16 v[252:255], a[56:59], a[220:223], v[252:255]
    ds_read_b128 a[188:191], v9 offset:6144
    v_mfma_f32_16x16x32_bf16 v[252:255], a[24:27], a[216:219], v[252:255]
    s_xor_b32 s76, s76, s90
    v_mfma_f32_16x16x32_bf16 v[120:123], a[20:23], a[216:219], v[120:123]
    v_mfma_f32_16x16x32_bf16 v[120:123], a[52:55], a[220:223], v[120:123]
    s_xor_b32 s89, s89, s90
    v_mfma_f32_16x16x32_bf16 v[248:251], a[48:51], a[220:223], v[248:251]
    v_mfma_f32_16x16x32_bf16 v[248:251], a[16:19], a[216:219], v[248:251]
    s_mov_b64 s[68:69], s[24:25]
    v_mfma_f32_16x16x32_bf16 v[116:119], a[12:15], a[216:219], v[116:119]
    v_mfma_f32_16x16x32_bf16 v[116:119], a[44:47], a[220:223], v[116:119]
    s_movk_i32 s70, 256
    v_mfma_f32_16x16x32_bf16 v[244:247], a[40:43], a[220:223], v[244:247]
    v_mfma_f32_16x16x32_bf16 v[244:247], a[8:11], a[216:219], v[244:247]
    s_lshl_b32 s84, s63, 12
    v_mfma_f32_16x16x32_bf16 v[112:115], a[4:7], a[216:219], v[112:115]
    v_mfma_f32_16x16x32_bf16 v[112:115], a[36:39], a[220:223], v[112:115]
    v_mov_b32 v26, 1
    v_mfma_f32_16x16x32_bf16 v[240:243], a[32:35], a[220:223], v[240:243]
    v_mfma_f32_16x16x32_bf16 v[240:243], a[0:3], a[216:219], v[240:243]
    buffer_atomic_add v26, v24, s[68:71], s84 offen sc1
    s_waitcnt lgkmcnt(0)
    v_mfma_f32_16x16x32_bf16 v[128:131], a[64:67], a[160:163], v[128:131]
    v_mfma_f32_16x16x32_bf16 v[128:131], a[96:99], a[164:167], v[128:131]
    s_add_u32 s77, s86, s85
    ds_read_b128 a[192:195], v8 offset:8192
    v_mfma_f32_16x16x32_bf16 a[128:131], a[100:103], a[164:167], a[128:131]
    v_mfma_f32_16x16x32_bf16 a[128:131], a[68:71], a[160:163], a[128:131]
    s_add_u32 m0, s77, 0
    ds_read_b128 a[196:199], v9 offset:8192
    v_mfma_f32_16x16x32_bf16 v[132:135], a[72:75], a[160:163], v[132:135]
    v_mfma_f32_16x16x32_bf16 v[132:135], a[104:107], a[164:167], v[132:135]
    s_add_u32 s82, s73, 0
    v_mfma_f32_16x16x32_bf16 a[132:135], a[108:111], a[164:167], a[132:135]
    ds_read_b128 a[200:203], v8 offset:10240
    v_mfma_f32_16x16x32_bf16 a[132:135], a[76:79], a[160:163], a[132:135]
    buffer_load_dwordx4 v3, s[40:43], s82 offen lds
    v_mfma_f32_16x16x32_bf16 v[136:139], a[80:83], a[160:163], v[136:139]
    ds_read_b128 a[204:207], v9 offset:10240
    v_mfma_f32_16x16x32_bf16 v[136:139], a[112:115], a[164:167], v[136:139]
    s_add_u32 m0, s77, 8192
    v_mfma_f32_16x16x32_bf16 a[136:139], a[116:119], a[164:167], a[136:139]
    v_mfma_f32_16x16x32_bf16 a[136:139], a[84:87], a[160:163], a[136:139]
    s_add_u32 s82, s73, 131072
    ds_read_b128 a[208:211], v8 offset:12288
    v_mfma_f32_16x16x32_bf16 v[140:143], a[88:91], a[160:163], v[140:143]
    v_mfma_f32_16x16x32_bf16 v[140:143], a[120:123], a[164:167], v[140:143]
    buffer_load_dwordx4 v3, s[40:43], s82 offen lds
    v_mfma_f32_16x16x32_bf16 a[140:143], a[124:127], a[164:167], a[140:143]
    ds_read_b128 a[212:215], v9 offset:12288
    v_mfma_f32_16x16x32_bf16 a[140:143], a[92:95], a[160:163], a[140:143]
    v_mfma_f32_16x16x32_bf16 a[156:159], a[92:95], a[168:171], a[156:159]
    s_add_u32 m0, s77, 16384
    ds_read_b128 a[216:219], v8 offset:14336
    v_mfma_f32_16x16x32_bf16 a[156:159], a[124:127], a[172:175], a[156:159]
    v_mfma_f32_16x16x32_bf16 v[156:159], a[120:123], a[172:175], v[156:159]
    s_add_u32 s82, s73, 262144
    v_mfma_f32_16x16x32_bf16 v[156:159], a[88:91], a[168:171], v[156:159]
    ds_read_b128 a[220:223], v9 offset:14336
    v_mfma_f32_16x16x32_bf16 a[152:155], a[84:87], a[168:171], a[152:155]
    buffer_load_dwordx4 v3, s[40:43], s82 offen lds
    v_mfma_f32_16x16x32_bf16 a[152:155], a[116:119], a[172:175], a[152:155]
    v_xor_b32 v8, 0x8000, v8
    v_mfma_f32_16x16x32_bf16 v[152:155], a[112:115], a[172:175], v[152:155]
    s_add_u32 m0, s77, 24576
    v_mfma_f32_16x16x32_bf16 v[152:155], a[80:83], a[168:171], v[152:155]
    v_mfma_f32_16x16x32_bf16 a[148:151], a[76:79], a[168:171], a[148:151]
    v_xor_b32 v9, 0x8000, v9
    v_mfma_f32_16x16x32_bf16 a[148:151], a[108:111], a[172:175], a[148:151]
    s_add_u32 s82, s73, 393216
    v_mfma_f32_16x16x32_bf16 v[148:151], a[104:107], a[172:175], v[148:151]
    s_add_u32 s80, s80, 1
    v_mfma_f32_16x16x32_bf16 v[148:151], a[72:75], a[168:171], v[148:151]
    buffer_load_dwordx4 v3, s[40:43], s82 offen lds
    v_mfma_f32_16x16x32_bf16 a[144:147], a[68:71], a[168:171], a[144:147]
    s_add_u32 m0, s77, 2048
    v_mfma_f32_16x16x32_bf16 a[144:147], a[100:103], a[172:175], a[144:147]
    s_cmp_eq_u32 s80, 3
    s_cselect_b32 s80, 0, s80
    s_cselect_b32 s79, 4294901760, s90
    v_mfma_f32_16x16x32_bf16 v[144:147], a[96:99], a[172:175], v[144:147]
    v_mfma_f32_16x16x32_bf16 v[144:147], a[64:67], a[168:171], v[144:147]
    s_add_u32 s82, s73, 32768
    v_add_u32 v16, s79, v16
    v_mfma_f32_16x16x32_bf16 v[160:163], a[64:67], a[176:179], v[160:163]
    v_mfma_f32_16x16x32_bf16 v[160:163], a[96:99], a[180:183], v[160:163]
    buffer_load_dwordx4 v3, s[40:43], s82 offen lds
    v_mfma_f32_16x16x32_bf16 v[32:35], a[100:103], a[180:183], v[32:35]
    v_add_u32 v17, s79, v17
    v_mfma_f32_16x16x32_bf16 v[32:35], a[68:71], a[176:179], v[32:35]
    s_add_u32 m0, s77, 10240
    v_mfma_f32_16x16x32_bf16 v[164:167], a[72:75], a[176:179], v[164:167]
    v_add_u32 v18, s79, v18
    v_mfma_f32_16x16x32_bf16 v[164:167], a[104:107], a[180:183], v[164:167]
    v_mfma_f32_16x16x32_bf16 v[36:39], a[108:111], a[180:183], v[36:39]
    s_add_u32 s82, s73, 163840
    v_mfma_f32_16x16x32_bf16 v[36:39], a[76:79], a[176:179], v[36:39]
    v_add_u32 v19, s79, v19
    v_mfma_f32_16x16x32_bf16 v[168:171], a[80:83], a[176:179], v[168:171]
    v_cvt_pk_bf16_f32 v128, v128, v129
    v_cvt_pk_bf16_f32 v129, v130, v131
    v_mfma_f32_16x16x32_bf16 v[168:171], a[112:115], a[180:183], v[168:171]
    buffer_load_dwordx4 v3, s[40:43], s82 offen lds
    v_mfma_f32_16x16x32_bf16 v[40:43], a[116:119], a[180:183], v[40:43]
    s_add_u32 m0, s77, 18432
    v_accvgpr_read_b32 v26, a128
    v_accvgpr_read_b32 v27, a129
    v_mfma_f32_16x16x32_bf16 v[40:43], a[84:87], a[176:179], v[40:43]
    v_accvgpr_read_b32 v28, a130
    v_accvgpr_read_b32 v29, a131
    v_mfma_f32_16x16x32_bf16 v[172:175], a[88:91], a[176:179], v[172:175]
    s_add_u32 s82, s73, 294912
    v_add_u32 v20, s79, v20
    v_cvt_pk_bf16_f32 v130, v26, v27
    v_mfma_f32_16x16x32_bf16 v[172:175], a[120:123], a[180:183], v[172:175]
    v_cvt_pk_bf16_f32 v131, v28, v29
    v_cvt_pk_bf16_f32 v132, v132, v133
    v_mfma_f32_16x16x32_bf16 v[44:47], a[124:127], a[180:183], v[44:47]
    v_cvt_pk_bf16_f32 v133, v134, v135
    v_accvgpr_read_b32 v26, a132
    v_mfma_f32_16x16x32_bf16 v[44:47], a[92:95], a[176:179], v[44:47]
    v_add_u32 v21, s79, v21
    v_add_u32 v22, s79, v22
    v_accvgpr_read_b32 v27, a133
    v_mfma_f32_16x16x32_bf16 v[60:63], a[92:95], a[184:187], v[60:63]
    v_accvgpr_read_b32 v28, a134
    v_accvgpr_read_b32 v29, a135
    v_cvt_pk_bf16_f32 v134, v26, v27
    v_mfma_f32_16x16x32_bf16 v[60:63], a[124:127], a[188:191], v[60:63]
    v_add_u32 v23, s79, v23
    v_cvt_pk_bf16_f32 v135, v28, v29
    v_cvt_pk_bf16_f32 v136, v136, v137
    v_mfma_f32_16x16x32_bf16 v[188:191], a[120:123], a[188:191], v[188:191]
    buffer_load_dwordx4 v3, s[40:43], s82 offen lds
    v_cvt_pk_bf16_f32 v137, v138, v139
    v_accvgpr_read_b32 v26, a136
    v_accvgpr_read_b32 v27, a137
    v_mfma_f32_16x16x32_bf16 v[188:191], a[88:91], a[184:187], v[188:191]
    s_add_u32 m0, s77, 26624
    v_accvgpr_read_b32 v28, a138
    v_accvgpr_read_b32 v29, a139
    v_cvt_pk_bf16_f32 v138, v26, v27
    v_mfma_f32_16x16x32_bf16 v[56:59], a[84:87], a[184:187], v[56:59]
    s_add_u32 s82, s73, 425984
    v_cvt_pk_bf16_f32 v139, v28, v29
    v_cvt_pk_bf16_f32 v140, v140, v141
    v_mfma_f32_16x16x32_bf16 v[56:59], a[116:119], a[188:191], v[56:59]
    buffer_load_dwordx4 v3, s[40:43], s82 offen lds
    v_cvt_pk_bf16_f32 v141, v142, v143
    v_accvgpr_read_b32 v26, a140
    v_accvgpr_read_b32 v27, a141
    v_mfma_f32_16x16x32_bf16 v[184:187], a[112:115], a[188:191], v[184:187]
    v_accvgpr_read_b32 v28, a142
    v_accvgpr_read_b32 v29, a143
    v_cvt_pk_bf16_f32 v142, v26, v27
    v_mfma_f32_16x16x32_bf16 v[184:187], a[80:83], a[184:187], v[184:187]
    s_add_u32 s73, s73, 524288
    v_cvt_pk_bf16_f32 v143, v28, v29
    v_cvt_pk_bf16_f32 v144, v144, v145
    v_mfma_f32_16x16x32_bf16 v[52:55], a[76:79], a[184:187], v[52:55]
    v_cvt_pk_bf16_f32 v145, v146, v147
    v_accvgpr_read_b32 v26, a144
    v_accvgpr_read_b32 v27, a145
    v_mfma_f32_16x16x32_bf16 v[52:55], a[108:111], a[188:191], v[52:55]
    s_add_u32 s86, s86, s90
    v_accvgpr_read_b32 v28, a146
    v_accvgpr_read_b32 v29, a147
    v_cvt_pk_bf16_f32 v146, v26, v27
    v_mfma_f32_16x16x32_bf16 v[180:183], a[104:107], a[188:191], v[180:183]
    v_cvt_pk_bf16_f32 v147, v28, v29
    v_cvt_pk_bf16_f32 v148, v148, v149
    v_mfma_f32_16x16x32_bf16 v[180:183], a[72:75], a[184:187], v[180:183]
    s_cmp_eq_u32 s86, 163840
    s_cselect_b32 s86, 65536, s86
    v_cvt_pk_bf16_f32 v149, v150, v151
    v_accvgpr_read_b32 v26, a148
    v_accvgpr_read_b32 v27, a149
    v_mfma_f32_16x16x32_bf16 v[48:51], a[68:71], a[184:187], v[48:51]
    v_accvgpr_read_b32 v28, a150
    v_accvgpr_read_b32 v29, a151
    v_cvt_pk_bf16_f32 v150, v26, v27
    v_mfma_f32_16x16x32_bf16 v[48:51], a[100:103], a[188:191], v[48:51]
    v_cvt_pk_bf16_f32 v151, v28, v29
    v_cvt_pk_bf16_f32 v152, v152, v153
    v_mfma_f32_16x16x32_bf16 v[176:179], a[96:99], a[188:191], v[176:179]
    v_cvt_pk_bf16_f32 v153, v154, v155
    v_accvgpr_read_b32 v26, a152
    v_accvgpr_read_b32 v27, a153
    v_mfma_f32_16x16x32_bf16 v[176:179], a[64:67], a[184:187], v[176:179]
    v_accvgpr_read_b32 v28, a154
    v_accvgpr_read_b32 v29, a155
    v_cvt_pk_bf16_f32 v154, v26, v27
    v_cvt_pk_bf16_f32 v155, v28, v29
    v_cvt_pk_bf16_f32 v156, v156, v157
    v_cvt_pk_bf16_f32 v157, v158, v159
    v_accvgpr_read_b32 v26, a156
    v_accvgpr_read_b32 v27, a157
    v_accvgpr_read_b32 v28, a158
    v_accvgpr_read_b32 v29, a159
    v_cvt_pk_bf16_f32 v158, v26, v27
    v_cvt_pk_bf16_f32 v159, v28, v29
    s_waitcnt vmcnt(9) lgkmcnt(0)
    s_barrier
    v_mfma_f32_16x16x32_bf16 v[192:195], a[64:67], a[192:195], v[192:195]
    s_lshl_b32 s83, s60, 12
    s_add_u32 m0, s76, 0
    v_mfma_f32_16x16x32_bf16 v[192:195], a[96:99], a[196:199], v[192:195]
    s_add_u32 s81, s72, 0
    v_add_u32 v8, s83, v30
    v_xor_b32 v9, 64, v8
    v_mfma_f32_16x16x32_bf16 v[64:67], a[100:103], a[196:199], v[64:67]
    buffer_load_dwordx4 v4, s[36:39], s81 offen lds
    v_mfma_f32_16x16x32_bf16 v[64:67], a[68:71], a[192:195], v[64:67]
    s_add_u32 m0, s76, 4096
    s_add_u32 s81, s72, 28672
    v_add_u32 v16, 98304, v7
    v_mfma_f32_16x16x32_bf16 v[196:199], a[72:75], a[192:195], v[196:199]
    buffer_load_dwordx4 v4, s[36:39], s81 offen lds
    v_mfma_f32_16x16x32_bf16 v[196:199], a[104:107], a[196:199], v[196:199]
    s_add_u32 m0, s76, 8192
    v_xor_b32 v17, 32, v16
    v_cvt_pk_bf16_f32 v160, v160, v161
    v_mfma_f32_16x16x32_bf16 v[68:71], a[108:111], a[196:199], v[68:71]
    s_add_u32 s81, s72, 57344
    v_xor_b32 v18, 64, v16
    v_cvt_pk_bf16_f32 v161, v162, v163
    v_mfma_f32_16x16x32_bf16 v[68:71], a[76:79], a[192:195], v[68:71]
    v_xor_b32 v19, 96, v16
    v_cvt_pk_bf16_f32 v162, v32, v33
    v_mfma_f32_16x16x32_bf16 v[200:203], a[80:83], a[192:195], v[200:203]
    buffer_load_dwordx4 v4, s[36:39], s81 offen lds
    v_mfma_f32_16x16x32_bf16 v[200:203], a[112:115], a[196:199], v[200:203]
    s_add_u32 m0, s76, 12288
    v_xor_b32 v20, 128, v16
    v_cvt_pk_bf16_f32 v163, v34, v35
    v_mfma_f32_16x16x32_bf16 v[72:75], a[116:119], a[196:199], v[72:75]
    s_add_u32 s81, s72, 86016
    v_xor_b32 v21, 160, v16
    v_cvt_pk_bf16_f32 v164, v164, v165
    v_mfma_f32_16x16x32_bf16 v[72:75], a[84:87], a[192:195], v[72:75]
    buffer_load_dwordx4 v4, s[36:39], s81 offen lds
    v_mfma_f32_16x16x32_bf16 v[204:207], a[88:91], a[192:195], v[204:207]
    s_add_u32 m0, s89, 16384
    v_cvt_pk_bf16_f32 v165, v166, v167
    v_cvt_pk_bf16_f32 v166, v36, v37
    v_mfma_f32_16x16x32_bf16 v[204:207], a[120:123], a[196:199], v[204:207]
    s_add_u32 s81, s74, 0
    v_xor_b32 v22, 192, v16
    v_cvt_pk_bf16_f32 v167, v38, v39
    v_cvt_pk_bf16_f32 v168, v168, v169
    v_mfma_f32_16x16x32_bf16 v[76:79], a[124:127], a[196:199], v[76:79]
    buffer_load_dwordx4 v6, s[44:47], s81 offen lds
    v_xor_b32 v23, 224, v16
    v_mfma_f32_16x16x32_bf16 v[76:79], a[92:95], a[192:195], v[76:79]
    s_add_u32 m0, s89, 20480
    s_add_u32 s81, s74, 43008
    v_add_u32 v10, 16384, v31
    v_cvt_pk_bf16_f32 v169, v170, v171
    v_mfma_f32_16x16x32_bf16 v[92:95], a[92:95], a[200:203], v[92:95]
    buffer_load_dwordx4 v6, s[44:47], s81 offen lds
    v_xor_b32 v11, 32, v10
    v_xor_b32 v12, 64, v10
    v_xor_b32 v13, 96, v10
    v_xor_b32 v14, 128, v10
    v_xor_b32 v15, 160, v10
    v_cvt_pk_bf16_f32 v170, v40, v41
    v_mfma_f32_16x16x32_bf16 v[92:95], a[124:127], a[204:207], v[92:95]
    s_add_u32 m0, s89, 24576
    v_cvt_pk_bf16_f32 v171, v42, v43
    v_cvt_pk_bf16_f32 v172, v172, v173
    v_cvt_pk_bf16_f32 v173, v174, v175
    v_mfma_f32_16x16x32_bf16 v[220:223], a[120:123], a[204:207], v[220:223]
    s_add_u32 s81, s74, 86016
    buffer_load_dwordx4 v6, s[44:47], s81 offen lds
    v_mfma_f32_16x16x32_bf16 v[220:223], a[88:91], a[200:203], v[220:223]
    s_add_u32 m0, s89, 28672
    s_add_u32 s81, s74, 129024
    v_cvt_pk_bf16_f32 v174, v44, v45
    v_mfma_f32_16x16x32_bf16 v[88:91], a[84:87], a[200:203], v[88:91]
    buffer_load_dwordx4 v6, s[44:47], s81 offen lds
    s_add_u32 s72, s72, 128
    s_add_u32 s74, s74, 172032
    s_xor_b32 s76, s76, s90
    s_xor_b32 s89, s89, s90
    v_cvt_pk_bf16_f32 v175, v46, v47
    v_mfma_f32_16x16x32_bf16 v[88:91], a[116:119], a[204:207], v[88:91]
    v_cvt_pk_bf16_f32 v176, v176, v177
    v_cvt_pk_bf16_f32 v177, v178, v179
    v_mfma_f32_16x16x32_bf16 v[216:219], a[112:115], a[204:207], v[216:219]
    v_cvt_pk_bf16_f32 v178, v48, v49
    v_cvt_pk_bf16_f32 v179, v50, v51
    v_mfma_f32_16x16x32_bf16 v[216:219], a[80:83], a[200:203], v[216:219]
    v_cvt_pk_bf16_f32 v180, v180, v181
    v_cvt_pk_bf16_f32 v181, v182, v183
    v_mfma_f32_16x16x32_bf16 v[84:87], a[76:79], a[200:203], v[84:87]
    v_cvt_pk_bf16_f32 v182, v52, v53
    v_cvt_pk_bf16_f32 v183, v54, v55
    v_mfma_f32_16x16x32_bf16 v[84:87], a[108:111], a[204:207], v[84:87]
    buffer_store_dwordx4 v[128:131], v1, s[48:51], s87 offen offset:0 sc1
    v_mfma_f32_16x16x32_bf16 v[212:215], a[104:107], a[204:207], v[212:215]
    v_cvt_pk_bf16_f32 v184, v184, v185
    v_cvt_pk_bf16_f32 v185, v186, v187
    v_mfma_f32_16x16x32_bf16 v[212:215], a[72:75], a[200:203], v[212:215]
    buffer_store_dwordx4 v[132:135], v1, s[48:51], s87 offen offset:1024 sc1
    v_mfma_f32_16x16x32_bf16 v[80:83], a[68:71], a[200:203], v[80:83]
    v_cvt_pk_bf16_f32 v186, v56, v57
    v_cvt_pk_bf16_f32 v187, v58, v59
    v_mfma_f32_16x16x32_bf16 v[80:83], a[100:103], a[204:207], v[80:83]
    v_cvt_pk_bf16_f32 v188, v188, v189
    v_cvt_pk_bf16_f32 v189, v190, v191
    v_cvt_pk_bf16_f32 v190, v60, v61
    v_mfma_f32_16x16x32_bf16 v[208:211], a[96:99], a[204:207], v[208:211]
    buffer_store_dwordx4 v[136:139], v1, s[48:51], s87 offen offset:2048 sc1
    v_cvt_pk_bf16_f32 v191, v62, v63
    v_mfma_f32_16x16x32_bf16 v[208:211], a[64:67], a[200:203], v[208:211]
    buffer_store_dwordx4 v[140:143], v1, s[48:51], s87 offen offset:3072 sc1
    v_mfma_f32_16x16x32_bf16 v[224:227], a[64:67], a[208:211], v[224:227]
    v_mfma_f32_16x16x32_bf16 v[224:227], a[96:99], a[212:215], v[224:227]
    v_mfma_f32_16x16x32_bf16 v[96:99], a[100:103], a[212:215], v[96:99]
    s_add_u32 s87, s87, s16
    v_mfma_f32_16x16x32_bf16 v[96:99], a[68:71], a[208:211], v[96:99]
    v_mfma_f32_16x16x32_bf16 v[228:231], a[72:75], a[208:211], v[228:231]
    v_mfma_f32_16x16x32_bf16 v[228:231], a[104:107], a[212:215], v[228:231]
    buffer_store_dwordx4 v[144:147], v1, s[48:51], s87 offen offset:0 sc1
    v_mfma_f32_16x16x32_bf16 v[100:103], a[108:111], a[212:215], v[100:103]
    v_mfma_f32_16x16x32_bf16 v[100:103], a[76:79], a[208:211], v[100:103]
    v_mfma_f32_16x16x32_bf16 v[232:235], a[80:83], a[208:211], v[232:235]
    buffer_store_dwordx4 v[148:151], v1, s[48:51], s87 offen offset:1024 sc1
    v_mfma_f32_16x16x32_bf16 v[232:235], a[112:115], a[212:215], v[232:235]
    v_cvt_pk_bf16_f32 v192, v192, v193
    v_cvt_pk_bf16_f32 v193, v194, v195
    v_mfma_f32_16x16x32_bf16 v[104:107], a[116:119], a[212:215], v[104:107]
    v_cvt_pk_bf16_f32 v194, v64, v65
    v_cvt_pk_bf16_f32 v195, v66, v67
    v_mfma_f32_16x16x32_bf16 v[104:107], a[84:87], a[208:211], v[104:107]
    buffer_store_dwordx4 v[152:155], v1, s[48:51], s87 offen offset:2048 sc1
    v_mfma_f32_16x16x32_bf16 v[236:239], a[88:91], a[208:211], v[236:239]
    v_cvt_pk_bf16_f32 v196, v196, v197
    v_cvt_pk_bf16_f32 v197, v198, v199
    v_mfma_f32_16x16x32_bf16 v[236:239], a[120:123], a[212:215], v[236:239]
    v_cvt_pk_bf16_f32 v198, v68, v69
    v_cvt_pk_bf16_f32 v199, v70, v71
    v_mfma_f32_16x16x32_bf16 v[108:111], a[124:127], a[212:215], v[108:111]
    buffer_store_dwordx4 v[156:159], v1, s[48:51], s87 offen offset:3072 sc1
    v_mfma_f32_16x16x32_bf16 v[108:111], a[92:95], a[208:211], v[108:111]
    v_cvt_pk_bf16_f32 v200, v200, v201
    v_cvt_pk_bf16_f32 v201, v202, v203
    v_mfma_f32_16x16x32_bf16 v[124:127], a[92:95], a[216:219], v[124:127]
    s_add_u32 s87, s87, s17
    v_cvt_pk_bf16_f32 v202, v72, v73
    v_cvt_pk_bf16_f32 v203, v74, v75
    v_mfma_f32_16x16x32_bf16 v[124:127], a[124:127], a[220:223], v[124:127]
    v_cvt_pk_bf16_f32 v204, v204, v205
    v_mfma_f32_16x16x32_bf16 v[252:255], a[120:123], a[220:223], v[252:255]
    v_cvt_pk_bf16_f32 v205, v206, v207
    v_cvt_pk_bf16_f32 v206, v76, v77
    v_mfma_f32_16x16x32_bf16 v[252:255], a[88:91], a[216:219], v[252:255]
    buffer_store_dwordx4 v[160:163], v1, s[48:51], s87 offen offset:0 sc1
    v_mfma_f32_16x16x32_bf16 v[120:123], a[84:87], a[216:219], v[120:123]
    v_cvt_pk_bf16_f32 v207, v78, v79
    v_cvt_pk_bf16_f32 v208, v208, v209
    v_mfma_f32_16x16x32_bf16 v[120:123], a[116:119], a[220:223], v[120:123]
    ds_read_b128 a[160:163], v8 offset:0
    v_cvt_pk_bf16_f32 v209, v210, v211
    v_mfma_f32_16x16x32_bf16 v[248:251], a[112:115], a[220:223], v[248:251]
    ds_read_b128 a[164:167], v8 offset:2048
    v_cvt_pk_bf16_f32 v210, v80, v81
    v_mfma_f32_16x16x32_bf16 v[248:251], a[80:83], a[216:219], v[248:251]
    buffer_store_dwordx4 v[164:167], v1, s[48:51], s87 offen offset:1024 sc1
    v_mfma_f32_16x16x32_bf16 v[116:119], a[76:79], a[216:219], v[116:119]
    ds_read_b64_tr_b16 a[0:1], v16 offset:0
    v_cvt_pk_bf16_f32 v211, v82, v83
    v_mfma_f32_16x16x32_bf16 v[116:119], a[108:111], a[220:223], v[116:119]
    ds_read_b64_tr_b16 a[2:3], v16 offset:2048
    v_cvt_pk_bf16_f32 v212, v212, v213
    v_mfma_f32_16x16x32_bf16 v[244:247], a[104:107], a[220:223], v[244:247]
    ds_read_b64_tr_b16 a[4:5], v17 offset:0
    v_cvt_pk_bf16_f32 v213, v214, v215
    v_mfma_f32_16x16x32_bf16 v[244:247], a[72:75], a[216:219], v[244:247]
    ds_read_b64_tr_b16 a[6:7], v17 offset:2048
    v_cvt_pk_bf16_f32 v214, v84, v85
    v_mfma_f32_16x16x32_bf16 v[112:115], a[68:71], a[216:219], v[112:115]
    buffer_store_dwordx4 v[168:171], v1, s[48:51], s87 offen offset:2048 sc1
    v_mfma_f32_16x16x32_bf16 v[112:115], a[100:103], a[220:223], v[112:115]
    v_cvt_pk_bf16_f32 v215, v86, v87
    v_cvt_pk_bf16_f32 v216, v216, v217
    v_mfma_f32_16x16x32_bf16 v[240:243], a[96:99], a[220:223], v[240:243]
    ds_read_b64_tr_b16 a[8:9], v18 offset:0
    v_cvt_pk_bf16_f32 v217, v218, v219
    v_cvt_pk_bf16_f32 v218, v88, v89
    v_cvt_pk_bf16_f32 v219, v90, v91
    v_cvt_pk_bf16_f32 v220, v220, v221
    v_cvt_pk_bf16_f32 v221, v222, v223
    v_cvt_pk_bf16_f32 v222, v92, v93
    v_mfma_f32_16x16x32_bf16 v[240:243], a[64:67], a[216:219], v[240:243]
    buffer_store_dwordx4 v[172:175], v1, s[48:51], s87 offen offset:3072 sc1
    s_add_u32 s87, s87, s16
    ds_read_b64_tr_b16 a[10:11], v18 offset:2048
    v_cvt_pk_bf16_f32 v223, v94, v95
    s_branch F_ph2_4
F_Ve_3:
    s_waitcnt lgkmcnt(0)
    v_mfma_f32_16x16x32_bf16 v[128:131], a[160:163], a[0:3], 0
    s_mov_b32 s39, 0x00020000
    v_mfma_f32_16x16x32_bf16 v[128:131], a[164:167], a[32:35], v[128:131]
    s_add_u32 s77, s86, s85
    s_mov_b32 s43, 0x00020000
    ds_read_b128 a[192:195], v8 offset:8192
    v_mfma_f32_16x16x32_bf16 v[132:135], a[164:167], a[36:39], 0
    s_mov_b32 s47, 0x00020000
    v_mfma_f32_16x16x32_bf16 v[132:135], a[160:163], a[4:7], v[132:135]
    s_add_u32 m0, s77, 0
    s_mov_b32 s51, 0x00020000
    ds_read_b128 a[196:199], v9 offset:8192
    v_mfma_f32_16x16x32_bf16 v[136:139], a[160:163], a[8:11], 0
    s_mov_b32 s71, 0x00020000
    v_mfma_f32_16x16x32_bf16 v[136:139], a[164:167], a[40:43], v[136:139]
    s_add_u32 s82, s67, 0
    s_mov_b32 s38, 1835008
    v_mfma_f32_16x16x32_bf16 v[140:143], a[164:167], a[44:47], 0
    s_mov_b32 s42, 3670016
    ds_read_b128 a[200:203], v8 offset:10240
    v_mfma_f32_16x16x32_bf16 v[140:143], a[160:163], a[12:15], v[140:143]
    s_mov_b32 s46, 1204224
    s_mov_b32 s50, 268435456
    v_mfma_f32_16x16x32_bf16 v[144:147], a[160:163], a[16:19], 0
    buffer_load_dwordx4 v3, s[32:35], s82 offen lds
    v_mfma_f32_16x16x32_bf16 v[144:147], a[164:167], a[48:51], v[144:147]
    s_add_u32 m0, s77, 8192
    s_mov_b32 s70, 896
    ds_read_b128 a[204:207], v9 offset:10240
    v_mfma_f32_16x16x32_bf16 v[148:151], a[164:167], a[52:55], 0
    s_mov_b64 s[36:37], s[4:5]
    s_mov_b64 s[40:41], s[8:9]
    v_mfma_f32_16x16x32_bf16 v[148:151], a[160:163], a[20:23], v[148:151]
    s_add_u32 s82, s67, 131072
    s_mov_b64 s[44:45], s[18:19]
    ds_read_b128 a[208:211], v8 offset:12288
    v_mfma_f32_16x16x32_bf16 v[152:155], a[160:163], a[24:27], 0
    s_mov_b64 s[48:49], s[26:27]
    v_mfma_f32_16x16x32_bf16 v[152:155], a[164:167], a[56:59], v[152:155]
    s_mov_b64 s[68:69], s[22:23]
    v_mfma_f32_16x16x32_bf16 v[156:159], a[164:167], a[60:63], 0
    s_mov_b64 s[18:19], s[14:15]
    ds_read_b128 a[212:215], v9 offset:12288
    v_mfma_f32_16x16x32_bf16 v[156:159], a[160:163], a[28:31], v[156:159]
    buffer_load_dwordx4 v3, s[32:35], s82 offen lds
    v_mfma_f32_16x16x32_bf16 a[156:159], a[168:171], a[28:31], 0
    s_add_u32 m0, s77, 16384
    s_mov_b64 s[0:1], s[20:21]
    ds_read_b128 a[216:219], v8 offset:14336
    v_mfma_f32_16x16x32_bf16 a[156:159], a[172:175], a[60:63], a[156:159]
    s_lshl_b32 s83, s75, 2
    v_and_b32 v26, 3, v0
    v_mfma_f32_16x16x32_bf16 a[152:155], a[172:175], a[56:59], 0
    s_add_u32 s82, s67, 262144
    v_add_u32 v26, s83, v26
    v_mfma_f32_16x16x32_bf16 a[152:155], a[168:171], a[24:27], a[152:155]
    ds_read_b128 a[220:223], v9 offset:14336
    v_min_u32 v26, 447, v26
    v_mfma_f32_16x16x32_bf16 a[148:151], a[168:171], a[20:23], 0
    v_lshrrev_b32 v27, 3, v26
    v_and_b32 v26, 7, v26
    v_mfma_f32_16x16x32_bf16 a[148:151], a[172:175], a[52:55], a[148:151]
    buffer_load_dwordx4 v3, s[32:35], s82 offen lds
    v_mfma_f32_16x16x32_bf16 a[144:147], a[172:175], a[48:51], 0
    s_add_u32 m0, s77, 24576
    v_xor_b32 v8, 0x8000, v8
    v_lshlrev_b32 v26, 7, v26
    v_mfma_f32_16x16x32_bf16 a[144:147], a[168:171], a[16:19], a[144:147]
    v_lshl_add_u32 v11, v27, 13, v26
    v_mfma_f32_16x16x32_bf16 a[140:143], a[168:171], a[12:15], 0
    s_and_b32 s84, s2, 7
    v_xor_b32 v9, 0x8000, v9
    v_mfma_f32_16x16x32_bf16 a[140:143], a[172:175], a[44:47], a[140:143]
    s_add_u32 s82, s67, 393216
    s_lshl_b32 s5, s84, 10
    v_mfma_f32_16x16x32_bf16 a[136:139], a[172:175], a[40:43], 0
    s_add_u32 s80, s80, 1
    s_mul_i32 s6, s84, 112
    v_mfma_f32_16x16x32_bf16 a[136:139], a[168:171], a[8:11], a[136:139]
    s_lshl_b32 s4, s2, 2
    s_add_u32 s4, s4, s60
    v_mfma_f32_16x16x32_bf16 a[132:135], a[168:171], a[4:7], 0
    buffer_load_dwordx4 v3, s[32:35], s82 offen lds
    v_mfma_f32_16x16x32_bf16 a[132:135], a[172:175], a[36:39], a[132:135]
    s_add_u32 m0, s77, 2048
    s_mul_i32 s4, s4, 1792
    v_min_u32 v10, 13, v0
    v_mfma_f32_16x16x32_bf16 a[128:131], a[172:175], a[32:35], 0
    s_cmp_eq_u32 s80, 3
    s_cselect_b32 s80, 0, s80
    s_cselect_b32 s79, 4294901760, s90
    v_mfma_f32_16x16x32_bf16 a[128:131], a[168:171], a[0:3], a[128:131]
    s_add_u32 s82, s67, 32768
    v_add_u32 v16, s79, v16
    v_lshlrev_b32 v10, 7, v10
    v_mfma_f32_16x16x32_bf16 v[160:163], a[176:179], a[0:3], 0
    s_sub_u32 s4, s4, 0
    v_mul_u32_u24 v12, 2688, v27
    v_mfma_f32_16x16x32_bf16 v[160:163], a[180:183], a[32:35], v[160:163]
    buffer_load_dwordx4 v3, s[32:35], s82 offen lds
    v_mfma_f32_16x16x32_bf16 v[164:167], a[180:183], a[36:39], 0
    v_add_u32 v17, s79, v17
    v_lshrrev_b32 v27, 8, v26
    v_mfma_f32_16x16x32_bf16 v[164:167], a[176:179], a[4:7], v[164:167]
    s_add_u32 m0, s77, 10240
    v_min_u32 v27, 2, v27
    v_mul_u32_u24 v27, 896, v27
    v_mfma_f32_16x16x32_bf16 v[168:171], a[176:179], a[8:11], 0
    v_add_u32 v18, s79, v18
    v_add_u32 v12, v12, v27
    v_mfma_f32_16x16x32_bf16 v[168:171], a[180:183], a[40:43], v[168:171]
    v_bfe_u32 v27, v26, 7, 1
    v_mfma_f32_16x16x32_bf16 v[172:175], a[180:183], a[44:47], 0
    s_add_u32 s82, s67, 163840
    v_mul_u32_u24 v27, 116, v27
    v_mfma_f32_16x16x32_bf16 v[172:175], a[176:179], a[12:15], v[172:175]
    v_add_u32 v19, s79, v19
    v_add_u32 v12, v12, v27
    v_mfma_f32_16x16x32_bf16 v[176:179], a[176:179], a[16:19], 0
    buffer_load_dwordx4 v3, s[32:35], s82 offen lds
    v_mfma_f32_16x16x32_bf16 v[176:179], a[180:183], a[48:51], v[176:179]
    s_mov_b64 s[8:9], s[36:37]
    s_mov_b32 s10, 0
    v_mfma_f32_16x16x32_bf16 v[180:183], a[180:183], a[52:55], 0
    s_add_u32 m0, s77, 18432
    s_mov_b32 s11, 0x00020000
    v_add_u32 v20, s79, v20
    v_mfma_f32_16x16x32_bf16 v[180:183], a[176:179], a[20:23], v[180:183]
    s_sub_u32 s4, s4, 67108864
    v_mfma_f32_16x16x32_bf16 v[184:187], a[176:179], a[24:27], 0
    s_add_u32 s82, s67, 294912
    s_mov_b64 s[12:13], s[40:41]
    v_add_u32 v21, s79, v21
    v_mfma_f32_16x16x32_bf16 v[184:187], a[180:183], a[56:59], v[184:187]
    s_mov_b32 s14, 0
    v_mfma_f32_16x16x32_bf16 v[188:191], a[180:183], a[60:63], 0
    s_mov_b32 s15, 0x00020000
    s_sub_u32 s5, s5, 1835008
    v_add_u32 v22, s79, v22
    v_mfma_f32_16x16x32_bf16 v[188:191], a[176:179], a[28:31], v[188:191]
    buffer_load_dwordx4 v3, s[32:35], s82 offen lds
    v_mfma_f32_16x16x32_bf16 v[60:63], a[184:187], a[28:31], 0
    s_mov_b64 s[20:21], s[44:45]
    v_mfma_f32_16x16x32_bf16 v[60:63], a[188:191], a[60:63], v[60:63]
    s_add_u32 m0, s77, 26624
    s_mov_b32 s22, 0
    v_add_u32 v23, s79, v23
    v_mfma_f32_16x16x32_bf16 v[56:59], a[188:191], a[56:59], 0
    s_mov_b32 s23, 0x00020000
    s_sub_u32 s6, s6, 602112
    v_mfma_f32_16x16x32_bf16 v[56:59], a[184:187], a[24:27], v[56:59]
    s_add_u32 s82, s67, 425984
    s_lshl_b32 s100, s2, 7
    v_mfma_f32_16x16x32_bf16 v[52:55], a[184:187], a[20:23], 0
    s_add_u32 s100, s100, 57671680
    v_mfma_f32_16x16x32_bf16 v[52:55], a[188:191], a[52:55], v[52:55]
    buffer_load_dwordx4 v3, s[32:35], s82 offen lds
    v_mfma_f32_16x16x32_bf16 v[48:51], a[188:191], a[48:51], 0
    s_and_b32 s101, s2, 0x87
    s_lshl_b32 s101, s101, 7
    v_mfma_f32_16x16x32_bf16 v[48:51], a[184:187], a[16:19], v[48:51]
    s_add_u32 s67, s67, 524288
    s_add_u32 s101, s101, 57671692
    v_mfma_f32_16x16x32_bf16 v[44:47], a[184:187], a[12:15], 0
    v_mov_b64 v[26:27], 0
    v_mfma_f32_16x16x32_bf16 v[44:47], a[188:191], a[44:47], v[44:47]
    s_add_u32 s86, s86, s90
    v_mov_b64 v[28:29], 0
    v_mfma_f32_16x16x32_bf16 v[40:43], a[188:191], a[40:43], 0
    v_lshlrev_b32 v1, 4, v0
    v_mfma_f32_16x16x32_bf16 v[40:43], a[184:187], a[8:11], v[40:43]
    s_cmp_eq_u32 s86, 163840
    s_cselect_b32 s86, 65536, s86
    v_mfma_f32_16x16x32_bf16 v[36:39], a[184:187], a[4:7], 0
    v_mfma_f32_16x16x32_bf16 v[36:39], a[188:191], a[36:39], v[36:39]
    buffer_store_dwordx4 v[26:29], v24, s[48:51], s100 offen sc1
    v_mfma_f32_16x16x32_bf16 v[32:35], a[188:191], a[32:35], 0
    buffer_store_dwordx4 v[26:29], v24, s[48:51], s100 offen offset:16 sc1
    v_mfma_f32_16x16x32_bf16 v[32:35], a[184:187], a[0:3], v[32:35]
    buffer_load_dword v13, v1, s[68:71], 0 offen
    s_waitcnt vmcnt(11) lgkmcnt(0)
    s_barrier
    v_mfma_f32_16x16x32_bf16 v[192:195], a[192:195], a[0:3], 0
    ds_read_b128 a[160:163], v8 offset:0
    v_mfma_f32_16x16x32_bf16 v[192:195], a[196:199], a[32:35], v[192:195]
    s_add_u32 m0, s76, 0
    ds_read_b128 a[164:167], v9 offset:0
    v_mfma_f32_16x16x32_bf16 v[196:199], a[196:199], a[36:39], 0
    v_mfma_f32_16x16x32_bf16 v[196:199], a[192:195], a[4:7], v[196:199]
    s_add_u32 s81, s66, 0
    ds_read_b64_tr_b16 a[64:65], v16 offset:0
    v_mfma_f32_16x16x32_bf16 v[200:203], a[192:195], a[8:11], 0
    ds_read_b64_tr_b16 a[66:67], v16 offset:2048
    v_mfma_f32_16x16x32_bf16 v[200:203], a[196:199], a[40:43], v[200:203]
    ds_read_b64_tr_b16 a[96:97], v16 offset:16384
    v_mfma_f32_16x16x32_bf16 v[204:207], a[196:199], a[44:47], 0
    buffer_load_dwordx4 v2, s[28:31], s81 offen lds
    v_mfma_f32_16x16x32_bf16 v[204:207], a[192:195], a[12:15], v[204:207]
    ds_read_b64_tr_b16 a[98:99], v16 offset:18432
    v_mfma_f32_16x16x32_bf16 v[208:211], a[192:195], a[16:19], 0
    s_add_u32 m0, s76, 4096
    ds_read_b64_tr_b16 a[68:69], v17 offset:0
    v_mfma_f32_16x16x32_bf16 v[208:211], a[196:199], a[48:51], v[208:211]
    ds_read_b64_tr_b16 a[70:71], v17 offset:2048
    v_mfma_f32_16x16x32_bf16 v[212:215], a[196:199], a[52:55], 0
    s_add_u32 s81, s66, 65536
    ds_read_b64_tr_b16 a[100:101], v17 offset:16384
    v_mfma_f32_16x16x32_bf16 v[212:215], a[192:195], a[20:23], v[212:215]
    v_mfma_f32_16x16x32_bf16 v[216:219], a[192:195], a[24:27], 0
    ds_read_b64_tr_b16 a[102:103], v17 offset:18432
    ds_read_b64_tr_b16 a[72:73], v18 offset:0
    v_mfma_f32_16x16x32_bf16 v[216:219], a[196:199], a[56:59], v[216:219]
    buffer_load_dwordx4 v2, s[28:31], s81 offen lds
    v_mfma_f32_16x16x32_bf16 v[220:223], a[196:199], a[60:63], 0
    ds_read_b64_tr_b16 a[74:75], v18 offset:2048
    v_mfma_f32_16x16x32_bf16 v[220:223], a[192:195], a[28:31], v[220:223]
    s_add_u32 m0, s76, 8192
    ds_read_b64_tr_b16 a[104:105], v18 offset:16384
    v_mfma_f32_16x16x32_bf16 v[92:95], a[200:203], a[28:31], 0
    v_mfma_f32_16x16x32_bf16 v[92:95], a[204:207], a[60:63], v[92:95]
    s_add_u32 s81, s66, 131072
    ds_read_b64_tr_b16 a[106:107], v18 offset:18432
    v_mfma_f32_16x16x32_bf16 v[88:91], a[204:207], a[56:59], 0
    ds_read_b64_tr_b16 a[76:77], v19 offset:0
    v_mfma_f32_16x16x32_bf16 v[88:91], a[200:203], a[24:27], v[88:91]
    ds_read_b64_tr_b16 a[78:79], v19 offset:2048
    v_mfma_f32_16x16x32_bf16 v[84:87], a[200:203], a[20:23], 0
    buffer_load_dwordx4 v2, s[28:31], s81 offen lds
    v_mfma_f32_16x16x32_bf16 v[84:87], a[204:207], a[52:55], v[84:87]
    ds_read_b64_tr_b16 a[108:109], v19 offset:16384
    v_mfma_f32_16x16x32_bf16 v[80:83], a[204:207], a[48:51], 0
    s_add_u32 m0, s76, 12288
    ds_read_b64_tr_b16 a[110:111], v19 offset:18432
    v_mfma_f32_16x16x32_bf16 v[80:83], a[200:203], a[16:19], v[80:83]
    ds_read_b64_tr_b16 a[80:81], v20 offset:0
    v_mfma_f32_16x16x32_bf16 v[76:79], a[200:203], a[12:15], 0
    s_add_u32 s81, s66, 196608
    ds_read_b64_tr_b16 a[82:83], v20 offset:2048
    v_mfma_f32_16x16x32_bf16 v[76:79], a[204:207], a[44:47], v[76:79]
    v_mfma_f32_16x16x32_bf16 v[72:75], a[204:207], a[40:43], 0
    ds_read_b64_tr_b16 a[112:113], v20 offset:16384
    ds_read_b64_tr_b16 a[114:115], v20 offset:18432
    v_mfma_f32_16x16x32_bf16 v[72:75], a[200:203], a[8:11], v[72:75]
    buffer_load_dwordx4 v2, s[28:31], s81 offen lds
    v_mfma_f32_16x16x32_bf16 v[68:71], a[200:203], a[4:7], 0
    ds_read_b64_tr_b16 a[84:85], v21 offset:0
    v_mfma_f32_16x16x32_bf16 v[68:71], a[204:207], a[36:39], v[68:71]
    s_add_u32 m0, s76, 16384
    ds_read_b64_tr_b16 a[86:87], v21 offset:2048
    v_mfma_f32_16x16x32_bf16 v[64:67], a[204:207], a[32:35], 0
    v_mfma_f32_16x16x32_bf16 v[64:67], a[200:203], a[0:3], v[64:67]
    s_add_u32 s81, s66, 262144
    ds_read_b64_tr_b16 a[116:117], v21 offset:16384
    v_mfma_f32_16x16x32_bf16 v[224:227], a[208:211], a[0:3], 0
    ds_read_b64_tr_b16 a[118:119], v21 offset:18432
    v_mfma_f32_16x16x32_bf16 v[224:227], a[212:215], a[32:35], v[224:227]
    ds_read_b64_tr_b16 a[88:89], v22 offset:0
    v_mfma_f32_16x16x32_bf16 v[228:231], a[212:215], a[36:39], 0
    buffer_load_dwordx4 v2, s[28:31], s81 offen lds
    v_mfma_f32_16x16x32_bf16 v[228:231], a[208:211], a[4:7], v[228:231]
    ds_read_b64_tr_b16 a[90:91], v22 offset:2048
    v_mfma_f32_16x16x32_bf16 v[232:235], a[208:211], a[8:11], 0
    s_add_u32 m0, s76, 20480
    ds_read_b64_tr_b16 a[120:121], v22 offset:16384
    v_mfma_f32_16x16x32_bf16 v[232:235], a[212:215], a[40:43], v[232:235]
    ds_read_b64_tr_b16 a[122:123], v22 offset:18432
    v_mfma_f32_16x16x32_bf16 v[236:239], a[212:215], a[44:47], 0
    s_add_u32 s81, s66, 327680
    ds_read_b64_tr_b16 a[92:93], v23 offset:0
    v_mfma_f32_16x16x32_bf16 v[236:239], a[208:211], a[12:15], v[236:239]
    v_mfma_f32_16x16x32_bf16 v[240:243], a[208:211], a[16:19], 0
    ds_read_b64_tr_b16 a[94:95], v23 offset:2048
    ds_read_b64_tr_b16 a[124:125], v23 offset:16384
    v_mfma_f32_16x16x32_bf16 v[240:243], a[212:215], a[48:51], v[240:243]
    buffer_load_dwordx4 v2, s[28:31], s81 offen lds
    v_mfma_f32_16x16x32_bf16 v[244:247], a[212:215], a[52:55], 0
    ds_read_b64_tr_b16 a[126:127], v23 offset:18432
    v_mfma_f32_16x16x32_bf16 v[244:247], a[208:211], a[20:23], v[244:247]
    s_add_u32 m0, s76, 24576
    ds_read_b128 a[168:171], v8 offset:2048
    v_mfma_f32_16x16x32_bf16 v[248:251], a[208:211], a[24:27], 0
    v_mfma_f32_16x16x32_bf16 v[248:251], a[212:215], a[56:59], v[248:251]
    s_add_u32 s81, s66, 393216
    ds_read_b128 a[172:175], v9 offset:2048
    v_mfma_f32_16x16x32_bf16 v[252:255], a[212:215], a[60:63], 0
    ds_read_b128 a[176:179], v8 offset:4096
    v_mfma_f32_16x16x32_bf16 v[252:255], a[208:211], a[28:31], v[252:255]
    ds_read_b128 a[180:183], v9 offset:4096
    v_mfma_f32_16x16x32_bf16 v[124:127], a[216:219], a[28:31], 0
    buffer_load_dwordx4 v2, s[28:31], s81 offen lds
    v_mfma_f32_16x16x32_bf16 v[124:127], a[220:223], a[60:63], v[124:127]
    ds_read_b128 a[184:187], v8 offset:6144
    v_mfma_f32_16x16x32_bf16 v[120:123], a[220:223], a[56:59], 0
    s_add_u32 m0, s76, 28672
    ds_read_b128 a[188:191], v9 offset:6144
    v_mfma_f32_16x16x32_bf16 v[120:123], a[216:219], a[24:27], v[120:123]
    v_mfma_f32_16x16x32_bf16 v[116:119], a[216:219], a[20:23], 0
    s_add_u32 s81, s66, 458752
    v_mfma_f32_16x16x32_bf16 v[116:119], a[220:223], a[52:55], v[116:119]
    v_mfma_f32_16x16x32_bf16 v[112:115], a[220:223], a[48:51], 0
    v_mfma_f32_16x16x32_bf16 v[112:115], a[216:219], a[16:19], v[112:115]
    buffer_load_dwordx4 v2, s[28:31], s81 offen lds
    v_mfma_f32_16x16x32_bf16 v[108:111], a[216:219], a[12:15], 0
    v_mfma_f32_16x16x32_bf16 v[108:111], a[220:223], a[44:47], v[108:111]
    s_add_u32 s66, s66, 128
    v_mfma_f32_16x16x32_bf16 v[104:107], a[220:223], a[40:43], 0
    v_mfma_f32_16x16x32_bf16 v[104:107], a[216:219], a[8:11], v[104:107]
    s_xor_b32 s76, s76, s90
    v_mfma_f32_16x16x32_bf16 v[100:103], a[216:219], a[4:7], 0
    v_mfma_f32_16x16x32_bf16 v[100:103], a[220:223], a[36:39], v[100:103]
    v_mfma_f32_16x16x32_bf16 v[96:99], a[220:223], a[32:35], 0
    v_mfma_f32_16x16x32_bf16 v[96:99], a[216:219], a[0:3], v[96:99]
    s_waitcnt lgkmcnt(0)
    v_mfma_f32_16x16x32_bf16 v[128:131], a[160:163], a[64:67], v[128:131]
    v_mfma_f32_16x16x32_bf16 v[128:131], a[164:167], a[96:99], v[128:131]
    s_add_u32 s77, s86, s85
    ds_read_b128 a[192:195], v8 offset:8192
    v_mfma_f32_16x16x32_bf16 v[132:135], a[164:167], a[100:103], v[132:135]
    v_mfma_f32_16x16x32_bf16 v[132:135], a[160:163], a[68:71], v[132:135]
    s_add_u32 m0, s77, 0
    ds_read_b128 a[196:199], v9 offset:8192
    v_mfma_f32_16x16x32_bf16 v[136:139], a[160:163], a[72:75], v[136:139]
    v_mfma_f32_16x16x32_bf16 v[136:139], a[164:167], a[104:107], v[136:139]
    s_add_u32 s82, s67, 0
    v_mfma_f32_16x16x32_bf16 v[140:143], a[164:167], a[108:111], v[140:143]
    ds_read_b128 a[200:203], v8 offset:10240
    v_mfma_f32_16x16x32_bf16 v[140:143], a[160:163], a[76:79], v[140:143]
    buffer_load_dwordx4 v3, s[32:35], s82 offen lds
    v_mfma_f32_16x16x32_bf16 v[144:147], a[160:163], a[80:83], v[144:147]
    ds_read_b128 a[204:207], v9 offset:10240
    v_mfma_f32_16x16x32_bf16 v[144:147], a[164:167], a[112:115], v[144:147]
    s_add_u32 m0, s77, 8192
    v_mfma_f32_16x16x32_bf16 v[148:151], a[164:167], a[116:119], v[148:151]
    v_mfma_f32_16x16x32_bf16 v[148:151], a[160:163], a[84:87], v[148:151]
    s_add_u32 s82, s67, 131072
    ds_read_b128 a[208:211], v8 offset:12288
    v_mfma_f32_16x16x32_bf16 v[152:155], a[160:163], a[88:91], v[152:155]
    v_mfma_f32_16x16x32_bf16 v[152:155], a[164:167], a[120:123], v[152:155]
    buffer_load_dwordx4 v3, s[32:35], s82 offen lds
    v_mfma_f32_16x16x32_bf16 v[156:159], a[164:167], a[124:127], v[156:159]
    ds_read_b128 a[212:215], v9 offset:12288
    v_mfma_f32_16x16x32_bf16 v[156:159], a[160:163], a[92:95], v[156:159]
    v_mfma_f32_16x16x32_bf16 a[156:159], a[168:171], a[92:95], a[156:159]
    s_add_u32 m0, s77, 16384
    ds_read_b128 a[216:219], v8 offset:14336
    v_mfma_f32_16x16x32_bf16 a[156:159], a[172:175], a[124:127], a[156:159]
    v_mfma_f32_16x16x32_bf16 a[152:155], a[172:175], a[120:123], a[152:155]
    s_add_u32 s82, s67, 262144
    v_mfma_f32_16x16x32_bf16 a[152:155], a[168:171], a[88:91], a[152:155]
    ds_read_b128 a[220:223], v9 offset:14336
    v_mfma_f32_16x16x32_bf16 a[148:151], a[168:171], a[84:87], a[148:151]
    buffer_load_dwordx4 v3, s[32:35], s82 offen lds
    v_mfma_f32_16x16x32_bf16 a[148:151], a[172:175], a[116:119], a[148:151]
    v_xor_b32 v8, 0x8000, v8
    v_mfma_f32_16x16x32_bf16 a[144:147], a[172:175], a[112:115], a[144:147]
    s_add_u32 m0, s77, 24576
    v_mfma_f32_16x16x32_bf16 a[144:147], a[168:171], a[80:83], a[144:147]
    v_mfma_f32_16x16x32_bf16 a[140:143], a[168:171], a[76:79], a[140:143]
    v_xor_b32 v9, 0x8000, v9
    v_mfma_f32_16x16x32_bf16 a[140:143], a[172:175], a[108:111], a[140:143]
    s_add_u32 s82, s67, 393216
    v_mfma_f32_16x16x32_bf16 a[136:139], a[172:175], a[104:107], a[136:139]
    s_add_u32 s80, s80, 1
    v_mfma_f32_16x16x32_bf16 a[136:139], a[168:171], a[72:75], a[136:139]
    buffer_load_dwordx4 v3, s[32:35], s82 offen lds
    v_mfma_f32_16x16x32_bf16 a[132:135], a[168:171], a[68:71], a[132:135]
    s_add_u32 m0, s77, 2048
    v_mfma_f32_16x16x32_bf16 a[132:135], a[172:175], a[100:103], a[132:135]
    s_cmp_eq_u32 s80, 3
    s_cselect_b32 s80, 0, s80
    s_cselect_b32 s79, 4294901760, s90
    v_mfma_f32_16x16x32_bf16 a[128:131], a[172:175], a[96:99], a[128:131]
    v_mfma_f32_16x16x32_bf16 a[128:131], a[168:171], a[64:67], a[128:131]
    s_add_u32 s82, s67, 32768
    v_add_u32 v16, s79, v16
    v_mfma_f32_16x16x32_bf16 v[160:163], a[176:179], a[64:67], v[160:163]
    v_mfma_f32_16x16x32_bf16 v[160:163], a[180:183], a[96:99], v[160:163]
    buffer_load_dwordx4 v3, s[32:35], s82 offen lds
    v_mfma_f32_16x16x32_bf16 v[164:167], a[180:183], a[100:103], v[164:167]
    v_add_u32 v17, s79, v17
    v_mfma_f32_16x16x32_bf16 v[164:167], a[176:179], a[68:71], v[164:167]
    s_add_u32 m0, s77, 10240
    v_mfma_f32_16x16x32_bf16 v[168:171], a[176:179], a[72:75], v[168:171]
    v_add_u32 v18, s79, v18
    v_mfma_f32_16x16x32_bf16 v[168:171], a[180:183], a[104:107], v[168:171]
    v_mfma_f32_16x16x32_bf16 v[172:175], a[180:183], a[108:111], v[172:175]
    s_add_u32 s82, s67, 163840
    v_mfma_f32_16x16x32_bf16 v[172:175], a[176:179], a[76:79], v[172:175]
    v_add_u32 v19, s79, v19
    v_mfma_f32_16x16x32_bf16 v[176:179], a[176:179], a[80:83], v[176:179]
    buffer_load_dwordx4 v3, s[32:35], s82 offen lds
    v_mfma_f32_16x16x32_bf16 v[176:179], a[180:183], a[112:115], v[176:179]
    v_mfma_f32_16x16x32_bf16 v[180:183], a[180:183], a[116:119], v[180:183]
    s_add_u32 m0, s77, 18432
    v_add_u32 v20, s79, v20
    v_mfma_f32_16x16x32_bf16 v[180:183], a[176:179], a[84:87], v[180:183]
    v_mfma_f32_16x16x32_bf16 v[184:187], a[176:179], a[88:91], v[184:187]
    s_add_u32 s82, s67, 294912
    v_add_u32 v21, s79, v21
    v_mfma_f32_16x16x32_bf16 v[184:187], a[180:183], a[120:123], v[184:187]
    v_mfma_f32_16x16x32_bf16 v[188:191], a[180:183], a[124:127], v[188:191]
    buffer_load_dwordx4 v3, s[32:35], s82 offen lds
    v_mfma_f32_16x16x32_bf16 v[188:191], a[176:179], a[92:95], v[188:191]
    v_add_u32 v22, s79, v22
    v_mfma_f32_16x16x32_bf16 v[60:63], a[184:187], a[92:95], v[60:63]
    v_mfma_f32_16x16x32_bf16 v[60:63], a[188:191], a[124:127], v[60:63]
    s_add_u32 m0, s77, 26624
    v_add_u32 v23, s79, v23
    v_mfma_f32_16x16x32_bf16 v[56:59], a[188:191], a[120:123], v[56:59]
    v_mfma_f32_16x16x32_bf16 v[56:59], a[184:187], a[88:91], v[56:59]
    s_add_u32 s82, s67, 425984
    v_mfma_f32_16x16x32_bf16 v[52:55], a[184:187], a[84:87], v[52:55]
    v_mfma_f32_16x16x32_bf16 v[52:55], a[188:191], a[116:119], v[52:55]
    buffer_load_dwordx4 v3, s[32:35], s82 offen lds
    v_mfma_f32_16x16x32_bf16 v[48:51], a[188:191], a[112:115], v[48:51]
    v_mfma_f32_16x16x32_bf16 v[48:51], a[184:187], a[80:83], v[48:51]
    s_add_u32 s67, s67, 524288
    v_mfma_f32_16x16x32_bf16 v[44:47], a[184:187], a[76:79], v[44:47]
    v_mfma_f32_16x16x32_bf16 v[44:47], a[188:191], a[108:111], v[44:47]
    s_add_u32 s86, s86, s90
    v_mfma_f32_16x16x32_bf16 v[40:43], a[188:191], a[104:107], v[40:43]
    v_mfma_f32_16x16x32_bf16 v[40:43], a[184:187], a[72:75], v[40:43]
    s_cmp_eq_u32 s86, 163840
    s_cselect_b32 s86, 65536, s86
    v_mfma_f32_16x16x32_bf16 v[36:39], a[184:187], a[68:71], v[36:39]
    v_mfma_f32_16x16x32_bf16 v[36:39], a[188:191], a[100:103], v[36:39]
    v_mfma_f32_16x16x32_bf16 v[32:35], a[188:191], a[96:99], v[32:35]
    v_mfma_f32_16x16x32_bf16 v[32:35], a[184:187], a[64:67], v[32:35]
    s_mov_b32 s78, 2
    s_waitcnt vmcnt(8) lgkmcnt(0)
    s_barrier
.p2align 6
F_loop_6:
    v_mfma_f32_16x16x32_bf16 v[192:195], a[192:195], a[64:67], v[192:195]
    s_add_u32 m0, s76, 0
    ds_read_b128 a[160:163], v8 offset:0
    v_mfma_f32_16x16x32_bf16 v[192:195], a[196:199], a[96:99], v[192:195]
    ds_read_b128 a[164:167], v9 offset:0
    v_mfma_f32_16x16x32_bf16 v[196:199], a[196:199], a[100:103], v[196:199]
    s_add_u32 s81, s66, 0
    v_mfma_f32_16x16x32_bf16 v[196:199], a[192:195], a[68:71], v[196:199]
    ds_read_b64_tr_b16 a[0:1], v16 offset:0
    v_mfma_f32_16x16x32_bf16 v[200:203], a[192:195], a[72:75], v[200:203]
    ds_read_b64_tr_b16 a[2:3], v16 offset:2048
    v_mfma_f32_16x16x32_bf16 v[200:203], a[196:199], a[104:107], v[200:203]
    buffer_load_dwordx4 v2, s[28:31], s81 offen lds
    v_mfma_f32_16x16x32_bf16 v[204:207], a[196:199], a[108:111], v[204:207]
    s_add_u32 m0, s76, 4096
    ds_read_b64_tr_b16 a[32:33], v16 offset:16384
    v_mfma_f32_16x16x32_bf16 v[204:207], a[192:195], a[76:79], v[204:207]
    ds_read_b64_tr_b16 a[34:35], v16 offset:18432
    v_mfma_f32_16x16x32_bf16 v[208:211], a[192:195], a[80:83], v[208:211]
    s_add_u32 s81, s66, 65536
    ds_read_b64_tr_b16 a[4:5], v17 offset:0
    v_mfma_f32_16x16x32_bf16 v[208:211], a[196:199], a[112:115], v[208:211]
    ds_read_b64_tr_b16 a[6:7], v17 offset:2048
    v_mfma_f32_16x16x32_bf16 v[212:215], a[196:199], a[116:119], v[212:215]
    buffer_load_dwordx4 v2, s[28:31], s81 offen lds
    v_mfma_f32_16x16x32_bf16 v[212:215], a[192:195], a[84:87], v[212:215]
    ds_read_b64_tr_b16 a[36:37], v17 offset:16384
    v_mfma_f32_16x16x32_bf16 v[216:219], a[192:195], a[88:91], v[216:219]
    s_add_u32 m0, s76, 8192
    ds_read_b64_tr_b16 a[38:39], v17 offset:18432
    v_mfma_f32_16x16x32_bf16 v[216:219], a[196:199], a[120:123], v[216:219]
    ds_read_b64_tr_b16 a[8:9], v18 offset:0
    v_mfma_f32_16x16x32_bf16 v[220:223], a[196:199], a[124:127], v[220:223]
    s_add_u32 s81, s66, 131072
    ds_read_b64_tr_b16 a[10:11], v18 offset:2048
    v_mfma_f32_16x16x32_bf16 v[220:223], a[192:195], a[92:95], v[220:223]
    ds_read_b64_tr_b16 a[40:41], v18 offset:16384
    v_mfma_f32_16x16x32_bf16 v[92:95], a[200:203], a[92:95], v[92:95]
    buffer_load_dwordx4 v2, s[28:31], s81 offen lds
    v_mfma_f32_16x16x32_bf16 v[92:95], a[204:207], a[124:127], v[92:95]
    ds_read_b64_tr_b16 a[42:43], v18 offset:18432
    v_mfma_f32_16x16x32_bf16 v[88:91], a[204:207], a[120:123], v[88:91]
    s_add_u32 m0, s76, 12288
    ds_read_b64_tr_b16 a[12:13], v19 offset:0
    v_mfma_f32_16x16x32_bf16 v[88:91], a[200:203], a[88:91], v[88:91]
    ds_read_b64_tr_b16 a[14:15], v19 offset:2048
    v_mfma_f32_16x16x32_bf16 v[84:87], a[200:203], a[84:87], v[84:87]
    s_add_u32 s81, s66, 196608
    v_mfma_f32_16x16x32_bf16 v[84:87], a[204:207], a[116:119], v[84:87]
    ds_read_b64_tr_b16 a[44:45], v19 offset:16384
    ds_read_b64_tr_b16 a[46:47], v19 offset:18432
    v_mfma_f32_16x16x32_bf16 v[80:83], a[204:207], a[112:115], v[80:83]
    buffer_load_dwordx4 v2, s[28:31], s81 offen lds
    v_mfma_f32_16x16x32_bf16 v[80:83], a[200:203], a[80:83], v[80:83]
    ds_read_b64_tr_b16 a[16:17], v20 offset:0
    v_mfma_f32_16x16x32_bf16 v[76:79], a[200:203], a[76:79], v[76:79]
    s_add_u32 m0, s76, 16384
    ds_read_b64_tr_b16 a[18:19], v20 offset:2048
    v_mfma_f32_16x16x32_bf16 v[76:79], a[204:207], a[108:111], v[76:79]
    v_mfma_f32_16x16x32_bf16 v[72:75], a[204:207], a[104:107], v[72:75]
    s_add_u32 s81, s66, 262144
    ds_read_b64_tr_b16 a[48:49], v20 offset:16384
    v_mfma_f32_16x16x32_bf16 v[72:75], a[200:203], a[72:75], v[72:75]
    ds_read_b64_tr_b16 a[50:51], v20 offset:18432
    v_mfma_f32_16x16x32_bf16 v[68:71], a[200:203], a[68:71], v[68:71]
    buffer_load_dwordx4 v2, s[28:31], s81 offen lds
    v_mfma_f32_16x16x32_bf16 v[68:71], a[204:207], a[100:103], v[68:71]
    ds_read_b64_tr_b16 a[20:21], v21 offset:0
    ds_read_b64_tr_b16 a[22:23], v21 offset:2048
    v_mfma_f32_16x16x32_bf16 v[64:67], a[204:207], a[96:99], v[64:67]
    s_add_u32 m0, s76, 20480
    v_mfma_f32_16x16x32_bf16 v[64:67], a[200:203], a[64:67], v[64:67]
    s_add_u32 s81, s66, 327680
    ds_read_b64_tr_b16 a[52:53], v21 offset:16384
    v_mfma_f32_16x16x32_bf16 v[224:227], a[208:211], a[64:67], v[224:227]
    ds_read_b64_tr_b16 a[54:55], v21 offset:18432
    v_mfma_f32_16x16x32_bf16 v[224:227], a[212:215], a[96:99], v[224:227]
    ds_read_b64_tr_b16 a[24:25], v22 offset:0
    v_mfma_f32_16x16x32_bf16 v[228:231], a[212:215], a[100:103], v[228:231]
    buffer_load_dwordx4 v2, s[28:31], s81 offen lds
    v_mfma_f32_16x16x32_bf16 v[228:231], a[208:211], a[68:71], v[228:231]
    s_add_u32 m0, s76, 24576
    ds_read_b64_tr_b16 a[26:27], v22 offset:2048
    v_mfma_f32_16x16x32_bf16 v[232:235], a[208:211], a[72:75], v[232:235]
    ds_read_b64_tr_b16 a[56:57], v22 offset:16384
    v_mfma_f32_16x16x32_bf16 v[232:235], a[212:215], a[104:107], v[232:235]
    s_add_u32 s81, s66, 393216
    ds_read_b64_tr_b16 a[58:59], v22 offset:18432
    v_mfma_f32_16x16x32_bf16 v[236:239], a[212:215], a[108:111], v[236:239]
    ds_read_b64_tr_b16 a[28:29], v23 offset:0
    v_mfma_f32_16x16x32_bf16 v[236:239], a[208:211], a[76:79], v[236:239]
    buffer_load_dwordx4 v2, s[28:31], s81 offen lds
    v_mfma_f32_16x16x32_bf16 v[240:243], a[208:211], a[80:83], v[240:243]
    ds_read_b64_tr_b16 a[30:31], v23 offset:2048
    v_mfma_f32_16x16x32_bf16 v[240:243], a[212:215], a[112:115], v[240:243]
    s_add_u32 m0, s76, 28672
    ds_read_b64_tr_b16 a[60:61], v23 offset:16384
    v_mfma_f32_16x16x32_bf16 v[244:247], a[212:215], a[116:119], v[244:247]
    ds_read_b64_tr_b16 a[62:63], v23 offset:18432
    v_mfma_f32_16x16x32_bf16 v[244:247], a[208:211], a[84:87], v[244:247]
    s_add_u32 s81, s66, 458752
    ds_read_b128 a[168:171], v8 offset:2048
    v_mfma_f32_16x16x32_bf16 v[248:251], a[208:211], a[88:91], v[248:251]
    v_mfma_f32_16x16x32_bf16 v[248:251], a[212:215], a[120:123], v[248:251]
    ds_read_b128 a[172:175], v9 offset:2048
    v_mfma_f32_16x16x32_bf16 v[252:255], a[212:215], a[124:127], v[252:255]
    buffer_load_dwordx4 v2, s[28:31], s81 offen lds
    v_mfma_f32_16x16x32_bf16 v[252:255], a[208:211], a[92:95], v[252:255]
    s_add_u32 s66, s66, 128
    ds_read_b128 a[176:179], v8 offset:4096
    ds_read_b128 a[180:183], v9 offset:4096
    v_mfma_f32_16x16x32_bf16 v[124:127], a[216:219], a[92:95], v[124:127]
    v_mfma_f32_16x16x32_bf16 v[124:127], a[220:223], a[124:127], v[124:127]
    s_xor_b32 s76, s76, s90
    ds_read_b128 a[184:187], v8 offset:6144
    v_mfma_f32_16x16x32_bf16 v[120:123], a[220:223], a[120:123], v[120:123]
    ds_read_b128 a[188:191], v9 offset:6144
    v_mfma_f32_16x16x32_bf16 v[120:123], a[216:219], a[88:91], v[120:123]
    s_cmp_eq_u32 s78, 6
    s_cselect_b32 s10, s38, s10
    s_cselect_b32 s14, s42, s14
    s_cselect_b32 s22, s46, s22
    v_mfma_f32_16x16x32_bf16 v[116:119], a[216:219], a[84:87], v[116:119]
    v_mfma_f32_16x16x32_bf16 v[116:119], a[220:223], a[116:119], v[116:119]
    buffer_load_dword v13, v10, s[8:11], s4 offen
    v_mfma_f32_16x16x32_bf16 v[112:115], a[220:223], a[112:115], v[112:115]
    v_mfma_f32_16x16x32_bf16 v[112:115], a[216:219], a[80:83], v[112:115]
    s_add_u32 s4, s4, 16777216
    v_mfma_f32_16x16x32_bf16 v[108:111], a[216:219], a[76:79], v[108:111]
    v_mfma_f32_16x16x32_bf16 v[108:111], a[220:223], a[108:111], v[108:111]
    buffer_load_dword v13, v11, s[12:15], s5 offen
    v_mfma_f32_16x16x32_bf16 v[104:107], a[220:223], a[104:107], v[104:107]
    v_mfma_f32_16x16x32_bf16 v[104:107], a[216:219], a[72:75], v[104:107]
    s_add_u32 s5, s5, 458752
    v_mfma_f32_16x16x32_bf16 v[100:103], a[216:219], a[68:71], v[100:103]
    v_mfma_f32_16x16x32_bf16 v[100:103], a[220:223], a[100:103], v[100:103]
    buffer_load_dword v13, v12, s[20:23], s6 offen
    v_mfma_f32_16x16x32_bf16 v[96:99], a[220:223], a[96:99], v[96:99]
    v_mfma_f32_16x16x32_bf16 v[96:99], a[216:219], a[64:67], v[96:99]
    s_add_u32 s6, s6, 150528
    s_waitcnt lgkmcnt(0)
    v_mfma_f32_16x16x32_bf16 v[128:131], a[160:163], a[0:3], v[128:131]
    v_mfma_f32_16x16x32_bf16 v[128:131], a[164:167], a[32:35], v[128:131]
    s_add_u32 s77, s86, s85
    ds_read_b128 a[192:195], v8 offset:8192
    v_mfma_f32_16x16x32_bf16 v[132:135], a[164:167], a[36:39], v[132:135]
    v_mfma_f32_16x16x32_bf16 v[132:135], a[160:163], a[4:7], v[132:135]
    s_add_u32 m0, s77, 0
    ds_read_b128 a[196:199], v9 offset:8192
    v_mfma_f32_16x16x32_bf16 v[136:139], a[160:163], a[8:11], v[136:139]
    v_mfma_f32_16x16x32_bf16 v[136:139], a[164:167], a[40:43], v[136:139]
    s_add_u32 s82, s67, 0
    v_mfma_f32_16x16x32_bf16 v[140:143], a[164:167], a[44:47], v[140:143]
    ds_read_b128 a[200:203], v8 offset:10240
    v_mfma_f32_16x16x32_bf16 v[140:143], a[160:163], a[12:15], v[140:143]
    buffer_load_dwordx4 v3, s[32:35], s82 offen lds
    v_mfma_f32_16x16x32_bf16 v[144:147], a[160:163], a[16:19], v[144:147]
    ds_read_b128 a[204:207], v9 offset:10240
    v_mfma_f32_16x16x32_bf16 v[144:147], a[164:167], a[48:51], v[144:147]
    s_add_u32 m0, s77, 8192
    v_mfma_f32_16x16x32_bf16 v[148:151], a[164:167], a[52:55], v[148:151]
    v_mfma_f32_16x16x32_bf16 v[148:151], a[160:163], a[20:23], v[148:151]
    s_add_u32 s82, s67, 131072
    ds_read_b128 a[208:211], v8 offset:12288
    v_mfma_f32_16x16x32_bf16 v[152:155], a[160:163], a[24:27], v[152:155]
    v_mfma_f32_16x16x32_bf16 v[152:155], a[164:167], a[56:59], v[152:155]
    buffer_load_dwordx4 v3, s[32:35], s82 offen lds
    v_mfma_f32_16x16x32_bf16 v[156:159], a[164:167], a[60:63], v[156:159]
    ds_read_b128 a[212:215], v9 offset:12288
    v_mfma_f32_16x16x32_bf16 v[156:159], a[160:163], a[28:31], v[156:159]
    v_mfma_f32_16x16x32_bf16 a[156:159], a[168:171], a[28:31], a[156:159]
    s_add_u32 m0, s77, 16384
    ds_read_b128 a[216:219], v8 offset:14336
    v_mfma_f32_16x16x32_bf16 a[156:159], a[172:175], a[60:63], a[156:159]
    v_mfma_f32_16x16x32_bf16 a[152:155], a[172:175], a[56:59], a[152:155]
    s_add_u32 s82, s67, 262144
    v_mfma_f32_16x16x32_bf16 a[152:155], a[168:171], a[24:27], a[152:155]
    ds_read_b128 a[220:223], v9 offset:14336
    v_mfma_f32_16x16x32_bf16 a[148:151], a[168:171], a[20:23], a[148:151]
    buffer_load_dwordx4 v3, s[32:35], s82 offen lds
    v_mfma_f32_16x16x32_bf16 a[148:151], a[172:175], a[52:55], a[148:151]
    v_xor_b32 v8, 0x8000, v8
    v_mfma_f32_16x16x32_bf16 a[144:147], a[172:175], a[48:51], a[144:147]
    s_add_u32 m0, s77, 24576
    v_mfma_f32_16x16x32_bf16 a[144:147], a[168:171], a[16:19], a[144:147]
    v_mfma_f32_16x16x32_bf16 a[140:143], a[168:171], a[12:15], a[140:143]
    v_xor_b32 v9, 0x8000, v9
    v_mfma_f32_16x16x32_bf16 a[140:143], a[172:175], a[44:47], a[140:143]
    s_add_u32 s82, s67, 393216
    v_mfma_f32_16x16x32_bf16 a[136:139], a[172:175], a[40:43], a[136:139]
    s_add_u32 s80, s80, 1
    v_mfma_f32_16x16x32_bf16 a[136:139], a[168:171], a[8:11], a[136:139]
    buffer_load_dwordx4 v3, s[32:35], s82 offen lds
    v_mfma_f32_16x16x32_bf16 a[132:135], a[168:171], a[4:7], a[132:135]
    s_add_u32 m0, s77, 2048
    v_mfma_f32_16x16x32_bf16 a[132:135], a[172:175], a[36:39], a[132:135]
    s_cmp_eq_u32 s80, 3
    s_cselect_b32 s80, 0, s80
    s_cselect_b32 s79, 4294901760, s90
    v_mfma_f32_16x16x32_bf16 a[128:131], a[172:175], a[32:35], a[128:131]
    v_mfma_f32_16x16x32_bf16 a[128:131], a[168:171], a[0:3], a[128:131]
    s_add_u32 s82, s67, 32768
    v_add_u32 v16, s79, v16
    v_mfma_f32_16x16x32_bf16 v[160:163], a[176:179], a[0:3], v[160:163]
    v_mfma_f32_16x16x32_bf16 v[160:163], a[180:183], a[32:35], v[160:163]
    buffer_load_dwordx4 v3, s[32:35], s82 offen lds
    v_mfma_f32_16x16x32_bf16 v[164:167], a[180:183], a[36:39], v[164:167]
    v_add_u32 v17, s79, v17
    v_mfma_f32_16x16x32_bf16 v[164:167], a[176:179], a[4:7], v[164:167]
    s_add_u32 m0, s77, 10240
    v_mfma_f32_16x16x32_bf16 v[168:171], a[176:179], a[8:11], v[168:171]
    v_add_u32 v18, s79, v18
    v_mfma_f32_16x16x32_bf16 v[168:171], a[180:183], a[40:43], v[168:171]
    v_mfma_f32_16x16x32_bf16 v[172:175], a[180:183], a[44:47], v[172:175]
    s_add_u32 s82, s67, 163840
    v_mfma_f32_16x16x32_bf16 v[172:175], a[176:179], a[12:15], v[172:175]
    v_add_u32 v19, s79, v19
    v_mfma_f32_16x16x32_bf16 v[176:179], a[176:179], a[16:19], v[176:179]
    buffer_load_dwordx4 v3, s[32:35], s82 offen lds
    v_mfma_f32_16x16x32_bf16 v[176:179], a[180:183], a[48:51], v[176:179]
    v_mfma_f32_16x16x32_bf16 v[180:183], a[180:183], a[52:55], v[180:183]
    s_add_u32 m0, s77, 18432
    v_add_u32 v20, s79, v20
    v_mfma_f32_16x16x32_bf16 v[180:183], a[176:179], a[20:23], v[180:183]
    v_mfma_f32_16x16x32_bf16 v[184:187], a[176:179], a[24:27], v[184:187]
    s_add_u32 s82, s67, 294912
    v_add_u32 v21, s79, v21
    v_mfma_f32_16x16x32_bf16 v[184:187], a[180:183], a[56:59], v[184:187]
    v_mfma_f32_16x16x32_bf16 v[188:191], a[180:183], a[60:63], v[188:191]
    buffer_load_dwordx4 v3, s[32:35], s82 offen lds
    v_mfma_f32_16x16x32_bf16 v[188:191], a[176:179], a[28:31], v[188:191]
    v_add_u32 v22, s79, v22
    v_mfma_f32_16x16x32_bf16 v[60:63], a[184:187], a[28:31], v[60:63]
    v_mfma_f32_16x16x32_bf16 v[60:63], a[188:191], a[60:63], v[60:63]
    s_add_u32 m0, s77, 26624
    v_add_u32 v23, s79, v23
    v_mfma_f32_16x16x32_bf16 v[56:59], a[188:191], a[56:59], v[56:59]
    v_mfma_f32_16x16x32_bf16 v[56:59], a[184:187], a[24:27], v[56:59]
    s_add_u32 s82, s67, 425984
    v_mfma_f32_16x16x32_bf16 v[52:55], a[184:187], a[20:23], v[52:55]
    v_mfma_f32_16x16x32_bf16 v[52:55], a[188:191], a[52:55], v[52:55]
    buffer_load_dwordx4 v3, s[32:35], s82 offen lds
    v_mfma_f32_16x16x32_bf16 v[48:51], a[188:191], a[48:51], v[48:51]
    v_mfma_f32_16x16x32_bf16 v[48:51], a[184:187], a[16:19], v[48:51]
    s_add_u32 s67, s67, 524288
    v_mfma_f32_16x16x32_bf16 v[44:47], a[184:187], a[12:15], v[44:47]
    v_mfma_f32_16x16x32_bf16 v[44:47], a[188:191], a[44:47], v[44:47]
    s_add_u32 s86, s86, s90
    v_mfma_f32_16x16x32_bf16 v[40:43], a[188:191], a[40:43], v[40:43]
    v_mfma_f32_16x16x32_bf16 v[40:43], a[184:187], a[8:11], v[40:43]
    s_cmp_eq_u32 s86, 163840
    s_cselect_b32 s86, 65536, s86
    v_mfma_f32_16x16x32_bf16 v[36:39], a[184:187], a[4:7], v[36:39]
    v_mfma_f32_16x16x32_bf16 v[36:39], a[188:191], a[36:39], v[36:39]
    v_mfma_f32_16x16x32_bf16 v[32:35], a[188:191], a[32:35], v[32:35]
    v_mfma_f32_16x16x32_bf16 v[32:35], a[184:187], a[0:3], v[32:35]
    s_add_u32 s78, s78, 1
    s_cmp_lt_u32 s78, 14
    s_waitcnt vmcnt(11) lgkmcnt(0)
    s_barrier
    v_mfma_f32_16x16x32_bf16 v[192:195], a[192:195], a[0:3], v[192:195]
    s_add_u32 m0, s76, 0
    ds_read_b128 a[160:163], v8 offset:0
    v_mfma_f32_16x16x32_bf16 v[192:195], a[196:199], a[32:35], v[192:195]
    ds_read_b128 a[164:167], v9 offset:0
    v_mfma_f32_16x16x32_bf16 v[196:199], a[196:199], a[36:39], v[196:199]
    s_add_u32 s81, s66, 0
    v_mfma_f32_16x16x32_bf16 v[196:199], a[192:195], a[4:7], v[196:199]
    ds_read_b64_tr_b16 a[64:65], v16 offset:0
    v_mfma_f32_16x16x32_bf16 v[200:203], a[192:195], a[8:11], v[200:203]
    ds_read_b64_tr_b16 a[66:67], v16 offset:2048
    v_mfma_f32_16x16x32_bf16 v[200:203], a[196:199], a[40:43], v[200:203]
    buffer_load_dwordx4 v2, s[28:31], s81 offen lds
    v_mfma_f32_16x16x32_bf16 v[204:207], a[196:199], a[44:47], v[204:207]
    s_add_u32 m0, s76, 4096
    ds_read_b64_tr_b16 a[96:97], v16 offset:16384
    v_mfma_f32_16x16x32_bf16 v[204:207], a[192:195], a[12:15], v[204:207]
    ds_read_b64_tr_b16 a[98:99], v16 offset:18432
    v_mfma_f32_16x16x32_bf16 v[208:211], a[192:195], a[16:19], v[208:211]
    s_add_u32 s81, s66, 65536
    ds_read_b64_tr_b16 a[68:69], v17 offset:0
    v_mfma_f32_16x16x32_bf16 v[208:211], a[196:199], a[48:51], v[208:211]
    ds_read_b64_tr_b16 a[70:71], v17 offset:2048
    v_mfma_f32_16x16x32_bf16 v[212:215], a[196:199], a[52:55], v[212:215]
    buffer_load_dwordx4 v2, s[28:31], s81 offen lds
    v_mfma_f32_16x16x32_bf16 v[212:215], a[192:195], a[20:23], v[212:215]
    ds_read_b64_tr_b16 a[100:101], v17 offset:16384
    v_mfma_f32_16x16x32_bf16 v[216:219], a[192:195], a[24:27], v[216:219]
    s_add_u32 m0, s76, 8192
    ds_read_b64_tr_b16 a[102:103], v17 offset:18432
    v_mfma_f32_16x16x32_bf16 v[216:219], a[196:199], a[56:59], v[216:219]
    ds_read_b64_tr_b16 a[72:73], v18 offset:0
    v_mfma_f32_16x16x32_bf16 v[220:223], a[196:199], a[60:63], v[220:223]
    s_add_u32 s81, s66, 131072
    ds_read_b64_tr_b16 a[74:75], v18 offset:2048
    v_mfma_f32_16x16x32_bf16 v[220:223], a[192:195], a[28:31], v[220:223]
    ds_read_b64_tr_b16 a[104:105], v18 offset:16384
    v_mfma_f32_16x16x32_bf16 v[92:95], a[200:203], a[28:31], v[92:95]
    buffer_load_dwordx4 v2, s[28:31], s81 offen lds
    v_mfma_f32_16x16x32_bf16 v[92:95], a[204:207], a[60:63], v[92:95]
    ds_read_b64_tr_b16 a[106:107], v18 offset:18432
    v_mfma_f32_16x16x32_bf16 v[88:91], a[204:207], a[56:59], v[88:91]
    s_add_u32 m0, s76, 12288
    ds_read_b64_tr_b16 a[76:77], v19 offset:0
    v_mfma_f32_16x16x32_bf16 v[88:91], a[200:203], a[24:27], v[88:91]
    ds_read_b64_tr_b16 a[78:79], v19 offset:2048
    v_mfma_f32_16x16x32_bf16 v[84:87], a[200:203], a[20:23], v[84:87]
    s_add_u32 s81, s66, 196608
    v_mfma_f32_16x16x32_bf16 v[84:87], a[204:207], a[52:55], v[84:87]
    ds_read_b64_tr_b16 a[108:109], v19 offset:16384
    ds_read_b64_tr_b16 a[110:111], v19 offset:18432
    v_mfma_f32_16x16x32_bf16 v[80:83], a[204:207], a[48:51], v[80:83]
    buffer_load_dwordx4 v2, s[28:31], s81 offen lds
    v_mfma_f32_16x16x32_bf16 v[80:83], a[200:203], a[16:19], v[80:83]
    ds_read_b64_tr_b16 a[80:81], v20 offset:0
    v_mfma_f32_16x16x32_bf16 v[76:79], a[200:203], a[12:15], v[76:79]
    s_add_u32 m0, s76, 16384
    ds_read_b64_tr_b16 a[82:83], v20 offset:2048
    v_mfma_f32_16x16x32_bf16 v[76:79], a[204:207], a[44:47], v[76:79]
    v_mfma_f32_16x16x32_bf16 v[72:75], a[204:207], a[40:43], v[72:75]
    s_add_u32 s81, s66, 262144
    ds_read_b64_tr_b16 a[112:113], v20 offset:16384
    v_mfma_f32_16x16x32_bf16 v[72:75], a[200:203], a[8:11], v[72:75]
    ds_read_b64_tr_b16 a[114:115], v20 offset:18432
    v_mfma_f32_16x16x32_bf16 v[68:71], a[200:203], a[4:7], v[68:71]
    buffer_load_dwordx4 v2, s[28:31], s81 offen lds
    v_mfma_f32_16x16x32_bf16 v[68:71], a[204:207], a[36:39], v[68:71]
    ds_read_b64_tr_b16 a[84:85], v21 offset:0
    ds_read_b64_tr_b16 a[86:87], v21 offset:2048
    v_mfma_f32_16x16x32_bf16 v[64:67], a[204:207], a[32:35], v[64:67]
    s_add_u32 m0, s76, 20480
    v_mfma_f32_16x16x32_bf16 v[64:67], a[200:203], a[0:3], v[64:67]
    s_add_u32 s81, s66, 327680
    ds_read_b64_tr_b16 a[116:117], v21 offset:16384
    v_mfma_f32_16x16x32_bf16 v[224:227], a[208:211], a[0:3], v[224:227]
    ds_read_b64_tr_b16 a[118:119], v21 offset:18432
    v_mfma_f32_16x16x32_bf16 v[224:227], a[212:215], a[32:35], v[224:227]
    ds_read_b64_tr_b16 a[88:89], v22 offset:0
    v_mfma_f32_16x16x32_bf16 v[228:231], a[212:215], a[36:39], v[228:231]
    buffer_load_dwordx4 v2, s[28:31], s81 offen lds
    v_mfma_f32_16x16x32_bf16 v[228:231], a[208:211], a[4:7], v[228:231]
    s_add_u32 m0, s76, 24576
    ds_read_b64_tr_b16 a[90:91], v22 offset:2048
    v_mfma_f32_16x16x32_bf16 v[232:235], a[208:211], a[8:11], v[232:235]
    ds_read_b64_tr_b16 a[120:121], v22 offset:16384
    v_mfma_f32_16x16x32_bf16 v[232:235], a[212:215], a[40:43], v[232:235]
    s_add_u32 s81, s66, 393216
    ds_read_b64_tr_b16 a[122:123], v22 offset:18432
    v_mfma_f32_16x16x32_bf16 v[236:239], a[212:215], a[44:47], v[236:239]
    ds_read_b64_tr_b16 a[92:93], v23 offset:0
    v_mfma_f32_16x16x32_bf16 v[236:239], a[208:211], a[12:15], v[236:239]
    buffer_load_dwordx4 v2, s[28:31], s81 offen lds
    v_mfma_f32_16x16x32_bf16 v[240:243], a[208:211], a[16:19], v[240:243]
    ds_read_b64_tr_b16 a[94:95], v23 offset:2048
    v_mfma_f32_16x16x32_bf16 v[240:243], a[212:215], a[48:51], v[240:243]
    s_add_u32 m0, s76, 28672
    ds_read_b64_tr_b16 a[124:125], v23 offset:16384
    v_mfma_f32_16x16x32_bf16 v[244:247], a[212:215], a[52:55], v[244:247]
    ds_read_b64_tr_b16 a[126:127], v23 offset:18432
    v_mfma_f32_16x16x32_bf16 v[244:247], a[208:211], a[20:23], v[244:247]
    s_add_u32 s81, s66, 458752
    ds_read_b128 a[168:171], v8 offset:2048
    v_mfma_f32_16x16x32_bf16 v[248:251], a[208:211], a[24:27], v[248:251]
    v_mfma_f32_16x16x32_bf16 v[248:251], a[212:215], a[56:59], v[248:251]
    ds_read_b128 a[172:175], v9 offset:2048
    v_mfma_f32_16x16x32_bf16 v[252:255], a[212:215], a[60:63], v[252:255]
    buffer_load_dwordx4 v2, s[28:31], s81 offen lds
    v_mfma_f32_16x16x32_bf16 v[252:255], a[208:211], a[28:31], v[252:255]
    s_add_u32 s66, s66, 128
    ds_read_b128 a[176:179], v8 offset:4096
    ds_read_b128 a[180:183], v9 offset:4096
    v_mfma_f32_16x16x32_bf16 v[124:127], a[216:219], a[28:31], v[124:127]
    v_mfma_f32_16x16x32_bf16 v[124:127], a[220:223], a[60:63], v[124:127]
    s_xor_b32 s76, s76, s90
    ds_read_b128 a[184:187], v8 offset:6144
    v_mfma_f32_16x16x32_bf16 v[120:123], a[220:223], a[56:59], v[120:123]
    ds_read_b128 a[188:191], v9 offset:6144
    v_mfma_f32_16x16x32_bf16 v[120:123], a[216:219], a[24:27], v[120:123]
    s_cmp_eq_u32 s78, 6
    s_cselect_b32 s10, s38, s10
    s_cselect_b32 s14, s42, s14
    s_cselect_b32 s22, s46, s22
    v_mfma_f32_16x16x32_bf16 v[116:119], a[216:219], a[20:23], v[116:119]
    v_mfma_f32_16x16x32_bf16 v[116:119], a[220:223], a[52:55], v[116:119]
    buffer_load_dword v13, v10, s[8:11], s4 offen
    v_mfma_f32_16x16x32_bf16 v[112:115], a[220:223], a[48:51], v[112:115]
    v_mfma_f32_16x16x32_bf16 v[112:115], a[216:219], a[16:19], v[112:115]
    s_add_u32 s4, s4, 16777216
    v_mfma_f32_16x16x32_bf16 v[108:111], a[216:219], a[12:15], v[108:111]
    v_mfma_f32_16x16x32_bf16 v[108:111], a[220:223], a[44:47], v[108:111]
    buffer_load_dword v13, v11, s[12:15], s5 offen
    v_mfma_f32_16x16x32_bf16 v[104:107], a[220:223], a[40:43], v[104:107]
    v_mfma_f32_16x16x32_bf16 v[104:107], a[216:219], a[8:11], v[104:107]
    s_add_u32 s5, s5, 458752
    v_mfma_f32_16x16x32_bf16 v[100:103], a[216:219], a[4:7], v[100:103]
    v_mfma_f32_16x16x32_bf16 v[100:103], a[220:223], a[36:39], v[100:103]
    buffer_load_dword v13, v12, s[20:23], s6 offen
    v_mfma_f32_16x16x32_bf16 v[96:99], a[220:223], a[32:35], v[96:99]
    v_mfma_f32_16x16x32_bf16 v[96:99], a[216:219], a[0:3], v[96:99]
    s_add_u32 s6, s6, 150528
    s_waitcnt lgkmcnt(0)
    v_mfma_f32_16x16x32_bf16 v[128:131], a[160:163], a[64:67], v[128:131]
    v_mfma_f32_16x16x32_bf16 v[128:131], a[164:167], a[96:99], v[128:131]
    s_add_u32 s77, s86, s85
    ds_read_b128 a[192:195], v8 offset:8192
    v_mfma_f32_16x16x32_bf16 v[132:135], a[164:167], a[100:103], v[132:135]
    v_mfma_f32_16x16x32_bf16 v[132:135], a[160:163], a[68:71], v[132:135]
    s_add_u32 m0, s77, 0
    ds_read_b128 a[196:199], v9 offset:8192
    v_mfma_f32_16x16x32_bf16 v[136:139], a[160:163], a[72:75], v[136:139]
    v_mfma_f32_16x16x32_bf16 v[136:139], a[164:167], a[104:107], v[136:139]
    s_add_u32 s82, s67, 0
    v_mfma_f32_16x16x32_bf16 v[140:143], a[164:167], a[108:111], v[140:143]
    ds_read_b128 a[200:203], v8 offset:10240
    v_mfma_f32_16x16x32_bf16 v[140:143], a[160:163], a[76:79], v[140:143]
    buffer_load_dwordx4 v3, s[32:35], s82 offen lds
    v_mfma_f32_16x16x32_bf16 v[144:147], a[160:163], a[80:83], v[144:147]
    ds_read_b128 a[204:207], v9 offset:10240
    v_mfma_f32_16x16x32_bf16 v[144:147], a[164:167], a[112:115], v[144:147]
    s_add_u32 m0, s77, 8192
    v_mfma_f32_16x16x32_bf16 v[148:151], a[164:167], a[116:119], v[148:151]
    v_mfma_f32_16x16x32_bf16 v[148:151], a[160:163], a[84:87], v[148:151]
    s_add_u32 s82, s67, 131072
    ds_read_b128 a[208:211], v8 offset:12288
    v_mfma_f32_16x16x32_bf16 v[152:155], a[160:163], a[88:91], v[152:155]
    v_mfma_f32_16x16x32_bf16 v[152:155], a[164:167], a[120:123], v[152:155]
    buffer_load_dwordx4 v3, s[32:35], s82 offen lds
    v_mfma_f32_16x16x32_bf16 v[156:159], a[164:167], a[124:127], v[156:159]
    ds_read_b128 a[212:215], v9 offset:12288
    v_mfma_f32_16x16x32_bf16 v[156:159], a[160:163], a[92:95], v[156:159]
    v_mfma_f32_16x16x32_bf16 a[156:159], a[168:171], a[92:95], a[156:159]
    s_add_u32 m0, s77, 16384
    ds_read_b128 a[216:219], v8 offset:14336
    v_mfma_f32_16x16x32_bf16 a[156:159], a[172:175], a[124:127], a[156:159]
    v_mfma_f32_16x16x32_bf16 a[152:155], a[172:175], a[120:123], a[152:155]
    s_add_u32 s82, s67, 262144
    v_mfma_f32_16x16x32_bf16 a[152:155], a[168:171], a[88:91], a[152:155]
    ds_read_b128 a[220:223], v9 offset:14336
    v_mfma_f32_16x16x32_bf16 a[148:151], a[168:171], a[84:87], a[148:151]
    buffer_load_dwordx4 v3, s[32:35], s82 offen lds
    v_mfma_f32_16x16x32_bf16 a[148:151], a[172:175], a[116:119], a[148:151]
    v_xor_b32 v8, 0x8000, v8
    v_mfma_f32_16x16x32_bf16 a[144:147], a[172:175], a[112:115], a[144:147]
    s_add_u32 m0, s77, 24576
    v_mfma_f32_16x16x32_bf16 a[144:147], a[168:171], a[80:83], a[144:147]
    v_mfma_f32_16x16x32_bf16 a[140:143], a[168:171], a[76:79], a[140:143]
    v_xor_b32 v9, 0x8000, v9
    v_mfma_f32_16x16x32_bf16 a[140:143], a[172:175], a[108:111], a[140:143]
    s_add_u32 s82, s67, 393216
    v_mfma_f32_16x16x32_bf16 a[136:139], a[172:175], a[104:107], a[136:139]
    s_add_u32 s80, s80, 1
    v_mfma_f32_16x16x32_bf16 a[136:139], a[168:171], a[72:75], a[136:139]
    buffer_load_dwordx4 v3, s[32:35], s82 offen lds
    v_mfma_f32_16x16x32_bf16 a[132:135], a[168:171], a[68:71], a[132:135]
    s_add_u32 m0, s77, 2048
    v_mfma_f32_16x16x32_bf16 a[132:135], a[172:175], a[100:103], a[132:135]
    s_cmp_eq_u32 s80, 3
    s_cselect_b32 s80, 0, s80
    s_cselect_b32 s79, 4294901760, s90
    v_mfma_f32_16x16x32_bf16 a[128:131], a[172:175], a[96:99], a[128:131]
    v_mfma_f32_16x16x32_bf16 a[128:131], a[168:171], a[64:67], a[128:131]
    s_add_u32 s82, s67, 32768
    v_add_u32 v16, s79, v16
    v_mfma_f32_16x16x32_bf16 v[160:163], a[176:179], a[64:67], v[160:163]
    v_mfma_f32_16x16x32_bf16 v[160:163], a[180:183], a[96:99], v[160:163]
    buffer_load_dwordx4 v3, s[32:35], s82 offen lds
    v_mfma_f32_16x16x32_bf16 v[164:167], a[180:183], a[100:103], v[164:167]
    v_add_u32 v17, s79, v17
    v_mfma_f32_16x16x32_bf16 v[164:167], a[176:179], a[68:71], v[164:167]
    s_add_u32 m0, s77, 10240
    v_mfma_f32_16x16x32_bf16 v[168:171], a[176:179], a[72:75], v[168:171]
    v_add_u32 v18, s79, v18
    v_mfma_f32_16x16x32_bf16 v[168:171], a[180:183], a[104:107], v[168:171]
    v_mfma_f32_16x16x32_bf16 v[172:175], a[180:183], a[108:111], v[172:175]
    s_add_u32 s82, s67, 163840
    v_mfma_f32_16x16x32_bf16 v[172:175], a[176:179], a[76:79], v[172:175]
    v_add_u32 v19, s79, v19
    v_mfma_f32_16x16x32_bf16 v[176:179], a[176:179], a[80:83], v[176:179]
    buffer_load_dwordx4 v3, s[32:35], s82 offen lds
    v_mfma_f32_16x16x32_bf16 v[176:179], a[180:183], a[112:115], v[176:179]
    v_mfma_f32_16x16x32_bf16 v[180:183], a[180:183], a[116:119], v[180:183]
    s_add_u32 m0, s77, 18432
    v_add_u32 v20, s79, v20
    v_mfma_f32_16x16x32_bf16 v[180:183], a[176:179], a[84:87], v[180:183]
    v_mfma_f32_16x16x32_bf16 v[184:187], a[176:179], a[88:91], v[184:187]
    s_add_u32 s82, s67, 294912
    v_add_u32 v21, s79, v21
    v_mfma_f32_16x16x32_bf16 v[184:187], a[180:183], a[120:123], v[184:187]
    v_mfma_f32_16x16x32_bf16 v[188:191], a[180:183], a[124:127], v[188:191]
    buffer_load_dwordx4 v3, s[32:35], s82 offen lds
    v_mfma_f32_16x16x32_bf16 v[188:191], a[176:179], a[92:95], v[188:191]
    v_add_u32 v22, s79, v22
    v_mfma_f32_16x16x32_bf16 v[60:63], a[184:187], a[92:95], v[60:63]
    v_mfma_f32_16x16x32_bf16 v[60:63], a[188:191], a[124:127], v[60:63]
    s_add_u32 m0, s77, 26624
    v_add_u32 v23, s79, v23
    v_mfma_f32_16x16x32_bf16 v[56:59], a[188:191], a[120:123], v[56:59]
    v_mfma_f32_16x16x32_bf16 v[56:59], a[184:187], a[88:91], v[56:59]
    s_add_u32 s82, s67, 425984
    v_mfma_f32_16x16x32_bf16 v[52:55], a[184:187], a[84:87], v[52:55]
    v_mfma_f32_16x16x32_bf16 v[52:55], a[188:191], a[116:119], v[52:55]
    buffer_load_dwordx4 v3, s[32:35], s82 offen lds
    v_mfma_f32_16x16x32_bf16 v[48:51], a[188:191], a[112:115], v[48:51]
    v_mfma_f32_16x16x32_bf16 v[48:51], a[184:187], a[80:83], v[48:51]
    s_add_u32 s67, s67, 524288
    v_mfma_f32_16x16x32_bf16 v[44:47], a[184:187], a[76:79], v[44:47]
    v_mfma_f32_16x16x32_bf16 v[44:47], a[188:191], a[108:111], v[44:47]
    s_add_u32 s86, s86, s90
    v_mfma_f32_16x16x32_bf16 v[40:43], a[188:191], a[104:107], v[40:43]
    v_mfma_f32_16x16x32_bf16 v[40:43], a[184:187], a[72:75], v[40:43]
    s_cmp_eq_u32 s86, 163840
    s_cselect_b32 s86, 65536, s86
    v_mfma_f32_16x16x32_bf16 v[36:39], a[184:187], a[68:71], v[36:39]
    v_mfma_f32_16x16x32_bf16 v[36:39], a[188:191], a[100:103], v[36:39]
    v_mfma_f32_16x16x32_bf16 v[32:35], a[188:191], a[96:99], v[32:35]
    v_mfma_f32_16x16x32_bf16 v[32:35], a[184:187], a[64:67], v[32:35]
    s_add_u32 s78, s78, 1
    s_cmp_lt_u32 s78, 14
    s_waitcnt vmcnt(11) lgkmcnt(0)
    s_barrier
    s_cbranch_scc1 F_loop_6
    v_mfma_f32_16x16x32_bf16 v[192:195], a[192:195], a[64:67], v[192:195]
    s_add_u32 m0, s76, 0
    s_lshl_b32 s73, s64, 9
    ds_read_b128 a[160:163], v8 offset:0
    v_mfma_f32_16x16x32_bf16 v[192:195], a[196:199], a[96:99], v[192:195]
    ds_read_b128 a[164:167], v9 offset:0
    v_mfma_f32_16x16x32_bf16 v[196:199], a[196:199], a[100:103], v[196:199]
    s_add_u32 s81, s66, 0
    v_lshrrev_b32 v26, 4, v0
    v_mfma_f32_16x16x32_bf16 v[196:199], a[192:195], a[68:71], v[196:199]
    s_lshl_b32 s83, s62, 2
    ds_read_b64_tr_b16 a[0:1], v16 offset:0
    ds_read_b64_tr_b16 a[2:3], v16 offset:2048
    v_mfma_f32_16x16x32_bf16 v[200:203], a[192:195], a[72:75], v[200:203]
    buffer_load_dwordx4 v2, s[28:31], s81 offen lds
    v_mfma_f32_16x16x32_bf16 v[200:203], a[196:199], a[104:107], v[200:203]
    s_add_u32 m0, s76, 4096
    ds_read_b64_tr_b16 a[32:33], v16 offset:16384
    v_or_b32 v27, s83, v26
    v_mfma_f32_16x16x32_bf16 v[204:207], a[196:199], a[108:111], v[204:207]
    v_lshlrev_b32 v27, 1, v27
    v_mfma_f32_16x16x32_bf16 v[204:207], a[192:195], a[76:79], v[204:207]
    s_add_u32 s81, s66, 65536
    ds_read_b64_tr_b16 a[34:35], v16 offset:18432
    v_and_b32 v28, 15, v0
    v_mfma_f32_16x16x32_bf16 v[208:211], a[192:195], a[80:83], v[208:211]
    ds_read_b64_tr_b16 a[4:5], v17 offset:0
    v_xor_b32 v27, v27, v28
    v_mfma_f32_16x16x32_bf16 v[208:211], a[196:199], a[112:115], v[208:211]
    buffer_load_dwordx4 v2, s[28:31], s81 offen lds
    v_mfma_f32_16x16x32_bf16 v[212:215], a[196:199], a[116:119], v[212:215]
    s_lshl_b32 s83, s62, 1
    ds_read_b64_tr_b16 a[6:7], v17 offset:2048
    ds_read_b64_tr_b16 a[36:37], v17 offset:16384
    v_mfma_f32_16x16x32_bf16 v[212:215], a[192:195], a[84:87], v[212:215]
    s_add_u32 m0, s76, 8192
    v_mfma_f32_16x16x32_bf16 v[216:219], a[192:195], a[88:91], v[216:219]
    s_add_u32 s81, s66, 131072
    s_add_u32 s83, s83, s61
    ds_read_b64_tr_b16 a[38:39], v17 offset:18432
    v_mfma_f32_16x16x32_bf16 v[216:219], a[196:199], a[120:123], v[216:219]
    s_lshl_b32 s84, s83, 2
    ds_read_b64_tr_b16 a[8:9], v18 offset:0
    v_mfma_f32_16x16x32_bf16 v[220:223], a[196:199], a[124:127], v[220:223]
    buffer_load_dwordx4 v2, s[28:31], s81 offen lds
    v_mfma_f32_16x16x32_bf16 v[220:223], a[192:195], a[92:95], v[220:223]
    s_add_u32 m0, s76, 12288
    ds_read_b64_tr_b16 a[10:11], v18 offset:2048
    v_add_u32 v26, s84, v26
    v_mfma_f32_16x16x32_bf16 v[92:95], a[200:203], a[92:95], v[92:95]
    s_lshl_b32 s89, s83, 10
    ds_read_b64_tr_b16 a[40:41], v18 offset:16384
    v_mfma_f32_16x16x32_bf16 v[92:95], a[204:207], a[124:127], v[92:95]
    s_add_u32 s81, s66, 196608
    ds_read_b64_tr_b16 a[42:43], v18 offset:18432
    v_mfma_f32_16x16x32_bf16 v[88:91], a[204:207], a[120:123], v[88:91]
    ds_read_b64_tr_b16 a[12:13], v19 offset:0
    v_lshrrev_b32 v28, 2, v27
    v_mfma_f32_16x16x32_bf16 v[88:91], a[200:203], a[88:91], v[88:91]
    buffer_load_dwordx4 v2, s[28:31], s81 offen lds
    v_mfma_f32_16x16x32_bf16 v[84:87], a[200:203], a[84:87], v[84:87]
    ds_read_b64_tr_b16 a[14:15], v19 offset:2048
    v_add_u32 v29, 1, v28
    v_mfma_f32_16x16x32_bf16 v[84:87], a[204:207], a[116:119], v[84:87]
    s_add_u32 m0, s76, 16384
    ds_read_b64_tr_b16 a[44:45], v19 offset:16384
    v_and_b32 v29, 4, v29
    v_mfma_f32_16x16x32_bf16 v[80:83], a[204:207], a[112:115], v[80:83]
    s_add_u32 s81, s66, 262144
    ds_read_b64_tr_b16 a[46:47], v19 offset:18432
    v_mul_u32_u24 v28, 896, v28
    v_mfma_f32_16x16x32_bf16 v[80:83], a[200:203], a[80:83], v[80:83]
    ds_read_b64_tr_b16 a[16:17], v20 offset:0
    v_lshl_add_u32 v28, v29, 28, v28
    v_mfma_f32_16x16x32_bf16 v[76:79], a[200:203], a[76:79], v[76:79]
    buffer_load_dwordx4 v2, s[28:31], s81 offen lds
    v_mfma_f32_16x16x32_bf16 v[76:79], a[204:207], a[108:111], v[76:79]
    ds_read_b64_tr_b16 a[18:19], v20 offset:2048
    v_and_b32 v27, 3, v27
    v_mfma_f32_16x16x32_bf16 v[72:75], a[204:207], a[104:107], v[72:75]
    s_add_u32 m0, s76, 20480
    ds_read_b64_tr_b16 a[48:49], v20 offset:16384
    v_lshl_add_u32 v28, v27, 4, v28
    v_mfma_f32_16x16x32_bf16 v[72:75], a[200:203], a[72:75], v[72:75]
    s_add_u32 s81, s66, 327680
    ds_read_b64_tr_b16 a[50:51], v20 offset:18432
    v_mfma_f32_16x16x32_bf16 v[68:71], a[200:203], a[68:71], v[68:71]
    ds_read_b64_tr_b16 a[20:21], v21 offset:0
    v_mul_u32_u24 v6, 2688, v26
    v_mfma_f32_16x16x32_bf16 v[68:71], a[204:207], a[100:103], v[68:71]
    buffer_load_dwordx4 v2, s[28:31], s81 offen lds
    v_mfma_f32_16x16x32_bf16 v[64:67], a[204:207], a[96:99], v[64:67]
    ds_read_b64_tr_b16 a[22:23], v21 offset:2048
    v_add_u32 v6, v6, v28
    v_mfma_f32_16x16x32_bf16 v[64:67], a[200:203], a[64:67], v[64:67]
    s_add_u32 m0, s76, 24576
    s_sub_u32 s83, 15, s63
    ds_read_b64_tr_b16 a[52:53], v21 offset:16384
    v_mfma_f32_16x16x32_bf16 v[224:227], a[208:211], a[64:67], v[224:227]
    s_cmp_eq_u32 s65, 1
    s_cselect_b32 s88, s83, s63
    ds_read_b64_tr_b16 a[54:55], v21 offset:18432
    v_mfma_f32_16x16x32_bf16 v[224:227], a[212:215], a[96:99], v[224:227]
    s_add_u32 s81, s66, 393216
    ds_read_b64_tr_b16 a[24:25], v22 offset:0
    v_mfma_f32_16x16x32_bf16 v[228:231], a[212:215], a[100:103], v[228:231]
    s_mul_i32 s72, s88, 114688
    ds_read_b64_tr_b16 a[26:27], v22 offset:2048
    v_mfma_f32_16x16x32_bf16 v[228:231], a[208:211], a[68:71], v[228:231]
    buffer_load_dwordx4 v2, s[28:31], s81 offen lds
    v_mfma_f32_16x16x32_bf16 v[232:235], a[208:211], a[72:75], v[232:235]
    s_add_u32 m0, s76, 28672
    s_mul_i32 s74, s64, 56
    ds_read_b64_tr_b16 a[56:57], v22 offset:16384
    v_mfma_f32_16x16x32_bf16 v[232:235], a[212:215], a[104:107], v[232:235]
    s_add_u32 s81, s66, 458752
    s_lshl_b32 s87, s64, 7
    ds_read_b64_tr_b16 a[58:59], v22 offset:18432
    v_mfma_f32_16x16x32_bf16 v[236:239], a[212:215], a[108:111], v[236:239]
    s_lshl_b32 s84, s63, 4
    ds_read_b64_tr_b16 a[28:29], v23 offset:0
    v_mfma_f32_16x16x32_bf16 v[236:239], a[208:211], a[76:79], v[236:239]
    buffer_load_dwordx4 v2, s[28:31], s81 offen lds
    v_mfma_f32_16x16x32_bf16 v[240:243], a[208:211], a[80:83], v[240:243]
    s_add_u32 s87, s87, s84
    ds_read_b64_tr_b16 a[30:31], v23 offset:2048
    v_mfma_f32_16x16x32_bf16 v[240:243], a[212:215], a[112:115], v[240:243]
    s_add_u32 s66, s66, 128
    s_lshl_b32 s84, s61, 3
    ds_read_b64_tr_b16 a[60:61], v23 offset:16384
    v_mfma_f32_16x16x32_bf16 v[244:247], a[212:215], a[116:119], v[244:247]
    s_xor_b32 s76, s76, s90
    s_add_u32 s87, s87, s84
    ds_read_b64_tr_b16 a[62:63], v23 offset:18432
    v_mfma_f32_16x16x32_bf16 v[244:247], a[208:211], a[84:87], v[244:247]
    ds_read_b128 a[168:171], v8 offset:2048
    v_mfma_f32_16x16x32_bf16 v[248:251], a[208:211], a[88:91], v[248:251]
    s_lshl_b32 s87, s87, 13
    v_and_b32 v25, 48, v0
    v_mfma_f32_16x16x32_bf16 v[248:251], a[212:215], a[120:123], v[248:251]
    s_add_u32 s83, s65, 12
    ds_read_b128 a[172:175], v9 offset:2048
    v_mfma_f32_16x16x32_bf16 v[252:255], a[212:215], a[124:127], v[252:255]
    s_mov_b64 s[8:9], s[68:69]
    ds_read_b128 a[176:179], v8 offset:4096
    v_mfma_f32_16x16x32_bf16 v[252:255], a[208:211], a[92:95], v[252:255]
    s_movk_i32 s10, 896
    s_lshl_b32 s84, s62, s83
    ds_read_b128 a[180:183], v9 offset:4096
    v_mfma_f32_16x16x32_bf16 v[124:127], a[216:219], a[92:95], v[124:127]
    s_add_u32 s87, s87, s84
    v_mfma_f32_16x16x32_bf16 v[124:127], a[220:223], a[124:127], v[124:127]
    s_mov_b32 s11, 0x00020000
    ds_read_b128 a[184:187], v8 offset:6144
    v_mfma_f32_16x16x32_bf16 v[120:123], a[220:223], a[120:123], v[120:123]
    s_lshl_b32 s84, s65, 24
    ds_read_b128 a[188:191], v9 offset:6144
    v_mfma_f32_16x16x32_bf16 v[120:123], a[216:219], a[88:91], v[120:123]
    buffer_load_dwordx4 a[252:255], v25, s[8:11], 0 offen offset:0
    v_mfma_f32_16x16x32_bf16 v[116:119], a[216:219], a[84:87], v[116:119]
    s_add_u32 s87, s87, s84
    s_lshl_b32 s84, s65, 12
    v_mfma_f32_16x16x32_bf16 v[116:119], a[220:223], a[116:119], v[116:119]
    buffer_load_dwordx4 a[248:251], v25, s[8:11], 0 offen offset:64
    v_mfma_f32_16x16x32_bf16 v[112:115], a[220:223], a[112:115], v[112:115]
    s_sub_u32 s16, 8192, s84
    v_mfma_f32_16x16x32_bf16 v[112:115], a[216:219], a[80:83], v[112:115]
    buffer_load_dwordx4 a[244:247], v25, s[8:11], 0 offen offset:128
    v_mfma_f32_16x16x32_bf16 v[108:111], a[216:219], a[76:79], v[108:111]
    s_add_u32 s17, 8192, s84
    s_lshl_b32 s91, s64, 7
    v_mfma_f32_16x16x32_bf16 v[108:111], a[220:223], a[108:111], v[108:111]
    buffer_load_dwordx4 a[240:243], v25, s[8:11], 0 offen offset:192
    v_mfma_f32_16x16x32_bf16 v[104:107], a[220:223], a[104:107], v[104:107]
    buffer_load_dwordx4 a[236:239], v25, s[8:11], 0 offen offset:256
    v_mfma_f32_16x16x32_bf16 v[104:107], a[216:219], a[72:75], v[104:107]
    s_lshl_b32 s84, s88, 3
    s_add_u32 s91, s91, s84
    v_mfma_f32_16x16x32_bf16 v[100:103], a[216:219], a[68:71], v[100:103]
    buffer_load_dwordx4 a[232:235], v25, s[8:11], 0 offen offset:320
    v_mfma_f32_16x16x32_bf16 v[100:103], a[220:223], a[100:103], v[100:103]
    buffer_load_dwordx4 a[228:231], v25, s[8:11], 0 offen offset:384
    v_mfma_f32_16x16x32_bf16 v[96:99], a[220:223], a[96:99], v[96:99]
    s_lshl_b32 s84, s60, 1
    s_add_u32 s91, s91, s84
    v_mfma_f32_16x16x32_bf16 v[96:99], a[216:219], a[64:67], v[96:99]
    buffer_load_dwordx4 a[224:227], v25, s[8:11], 0 offen offset:448
    s_waitcnt lgkmcnt(0)
    v_mfma_f32_16x16x32_bf16 v[128:131], a[160:163], a[0:3], v[128:131]
    v_mfma_f32_16x16x32_bf16 v[128:131], a[164:167], a[32:35], v[128:131]
    s_add_u32 s77, s86, s85
    ds_read_b128 a[192:195], v8 offset:8192
    v_mfma_f32_16x16x32_bf16 v[132:135], a[164:167], a[36:39], v[132:135]
    v_mfma_f32_16x16x32_bf16 v[132:135], a[160:163], a[4:7], v[132:135]
    s_add_u32 m0, s77, 0
    ds_read_b128 a[196:199], v9 offset:8192
    v_mfma_f32_16x16x32_bf16 v[136:139], a[160:163], a[8:11], v[136:139]
    v_mfma_f32_16x16x32_bf16 v[136:139], a[164:167], a[40:43], v[136:139]
    s_add_u32 s82, s73, 0
    v_mfma_f32_16x16x32_bf16 v[140:143], a[164:167], a[44:47], v[140:143]
    ds_read_b128 a[200:203], v8 offset:10240
    v_mfma_f32_16x16x32_bf16 v[140:143], a[160:163], a[12:15], v[140:143]
    buffer_load_dwordx4 v3, s[40:43], s82 offen lds
    v_mfma_f32_16x16x32_bf16 v[144:147], a[160:163], a[16:19], v[144:147]
    ds_read_b128 a[204:207], v9 offset:10240
    v_mfma_f32_16x16x32_bf16 v[144:147], a[164:167], a[48:51], v[144:147]
    s_add_u32 m0, s77, 8192
    v_mfma_f32_16x16x32_bf16 v[148:151], a[164:167], a[52:55], v[148:151]
    v_mfma_f32_16x16x32_bf16 v[148:151], a[160:163], a[20:23], v[148:151]
    s_add_u32 s82, s73, 131072
    ds_read_b128 a[208:211], v8 offset:12288
    v_mfma_f32_16x16x32_bf16 v[152:155], a[160:163], a[24:27], v[152:155]
    v_mfma_f32_16x16x32_bf16 v[152:155], a[164:167], a[56:59], v[152:155]
    buffer_load_dwordx4 v3, s[40:43], s82 offen lds
    v_mfma_f32_16x16x32_bf16 v[156:159], a[164:167], a[60:63], v[156:159]
    ds_read_b128 a[212:215], v9 offset:12288
    v_mfma_f32_16x16x32_bf16 v[156:159], a[160:163], a[28:31], v[156:159]
    v_mfma_f32_16x16x32_bf16 a[156:159], a[168:171], a[28:31], a[156:159]
    s_add_u32 m0, s77, 16384
    ds_read_b128 a[216:219], v8 offset:14336
    v_mfma_f32_16x16x32_bf16 a[156:159], a[172:175], a[60:63], a[156:159]
    v_mfma_f32_16x16x32_bf16 a[152:155], a[172:175], a[56:59], a[152:155]
    s_add_u32 s82, s73, 262144
    v_mfma_f32_16x16x32_bf16 a[152:155], a[168:171], a[24:27], a[152:155]
    ds_read_b128 a[220:223], v9 offset:14336
    v_mfma_f32_16x16x32_bf16 a[148:151], a[168:171], a[20:23], a[148:151]
    buffer_load_dwordx4 v3, s[40:43], s82 offen lds
    v_mfma_f32_16x16x32_bf16 a[148:151], a[172:175], a[52:55], a[148:151]
    v_xor_b32 v8, 0x8000, v8
    v_mfma_f32_16x16x32_bf16 a[144:147], a[172:175], a[48:51], a[144:147]
    s_add_u32 m0, s77, 24576
    v_mfma_f32_16x16x32_bf16 a[144:147], a[168:171], a[16:19], a[144:147]
    v_mfma_f32_16x16x32_bf16 a[140:143], a[168:171], a[12:15], a[140:143]
    v_xor_b32 v9, 0x8000, v9
    v_mfma_f32_16x16x32_bf16 a[140:143], a[172:175], a[44:47], a[140:143]
    s_add_u32 s82, s73, 393216
    v_mfma_f32_16x16x32_bf16 a[136:139], a[172:175], a[40:43], a[136:139]
    s_add_u32 s80, s80, 1
    v_mfma_f32_16x16x32_bf16 a[136:139], a[168:171], a[8:11], a[136:139]
    buffer_load_dwordx4 v3, s[40:43], s82 offen lds
    v_mfma_f32_16x16x32_bf16 a[132:135], a[168:171], a[4:7], a[132:135]
    s_add_u32 m0, s77, 2048
    v_mfma_f32_16x16x32_bf16 a[132:135], a[172:175], a[36:39], a[132:135]
    s_cmp_eq_u32 s80, 3
    s_cselect_b32 s80, 0, s80
    s_cselect_b32 s79, 4294901760, s90
    v_mfma_f32_16x16x32_bf16 a[128:131], a[172:175], a[32:35], a[128:131]
    v_mfma_f32_16x16x32_bf16 a[128:131], a[168:171], a[0:3], a[128:131]
    s_add_u32 s82, s73, 32768
    v_add_u32 v16, s79, v16
    v_mfma_f32_16x16x32_bf16 v[160:163], a[176:179], a[0:3], v[160:163]
    v_mfma_f32_16x16x32_bf16 v[160:163], a[180:183], a[32:35], v[160:163]
    buffer_load_dwordx4 v3, s[40:43], s82 offen lds
    v_mfma_f32_16x16x32_bf16 v[164:167], a[180:183], a[36:39], v[164:167]
    v_add_u32 v17, s79, v17
    v_mfma_f32_16x16x32_bf16 v[164:167], a[176:179], a[4:7], v[164:167]
    s_add_u32 m0, s77, 10240
    v_mfma_f32_16x16x32_bf16 v[168:171], a[176:179], a[8:11], v[168:171]
    v_add_u32 v18, s79, v18
    v_mfma_f32_16x16x32_bf16 v[168:171], a[180:183], a[40:43], v[168:171]
    v_mfma_f32_16x16x32_bf16 v[172:175], a[180:183], a[44:47], v[172:175]
    s_add_u32 s82, s73, 163840
    v_mfma_f32_16x16x32_bf16 v[172:175], a[176:179], a[12:15], v[172:175]
    v_add_u32 v19, s79, v19
    v_mfma_f32_16x16x32_bf16 v[176:179], a[176:179], a[16:19], v[176:179]
    buffer_load_dwordx4 v3, s[40:43], s82 offen lds
    v_mfma_f32_16x16x32_bf16 v[176:179], a[180:183], a[48:51], v[176:179]
    v_mfma_f32_16x16x32_bf16 v[180:183], a[180:183], a[52:55], v[180:183]
    s_add_u32 m0, s77, 18432
    v_add_u32 v20, s79, v20
    v_mfma_f32_16x16x32_bf16 v[180:183], a[176:179], a[20:23], v[180:183]
    v_mfma_f32_16x16x32_bf16 v[184:187], a[176:179], a[24:27], v[184:187]
    s_add_u32 s82, s73, 294912
    v_add_u32 v21, s79, v21
    v_mfma_f32_16x16x32_bf16 v[184:187], a[180:183], a[56:59], v[184:187]
    v_mfma_f32_16x16x32_bf16 v[188:191], a[180:183], a[60:63], v[188:191]
    buffer_load_dwordx4 v3, s[40:43], s82 offen lds
    v_mfma_f32_16x16x32_bf16 v[188:191], a[176:179], a[28:31], v[188:191]
    v_add_u32 v22, s79, v22
    v_mfma_f32_16x16x32_bf16 v[60:63], a[184:187], a[28:31], v[60:63]
    v_mfma_f32_16x16x32_bf16 v[60:63], a[188:191], a[60:63], v[60:63]
    s_add_u32 m0, s77, 26624
    v_add_u32 v23, s79, v23
    v_mfma_f32_16x16x32_bf16 v[56:59], a[188:191], a[56:59], v[56:59]
    v_mfma_f32_16x16x32_bf16 v[56:59], a[184:187], a[24:27], v[56:59]
    s_add_u32 s82, s73, 425984
    v_mfma_f32_16x16x32_bf16 v[52:55], a[184:187], a[20:23], v[52:55]
    v_mfma_f32_16x16x32_bf16 v[52:55], a[188:191], a[52:55], v[52:55]
    buffer_load_dwordx4 v3, s[40:43], s82 offen lds
    v_mfma_f32_16x16x32_bf16 v[48:51], a[188:191], a[48:51], v[48:51]
    v_mfma_f32_16x16x32_bf16 v[48:51], a[184:187], a[16:19], v[48:51]
    s_add_u32 s73, s73, 524288
    v_mfma_f32_16x16x32_bf16 v[44:47], a[184:187], a[12:15], v[44:47]
    v_mfma_f32_16x16x32_bf16 v[44:47], a[188:191], a[44:47], v[44:47]
    s_add_u32 s86, s86, s90
    v_mfma_f32_16x16x32_bf16 v[40:43], a[188:191], a[40:43], v[40:43]
    v_mfma_f32_16x16x32_bf16 v[40:43], a[184:187], a[8:11], v[40:43]
    s_cmp_eq_u32 s86, 163840
    s_cselect_b32 s86, 65536, s86
    v_mfma_f32_16x16x32_bf16 v[36:39], a[184:187], a[4:7], v[36:39]
    v_mfma_f32_16x16x32_bf16 v[36:39], a[188:191], a[36:39], v[36:39]
    v_mfma_f32_16x16x32_bf16 v[32:35], a[188:191], a[32:35], v[32:35]
    v_mfma_f32_16x16x32_bf16 v[32:35], a[184:187], a[0:3], v[32:35]
    s_waitcnt vmcnt(16) lgkmcnt(0)
    s_barrier
    v_mfma_f32_16x16x32_bf16 v[192:195], a[192:195], a[0:3], v[192:195]
    s_add_u32 m0, s76, 0
    ds_read_b128 a[160:163], v8 offset:0
    v_mfma_f32_16x16x32_bf16 v[192:195], a[196:199], a[32:35], v[192:195]
    ds_read_b128 a[164:167], v9 offset:0
    v_mfma_f32_16x16x32_bf16 v[196:199], a[196:199], a[36:39], v[196:199]
    s_add_u32 s81, s72, 0
    v_mfma_f32_16x16x32_bf16 v[196:199], a[192:195], a[4:7], v[196:199]
    ds_read_b64_tr_b16 a[64:65], v16 offset:0
    v_mfma_f32_16x16x32_bf16 v[200:203], a[192:195], a[8:11], v[200:203]
    ds_read_b64_tr_b16 a[66:67], v16 offset:2048
    v_mfma_f32_16x16x32_bf16 v[200:203], a[196:199], a[40:43], v[200:203]
    buffer_load_dwordx4 v4, s[36:39], s81 offen lds
    v_mfma_f32_16x16x32_bf16 v[204:207], a[196:199], a[44:47], v[204:207]
    s_add_u32 m0, s76, 4096
    ds_read_b64_tr_b16 a[96:97], v16 offset:16384
    v_mfma_f32_16x16x32_bf16 v[204:207], a[192:195], a[12:15], v[204:207]
    ds_read_b64_tr_b16 a[98:99], v16 offset:18432
    v_mfma_f32_16x16x32_bf16 v[208:211], a[192:195], a[16:19], v[208:211]
    s_add_u32 s81, s72, 28672
    ds_read_b64_tr_b16 a[68:69], v17 offset:0
    v_mfma_f32_16x16x32_bf16 v[208:211], a[196:199], a[48:51], v[208:211]
    ds_read_b64_tr_b16 a[70:71], v17 offset:2048
    v_mfma_f32_16x16x32_bf16 v[212:215], a[196:199], a[52:55], v[212:215]
    buffer_load_dwordx4 v4, s[36:39], s81 offen lds
    v_mfma_f32_16x16x32_bf16 v[212:215], a[192:195], a[20:23], v[212:215]
    ds_read_b64_tr_b16 a[100:101], v17 offset:16384
    v_mfma_f32_16x16x32_bf16 v[216:219], a[192:195], a[24:27], v[216:219]
    s_add_u32 m0, s76, 8192
    ds_read_b64_tr_b16 a[102:103], v17 offset:18432
    v_mfma_f32_16x16x32_bf16 v[216:219], a[196:199], a[56:59], v[216:219]
    ds_read_b64_tr_b16 a[72:73], v18 offset:0
    v_mfma_f32_16x16x32_bf16 v[220:223], a[196:199], a[60:63], v[220:223]
    s_add_u32 s81, s72, 57344
    ds_read_b64_tr_b16 a[74:75], v18 offset:2048
    v_mfma_f32_16x16x32_bf16 v[220:223], a[192:195], a[28:31], v[220:223]
    ds_read_b64_tr_b16 a[104:105], v18 offset:16384
    v_mfma_f32_16x16x32_bf16 v[92:95], a[200:203], a[28:31], v[92:95]
    buffer_load_dwordx4 v4, s[36:39], s81 offen lds
    v_mfma_f32_16x16x32_bf16 v[92:95], a[204:207], a[60:63], v[92:95]
    ds_read_b64_tr_b16 a[106:107], v18 offset:18432
    v_mfma_f32_16x16x32_bf16 v[88:91], a[204:207], a[56:59], v[88:91]
    s_add_u32 m0, s76, 12288
    ds_read_b64_tr_b16 a[76:77], v19 offset:0
    v_mfma_f32_16x16x32_bf16 v[88:91], a[200:203], a[24:27], v[88:91]
    ds_read_b64_tr_b16 a[78:79], v19 offset:2048
    v_mfma_f32_16x16x32_bf16 v[84:87], a[200:203], a[20:23], v[84:87]
    s_add_u32 s81, s72, 86016
    v_mfma_f32_16x16x32_bf16 v[84:87], a[204:207], a[52:55], v[84:87]
    ds_read_b64_tr_b16 a[108:109], v19 offset:16384
    ds_read_b64_tr_b16 a[110:111], v19 offset:18432
    v_mfma_f32_16x16x32_bf16 v[80:83], a[204:207], a[48:51], v[80:83]
    buffer_load_dwordx4 v4, s[36:39], s81 offen lds
    v_mfma_f32_16x16x32_bf16 v[80:83], a[200:203], a[16:19], v[80:83]
    ds_read_b64_tr_b16 a[80:81], v20 offset:0
    v_mfma_f32_16x16x32_bf16 v[76:79], a[200:203], a[12:15], v[76:79]
    s_add_u32 m0, s89, 16384
    ds_read_b64_tr_b16 a[82:83], v20 offset:2048
    v_mfma_f32_16x16x32_bf16 v[76:79], a[204:207], a[44:47], v[76:79]
    v_mfma_f32_16x16x32_bf16 v[72:75], a[204:207], a[40:43], v[72:75]
    s_add_u32 s81, s74, 0
    ds_read_b64_tr_b16 a[112:113], v20 offset:16384
    v_mfma_f32_16x16x32_bf16 v[72:75], a[200:203], a[8:11], v[72:75]
    ds_read_b64_tr_b16 a[114:115], v20 offset:18432
    v_mfma_f32_16x16x32_bf16 v[68:71], a[200:203], a[4:7], v[68:71]
    buffer_load_dwordx4 v6, s[44:47], s81 offen lds
    v_mfma_f32_16x16x32_bf16 v[68:71], a[204:207], a[36:39], v[68:71]
    ds_read_b64_tr_b16 a[84:85], v21 offset:0
    ds_read_b64_tr_b16 a[86:87], v21 offset:2048
    v_mfma_f32_16x16x32_bf16 v[64:67], a[204:207], a[32:35], v[64:67]
    s_add_u32 m0, s89, 20480
    v_mfma_f32_16x16x32_bf16 v[64:67], a[200:203], a[0:3], v[64:67]
    s_add_u32 s81, s74, 43008
    ds_read_b64_tr_b16 a[116:117], v21 offset:16384
    v_mfma_f32_16x16x32_bf16 v[224:227], a[208:211], a[0:3], v[224:227]
    ds_read_b64_tr_b16 a[118:119], v21 offset:18432
    v_mfma_f32_16x16x32_bf16 v[224:227], a[212:215], a[32:35], v[224:227]
    ds_read_b64_tr_b16 a[88:89], v22 offset:0
    v_mfma_f32_16x16x32_bf16 v[228:231], a[212:215], a[36:39], v[228:231]
    buffer_load_dwordx4 v6, s[44:47], s81 offen lds
    v_mfma_f32_16x16x32_bf16 v[228:231], a[208:211], a[4:7], v[228:231]
    s_add_u32 m0, s89, 24576
    ds_read_b64_tr_b16 a[90:91], v22 offset:2048
    v_mfma_f32_16x16x32_bf16 v[232:235], a[208:211], a[8:11], v[232:235]
    ds_read_b64_tr_b16 a[120:121], v22 offset:16384
    v_mfma_f32_16x16x32_bf16 v[232:235], a[212:215], a[40:43], v[232:235]
    s_add_u32 s81, s74, 86016
    ds_read_b64_tr_b16 a[122:123], v22 offset:18432
    v_mfma_f32_16x16x32_bf16 v[236:239], a[212:215], a[44:47], v[236:239]
    ds_read_b64_tr_b16 a[92:93], v23 offset:0
    v_mfma_f32_16x16x32_bf16 v[236:239], a[208:211], a[12:15], v[236:239]
    buffer_load_dwordx4 v6, s[44:47], s81 offen lds
    v_mfma_f32_16x16x32_bf16 v[240:243], a[208:211], a[16:19], v[240:243]
    ds_read_b64_tr_b16 a[94:95], v23 offset:2048
    v_mfma_f32_16x16x32_bf16 v[240:243], a[212:215], a[48:51], v[240:243]
    s_add_u32 m0, s89, 28672
    ds_read_b64_tr_b16 a[124:125], v23 offset:16384
    v_mfma_f32_16x16x32_bf16 v[244:247], a[212:215], a[52:55], v[244:247]
    ds_read_b64_tr_b16 a[126:127], v23 offset:18432
    v_mfma_f32_16x16x32_bf16 v[244:247], a[208:211], a[20:23], v[244:247]
    s_add_u32 s81, s74, 129024
    ds_read_b128 a[168:171], v8 offset:2048
    v_mfma_f32_16x16x32_bf16 v[248:251], a[208:211], a[24:27], v[248:251]
    v_mfma_f32_16x16x32_bf16 v[248:251], a[212:215], a[56:59], v[248:251]
    ds_read_b128 a[172:175], v9 offset:2048
    v_mfma_f32_16x16x32_bf16 v[252:255], a[212:215], a[60:63], v[252:255]
    buffer_load_dwordx4 v6, s[44:47], s81 offen lds
    v_mfma_f32_16x16x32_bf16 v[252:255], a[208:211], a[28:31], v[252:255]
    s_add_u32 s72, s72, 128
    ds_read_b128 a[176:179], v8 offset:4096
    ds_read_b128 a[180:183], v9 offset:4096
    v_mfma_f32_16x16x32_bf16 v[124:127], a[216:219], a[28:31], v[124:127]
    v_mfma_f32_16x16x32_bf16 v[124:127], a[220:223], a[60:63], v[124:127]
    s_add_u32 s74, s74, 172032
    ds_read_b128 a[184:187], v8 offset:6144
    v_mfma_f32_16x16x32_bf16 v[120:123], a[220:223], a[56:59], v[120:123]
    ds_read_b128 a[188:191], v9 offset:6144
    v_mfma_f32_16x16x32_bf16 v[120:123], a[216:219], a[24:27], v[120:123]
    s_xor_b32 s76, s76, s90
    v_mfma_f32_16x16x32_bf16 v[116:119], a[216:219], a[20:23], v[116:119]
    v_mfma_f32_16x16x32_bf16 v[116:119], a[220:223], a[52:55], v[116:119]
    s_xor_b32 s89, s89, s90
    v_mfma_f32_16x16x32_bf16 v[112:115], a[220:223], a[48:51], v[112:115]
    v_mfma_f32_16x16x32_bf16 v[112:115], a[216:219], a[16:19], v[112:115]
    s_mov_b64 s[68:69], s[24:25]
    v_mfma_f32_16x16x32_bf16 v[108:111], a[216:219], a[12:15], v[108:111]
    v_mfma_f32_16x16x32_bf16 v[108:111], a[220:223], a[44:47], v[108:111]
    s_movk_i32 s70, 256
    v_mfma_f32_16x16x32_bf16 v[104:107], a[220:223], a[40:43], v[104:107]
    v_mfma_f32_16x16x32_bf16 v[104:107], a[216:219], a[8:11], v[104:107]
    s_lshl_b32 s84, s63, 12
    v_mfma_f32_16x16x32_bf16 v[100:103], a[216:219], a[4:7], v[100:103]
    v_mfma_f32_16x16x32_bf16 v[100:103], a[220:223], a[36:39], v[100:103]
    v_mov_b32 v26, 1
    v_mfma_f32_16x16x32_bf16 v[96:99], a[220:223], a[32:35], v[96:99]
    v_mfma_f32_16x16x32_bf16 v[96:99], a[216:219], a[0:3], v[96:99]
    buffer_atomic_add v26, v24, s[68:71], s84 offen sc1
    s_waitcnt lgkmcnt(0)
    v_mfma_f32_16x16x32_bf16 v[128:131], a[160:163], a[64:67], v[128:131]
    v_mfma_f32_16x16x32_bf16 v[128:131], a[164:167], a[96:99], v[128:131]
    s_add_u32 s77, s86, s85
    ds_read_b128 a[192:195], v8 offset:8192
    v_mfma_f32_16x16x32_bf16 v[132:135], a[164:167], a[100:103], v[132:135]
    v_mfma_f32_16x16x32_bf16 v[132:135], a[160:163], a[68:71], v[132:135]
    s_add_u32 m0, s77, 0
    ds_read_b128 a[196:199], v9 offset:8192
    v_mfma_f32_16x16x32_bf16 v[136:139], a[160:163], a[72:75], v[136:139]
    v_mfma_f32_16x16x32_bf16 v[136:139], a[164:167], a[104:107], v[136:139]
    s_add_u32 s82, s73, 0
    v_mfma_f32_16x16x32_bf16 v[140:143], a[164:167], a[108:111], v[140:143]
    ds_read_b128 a[200:203], v8 offset:10240
    v_mfma_f32_16x16x32_bf16 v[140:143], a[160:163], a[76:79], v[140:143]
    buffer_load_dwordx4 v3, s[40:43], s82 offen lds
    v_mfma_f32_16x16x32_bf16 v[144:147], a[160:163], a[80:83], v[144:147]
    ds_read_b128 a[204:207], v9 offset:10240
    v_mfma_f32_16x16x32_bf16 v[144:147], a[164:167], a[112:115], v[144:147]
    s_add_u32 m0, s77, 8192
    v_mfma_f32_16x16x32_bf16 v[148:151], a[164:167], a[116:119], v[148:151]
    v_mfma_f32_16x16x32_bf16 v[148:151], a[160:163], a[84:87], v[148:151]
    s_add_u32 s82, s73, 131072
    ds_read_b128 a[208:211], v8 offset:12288
    v_mfma_f32_16x16x32_bf16 v[152:155], a[160:163], a[88:91], v[152:155]
    v_mfma_f32_16x16x32_bf16 v[152:155], a[164:167], a[120:123], v[152:155]
    buffer_load_dwordx4 v3, s[40:43], s82 offen lds
    v_mfma_f32_16x16x32_bf16 v[156:159], a[164:167], a[124:127], v[156:159]
    ds_read_b128 a[212:215], v9 offset:12288
    v_mfma_f32_16x16x32_bf16 v[156:159], a[160:163], a[92:95], v[156:159]
    v_mfma_f32_16x16x32_bf16 a[156:159], a[168:171], a[92:95], a[156:159]
    s_add_u32 m0, s77, 16384
    ds_read_b128 a[216:219], v8 offset:14336
    v_mfma_f32_16x16x32_bf16 a[156:159], a[172:175], a[124:127], a[156:159]
    v_mfma_f32_16x16x32_bf16 a[152:155], a[172:175], a[120:123], a[152:155]
    s_add_u32 s82, s73, 262144
    v_mfma_f32_16x16x32_bf16 a[152:155], a[168:171], a[88:91], a[152:155]
    ds_read_b128 a[220:223], v9 offset:14336
    v_mfma_f32_16x16x32_bf16 a[148:151], a[168:171], a[84:87], a[148:151]
    buffer_load_dwordx4 v3, s[40:43], s82 offen lds
    v_mfma_f32_16x16x32_bf16 a[148:151], a[172:175], a[116:119], a[148:151]
    v_xor_b32 v8, 0x8000, v8
    v_mfma_f32_16x16x32_bf16 a[144:147], a[172:175], a[112:115], a[144:147]
    s_add_u32 m0, s77, 24576
    v_mfma_f32_16x16x32_bf16 a[144:147], a[168:171], a[80:83], a[144:147]
    v_mfma_f32_16x16x32_bf16 a[140:143], a[168:171], a[76:79], a[140:143]
    v_xor_b32 v9, 0x8000, v9
    v_mfma_f32_16x16x32_bf16 a[140:143], a[172:175], a[108:111], a[140:143]
    s_add_u32 s82, s73, 393216
    v_mfma_f32_16x16x32_bf16 a[136:139], a[172:175], a[104:107], a[136:139]
    s_add_u32 s80, s80, 1
    v_mfma_f32_16x16x32_bf16 a[136:139], a[168:171], a[72:75], a[136:139]
    buffer_load_dwordx4 v3, s[40:43], s82 offen lds
    v_mfma_f32_16x16x32_bf16 a[132:135], a[168:171], a[68:71], a[132:135]
    s_add_u32 m0, s77, 2048
    v_mfma_f32_16x16x32_bf16 a[132:135], a[172:175], a[100:103], a[132:135]
    s_cmp_eq_u32 s80, 3
    s_cselect_b32 s80, 0, s80
    s_cselect_b32 s79, 4294901760, s90
    v_mfma_f32_16x16x32_bf16 a[128:131], a[172:175], a[96:99], a[128:131]
    v_mfma_f32_16x16x32_bf16 a[128:131], a[168:171], a[64:67], a[128:131]
    s_add_u32 s82, s73, 32768
    v_add_u32 v16, s79, v16
    v_mfma_f32_16x16x32_bf16 v[160:163], a[176:179], a[64:67], v[160:163]
    v_mfma_f32_16x16x32_bf16 v[160:163], a[180:183], a[96:99], v[160:163]
    buffer_load_dwordx4 v3, s[40:43], s82 offen lds
    v_mfma_f32_16x16x32_bf16 v[164:167], a[180:183], a[100:103], v[164:167]
    v_add_u32 v17, s79, v17
    v_mfma_f32_16x16x32_bf16 v[164:167], a[176:179], a[68:71], v[164:167]
    s_add_u32 m0, s77, 10240
    v_mfma_f32_16x16x32_bf16 v[168:171], a[176:179], a[72:75], v[168:171]
    v_add_u32 v18, s79, v18
    v_mfma_f32_16x16x32_bf16 v[168:171], a[180:183], a[104:107], v[168:171]
    v_mfma_f32_16x16x32_bf16 v[172:175], a[180:183], a[108:111], v[172:175]
    s_add_u32 s82, s73, 163840
    v_mfma_f32_16x16x32_bf16 v[172:175], a[176:179], a[76:79], v[172:175]
    v_add_u32 v19, s79, v19
    v_mfma_f32_16x16x32_bf16 v[176:179], a[176:179], a[80:83], v[176:179]
    v_cvt_pk_bf16_f32 v156, v156, v157
    v_cvt_pk_bf16_f32 v157, v158, v159
    v_mfma_f32_16x16x32_bf16 v[176:179], a[180:183], a[112:115], v[176:179]
    buffer_load_dwordx4 v3, s[40:43], s82 offen lds
    v_mfma_f32_16x16x32_bf16 v[180:183], a[180:183], a[116:119], v[180:183]
    s_add_u32 m0, s77, 18432
    v_accvgpr_read_b32 v26, a156
    v_accvgpr_read_b32 v27, a157
    v_mfma_f32_16x16x32_bf16 v[180:183], a[176:179], a[84:87], v[180:183]
    v_accvgpr_read_b32 v28, a158
    v_accvgpr_read_b32 v29, a159
    v_mfma_f32_16x16x32_bf16 v[184:187], a[176:179], a[88:91], v[184:187]
    s_add_u32 s82, s73, 294912
    v_add_u32 v20, s79, v20
    v_cvt_pk_bf16_f32 v158, v26, v27
    v_mfma_f32_16x16x32_bf16 v[184:187], a[180:183], a[120:123], v[184:187]
    v_cvt_pk_bf16_f32 v159, v28, v29
    v_cvt_pk_bf16_f32 v152, v152, v153
    v_mfma_f32_16x16x32_bf16 v[188:191], a[180:183], a[124:127], v[188:191]
    v_cvt_pk_bf16_f32 v153, v154, v155
    v_accvgpr_read_b32 v26, a152
    v_mfma_f32_16x16x32_bf16 v[188:191], a[176:179], a[92:95], v[188:191]
    v_add_u32 v21, s79, v21
    v_add_u32 v22, s79, v22
    v_accvgpr_read_b32 v27, a153
    v_mfma_f32_16x16x32_bf16 v[60:63], a[184:187], a[92:95], v[60:63]
    v_accvgpr_read_b32 v28, a154
    v_accvgpr_read_b32 v29, a155
    v_cvt_pk_bf16_f32 v154, v26, v27
    v_mfma_f32_16x16x32_bf16 v[60:63], a[188:191], a[124:127], v[60:63]
    v_add_u32 v23, s79, v23
    v_cvt_pk_bf16_f32 v155, v28, v29
    v_cvt_pk_bf16_f32 v148, v148, v149
    v_mfma_f32_16x16x32_bf16 v[56:59], a[188:191], a[120:123], v[56:59]
    buffer_load_dwordx4 v3, s[40:43], s82 offen lds
    v_cvt_pk_bf16_f32 v149, v150, v151
    v_accvgpr_read_b32 v26, a148
    v_accvgpr_read_b32 v27, a149
    v_mfma_f32_16x16x32_bf16 v[56:59], a[184:187], a[88:91], v[56:59]
    s_add_u32 m0, s77, 26624
    v_accvgpr_read_b32 v28, a150
    v_accvgpr_read_b32 v29, a151
    v_cvt_pk_bf16_f32 v150, v26, v27
    v_mfma_f32_16x16x32_bf16 v[52:55], a[184:187], a[84:87], v[52:55]
    s_add_u32 s82, s73, 425984
    v_cvt_pk_bf16_f32 v151, v28, v29
    v_cvt_pk_bf16_f32 v144, v144, v145
    v_mfma_f32_16x16x32_bf16 v[52:55], a[188:191], a[116:119], v[52:55]
    buffer_load_dwordx4 v3, s[40:43], s82 offen lds
    v_cvt_pk_bf16_f32 v145, v146, v147
    v_accvgpr_read_b32 v26, a144
    v_accvgpr_read_b32 v27, a145
    v_mfma_f32_16x16x32_bf16 v[48:51], a[188:191], a[112:115], v[48:51]
    v_accvgpr_read_b32 v28, a146
    v_accvgpr_read_b32 v29, a147
    v_cvt_pk_bf16_f32 v146, v26, v27
    v_mfma_f32_16x16x32_bf16 v[48:51], a[184:187], a[80:83], v[48:51]
    s_add_u32 s73, s73, 524288
    v_cvt_pk_bf16_f32 v147, v28, v29
    v_cvt_pk_bf16_f32 v140, v140, v141
    v_mfma_f32_16x16x32_bf16 v[44:47], a[184:187], a[76:79], v[44:47]
    v_cvt_pk_bf16_f32 v141, v142, v143
    v_accvgpr_read_b32 v26, a140
    v_accvgpr_read_b32 v27, a141
    v_mfma_f32_16x16x32_bf16 v[44:47], a[188:191], a[108:111], v[44:47]
    s_add_u32 s86, s86, s90
    v_accvgpr_read_b32 v28, a142
    v_accvgpr_read_b32 v29, a143
    v_cvt_pk_bf16_f32 v142, v26, v27
    v_mfma_f32_16x16x32_bf16 v[40:43], a[188:191], a[104:107], v[40:43]
    v_cvt_pk_bf16_f32 v143, v28, v29
    v_cvt_pk_bf16_f32 v136, v136, v137
    v_mfma_f32_16x16x32_bf16 v[40:43], a[184:187], a[72:75], v[40:43]
    s_cmp_eq_u32 s86, 163840
    s_cselect_b32 s86, 65536, s86
    v_cvt_pk_bf16_f32 v137, v138, v139
    v_accvgpr_read_b32 v26, a136
    v_accvgpr_read_b32 v27, a137
    v_mfma_f32_16x16x32_bf16 v[36:39], a[184:187], a[68:71], v[36:39]
    v_accvgpr_read_b32 v28, a138
    v_accvgpr_read_b32 v29, a139
    v_cvt_pk_bf16_f32 v138, v26, v27
    v_mfma_f32_16x16x32_bf16 v[36:39], a[188:191], a[100:103], v[36:39]
    v_cvt_pk_bf16_f32 v139, v28, v29
    v_cvt_pk_bf16_f32 v132, v132, v133
    v_mfma_f32_16x16x32_bf16 v[32:35], a[188:191], a[96:99], v[32:35]
    v_cvt_pk_bf16_f32 v133, v134, v135
    v_accvgpr_read_b32 v26, a132
    v_accvgpr_read_b32 v27, a133
    v_mfma_f32_16x16x32_bf16 v[32:35], a[184:187], a[64:67], v[32:35]
    v_accvgpr_read_b32 v28, a134
    v_accvgpr_read_b32 v29, a135
    v_cvt_pk_bf16_f32 v134, v26, v27
    v_cvt_pk_bf16_f32 v135, v28, v29
    v_cvt_pk_bf16_f32 v128, v128, v129
    v_cvt_pk_bf16_f32 v129, v130, v131
    v_accvgpr_read_b32 v26, a128
    v_accvgpr_read_b32 v27, a129
    v_accvgpr_read_b32 v28, a130
    v_accvgpr_read_b32 v29, a131
    v_cvt_pk_bf16_f32 v130, v26, v27
    v_cvt_pk_bf16_f32 v131, v28, v29
    s_waitcnt vmcnt(9) lgkmcnt(0)
    s_barrier
    v_mfma_f32_16x16x32_bf16 v[192:195], a[192:195], a[64:67], v[192:195]
    s_lshl_b32 s83, s60, 12
    s_add_u32 m0, s76, 0
    v_mfma_f32_16x16x32_bf16 v[192:195], a[196:199], a[96:99], v[192:195]
    s_add_u32 s81, s72, 0
    v_add_u32 v8, s83, v30
    v_xor_b32 v9, 64, v8
    v_mfma_f32_16x16x32_bf16 v[196:199], a[196:199], a[100:103], v[196:199]
    buffer_load_dwordx4 v4, s[36:39], s81 offen lds
    v_mfma_f32_16x16x32_bf16 v[196:199], a[192:195], a[68:71], v[196:199]
    s_add_u32 m0, s76, 4096
    s_add_u32 s81, s72, 28672
    v_add_u32 v16, 98304, v7
    v_mfma_f32_16x16x32_bf16 v[200:203], a[192:195], a[72:75], v[200:203]
    buffer_load_dwordx4 v4, s[36:39], s81 offen lds
    v_mfma_f32_16x16x32_bf16 v[200:203], a[196:199], a[104:107], v[200:203]
    s_add_u32 m0, s76, 8192
    v_xor_b32 v17, 32, v16
    v_cvt_pk_bf16_f32 v188, v188, v189
    v_mfma_f32_16x16x32_bf16 v[204:207], a[196:199], a[108:111], v[204:207]
    s_add_u32 s81, s72, 57344
    v_xor_b32 v18, 64, v16
    v_cvt_pk_bf16_f32 v189, v190, v191
    v_mfma_f32_16x16x32_bf16 v[204:207], a[192:195], a[76:79], v[204:207]
    v_xor_b32 v19, 96, v16
    v_cvt_pk_bf16_f32 v190, v60, v61
    v_mfma_f32_16x16x32_bf16 v[208:211], a[192:195], a[80:83], v[208:211]
    buffer_load_dwordx4 v4, s[36:39], s81 offen lds
    v_mfma_f32_16x16x32_bf16 v[208:211], a[196:199], a[112:115], v[208:211]
    s_add_u32 m0, s76, 12288
    v_xor_b32 v20, 128, v16
    v_cvt_pk_bf16_f32 v191, v62, v63
    v_mfma_f32_16x16x32_bf16 v[212:215], a[196:199], a[116:119], v[212:215]
    s_add_u32 s81, s72, 86016
    v_xor_b32 v21, 160, v16
    v_cvt_pk_bf16_f32 v184, v184, v185
    v_mfma_f32_16x16x32_bf16 v[212:215], a[192:195], a[84:87], v[212:215]
    buffer_load_dwordx4 v4, s[36:39], s81 offen lds
    v_mfma_f32_16x16x32_bf16 v[216:219], a[192:195], a[88:91], v[216:219]
    s_add_u32 m0, s89, 16384
    v_cvt_pk_bf16_f32 v185, v186, v187
    v_cvt_pk_bf16_f32 v186, v56, v57
    v_mfma_f32_16x16x32_bf16 v[216:219], a[196:199], a[120:123], v[216:219]
    s_add_u32 s81, s74, 0
    v_xor_b32 v22, 192, v16
    v_cvt_pk_bf16_f32 v187, v58, v59
    v_cvt_pk_bf16_f32 v180, v180, v181
    v_mfma_f32_16x16x32_bf16 v[220:223], a[196:199], a[124:127], v[220:223]
    buffer_load_dwordx4 v6, s[44:47], s81 offen lds
    v_xor_b32 v23, 224, v16
    v_mfma_f32_16x16x32_bf16 v[220:223], a[192:195], a[92:95], v[220:223]
    s_add_u32 m0, s89, 20480
    s_add_u32 s81, s74, 43008
    v_add_u32 v10, 16384, v31
    v_cvt_pk_bf16_f32 v181, v182, v183
    v_mfma_f32_16x16x32_bf16 v[92:95], a[200:203], a[92:95], v[92:95]
    buffer_load_dwordx4 v6, s[44:47], s81 offen lds
    v_xor_b32 v11, 32, v10
    v_xor_b32 v12, 64, v10
    v_xor_b32 v13, 96, v10
    v_xor_b32 v14, 128, v10
    v_xor_b32 v15, 160, v10
    v_cvt_pk_bf16_f32 v182, v52, v53
    v_mfma_f32_16x16x32_bf16 v[92:95], a[204:207], a[124:127], v[92:95]
    s_add_u32 m0, s89, 24576
    v_cvt_pk_bf16_f32 v183, v54, v55
    v_cvt_pk_bf16_f32 v176, v176, v177
    v_cvt_pk_bf16_f32 v177, v178, v179
    v_mfma_f32_16x16x32_bf16 v[88:91], a[204:207], a[120:123], v[88:91]
    s_add_u32 s81, s74, 86016
    buffer_load_dwordx4 v6, s[44:47], s81 offen lds
    v_mfma_f32_16x16x32_bf16 v[88:91], a[200:203], a[88:91], v[88:91]
    s_add_u32 m0, s89, 28672
    s_add_u32 s81, s74, 129024
    v_cvt_pk_bf16_f32 v178, v48, v49
    v_mfma_f32_16x16x32_bf16 v[84:87], a[200:203], a[84:87], v[84:87]
    buffer_load_dwordx4 v6, s[44:47], s81 offen lds
    s_add_u32 s72, s72, 128
    s_add_u32 s74, s74, 172032
    s_xor_b32 s76, s76, s90
    s_xor_b32 s89, s89, s90
    v_cvt_pk_bf16_f32 v179, v50, v51
    v_mfma_f32_16x16x32_bf16 v[84:87], a[204:207], a[116:119], v[84:87]
    v_cvt_pk_bf16_f32 v172, v172, v173
    v_cvt_pk_bf16_f32 v173, v174, v175
    v_mfma_f32_16x16x32_bf16 v[80:83], a[204:207], a[112:115], v[80:83]
    v_cvt_pk_bf16_f32 v174, v44, v45
    v_cvt_pk_bf16_f32 v175, v46, v47
    v_mfma_f32_16x16x32_bf16 v[80:83], a[200:203], a[80:83], v[80:83]
    v_cvt_pk_bf16_f32 v168, v168, v169
    v_cvt_pk_bf16_f32 v169, v170, v171
    v_mfma_f32_16x16x32_bf16 v[76:79], a[200:203], a[76:79], v[76:79]
    v_cvt_pk_bf16_f32 v170, v40, v41
    v_cvt_pk_bf16_f32 v171, v42, v43
    v_mfma_f32_16x16x32_bf16 v[76:79], a[204:207], a[108:111], v[76:79]
    buffer_store_dwordx4 v[128:131], v1, s[48:51], s87 offen offset:0 sc1
    v_mfma_f32_16x16x32_bf16 v[72:75], a[204:207], a[104:107], v[72:75]
    v_cvt_pk_bf16_f32 v164, v164, v165
    v_cvt_pk_bf16_f32 v165, v166, v167
    v_mfma_f32_16x16x32_bf16 v[72:75], a[200:203], a[72:75], v[72:75]
    buffer_store_dwordx4 v[132:135], v1, s[48:51], s87 offen offset:1024 sc1
    v_mfma_f32_16x16x32_bf16 v[68:71], a[200:203], a[68:71], v[68:71]
    v_cvt_pk_bf16_f32 v166, v36, v37
    v_cvt_pk_bf16_f32 v167, v38, v39
    v_mfma_f32_16x16x32_bf16 v[68:71], a[204:207], a[100:103], v[68:71]
    v_cvt_pk_bf16_f32 v160, v160, v161
    v_cvt_pk_bf16_f32 v161, v162, v163
    v_cvt_pk_bf16_f32 v162, v32, v33
    v_mfma_f32_16x16x32_bf16 v[64:67], a[204:207], a[96:99], v[64:67]
    buffer_store_dwordx4 v[136:139], v1, s[48:51], s87 offen offset:2048 sc1
    v_cvt_pk_bf16_f32 v163, v34, v35
    v_mfma_f32_16x16x32_bf16 v[64:67], a[200:203], a[64:67], v[64:67]
    buffer_store_dwordx4 v[140:143], v1, s[48:51], s87 offen offset:3072 sc1
    v_mfma_f32_16x16x32_bf16 v[224:227], a[208:211], a[64:67], v[224:227]
    v_mfma_f32_16x16x32_bf16 v[224:227], a[212:215], a[96:99], v[224:227]
    v_mfma_f32_16x16x32_bf16 v[228:231], a[212:215], a[100:103], v[228:231]
    s_add_u32 s87, s87, s16
    v_mfma_f32_16x16x32_bf16 v[228:231], a[208:211], a[68:71], v[228:231]
    v_mfma_f32_16x16x32_bf16 v[232:235], a[208:211], a[72:75], v[232:235]
    v_mfma_f32_16x16x32_bf16 v[232:235], a[212:215], a[104:107], v[232:235]
    buffer_store_dwordx4 v[144:147], v1, s[48:51], s87 offen offset:0 sc1
    v_mfma_f32_16x16x32_bf16 v[236:239], a[212:215], a[108:111], v[236:239]
    v_mfma_f32_16x16x32_bf16 v[236:239], a[208:211], a[76:79], v[236:239]
    v_mfma_f32_16x16x32_bf16 v[240:243], a[208:211], a[80:83], v[240:243]
    buffer_store_dwordx4 v[148:151], v1, s[48:51], s87 offen offset:1024 sc1
    v_mfma_f32_16x16x32_bf16 v[240:243], a[212:215], a[112:115], v[240:243]
    v_cvt_pk_bf16_f32 v220, v220, v221
    v_cvt_pk_bf16_f32 v221, v222, v223
    v_mfma_f32_16x16x32_bf16 v[244:247], a[212:215], a[116:119], v[244:247]
    v_cvt_pk_bf16_f32 v222, v92, v93
    v_cvt_pk_bf16_f32 v223, v94, v95
    v_mfma_f32_16x16x32_bf16 v[244:247], a[208:211], a[84:87], v[244:247]
    buffer_store_dwordx4 v[152:155], v1, s[48:51], s87 offen offset:2048 sc1
    v_mfma_f32_16x16x32_bf16 v[248:251], a[208:211], a[88:91], v[248:251]
    v_cvt_pk_bf16_f32 v216, v216, v217
    v_cvt_pk_bf16_f32 v217, v218, v219
    v_mfma_f32_16x16x32_bf16 v[248:251], a[212:215], a[120:123], v[248:251]
    v_cvt_pk_bf16_f32 v218, v88, v89
    v_cvt_pk_bf16_f32 v219, v90, v91
    v_mfma_f32_16x16x32_bf16 v[252:255], a[212:215], a[124:127], v[252:255]
    buffer_store_dwordx4 v[156:159], v1, s[48:51], s87 offen offset:3072 sc1
    v_mfma_f32_16x16x32_bf16 v[252:255], a[208:211], a[92:95], v[252:255]
    v_cvt_pk_bf16_f32 v212, v212, v213
    v_cvt_pk_bf16_f32 v213, v214, v215
    v_mfma_f32_16x16x32_bf16 v[124:127], a[216:219], a[92:95], v[124:127]
    s_add_u32 s87, s87, s17
    v_cvt_pk_bf16_f32 v214, v84, v85
    v_cvt_pk_bf16_f32 v215, v86, v87
    v_mfma_f32_16x16x32_bf16 v[124:127], a[220:223], a[124:127], v[124:127]
    v_cvt_pk_bf16_f32 v208, v208, v209
    v_mfma_f32_16x16x32_bf16 v[120:123], a[220:223], a[120:123], v[120:123]
    v_cvt_pk_bf16_f32 v209, v210, v211
    v_cvt_pk_bf16_f32 v210, v80, v81
    v_mfma_f32_16x16x32_bf16 v[120:123], a[216:219], a[88:91], v[120:123]
    buffer_store_dwordx4 v[160:163], v1, s[48:51], s87 offen offset:0 sc1
    v_mfma_f32_16x16x32_bf16 v[116:119], a[216:219], a[84:87], v[116:119]
    v_cvt_pk_bf16_f32 v211, v82, v83
    v_cvt_pk_bf16_f32 v204, v204, v205
    v_mfma_f32_16x16x32_bf16 v[116:119], a[220:223], a[116:119], v[116:119]
    ds_read_b128 a[160:163], v8 offset:0
    v_cvt_pk_bf16_f32 v205, v206, v207
    v_mfma_f32_16x16x32_bf16 v[112:115], a[220:223], a[112:115], v[112:115]
    ds_read_b128 a[164:167], v8 offset:2048
    v_cvt_pk_bf16_f32 v206, v76, v77
    v_mfma_f32_16x16x32_bf16 v[112:115], a[216:219], a[80:83], v[112:115]
    buffer_store_dwordx4 v[164:167], v1, s[48:51], s87 offen offset:1024 sc1
    v_mfma_f32_16x16x32_bf16 v[108:111], a[216:219], a[76:79], v[108:111]
    ds_read_b64_tr_b16 a[0:1], v16 offset:0
    v_cvt_pk_bf16_f32 v207, v78, v79
    v_mfma_f32_16x16x32_bf16 v[108:111], a[220:223], a[108:111], v[108:111]
    ds_read_b64_tr_b16 a[2:3], v16 offset:2048
    v_cvt_pk_bf16_f32 v200, v200, v201
    v_mfma_f32_16x16x32_bf16 v[104:107], a[220:223], a[104:107], v[104:107]
    ds_read_b64_tr_b16 a[4:5], v17 offset:0
    v_cvt_pk_bf16_f32 v201, v202, v203
    v_mfma_f32_16x16x32_bf16 v[104:107], a[216:219], a[72:75], v[104:107]
    ds_read_b64_tr_b16 a[6:7], v17 offset:2048
    v_cvt_pk_bf16_f32 v202, v72, v73
    v_mfma_f32_16x16x32_bf16 v[100:103], a[216:219], a[68:71], v[100:103]
    buffer_store_dwordx4 v[168:171], v1, s[48:51], s87 offen offset:2048 sc1
    v_mfma_f32_16x16x32_bf16 v[100:103], a[220:223], a[100:103], v[100:103]
    v_cvt_pk_bf16_f32 v203, v74, v75
    v_cvt_pk_bf16_f32 v196, v196, v197
    v_mfma_f32_16x16x32_bf16 v[96:99], a[220:223], a[96:99], v[96:99]
    ds_read_b64_tr_b16 a[8:9], v18 offset:0
    v_cvt_pk_bf16_f32 v197, v198, v199
    v_cvt_pk_bf16_f32 v198, v68, v69
    v_cvt_pk_bf16_f32 v199, v70, v71
    v_cvt_pk_bf16_f32 v192, v192, v193
    v_cvt_pk_bf16_f32 v193, v194, v195
    v_cvt_pk_bf16_f32 v194, v64, v65
    v_mfma_f32_16x16x32_bf16 v[96:99], a[216:219], a[64:67], v[96:99]
    buffer_store_dwordx4 v[172:175], v1, s[48:51], s87 offen offset:3072 sc1
    s_add_u32 s87, s87, s16
    ds_read_b64_tr_b16 a[10:11], v18 offset:2048
    v_cvt_pk_bf16_f32 v195, v66, v67
F_ph2_4:
    s_waitcnt lgkmcnt(4)
    v_mfma_f32_16x16x32_bf16 v[32:35], a[252:255], a[160:163], 0
    ds_read_b64_tr_b16 a[12:13], v19 offset:0
    v_cvt_pk_bf16_f32 v252, v252, v253
    v_mfma_f32_16x16x32_bf16 v[36:39], a[252:255], a[164:167], 0
    buffer_load_dwordx4 a[220:223], v25, s[8:11], 0 offen offset:512
    v_mfma_f32_16x16x32_bf16 a[68:71], a[0:3], a[164:167], 0
    ds_read_b64_tr_b16 a[14:15], v19 offset:2048
    v_cvt_pk_bf16_f32 v253, v254, v255
    v_mfma_f32_16x16x32_bf16 a[64:67], a[0:3], a[160:163], 0
    s_waitcnt lgkmcnt(2)
    ds_read_b64_tr_b16 a[16:17], v20 offset:0
    ds_read_b64_tr_b16 a[18:19], v20 offset:2048
    v_mfma_f32_16x16x32_bf16 a[72:75], a[4:7], a[160:163], 0
    ds_read_b64_tr_b16 a[20:21], v21 offset:0
    v_cvt_pk_bf16_f32 v254, v124, v125
    v_mfma_f32_16x16x32_bf16 a[76:79], a[4:7], a[164:167], 0
    buffer_load_dwordx4 a[216:219], v25, s[8:11], 0 offen offset:576
    buffer_load_dwordx4 a[212:215], v25, s[8:11], 0 offen offset:640
    v_mfma_f32_16x16x32_bf16 a[84:87], a[8:11], a[164:167], 0
    ds_read_b64_tr_b16 a[22:23], v21 offset:2048
    v_cvt_pk_bf16_f32 v255, v126, v127
    v_mfma_f32_16x16x32_bf16 a[80:83], a[8:11], a[160:163], 0
    s_waitcnt lgkmcnt(2)
    ds_read_b64_tr_b16 a[24:25], v22 offset:0
    ds_read_b64_tr_b16 a[26:27], v22 offset:2048
    v_cvt_pk_bf16_f32 v248, v248, v249
    v_mfma_f32_16x16x32_bf16 a[88:91], a[12:15], a[160:163], 0
    ds_read_b64_tr_b16 a[28:29], v23 offset:0
    ds_read_b64_tr_b16 a[30:31], v23 offset:2048
    v_cvt_pk_bf16_f32 v249, v250, v251
    v_cvt_pk_bf16_f32 v250, v120, v121
    v_mfma_f32_16x16x32_bf16 a[92:95], a[12:15], a[164:167], 0
    ds_read_b64_tr_b16 a[32:33], v16 offset:256
    ds_read_b64_tr_b16 a[34:35], v16 offset:2304
    v_cvt_pk_bf16_f32 v251, v122, v123
    v_cvt_pk_bf16_f32 v244, v244, v245
    v_mfma_f32_16x16x32_bf16 a[100:103], a[16:19], a[164:167], 0
    buffer_load_dwordx4 a[208:211], v25, s[8:11], 0 offen offset:704
    v_mfma_f32_16x16x32_bf16 a[96:99], a[16:19], a[160:163], 0
    s_waitcnt lgkmcnt(4)
    ds_read_b64_tr_b16 a[36:37], v17 offset:256
    ds_read_b64_tr_b16 a[38:39], v17 offset:2304
    v_cvt_pk_bf16_f32 v245, v246, v247
    v_cvt_pk_bf16_f32 v246, v116, v117
    v_mfma_f32_16x16x32_bf16 a[104:107], a[20:23], a[160:163], 0
    buffer_load_dwordx4 a[204:207], v25, s[8:11], 0 offen offset:768
    v_mfma_f32_16x16x32_bf16 a[108:111], a[20:23], a[164:167], 0
    ds_read_b64_tr_b16 a[40:41], v18 offset:256
    ds_read_b64_tr_b16 a[42:43], v18 offset:2304
    v_cvt_pk_bf16_f32 v247, v118, v119
    v_mfma_f32_16x16x32_bf16 a[116:119], a[24:27], a[164:167], 0
    buffer_load_dwordx4 a[200:203], v25, s[8:11], 0 offen offset:832
    v_cvt_pk_bf16_f32 v240, v240, v241
    v_cvt_pk_bf16_f32 v241, v242, v243
    v_mfma_f32_16x16x32_bf16 a[112:115], a[24:27], a[160:163], 0
    s_waitcnt lgkmcnt(4)
    ds_read_b64_tr_b16 a[44:45], v19 offset:256
    ds_read_b64_tr_b16 a[46:47], v19 offset:2304
    v_cvt_pk_bf16_f32 v242, v112, v113
    v_cvt_pk_bf16_f32 v243, v114, v115
    v_mfma_f32_16x16x32_bf16 a[120:123], a[28:31], a[160:163], 0
    buffer_store_dwordx4 v[176:179], v1, s[48:51], s87 offen offset:0 sc1
    v_mfma_f32_16x16x32_bf16 a[124:127], a[28:31], a[164:167], 0
    ds_read_b64_tr_b16 a[48:49], v20 offset:256
    ds_read_b64_tr_b16 a[50:51], v20 offset:2304
    v_cvt_pk_bf16_f32 v236, v236, v237
    v_cvt_pk_bf16_f32 v237, v238, v239
    v_mfma_f32_16x16x32_bf16 a[132:135], a[32:35], a[164:167], 0
    buffer_store_dwordx4 v[180:183], v1, s[48:51], s87 offen offset:1024 sc1
    v_mfma_f32_16x16x32_bf16 a[128:131], a[32:35], a[160:163], 0
    s_waitcnt lgkmcnt(4)
    v_cvt_pk_bf16_f32 v238, v108, v109
    v_cvt_pk_bf16_f32 v239, v110, v111
    v_cvt_pk_bf16_f32 v232, v232, v233
    v_mfma_f32_16x16x32_bf16 a[136:139], a[36:39], a[160:163], 0
    ds_read_b64_tr_b16 a[52:53], v21 offset:256
    ds_read_b64_tr_b16 a[54:55], v21 offset:2304
    buffer_store_dwordx4 v[184:187], v1, s[48:51], s87 offen offset:2048 sc1
    v_mfma_f32_16x16x32_bf16 a[140:143], a[36:39], a[164:167], 0
    ds_read_b64_tr_b16 a[56:57], v22 offset:256
    ds_read_b64_tr_b16 a[58:59], v22 offset:2304
    v_cvt_pk_bf16_f32 v233, v234, v235
    v_cvt_pk_bf16_f32 v234, v104, v105
    v_mfma_f32_16x16x32_bf16 a[148:151], a[40:43], a[164:167], 0
    buffer_store_dwordx4 v[188:191], v1, s[48:51], s87 offen offset:3072 sc1
    v_mfma_f32_16x16x32_bf16 a[144:147], a[40:43], a[160:163], 0
    s_waitcnt lgkmcnt(4)
    ds_read_b64_tr_b16 a[60:61], v23 offset:256
    v_cvt_pk_bf16_f32 v235, v106, v107
    v_mfma_f32_16x16x32_bf16 v[40:43], a[44:47], a[160:163], 0
    s_add_u32 s87, s87, s17
    ds_read_b64_tr_b16 a[62:63], v23 offset:2304
    v_cvt_pk_bf16_f32 v228, v228, v229
    v_mfma_f32_16x16x32_bf16 v[44:47], a[44:47], a[164:167], 0
    buffer_store_dwordx4 v[192:195], v1, s[48:51], s87 offen offset:0 sc1
    v_cvt_pk_bf16_f32 v229, v230, v231
    v_cvt_pk_bf16_f32 v230, v100, v101
    v_cvt_pk_bf16_f32 v231, v102, v103
    v_cvt_pk_bf16_f32 v224, v224, v225
    v_cvt_pk_bf16_f32 v225, v226, v227
    v_cvt_pk_bf16_f32 v226, v96, v97
    v_mfma_f32_16x16x32_bf16 v[68:71], a[48:51], a[164:167], 0
    ds_read_b64_tr_b16 a[0:1], v10 offset:0
    ds_read_b64_tr_b16 a[2:3], v10 offset:1024
    v_cvt_pk_bf16_f32 v227, v98, v99
    v_mfma_f32_16x16x32_bf16 v[64:67], a[48:51], a[160:163], 0
    s_waitcnt lgkmcnt(4)
    buffer_store_dwordx4 v[196:199], v1, s[48:51], s87 offen offset:1024 sc1
    v_mfma_f32_16x16x32_bf16 v[72:75], a[52:55], a[160:163], 0
    ds_read_b64_tr_b16 a[4:5], v11 offset:0
    ds_read_b64_tr_b16 a[6:7], v11 offset:1024
    v_mfma_f32_16x16x32_bf16 v[76:79], a[52:55], a[164:167], 0
    buffer_store_dwordx4 v[200:203], v1, s[48:51], s87 offen offset:2048 sc1
    v_mfma_f32_16x16x32_bf16 v[84:87], a[56:59], a[164:167], 0
    s_add_u32 s77, s86, s85
    ds_read_b64_tr_b16 a[8:9], v12 offset:0
    ds_read_b64_tr_b16 a[10:11], v12 offset:1024
    v_mfma_f32_16x16x32_bf16 v[80:83], a[56:59], a[160:163], 0
    s_waitcnt lgkmcnt(4)
    ds_read_b64_tr_b16 a[12:13], v13 offset:0
    ds_read_b64_tr_b16 a[14:15], v13 offset:1024
    v_mfma_f32_16x16x32_bf16 v[88:91], a[60:63], a[160:163], 0
    s_add_u32 m0, s77, 0
    ds_read_b64_tr_b16 a[16:17], v14 offset:0
    ds_read_b64_tr_b16 a[18:19], v14 offset:1024
    v_mfma_f32_16x16x32_bf16 v[92:95], a[60:63], a[164:167], 0
    s_add_u32 s82, s73, 0
    ds_read_b64_tr_b16 a[20:21], v15 offset:0
    ds_read_b64_tr_b16 a[22:23], v15 offset:1024
    v_mfma_f32_16x16x32_bf16 v[112:115], a[0:3], a[164:167], 0
    buffer_load_dwordx4 v3, s[40:43], s82 offen lds
    v_mfma_f32_16x16x32_bf16 v[96:99], a[0:3], a[160:163], 0
    s_waitcnt lgkmcnt(6)
    ds_read_b128 a[168:171], v9 offset:0
    ds_read_b128 a[172:175], v9 offset:2048
    v_mfma_f32_16x16x32_bf16 v[100:103], a[4:7], a[160:163], 0
    s_add_u32 m0, s77, 8192
    ds_read_b64_tr_b16 a[24:25], v16 offset:16384
    ds_read_b64_tr_b16 a[26:27], v16 offset:18432
    v_mfma_f32_16x16x32_bf16 v[116:119], a[4:7], a[164:167], 0
    v_mfma_f32_16x16x32_bf16 v[120:123], a[8:11], a[164:167], 0
    s_add_u32 s82, s73, 131072
    ds_read_b64_tr_b16 a[28:29], v17 offset:16384
    ds_read_b64_tr_b16 a[30:31], v17 offset:18432
    v_mfma_f32_16x16x32_bf16 v[104:107], a[8:11], a[160:163], 0
    s_waitcnt lgkmcnt(8)
    ds_read_b64_tr_b16 a[32:33], v18 offset:16384
    v_mfma_f32_16x16x32_bf16 v[108:111], a[12:15], a[160:163], 0
    buffer_load_dwordx4 v3, s[40:43], s82 offen lds
    v_mfma_f32_16x16x32_bf16 v[124:127], a[12:15], a[164:167], 0
    s_add_u32 m0, s77, 16384
    ds_read_b64_tr_b16 a[34:35], v18 offset:18432
    v_mfma_f32_16x16x32_bf16 v[56:59], a[164:167], a[16:19], 0
    ds_read_b64_tr_b16 a[36:37], v19 offset:16384
    ds_read_b64_tr_b16 a[38:39], v19 offset:18432
    v_mfma_f32_16x16x32_bf16 v[48:51], a[160:163], a[16:19], 0
    s_waitcnt lgkmcnt(8)
    s_add_u32 s82, s73, 262144
    v_mfma_f32_16x16x32_bf16 v[52:55], a[160:163], a[20:23], 0
    ds_read_b64_tr_b16 a[40:41], v20 offset:16384
    ds_read_b64_tr_b16 a[42:43], v20 offset:18432
    v_mfma_f32_16x16x32_bf16 v[60:63], a[164:167], a[20:23], 0
    buffer_load_dwordx4 v3, s[40:43], s82 offen lds
    v_mfma_f32_16x16x32_bf16 v[32:35], a[248:251], a[168:171], v[32:35]
    ds_read_b64_tr_b16 a[44:45], v21 offset:16384
    ds_read_b64_tr_b16 a[46:47], v21 offset:18432
    v_mfma_f32_16x16x32_bf16 v[36:39], a[248:251], a[172:175], v[36:39]
    s_waitcnt lgkmcnt(8)
    s_add_u32 m0, s77, 24576
    v_mfma_f32_16x16x32_bf16 a[68:71], a[24:27], a[172:175], a[68:71]
    ds_read_b64_tr_b16 a[48:49], v22 offset:16384
    ds_read_b64_tr_b16 a[50:51], v22 offset:18432
    v_mfma_f32_16x16x32_bf16 a[64:67], a[24:27], a[168:171], a[64:67]
    s_add_u32 s82, s73, 393216
    v_mfma_f32_16x16x32_bf16 a[72:75], a[28:31], a[168:171], a[72:75]
    ds_read_b64_tr_b16 a[52:53], v23 offset:16384
    ds_read_b64_tr_b16 a[54:55], v23 offset:18432
    v_mfma_f32_16x16x32_bf16 a[76:79], a[28:31], a[172:175], a[76:79]
    s_waitcnt lgkmcnt(8)
    ds_read_b64_tr_b16 a[56:57], v16 offset:16640
    v_mfma_f32_16x16x32_bf16 a[84:87], a[32:35], a[172:175], a[84:87]
    buffer_load_dwordx4 v3, s[40:43], s82 offen lds
    v_mfma_f32_16x16x32_bf16 a[80:83], a[32:35], a[168:171], a[80:83]
    s_add_u32 m0, s77, 2048
    ds_read_b64_tr_b16 a[58:59], v16 offset:18688
    v_mfma_f32_16x16x32_bf16 a[88:91], a[36:39], a[168:171], a[88:91]
    ds_read_b64_tr_b16 a[60:61], v17 offset:16640
    ds_read_b64_tr_b16 a[62:63], v17 offset:18688
    v_mfma_f32_16x16x32_bf16 a[92:95], a[36:39], a[172:175], a[92:95]
    s_waitcnt lgkmcnt(8)
    s_add_u32 s82, s73, 32768
    v_mfma_f32_16x16x32_bf16 a[100:103], a[40:43], a[172:175], a[100:103]
    ds_read_b64_tr_b16 a[0:1], v18 offset:16640
    ds_read_b64_tr_b16 a[2:3], v18 offset:18688
    v_mfma_f32_16x16x32_bf16 a[96:99], a[40:43], a[168:171], a[96:99]
    buffer_load_dwordx4 v3, s[40:43], s82 offen lds
    v_mfma_f32_16x16x32_bf16 a[104:107], a[44:47], a[168:171], a[104:107]
    ds_read_b64_tr_b16 a[4:5], v19 offset:16640
    ds_read_b64_tr_b16 a[6:7], v19 offset:18688
    v_mfma_f32_16x16x32_bf16 a[108:111], a[44:47], a[172:175], a[108:111]
    s_waitcnt lgkmcnt(8)
    s_add_u32 m0, s77, 10240
    v_mfma_f32_16x16x32_bf16 a[116:119], a[48:51], a[172:175], a[116:119]
    ds_read_b64_tr_b16 a[8:9], v20 offset:16640
    ds_read_b64_tr_b16 a[10:11], v20 offset:18688
    v_mfma_f32_16x16x32_bf16 a[112:115], a[48:51], a[168:171], a[112:115]
    s_add_u32 s82, s73, 163840
    v_mfma_f32_16x16x32_bf16 a[120:123], a[52:55], a[168:171], a[120:123]
    ds_read_b64_tr_b16 a[12:13], v21 offset:16640
    ds_read_b64_tr_b16 a[14:15], v21 offset:18688
    v_mfma_f32_16x16x32_bf16 a[124:127], a[52:55], a[172:175], a[124:127]
    s_waitcnt lgkmcnt(8)
    ds_read_b64_tr_b16 a[16:17], v22 offset:16640
    v_mfma_f32_16x16x32_bf16 a[132:135], a[56:59], a[172:175], a[132:135]
    buffer_load_dwordx4 v3, s[40:43], s82 offen lds
    v_mfma_f32_16x16x32_bf16 a[128:131], a[56:59], a[168:171], a[128:131]
    s_add_u32 m0, s77, 18432
    ds_read_b64_tr_b16 a[18:19], v22 offset:18688
    v_mfma_f32_16x16x32_bf16 a[136:139], a[60:63], a[168:171], a[136:139]
    ds_read_b64_tr_b16 a[20:21], v23 offset:16640
    ds_read_b64_tr_b16 a[22:23], v23 offset:18688
    v_mfma_f32_16x16x32_bf16 a[140:143], a[60:63], a[172:175], a[140:143]
    s_waitcnt lgkmcnt(8)
    s_add_u32 s82, s73, 294912
    v_mfma_f32_16x16x32_bf16 a[148:151], a[0:3], a[172:175], a[148:151]
    ds_read_b64_tr_b16 a[24:25], v10 offset:8192
    ds_read_b64_tr_b16 a[26:27], v10 offset:9216
    v_mfma_f32_16x16x32_bf16 a[144:147], a[0:3], a[168:171], a[144:147]
    buffer_load_dwordx4 v3, s[40:43], s82 offen lds
    v_mfma_f32_16x16x32_bf16 v[40:43], a[4:7], a[168:171], v[40:43]
    ds_read_b64_tr_b16 a[28:29], v11 offset:8192
    ds_read_b64_tr_b16 a[30:31], v11 offset:9216
    v_mfma_f32_16x16x32_bf16 v[44:47], a[4:7], a[172:175], v[44:47]
    s_waitcnt lgkmcnt(8)
    s_add_u32 m0, s77, 26624
    v_mfma_f32_16x16x32_bf16 v[68:71], a[8:11], a[172:175], v[68:71]
    ds_read_b64_tr_b16 a[32:33], v12 offset:8192
    ds_read_b64_tr_b16 a[34:35], v12 offset:9216
    v_mfma_f32_16x16x32_bf16 v[64:67], a[8:11], a[168:171], v[64:67]
    s_add_u32 s82, s73, 425984
    v_mfma_f32_16x16x32_bf16 v[72:75], a[12:15], a[168:171], v[72:75]
    ds_read_b64_tr_b16 a[36:37], v13 offset:8192
    ds_read_b64_tr_b16 a[38:39], v13 offset:9216
    v_mfma_f32_16x16x32_bf16 v[76:79], a[12:15], a[172:175], v[76:79]
    s_waitcnt lgkmcnt(8)
    ds_read_b64_tr_b16 a[40:41], v14 offset:8192
    v_mfma_f32_16x16x32_bf16 v[84:87], a[16:19], a[172:175], v[84:87]
    buffer_load_dwordx4 v3, s[40:43], s82 offen lds
    v_mfma_f32_16x16x32_bf16 v[80:83], a[16:19], a[168:171], v[80:83]
    s_add_u32 s73, s73, 524288
    ds_read_b64_tr_b16 a[42:43], v14 offset:9216
    v_mfma_f32_16x16x32_bf16 v[88:91], a[20:23], a[168:171], v[88:91]
    ds_read_b64_tr_b16 a[44:45], v15 offset:8192
    ds_read_b64_tr_b16 a[46:47], v15 offset:9216
    v_mfma_f32_16x16x32_bf16 v[92:95], a[20:23], a[172:175], v[92:95]
    s_waitcnt lgkmcnt(8)
    s_add_u32 s86, s86, s90
    v_mfma_f32_16x16x32_bf16 v[112:115], a[24:27], a[172:175], v[112:115]
    v_xor_b32 v8, 0x8000, v8
    v_xor_b32 v9, 0x8000, v9
    v_mfma_f32_16x16x32_bf16 v[96:99], a[24:27], a[168:171], v[96:99]
    s_cmp_eq_u32 s86, 163840
    s_cselect_b32 s86, 65536, s86
    v_xor_b32 v10, 0x8000, v10
    v_mfma_f32_16x16x32_bf16 v[100:103], a[28:31], a[168:171], v[100:103]
    v_xor_b32 v11, 0x8000, v11
    v_xor_b32 v12, 0x8000, v12
    v_mfma_f32_16x16x32_bf16 v[116:119], a[28:31], a[172:175], v[116:119]
    s_waitcnt vmcnt(33) lgkmcnt(0)
    s_barrier
    v_xor_b32 v13, 0x8000, v13
    v_mfma_f32_16x16x32_bf16 v[120:123], a[32:35], a[172:175], v[120:123]
    v_xor_b32 v14, 0x8000, v14
    v_xor_b32 v15, 0x8000, v15
    v_add_u32 v16, 0x8000, v16
    v_add_u32 v17, 0x8000, v17
    v_add_u32 v18, 0x8000, v18
    v_add_u32 v19, 0x8000, v19
    v_add_u32 v20, 0x8000, v20
    v_add_u32 v21, 0x8000, v21
    v_add_u32 v22, 0x8000, v22
    v_add_u32 v23, 0x8000, v23
    v_mfma_f32_16x16x32_bf16 v[104:107], a[32:35], a[168:171], v[104:107]
    ds_read_b128 a[160:163], v8 offset:0
    ds_read_b128 a[164:167], v8 offset:2048
    v_mfma_f32_16x16x32_bf16 v[108:111], a[36:39], a[168:171], v[108:111]
    ds_read_b64_tr_b16 a[48:49], v16 offset:0
    v_mfma_f32_16x16x32_bf16 v[124:127], a[36:39], a[172:175], v[124:127]
    ds_read_b64_tr_b16 a[50:51], v16 offset:2048
    ds_read_b64_tr_b16 a[52:53], v17 offset:0
    v_mfma_f32_16x16x32_bf16 v[56:59], a[172:175], a[40:43], v[56:59]
    ds_read_b64_tr_b16 a[54:55], v17 offset:2048
    v_mfma_f32_16x16x32_bf16 v[48:51], a[168:171], a[40:43], v[48:51]
    ds_read_b64_tr_b16 a[56:57], v18 offset:0
    ds_read_b64_tr_b16 a[58:59], v18 offset:2048
    v_mfma_f32_16x16x32_bf16 v[52:55], a[168:171], a[44:47], v[52:55]
    v_mfma_f32_16x16x32_bf16 v[60:63], a[172:175], a[44:47], v[60:63]
    s_waitcnt lgkmcnt(4)
    v_mfma_f32_16x16x32_bf16 v[32:35], a[244:247], a[160:163], v[32:35]
    s_add_u32 m0, s76, 0
    ds_read_b64_tr_b16 a[60:61], v19 offset:0
    ds_read_b64_tr_b16 a[62:63], v19 offset:2048
    v_mfma_f32_16x16x32_bf16 v[36:39], a[244:247], a[164:167], v[36:39]
    s_add_u32 s81, s72, 0
    ds_read_b64_tr_b16 a[0:1], v20 offset:0
    ds_read_b64_tr_b16 a[2:3], v20 offset:2048
    v_mfma_f32_16x16x32_bf16 a[68:71], a[48:51], a[164:167], a[68:71]
    ds_read_b64_tr_b16 a[4:5], v21 offset:0
    ds_read_b64_tr_b16 a[6:7], v21 offset:2048
    v_mfma_f32_16x16x32_bf16 a[64:67], a[48:51], a[160:163], a[64:67]
    s_waitcnt lgkmcnt(6)
    s_lshl_b32 s83, s63, 1
    ds_read_b64_tr_b16 a[8:9], v22 offset:0
    v_mfma_f32_16x16x32_bf16 a[72:75], a[52:55], a[160:163], a[72:75]
    buffer_load_dwordx4 v4, s[36:39], s81 offen lds
    v_mfma_f32_16x16x32_bf16 a[76:79], a[52:55], a[164:167], a[76:79]
    s_add_u32 m0, s76, 4096
    ds_read_b64_tr_b16 a[10:11], v22 offset:2048
    ds_read_b64_tr_b16 a[12:13], v23 offset:0
    v_mfma_f32_16x16x32_bf16 a[84:87], a[56:59], a[164:167], a[84:87]
    s_add_u32 s81, s72, 28672
    ds_read_b64_tr_b16 a[14:15], v23 offset:2048
    ds_read_b64_tr_b16 a[16:17], v16 offset:256
    v_mfma_f32_16x16x32_bf16 a[80:83], a[56:59], a[160:163], a[80:83]
    s_waitcnt lgkmcnt(7)
    s_sub_u32 s84, 32, s83
    ds_read_b64_tr_b16 a[18:19], v16 offset:2304
    v_mfma_f32_16x16x32_bf16 a[88:91], a[60:63], a[160:163], a[88:91]
    buffer_load_dwordx4 v4, s[36:39], s81 offen lds
    v_mfma_f32_16x16x32_bf16 a[92:95], a[60:63], a[164:167], a[92:95]
    s_add_u32 m0, s76, 8192
    ds_read_b64_tr_b16 a[20:21], v17 offset:256
    ds_read_b64_tr_b16 a[22:23], v17 offset:2304
    v_mfma_f32_16x16x32_bf16 a[100:103], a[0:3], a[164:167], a[100:103]
    s_add_u32 s81, s72, 57344
    s_min_u32 s6, s84, 19
    ds_read_b64_tr_b16 a[24:25], v18 offset:256
    v_mfma_f32_16x16x32_bf16 a[96:99], a[0:3], a[160:163], a[96:99]
    s_waitcnt lgkmcnt(7)
    ds_read_b64_tr_b16 a[26:27], v18 offset:2304
    ds_read_b64_tr_b16 a[28:29], v19 offset:256
    v_mfma_f32_16x16x32_bf16 a[104:107], a[4:7], a[160:163], a[104:107]
    buffer_load_dwordx4 v4, s[36:39], s81 offen lds
    v_mfma_f32_16x16x32_bf16 a[108:111], a[4:7], a[164:167], a[108:111]
    s_add_u32 m0, s76, 12288
    s_lshl_b32 s3, s84, 15
    ds_read_b64_tr_b16 a[30:31], v19 offset:2304
    v_mfma_f32_16x16x32_bf16 a[116:119], a[8:11], a[164:167], a[116:119]
    s_add_u32 s81, s72, 86016
    ds_read_b64_tr_b16 a[32:33], v20 offset:256
    ds_read_b64_tr_b16 a[34:35], v20 offset:2304
    v_mfma_f32_16x16x32_bf16 a[112:115], a[8:11], a[160:163], a[112:115]
    s_waitcnt lgkmcnt(8)
    s_cmp_gt_u32 s84, 19
    s_cselect_b32 s7, 1, 0
    v_mfma_f32_16x16x32_bf16 a[120:123], a[12:15], a[160:163], a[120:123]
    buffer_load_dwordx4 v4, s[36:39], s81 offen lds
    v_mfma_f32_16x16x32_bf16 a[124:127], a[12:15], a[164:167], a[124:127]
    s_add_u32 m0, s89, 16384
    ds_read_b64_tr_b16 a[36:37], v21 offset:256
    ds_read_b64_tr_b16 a[38:39], v21 offset:2304
    v_mfma_f32_16x16x32_bf16 a[132:135], a[16:19], a[164:167], a[132:135]
    s_add_u32 s81, s74, 0
    s_and_b32 s22, s7, s65
    ds_read_b64_tr_b16 a[40:41], v22 offset:256
    v_mfma_f32_16x16x32_bf16 a[128:131], a[16:19], a[160:163], a[128:131]
    s_waitcnt lgkmcnt(7)
    ds_read_b64_tr_b16 a[42:43], v22 offset:2304
    ds_read_b64_tr_b16 a[44:45], v23 offset:256
    v_mfma_f32_16x16x32_bf16 a[136:139], a[20:23], a[160:163], a[136:139]
    buffer_load_dwordx4 v6, s[44:47], s81 offen lds
    v_mfma_f32_16x16x32_bf16 a[140:143], a[20:23], a[164:167], a[140:143]
    s_add_u32 m0, s89, 20480
    s_add_u32 s81, s74, 43008
    ds_read_b64_tr_b16 a[46:47], v23 offset:2304
    v_mfma_f32_16x16x32_bf16 a[148:151], a[24:27], a[164:167], a[148:151]
    s_mul_i32 s22, s22, 268435456
    ds_read_b64_tr_b16 a[48:49], v10 offset:0
    ds_read_b64_tr_b16 a[50:51], v10 offset:1024
    v_mfma_f32_16x16x32_bf16 a[144:147], a[24:27], a[160:163], a[144:147]
    s_waitcnt lgkmcnt(8)
    s_mov_b64 s[20:21], s[48:49]
    ds_read_b64_tr_b16 a[52:53], v11 offset:0
    v_mfma_f32_16x16x32_bf16 v[40:43], a[28:31], a[160:163], v[40:43]
    buffer_load_dwordx4 v6, s[44:47], s81 offen lds
    v_mfma_f32_16x16x32_bf16 v[44:47], a[28:31], a[164:167], v[44:47]
    s_add_u32 m0, s89, 24576
    s_add_u32 s81, s74, 86016
    ds_read_b64_tr_b16 a[54:55], v11 offset:1024
    v_mfma_f32_16x16x32_bf16 v[68:71], a[32:35], a[164:167], v[68:71]
    buffer_load_dwordx4 v6, s[44:47], s81 offen lds
    v_mfma_f32_16x16x32_bf16 v[64:67], a[32:35], a[160:163], v[64:67]
    s_waitcnt lgkmcnt(6)
    ds_read_b64_tr_b16 a[56:57], v12 offset:0
    ds_read_b64_tr_b16 a[58:59], v12 offset:1024
    v_mfma_f32_16x16x32_bf16 v[72:75], a[36:39], a[160:163], v[72:75]
    s_add_u32 m0, s89, 28672
    s_add_u32 s81, s74, 129024
    s_mov_b32 s23, 0x00020000
    v_mfma_f32_16x16x32_bf16 v[76:79], a[36:39], a[164:167], v[76:79]
    s_lshl_b32 s7, s7, s65
    ds_read_b64_tr_b16 a[60:61], v13 offset:0
    ds_read_b64_tr_b16 a[62:63], v13 offset:1024
    v_mfma_f32_16x16x32_bf16 v[84:87], a[40:43], a[164:167], v[84:87]
    buffer_load_dwordx4 v6, s[44:47], s81 offen lds
    v_mfma_f32_16x16x32_bf16 v[80:83], a[40:43], a[160:163], v[80:83]
    s_waitcnt lgkmcnt(6)
    s_add_u32 s72, s72, 128
    ds_read_b64_tr_b16 a[0:1], v14 offset:0
    v_mfma_f32_16x16x32_bf16 v[88:91], a[44:47], a[160:163], v[88:91]
    s_add_u32 s74, s74, 172032
    ds_read_b64_tr_b16 a[2:3], v14 offset:1024
    ds_read_b64_tr_b16 a[4:5], v15 offset:0
    v_mfma_f32_16x16x32_bf16 v[92:95], a[44:47], a[164:167], v[92:95]
    s_xor_b32 s76, s76, s90
    s_sub_u32 s4, 15, s63
    ds_read_b64_tr_b16 a[6:7], v15 offset:1024
    v_mfma_f32_16x16x32_bf16 v[112:115], a[48:51], a[164:167], v[112:115]
    s_xor_b32 s89, s89, s90
    ds_read_b128 a[168:171], v9 offset:0
    ds_read_b128 a[172:175], v9 offset:2048
    v_mfma_f32_16x16x32_bf16 v[96:99], a[48:51], a[160:163], v[96:99]
    s_waitcnt lgkmcnt(8)
    ds_read_b64_tr_b16 a[8:9], v16 offset:16384
    ds_read_b64_tr_b16 a[10:11], v16 offset:18432
    v_mfma_f32_16x16x32_bf16 v[100:103], a[52:55], a[160:163], v[100:103]
    buffer_store_dwordx4 v[204:207], v1, s[48:51], s87 offen offset:3072 sc1
    v_mfma_f32_16x16x32_bf16 v[116:119], a[52:55], a[164:167], v[116:119]
    s_cmp_eq_u32 s7, 1
    s_cselect_b32 s4, s4, s88
    s_cselect_b32 s5, 19, 0
    s_cselect_b32 s3, s3, -1
    v_mfma_f32_16x16x32_bf16 v[120:123], a[56:59], a[164:167], v[120:123]
    s_add_u32 s87, s87, s16
    ds_read_b64_tr_b16 a[12:13], v17 offset:16384
    ds_read_b64_tr_b16 a[14:15], v17 offset:18432
    v_mfma_f32_16x16x32_bf16 v[104:107], a[56:59], a[160:163], v[104:107]
    s_waitcnt lgkmcnt(8)
    s_add_u32 s83, s83, 2
    ds_read_b64_tr_b16 a[16:17], v18 offset:16384
    v_mfma_f32_16x16x32_bf16 v[108:111], a[60:63], a[160:163], v[108:111]
    buffer_store_dwordx4 v[208:211], v1, s[48:51], s87 offen offset:0 sc1
    v_mfma_f32_16x16x32_bf16 v[124:127], a[60:63], a[164:167], v[124:127]
    buffer_store_dwordx4 v[212:215], v1, s[48:51], s87 offen offset:1024 sc1
    v_mfma_f32_16x16x32_bf16 v[56:59], a[164:167], a[0:3], v[56:59]
    ds_read_b64_tr_b16 a[18:19], v18 offset:18432
    ds_read_b64_tr_b16 a[20:21], v19 offset:16384
    v_mfma_f32_16x16x32_bf16 v[48:51], a[160:163], a[0:3], v[48:51]
    s_waitcnt lgkmcnt(7)
    s_cmp_eq_u32 s65, 1
    s_cselect_b32 s6, s6, s83
    v_mfma_f32_16x16x32_bf16 v[52:55], a[160:163], a[4:7], v[52:55]
    buffer_store_dwordx4 v[216:219], v1, s[48:51], s87 offen offset:2048 sc1
    v_mfma_f32_16x16x32_bf16 v[60:63], a[164:167], a[4:7], v[60:63]
    buffer_store_dwordx4 v[220:223], v1, s[48:51], s87 offen offset:3072 sc1
    v_mfma_f32_16x16x32_bf16 v[32:35], a[240:243], a[168:171], v[32:35]
    s_add_u32 s87, s87, s17
    ds_read_b64_tr_b16 a[22:23], v19 offset:18432
    ds_read_b64_tr_b16 a[24:25], v20 offset:16384
    v_mfma_f32_16x16x32_bf16 v[36:39], a[240:243], a[172:175], v[36:39]
    s_waitcnt lgkmcnt(5)
    s_lshl_b32 s10, s6, 15
    ds_read_b64_tr_b16 a[26:27], v20 offset:18432
    v_mfma_f32_16x16x32_bf16 a[68:71], a[8:11], a[172:175], a[68:71]
    buffer_store_dwordx4 v[224:227], v1, s[48:51], s87 offen offset:0 sc1
    v_mfma_f32_16x16x32_bf16 a[64:67], a[8:11], a[168:171], a[64:67]
    buffer_store_dwordx4 v[228:231], v1, s[48:51], s87 offen offset:1024 sc1
    v_mfma_f32_16x16x32_bf16 a[72:75], a[12:15], a[168:171], a[72:75]
    s_add_u32 s77, s86, s85
    ds_read_b64_tr_b16 a[28:29], v21 offset:16384
    ds_read_b64_tr_b16 a[30:31], v21 offset:18432
    v_mfma_f32_16x16x32_bf16 a[76:79], a[12:15], a[172:175], a[76:79]
    s_waitcnt lgkmcnt(4)
    s_add_u32 m0, s77, 0
    ds_read_b64_tr_b16 a[32:33], v22 offset:16384
    ds_read_b64_tr_b16 a[34:35], v22 offset:18432
    v_mfma_f32_16x16x32_bf16 a[84:87], a[16:19], a[172:175], a[84:87]
    s_cmp_eq_u32 s7, 1
    s_cselect_b32 s6, s84, s6
    s_cselect_b32 s10, 1048576, s10
    v_mfma_f32_16x16x32_bf16 a[80:83], a[16:19], a[168:171], a[80:83]
    s_add_u32 s82, s73, 0
    ds_read_b64_tr_b16 a[36:37], v23 offset:16384
    ds_read_b64_tr_b16 a[38:39], v23 offset:18432
    v_mfma_f32_16x16x32_bf16 a[88:91], a[20:23], a[168:171], a[88:91]
    buffer_load_dwordx4 v3, s[40:43], s82 offen lds
    v_mfma_f32_16x16x32_bf16 a[92:95], a[20:23], a[172:175], a[92:95]
    s_waitcnt lgkmcnt(4)
    s_add_u32 m0, s77, 8192
    s_sub_u32 s6, s6, 1
    v_mfma_f32_16x16x32_bf16 a[100:103], a[24:27], a[172:175], a[100:103]
    s_add_u32 s82, s73, 131072
    ds_read_b64_tr_b16 a[40:41], v16 offset:16640
    ds_read_b64_tr_b16 a[42:43], v16 offset:18688
    v_mfma_f32_16x16x32_bf16 a[96:99], a[24:27], a[168:171], a[96:99]
    s_mov_b32 s14, s10
    ds_read_b64_tr_b16 a[44:45], v17 offset:16640
    ds_read_b64_tr_b16 a[46:47], v17 offset:18688
    v_mfma_f32_16x16x32_bf16 a[104:107], a[28:31], a[168:171], a[104:107]
    buffer_load_dwordx4 v3, s[40:43], s82 offen lds
    v_mfma_f32_16x16x32_bf16 a[108:111], a[28:31], a[172:175], a[108:111]
    s_waitcnt lgkmcnt(4)
    s_add_u32 m0, s77, 16384
    ds_read_b64_tr_b16 a[48:49], v18 offset:16640
    v_mfma_f32_16x16x32_bf16 a[116:119], a[32:35], a[172:175], a[116:119]
    s_add_u32 s82, s73, 262144
    s_mov_b32 s11, 0x00020000
    ds_read_b64_tr_b16 a[50:51], v18 offset:18688
    v_mfma_f32_16x16x32_bf16 a[112:115], a[32:35], a[168:171], a[112:115]
    s_mov_b32 s15, 0x00020000
    ds_read_b64_tr_b16 a[52:53], v19 offset:16640
    ds_read_b64_tr_b16 a[54:55], v19 offset:18688
    v_mfma_f32_16x16x32_bf16 a[120:123], a[36:39], a[168:171], a[120:123]
    buffer_load_dwordx4 v3, s[40:43], s82 offen lds
    v_mfma_f32_16x16x32_bf16 a[124:127], a[36:39], a[172:175], a[124:127]
    s_waitcnt lgkmcnt(4)
    s_add_u32 m0, s77, 24576
    ds_read_b64_tr_b16 a[56:57], v20 offset:16640
    v_mfma_f32_16x16x32_bf16 a[132:135], a[40:43], a[172:175], a[132:135]
    s_add_u32 s82, s73, 393216
    ds_read_b64_tr_b16 a[58:59], v20 offset:18688
    ds_read_b64_tr_b16 a[60:61], v21 offset:16640
    v_mfma_f32_16x16x32_bf16 a[128:131], a[40:43], a[168:171], a[128:131]
    buffer_load_dwordx4 v3, s[40:43], s82 offen lds
    v_mfma_f32_16x16x32_bf16 a[136:139], a[44:47], a[168:171], a[136:139]
    s_add_u32 m0, s77, 2048
    s_lshl_b32 s83, s64, 20
    ds_read_b64_tr_b16 a[62:63], v21 offset:18688
    v_mfma_f32_16x16x32_bf16 a[140:143], a[44:47], a[172:175], a[140:143]
    s_waitcnt lgkmcnt(4)
    s_add_u32 s82, s73, 32768
    ds_read_b64_tr_b16 a[0:1], v22 offset:16640
    v_mfma_f32_16x16x32_bf16 a[148:151], a[48:51], a[172:175], a[148:151]
    ds_read_b64_tr_b16 a[2:3], v22 offset:18688
    ds_read_b64_tr_b16 a[4:5], v23 offset:16640
    ds_read_b64_tr_b16 a[6:7], v23 offset:18688
    v_mfma_f32_16x16x32_bf16 a[144:147], a[48:51], a[168:171], a[144:147]
    buffer_load_dwordx4 v3, s[40:43], s82 offen lds
    s_add_u32 m0, s77, 10240
    v_mfma_f32_16x16x32_bf16 v[40:43], a[52:55], a[168:171], v[40:43]
    s_add_u32 s8, s48, s83
    s_addc_u32 s9, s49, 0
    s_add_u32 s12, s8, 16777216
    s_addc_u32 s13, s9, 0
    v_mfma_f32_16x16x32_bf16 v[44:47], a[52:55], a[172:175], v[44:47]
    s_waitcnt lgkmcnt(4)
    s_add_u32 s82, s73, 163840
    ds_read_b64_tr_b16 a[8:9], v10 offset:8192
    v_mfma_f32_16x16x32_bf16 v[68:71], a[56:59], a[172:175], v[68:71]
    s_lshl_b32 s27, s5, 15
    ds_read_b64_tr_b16 a[10:11], v10 offset:9216
    ds_read_b64_tr_b16 a[12:13], v11 offset:8192
    v_mfma_f32_16x16x32_bf16 v[64:67], a[56:59], a[168:171], v[64:67]
    buffer_load_dwordx4 v3, s[40:43], s82 offen lds
    v_mfma_f32_16x16x32_bf16 v[72:75], a[60:63], a[168:171], v[72:75]
    s_add_u32 m0, s77, 18432
    ds_read_b64_tr_b16 a[14:15], v11 offset:9216
    ds_read_b64_tr_b16 a[16:17], v12 offset:8192
    v_mfma_f32_16x16x32_bf16 v[76:79], a[60:63], a[172:175], v[76:79]
    s_waitcnt lgkmcnt(5)
    s_add_u32 s82, s73, 294912
    s_add_u32 s26, s27, s90
    v_mfma_f32_16x16x32_bf16 v[84:87], a[0:3], a[172:175], v[84:87]
    ds_read_b64_tr_b16 a[18:19], v12 offset:9216
    ds_read_b64_tr_b16 a[20:21], v13 offset:8192
    v_mfma_f32_16x16x32_bf16 v[80:83], a[0:3], a[168:171], v[80:83]
    buffer_load_dwordx4 v3, s[40:43], s82 offen lds
    v_mfma_f32_16x16x32_bf16 v[88:91], a[4:7], a[168:171], v[88:91]
    s_add_u32 m0, s77, 26624
    s_add_u32 s82, s73, 425984
    ds_read_b64_tr_b16 a[22:23], v13 offset:9216
    ds_read_b64_tr_b16 a[24:25], v14 offset:8192
    ds_read_b64_tr_b16 a[26:27], v14 offset:9216
    ds_read_b64_tr_b16 a[28:29], v15 offset:8192
    ds_read_b64_tr_b16 a[30:31], v15 offset:9216
    v_mfma_f32_16x16x32_bf16 v[92:95], a[4:7], a[172:175], v[92:95]
    s_waitcnt lgkmcnt(8)
    s_cmp_eq_u32 s26, s3
    s_cselect_b32 s26, 0, s26
    v_mfma_f32_16x16x32_bf16 v[112:115], a[8:11], a[172:175], v[112:115]
    buffer_load_dwordx4 v3, s[40:43], s82 offen lds
    v_mfma_f32_16x16x32_bf16 v[96:99], a[8:11], a[168:171], v[96:99]
    s_add_u32 s73, s73, 524288
    s_add_u32 s86, s86, s90
    s_cmp_eq_u32 s86, 163840
    s_cselect_b32 s86, 65536, s86
    s_lshl_b32 s83, s60, 13
    v_mfma_f32_16x16x32_bf16 v[100:103], a[12:15], a[168:171], v[100:103]
    v_xor_b32 v8, 0x8000, v8
    v_xor_b32 v9, 0x8000, v9
    v_mfma_f32_16x16x32_bf16 v[116:119], a[12:15], a[172:175], v[116:119]
    s_waitcnt vmcnt(15) lgkmcnt(0)
    s_barrier
    v_xor_b32 v10, 0x8000, v10
    v_mfma_f32_16x16x32_bf16 v[120:123], a[16:19], a[172:175], v[120:123]
    v_xor_b32 v11, 0x8000, v11
    v_xor_b32 v12, 0x8000, v12
    v_xor_b32 v13, 0x8000, v13
    v_xor_b32 v14, 0x8000, v14
    v_xor_b32 v15, 0x8000, v15
    v_add_u32 v16, 0xffff0000, v16
    v_add_u32 v17, 0xffff0000, v17
    v_add_u32 v18, 0xffff0000, v18
    v_add_u32 v19, 0xffff0000, v19
    v_add_u32 v20, 0xffff0000, v20
    v_add_u32 v21, 0xffff0000, v21
    v_add_u32 v22, 0xffff0000, v22
    v_add_u32 v23, 0xffff0000, v23
    v_mfma_f32_16x16x32_bf16 v[104:107], a[16:19], a[168:171], v[104:107]
    v_add_u32 v2, s83, v1
    v_add_u32 v5, 4096, v2
    v_mfma_f32_16x16x32_bf16 v[108:111], a[20:23], a[168:171], v[108:111]
    ds_read_b128 a[160:163], v8 offset:0
    ds_read_b128 a[164:167], v8 offset:2048
    v_mfma_f32_16x16x32_bf16 v[124:127], a[20:23], a[172:175], v[124:127]
    s_mov_b32 s66, s83
    ds_read_b64_tr_b16 a[32:33], v16 offset:0
    ds_read_b64_tr_b16 a[34:35], v16 offset:2048
    v_mfma_f32_16x16x32_bf16 v[56:59], a[172:175], a[24:27], v[56:59]
    ds_read_b64_tr_b16 a[36:37], v17 offset:0
    ds_read_b64_tr_b16 a[38:39], v17 offset:2048
    v_mfma_f32_16x16x32_bf16 v[48:51], a[168:171], a[24:27], v[48:51]
    ds_read_b64_tr_b16 a[40:41], v18 offset:0
    ds_read_b64_tr_b16 a[42:43], v18 offset:2048
    v_mfma_f32_16x16x32_bf16 v[52:55], a[168:171], a[28:31], v[52:55]
    v_mfma_f32_16x16x32_bf16 v[60:63], a[172:175], a[28:31], v[60:63]
    s_waitcnt lgkmcnt(4)
    v_mfma_f32_16x16x32_bf16 v[32:35], a[236:239], a[160:163], v[32:35]
    s_add_u32 m0, s76, 0
    ds_read_b64_tr_b16 a[44:45], v19 offset:0
    ds_read_b64_tr_b16 a[46:47], v19 offset:2048
    v_mfma_f32_16x16x32_bf16 v[36:39], a[236:239], a[164:167], v[36:39]
    s_add_u32 s81, s72, 0
    ds_read_b64_tr_b16 a[48:49], v20 offset:0
    ds_read_b64_tr_b16 a[50:51], v20 offset:2048
    v_mfma_f32_16x16x32_bf16 a[68:71], a[32:35], a[164:167], a[68:71]
    ds_read_b64_tr_b16 a[52:53], v21 offset:0
    ds_read_b64_tr_b16 a[54:55], v21 offset:2048
    v_mfma_f32_16x16x32_bf16 a[64:67], a[32:35], a[160:163], a[64:67]
    s_waitcnt lgkmcnt(6)
    ds_read_b64_tr_b16 a[56:57], v22 offset:0
    ds_read_b64_tr_b16 a[58:59], v22 offset:2048
    v_mfma_f32_16x16x32_bf16 a[72:75], a[36:39], a[160:163], a[72:75]
    buffer_load_dwordx4 v4, s[36:39], s81 offen lds
    v_mfma_f32_16x16x32_bf16 a[76:79], a[36:39], a[164:167], a[76:79]
    s_add_u32 m0, s76, 4096
    ds_read_b64_tr_b16 a[60:61], v23 offset:0
    ds_read_b64_tr_b16 a[62:63], v23 offset:2048
    v_mfma_f32_16x16x32_bf16 a[84:87], a[40:43], a[164:167], a[84:87]
    s_add_u32 s81, s72, 28672
    ds_read_b64_tr_b16 a[0:1], v16 offset:256
    ds_read_b64_tr_b16 a[2:3], v16 offset:2304
    v_mfma_f32_16x16x32_bf16 a[80:83], a[40:43], a[160:163], a[80:83]
    s_waitcnt lgkmcnt(8)
    ds_read_b64_tr_b16 a[4:5], v17 offset:256
    v_mfma_f32_16x16x32_bf16 a[88:91], a[44:47], a[160:163], a[88:91]
    buffer_load_dwordx4 v4, s[36:39], s81 offen lds
    v_mfma_f32_16x16x32_bf16 a[92:95], a[44:47], a[164:167], a[92:95]
    s_add_u32 m0, s76, 8192
    s_add_u32 s81, s72, 57344
    ds_read_b64_tr_b16 a[6:7], v17 offset:2304
    v_mfma_f32_16x16x32_bf16 a[100:103], a[48:51], a[164:167], a[100:103]
    ds_read_b64_tr_b16 a[8:9], v18 offset:256
    ds_read_b64_tr_b16 a[10:11], v18 offset:2304
    v_mfma_f32_16x16x32_bf16 a[96:99], a[48:51], a[160:163], a[96:99]
    s_waitcnt lgkmcnt(8)
    ds_read_b64_tr_b16 a[12:13], v19 offset:256
    v_mfma_f32_16x16x32_bf16 a[104:107], a[52:55], a[160:163], a[104:107]
    buffer_load_dwordx4 v4, s[36:39], s81 offen lds
    v_mfma_f32_16x16x32_bf16 a[108:111], a[52:55], a[164:167], a[108:111]
    s_add_u32 m0, s76, 12288
    s_add_u32 s81, s72, 86016
    ds_read_b64_tr_b16 a[14:15], v19 offset:2304
    v_mfma_f32_16x16x32_bf16 a[116:119], a[56:59], a[164:167], a[116:119]
    buffer_load_dwordx4 v4, s[36:39], s81 offen lds
    v_mfma_f32_16x16x32_bf16 a[112:115], a[56:59], a[160:163], a[112:115]
    s_waitcnt lgkmcnt(6)
    ds_read_b64_tr_b16 a[16:17], v20 offset:256
    ds_read_b64_tr_b16 a[18:19], v20 offset:2304
    v_mfma_f32_16x16x32_bf16 a[120:123], a[60:63], a[160:163], a[120:123]
    s_add_u32 m0, s89, 16384
    s_add_u32 s81, s74, 0
    ds_read_b64_tr_b16 a[20:21], v21 offset:256
    v_mfma_f32_16x16x32_bf16 a[124:127], a[60:63], a[164:167], a[124:127]
    ds_read_b64_tr_b16 a[22:23], v21 offset:2304
    ds_read_b64_tr_b16 a[24:25], v22 offset:256
    v_mfma_f32_16x16x32_bf16 a[132:135], a[0:3], a[164:167], a[132:135]
    buffer_load_dwordx4 v6, s[44:47], s81 offen lds
    v_mfma_f32_16x16x32_bf16 a[128:131], a[0:3], a[160:163], a[128:131]
    s_waitcnt lgkmcnt(7)
    s_add_u32 m0, s89, 20480
    ds_read_b64_tr_b16 a[26:27], v22 offset:2304
    v_mfma_f32_16x16x32_bf16 a[136:139], a[4:7], a[160:163], a[136:139]
    s_add_u32 s81, s74, 43008
    ds_read_b64_tr_b16 a[28:29], v23 offset:256
    ds_read_b64_tr_b16 a[30:31], v23 offset:2304
    v_mfma_f32_16x16x32_bf16 a[140:143], a[4:7], a[164:167], a[140:143]
    buffer_load_dwordx4 v6, s[44:47], s81 offen lds
    v_mfma_f32_16x16x32_bf16 a[148:151], a[8:11], a[164:167], a[148:151]
    s_add_u32 m0, s89, 24576
    ds_read_b64_tr_b16 a[32:33], v10 offset:0
    ds_read_b64_tr_b16 a[34:35], v10 offset:1024
    v_mfma_f32_16x16x32_bf16 a[144:147], a[8:11], a[160:163], a[144:147]
    s_waitcnt lgkmcnt(8)
    v_mfma_f32_16x16x32_bf16 v[40:43], a[12:15], a[160:163], v[40:43]
    s_add_u32 s81, s74, 86016
    ds_read_b64_tr_b16 a[36:37], v11 offset:0
    ds_read_b64_tr_b16 a[38:39], v11 offset:1024
    v_mfma_f32_16x16x32_bf16 v[44:47], a[12:15], a[164:167], v[44:47]
    buffer_load_dwordx4 v6, s[44:47], s81 offen lds
    v_mfma_f32_16x16x32_bf16 v[68:71], a[16:19], a[164:167], v[68:71]
    s_add_u32 m0, s89, 28672
    ds_read_b64_tr_b16 a[40:41], v12 offset:0
    ds_read_b64_tr_b16 a[42:43], v12 offset:1024
    v_mfma_f32_16x16x32_bf16 v[64:67], a[16:19], a[160:163], v[64:67]
    s_waitcnt lgkmcnt(8)
    s_add_u32 s81, s74, 129024
    v_mfma_f32_16x16x32_bf16 v[72:75], a[20:23], a[160:163], v[72:75]
    ds_read_b64_tr_b16 a[44:45], v13 offset:0
    ds_read_b64_tr_b16 a[46:47], v13 offset:1024
    v_mfma_f32_16x16x32_bf16 v[76:79], a[20:23], a[164:167], v[76:79]
    buffer_load_dwordx4 v6, s[44:47], s81 offen lds
    v_mfma_f32_16x16x32_bf16 v[84:87], a[24:27], a[164:167], v[84:87]
    s_add_u32 s72, s72, 128
    ds_read_b64_tr_b16 a[48:49], v14 offset:0
    ds_read_b64_tr_b16 a[50:51], v14 offset:1024
    v_mfma_f32_16x16x32_bf16 v[80:83], a[24:27], a[160:163], v[80:83]
    s_waitcnt lgkmcnt(8)
    s_add_u32 s74, s74, 172032
    v_mfma_f32_16x16x32_bf16 v[88:91], a[28:31], a[160:163], v[88:91]
    s_xor_b32 s76, s76, s90
    ds_read_b64_tr_b16 a[52:53], v15 offset:0
    ds_read_b64_tr_b16 a[54:55], v15 offset:1024
    v_mfma_f32_16x16x32_bf16 v[92:95], a[28:31], a[164:167], v[92:95]
    v_mfma_f32_16x16x32_bf16 v[112:115], a[32:35], a[164:167], v[112:115]
    s_xor_b32 s89, s89, s90
    ds_read_b128 a[168:171], v9 offset:0
    ds_read_b128 a[172:175], v9 offset:2048
    v_mfma_f32_16x16x32_bf16 v[96:99], a[32:35], a[160:163], v[96:99]
    s_waitcnt lgkmcnt(8)
    ds_read_b64_tr_b16 a[56:57], v16 offset:16384
    ds_read_b64_tr_b16 a[58:59], v16 offset:18432
    v_mfma_f32_16x16x32_bf16 v[100:103], a[36:39], a[160:163], v[100:103]
    buffer_store_dwordx4 v[232:235], v1, s[48:51], s87 offen offset:2048 sc1
    v_mfma_f32_16x16x32_bf16 v[116:119], a[36:39], a[164:167], v[116:119]
    buffer_store_dwordx4 v[236:239], v1, s[48:51], s87 offen offset:3072 sc1
    v_mfma_f32_16x16x32_bf16 v[120:123], a[40:43], a[164:167], v[120:123]
    s_add_u32 s87, s87, s16
    ds_read_b64_tr_b16 a[60:61], v17 offset:16384
    ds_read_b64_tr_b16 a[62:63], v17 offset:18432
    v_mfma_f32_16x16x32_bf16 v[104:107], a[40:43], a[160:163], v[104:107]
    s_waitcnt lgkmcnt(8)
    ds_read_b64_tr_b16 a[0:1], v18 offset:16384
    ds_read_b64_tr_b16 a[2:3], v18 offset:18432
    v_mfma_f32_16x16x32_bf16 v[108:111], a[44:47], a[160:163], v[108:111]
    buffer_store_dwordx4 v[240:243], v1, s[48:51], s87 offen offset:0 sc1
    v_mfma_f32_16x16x32_bf16 v[124:127], a[44:47], a[164:167], v[124:127]
    buffer_store_dwordx4 v[244:247], v1, s[48:51], s87 offen offset:1024 sc1
    v_mfma_f32_16x16x32_bf16 v[56:59], a[164:167], a[48:51], v[56:59]
    buffer_store_dwordx4 v[248:251], v1, s[48:51], s87 offen offset:2048 sc1
    v_mfma_f32_16x16x32_bf16 v[48:51], a[160:163], a[48:51], v[48:51]
    s_waitcnt lgkmcnt(6)
    ds_read_b64_tr_b16 a[4:5], v19 offset:16384
    ds_read_b64_tr_b16 a[6:7], v19 offset:18432
    v_mfma_f32_16x16x32_bf16 v[52:55], a[160:163], a[52:55], v[52:55]
    buffer_store_dwordx4 v[252:255], v1, s[48:51], s87 offen offset:3072 sc1
    v_mfma_f32_16x16x32_bf16 v[60:63], a[164:167], a[52:55], v[60:63]
    s_add_u32 s87, s87, s17
    ds_read_b64_tr_b16 a[8:9], v20 offset:16384
    ds_read_b64_tr_b16 a[10:11], v20 offset:18432
    v_mfma_f32_16x16x32_bf16 v[32:35], a[232:235], a[168:171], v[32:35]
    ds_read_b64_tr_b16 a[12:13], v21 offset:16384
    v_mov_b32 v25, 0
    v_mfma_f32_16x16x32_bf16 v[36:39], a[232:235], a[172:175], v[36:39]
    s_waitcnt lgkmcnt(7)
    ds_read_b64_tr_b16 a[14:15], v21 offset:18432
    ds_read_b64_tr_b16 a[16:17], v22 offset:16384
    v_mfma_f32_16x16x32_bf16 a[68:71], a[56:59], a[172:175], a[68:71]
    buffer_load_dword v25, v25, s[68:71], 0 offen sc1
    v_mfma_f32_16x16x32_bf16 a[64:67], a[56:59], a[168:171], a[64:67]
    s_add_u32 s77, s86, s85
    s_add_u32 m0, s77, 0
    ds_read_b64_tr_b16 a[18:19], v22 offset:18432
    v_mfma_f32_16x16x32_bf16 a[72:75], a[60:63], a[168:171], a[72:75]
    s_add_u32 s82, s73, 0
    ds_read_b64_tr_b16 a[20:21], v23 offset:16384
    ds_read_b64_tr_b16 a[22:23], v23 offset:18432
    v_mfma_f32_16x16x32_bf16 a[76:79], a[60:63], a[172:175], a[76:79]
    s_waitcnt lgkmcnt(8)
    ds_read_b64_tr_b16 a[24:25], v16 offset:16640
    v_mfma_f32_16x16x32_bf16 a[84:87], a[0:3], a[172:175], a[84:87]
    buffer_load_dwordx4 v3, s[40:43], s82 offen lds
    v_mfma_f32_16x16x32_bf16 a[80:83], a[0:3], a[168:171], a[80:83]
    s_add_u32 m0, s77, 8192
    ds_read_b64_tr_b16 a[26:27], v16 offset:18688
    v_mfma_f32_16x16x32_bf16 a[88:91], a[4:7], a[168:171], a[88:91]
    s_add_u32 s82, s73, 131072
    ds_read_b64_tr_b16 a[28:29], v17 offset:16640
    ds_read_b64_tr_b16 a[30:31], v17 offset:18688
    v_mfma_f32_16x16x32_bf16 a[92:95], a[4:7], a[172:175], a[92:95]
    s_waitcnt lgkmcnt(8)
    ds_read_b64_tr_b16 a[32:33], v18 offset:16640
    v_mfma_f32_16x16x32_bf16 a[100:103], a[8:11], a[172:175], a[100:103]
    buffer_load_dwordx4 v3, s[40:43], s82 offen lds
    v_mfma_f32_16x16x32_bf16 a[96:99], a[8:11], a[168:171], a[96:99]
    s_add_u32 m0, s77, 16384
    s_add_u32 s82, s73, 262144
    ds_read_b64_tr_b16 a[34:35], v18 offset:18688
    v_mfma_f32_16x16x32_bf16 a[104:107], a[12:15], a[168:171], a[104:107]
    ds_read_b64_tr_b16 a[36:37], v19 offset:16640
    ds_read_b64_tr_b16 a[38:39], v19 offset:18688
    v_mfma_f32_16x16x32_bf16 a[108:111], a[12:15], a[172:175], a[108:111]
    s_waitcnt lgkmcnt(8)
    ds_read_b64_tr_b16 a[40:41], v20 offset:16640
    v_mfma_f32_16x16x32_bf16 a[116:119], a[16:19], a[172:175], a[116:119]
    buffer_load_dwordx4 v3, s[40:43], s82 offen lds
    v_mfma_f32_16x16x32_bf16 a[112:115], a[16:19], a[168:171], a[112:115]
    s_add_u32 m0, s77, 24576
    s_add_u32 s82, s73, 393216
    ds_read_b64_tr_b16 a[42:43], v20 offset:18688
    v_mfma_f32_16x16x32_bf16 a[120:123], a[20:23], a[168:171], a[120:123]
    ds_read_b64_tr_b16 a[44:45], v21 offset:16640
    ds_read_b64_tr_b16 a[46:47], v21 offset:18688
    v_mfma_f32_16x16x32_bf16 a[124:127], a[20:23], a[172:175], a[124:127]
    s_waitcnt lgkmcnt(8)
    ds_read_b64_tr_b16 a[48:49], v22 offset:16640
    v_mfma_f32_16x16x32_bf16 a[132:135], a[24:27], a[172:175], a[132:135]
    buffer_load_dwordx4 v3, s[40:43], s82 offen lds
    v_mfma_f32_16x16x32_bf16 a[128:131], a[24:27], a[168:171], a[128:131]
    s_add_u32 m0, s77, 2048
    s_add_u32 s82, s73, 32768
    ds_read_b64_tr_b16 a[50:51], v22 offset:18688
    v_mfma_f32_16x16x32_bf16 a[136:139], a[28:31], a[168:171], a[136:139]
    buffer_load_dwordx4 v3, s[40:43], s82 offen lds
    v_mfma_f32_16x16x32_bf16 a[140:143], a[28:31], a[172:175], a[140:143]
    s_waitcnt lgkmcnt(6)
    ds_read_b64_tr_b16 a[52:53], v23 offset:16640
    ds_read_b64_tr_b16 a[54:55], v23 offset:18688
    v_mfma_f32_16x16x32_bf16 a[148:151], a[32:35], a[172:175], a[148:151]
    s_add_u32 m0, s77, 10240
    s_add_u32 s82, s73, 163840
    ds_read_b64_tr_b16 a[56:57], v10 offset:8192
    v_mfma_f32_16x16x32_bf16 a[144:147], a[32:35], a[168:171], a[144:147]
    ds_read_b64_tr_b16 a[58:59], v10 offset:9216
    ds_read_b64_tr_b16 a[60:61], v11 offset:8192
    v_mfma_f32_16x16x32_bf16 v[40:43], a[36:39], a[168:171], v[40:43]
    buffer_load_dwordx4 v3, s[40:43], s82 offen lds
    v_mfma_f32_16x16x32_bf16 v[44:47], a[36:39], a[172:175], v[44:47]
    s_waitcnt lgkmcnt(7)
    s_add_u32 m0, s77, 18432
    ds_read_b64_tr_b16 a[62:63], v11 offset:9216
    v_mfma_f32_16x16x32_bf16 v[68:71], a[40:43], a[172:175], v[68:71]
    s_add_u32 s82, s73, 294912
    ds_read_b64_tr_b16 a[0:1], v12 offset:8192
    ds_read_b64_tr_b16 a[2:3], v12 offset:9216
    v_mfma_f32_16x16x32_bf16 v[64:67], a[40:43], a[168:171], v[64:67]
    buffer_load_dwordx4 v3, s[40:43], s82 offen lds
    v_mfma_f32_16x16x32_bf16 v[72:75], a[44:47], a[168:171], v[72:75]
    ds_read_b64_tr_b16 a[4:5], v13 offset:8192
    ds_read_b64_tr_b16 a[6:7], v13 offset:9216
    v_mfma_f32_16x16x32_bf16 v[76:79], a[44:47], a[172:175], v[76:79]
    s_waitcnt lgkmcnt(8)
    s_add_u32 m0, s77, 26624
    v_mfma_f32_16x16x32_bf16 v[84:87], a[48:51], a[172:175], v[84:87]
    s_add_u32 s82, s73, 425984
    ds_read_b64_tr_b16 a[8:9], v14 offset:8192
    ds_read_b64_tr_b16 a[10:11], v14 offset:9216
    v_mfma_f32_16x16x32_bf16 v[80:83], a[48:51], a[168:171], v[80:83]
    buffer_load_dwordx4 v3, s[40:43], s82 offen lds
    v_mfma_f32_16x16x32_bf16 v[88:91], a[52:55], a[168:171], v[88:91]
    s_add_u32 s73, s73, 524288
    ds_read_b64_tr_b16 a[12:13], v15 offset:8192
    ds_read_b64_tr_b16 a[14:15], v15 offset:9216
    v_mfma_f32_16x16x32_bf16 v[92:95], a[52:55], a[172:175], v[92:95]
    s_waitcnt lgkmcnt(8)
    v_mfma_f32_16x16x32_bf16 v[112:115], a[56:59], a[172:175], v[112:115]
    s_add_u32 s86, s86, s90
    v_xor_b32 v8, 0x8000, v8
    v_xor_b32 v9, 0x8000, v9
    v_mfma_f32_16x16x32_bf16 v[96:99], a[56:59], a[168:171], v[96:99]
    s_cmp_eq_u32 s86, 163840
    s_cselect_b32 s86, 65536, s86
    v_xor_b32 v10, 0x8000, v10
    v_xor_b32 v11, 0x8000, v11
    v_mfma_f32_16x16x32_bf16 v[100:103], a[60:63], a[168:171], v[100:103]
    v_xor_b32 v12, 0x8000, v12
    v_xor_b32 v13, 0x8000, v13
    v_mfma_f32_16x16x32_bf16 v[116:119], a[60:63], a[172:175], v[116:119]
    s_waitcnt vmcnt(15) lgkmcnt(0)
    s_barrier
    v_xor_b32 v14, 0x8000, v14
    v_mfma_f32_16x16x32_bf16 v[120:123], a[0:3], a[172:175], v[120:123]
    v_xor_b32 v15, 0x8000, v15
    v_add_u32 v16, 0x8000, v16
    v_add_u32 v17, 0x8000, v17
    v_add_u32 v18, 0x8000, v18
    v_add_u32 v19, 0x8000, v19
    v_add_u32 v20, 0x8000, v20
    v_add_u32 v21, 0x8000, v21
    v_add_u32 v22, 0x8000, v22
    v_add_u32 v23, 0x8000, v23
    v_mfma_f32_16x16x32_bf16 v[104:107], a[0:3], a[168:171], v[104:107]
    ds_read_b128 a[160:163], v8 offset:0
    ds_read_b128 a[164:167], v8 offset:2048
    v_mfma_f32_16x16x32_bf16 v[108:111], a[4:7], a[168:171], v[108:111]
    ds_read_b64_tr_b16 a[16:17], v16 offset:0
    v_mfma_f32_16x16x32_bf16 v[124:127], a[4:7], a[172:175], v[124:127]
    ds_read_b64_tr_b16 a[18:19], v16 offset:2048
    ds_read_b64_tr_b16 a[20:21], v17 offset:0
    v_mfma_f32_16x16x32_bf16 v[56:59], a[172:175], a[8:11], v[56:59]
    ds_read_b64_tr_b16 a[22:23], v17 offset:2048
    v_mfma_f32_16x16x32_bf16 v[48:51], a[168:171], a[8:11], v[48:51]
    ds_read_b64_tr_b16 a[24:25], v18 offset:0
    ds_read_b64_tr_b16 a[26:27], v18 offset:2048
    v_mfma_f32_16x16x32_bf16 v[52:55], a[168:171], a[12:15], v[52:55]
    v_mfma_f32_16x16x32_bf16 v[60:63], a[172:175], a[12:15], v[60:63]
    s_waitcnt lgkmcnt(4)
    v_mfma_f32_16x16x32_bf16 v[32:35], a[228:231], a[160:163], v[32:35]
    s_add_u32 m0, s76, 0
    ds_read_b64_tr_b16 a[28:29], v19 offset:0
    ds_read_b64_tr_b16 a[30:31], v19 offset:2048
    v_mfma_f32_16x16x32_bf16 v[36:39], a[228:231], a[164:167], v[36:39]
    ds_read_b64_tr_b16 a[32:33], v20 offset:0
    ds_read_b64_tr_b16 a[34:35], v20 offset:2048
    v_mfma_f32_16x16x32_bf16 a[68:71], a[16:19], a[164:167], a[68:71]
    s_add_u32 s81, s72, 0
    ds_read_b64_tr_b16 a[36:37], v21 offset:0
    ds_read_b64_tr_b16 a[38:39], v21 offset:2048
    v_mfma_f32_16x16x32_bf16 a[64:67], a[16:19], a[160:163], a[64:67]
    s_waitcnt lgkmcnt(6)
    ds_read_b64_tr_b16 a[40:41], v22 offset:0
    ds_read_b64_tr_b16 a[42:43], v22 offset:2048
    v_mfma_f32_16x16x32_bf16 a[72:75], a[20:23], a[160:163], a[72:75]
    buffer_load_dwordx4 v4, s[36:39], s81 offen lds
    v_mfma_f32_16x16x32_bf16 a[76:79], a[20:23], a[164:167], a[76:79]
    s_add_u32 m0, s76, 4096
    ds_read_b64_tr_b16 a[44:45], v23 offset:0
    ds_read_b64_tr_b16 a[46:47], v23 offset:2048
    v_mfma_f32_16x16x32_bf16 a[84:87], a[24:27], a[164:167], a[84:87]
    s_add_u32 s81, s72, 28672
    ds_read_b64_tr_b16 a[48:49], v16 offset:256
    ds_read_b64_tr_b16 a[50:51], v16 offset:2304
    v_mfma_f32_16x16x32_bf16 a[80:83], a[24:27], a[160:163], a[80:83]
    s_waitcnt lgkmcnt(8)
    ds_read_b64_tr_b16 a[52:53], v17 offset:256
    v_mfma_f32_16x16x32_bf16 a[88:91], a[28:31], a[160:163], a[88:91]
    buffer_load_dwordx4 v4, s[36:39], s81 offen lds
    v_mfma_f32_16x16x32_bf16 a[92:95], a[28:31], a[164:167], a[92:95]
    s_add_u32 m0, s76, 8192
    ds_read_b64_tr_b16 a[54:55], v17 offset:2304
    v_mfma_f32_16x16x32_bf16 a[100:103], a[32:35], a[164:167], a[100:103]
    s_add_u32 s81, s72, 57344
    ds_read_b64_tr_b16 a[56:57], v18 offset:256
    ds_read_b64_tr_b16 a[58:59], v18 offset:2304
    v_mfma_f32_16x16x32_bf16 a[96:99], a[32:35], a[160:163], a[96:99]
    s_waitcnt lgkmcnt(8)
    ds_read_b64_tr_b16 a[60:61], v19 offset:256
    v_accvgpr_read_b32 v128, a64
    v_mfma_f32_16x16x32_bf16 a[104:107], a[36:39], a[160:163], a[104:107]
    buffer_load_dwordx4 v4, s[36:39], s81 offen lds
    v_mfma_f32_16x16x32_bf16 a[108:111], a[36:39], a[164:167], a[108:111]
    s_add_u32 m0, s76, 12288
    ds_read_b64_tr_b16 a[62:63], v19 offset:2304
    v_accvgpr_read_b32 v129, a65
    v_mfma_f32_16x16x32_bf16 a[116:119], a[40:43], a[164:167], a[116:119]
    s_add_u32 s81, s72, 86016
    ds_read_b64_tr_b16 a[0:1], v20 offset:256
    v_accvgpr_read_b32 v130, a66
    v_mfma_f32_16x16x32_bf16 a[112:115], a[40:43], a[160:163], a[112:115]
    s_waitcnt lgkmcnt(7)
    ds_read_b64_tr_b16 a[2:3], v20 offset:2304
    v_accvgpr_read_b32 v131, a67
    v_mfma_f32_16x16x32_bf16 a[120:123], a[44:47], a[160:163], a[120:123]
    ds_read_b64_tr_b16 a[4:5], v21 offset:256
    v_accvgpr_read_b32 v132, a68
    v_mfma_f32_16x16x32_bf16 a[124:127], a[44:47], a[164:167], a[124:127]
    ds_read_b64_tr_b16 a[6:7], v21 offset:2304
    v_accvgpr_read_b32 v133, a69
    v_mfma_f32_16x16x32_bf16 a[132:135], a[48:51], a[164:167], a[132:135]
    buffer_load_dwordx4 v4, s[36:39], s81 offen lds
    v_mfma_f32_16x16x32_bf16 a[128:131], a[48:51], a[160:163], a[128:131]
    s_waitcnt lgkmcnt(6)
    s_add_u32 m0, s89, 16384
    v_accvgpr_read_b32 v134, a70
    v_mfma_f32_16x16x32_bf16 a[136:139], a[52:55], a[160:163], a[136:139]
    s_add_u32 s81, s74, 0
    ds_read_b64_tr_b16 a[8:9], v22 offset:256
    v_accvgpr_read_b32 v135, a71
    v_mfma_f32_16x16x32_bf16 a[140:143], a[52:55], a[164:167], a[140:143]
    ds_read_b64_tr_b16 a[10:11], v22 offset:2304
    v_accvgpr_read_b32 v160, a96
    v_mfma_f32_16x16x32_bf16 a[148:151], a[56:59], a[164:167], a[148:151]
    ds_read_b64_tr_b16 a[12:13], v23 offset:256
    v_accvgpr_read_b32 v161, a97
    v_mfma_f32_16x16x32_bf16 a[144:147], a[56:59], a[160:163], a[144:147]
    s_waitcnt lgkmcnt(5)
    ds_read_b64_tr_b16 a[14:15], v23 offset:2304
    v_accvgpr_read_b32 v162, a98
    v_mfma_f32_16x16x32_bf16 v[40:43], a[60:63], a[160:163], v[40:43]
    buffer_load_dwordx4 v6, s[44:47], s81 offen lds
    v_mfma_f32_16x16x32_bf16 v[44:47], a[60:63], a[164:167], v[44:47]
    s_add_u32 m0, s89, 20480
    ds_read_b64_tr_b16 a[16:17], v10 offset:0
    v_accvgpr_read_b32 v163, a99
    v_mfma_f32_16x16x32_bf16 v[68:71], a[0:3], a[164:167], v[68:71]
    s_add_u32 s81, s74, 43008
    ds_read_b64_tr_b16 a[18:19], v10 offset:1024
    v_accvgpr_read_b32 v164, a100
    v_mfma_f32_16x16x32_bf16 v[64:67], a[0:3], a[160:163], v[64:67]
    s_waitcnt lgkmcnt(4)
    ds_read_b64_tr_b16 a[20:21], v11 offset:0
    v_accvgpr_read_b32 v165, a101
    v_mfma_f32_16x16x32_bf16 v[72:75], a[4:7], a[160:163], v[72:75]
    ds_read_b64_tr_b16 a[22:23], v11 offset:1024
    v_accvgpr_read_b32 v166, a102
    v_mfma_f32_16x16x32_bf16 v[76:79], a[4:7], a[164:167], v[76:79]
    buffer_load_dwordx4 v6, s[44:47], s81 offen lds
    v_mfma_f32_16x16x32_bf16 v[84:87], a[8:11], a[164:167], v[84:87]
    s_add_u32 m0, s89, 24576
    ds_read_b64_tr_b16 a[24:25], v12 offset:0
    ds_read_b64_tr_b16 a[26:27], v12 offset:1024
    v_accvgpr_read_b32 v167, a103
    v_mfma_f32_16x16x32_bf16 v[80:83], a[8:11], a[160:163], v[80:83]
    s_waitcnt lgkmcnt(4)
    ds_read_b64_tr_b16 a[28:29], v13 offset:0
    v_accvgpr_read_b32 v192, a128
    v_mfma_f32_16x16x32_bf16 v[88:91], a[12:15], a[160:163], v[88:91]
    s_add_u32 s81, s74, 86016
    ds_read_b64_tr_b16 a[30:31], v13 offset:1024
    v_accvgpr_read_b32 v193, a129
    v_mfma_f32_16x16x32_bf16 v[92:95], a[12:15], a[164:167], v[92:95]
    buffer_load_dwordx4 v6, s[44:47], s81 offen lds
    v_accvgpr_read_b32 v194, a130
    v_mfma_f32_16x16x32_bf16 v[112:115], a[16:19], a[164:167], v[112:115]
    s_add_u32 m0, s89, 28672
    ds_read_b64_tr_b16 a[32:33], v14 offset:0
    ds_read_b64_tr_b16 a[34:35], v14 offset:1024
    v_accvgpr_read_b32 v195, a131
    v_mfma_f32_16x16x32_bf16 v[96:99], a[16:19], a[160:163], v[96:99]
    s_waitcnt lgkmcnt(4)
    ds_read_b64_tr_b16 a[36:37], v15 offset:0
    v_accvgpr_read_b32 v196, a132
    v_mfma_f32_16x16x32_bf16 v[100:103], a[20:23], a[160:163], v[100:103]
    s_add_u32 s81, s74, 129024
    ds_read_b64_tr_b16 a[38:39], v15 offset:1024
    v_accvgpr_read_b32 v197, a133
    v_mfma_f32_16x16x32_bf16 v[116:119], a[20:23], a[164:167], v[116:119]
    buffer_load_dwordx4 v6, s[44:47], s81 offen lds
    v_accvgpr_read_b32 v198, a134
    v_accvgpr_read_b32 v199, a135
    v_mfma_f32_16x16x32_bf16 v[120:123], a[24:27], a[164:167], v[120:123]
    s_add_u32 s72, s72, 128
    ds_read_b128 a[168:171], v9 offset:0
    ds_read_b128 a[172:175], v9 offset:2048
    v_mfma_f32_16x16x32_bf16 v[104:107], a[24:27], a[160:163], v[104:107]
    s_waitcnt lgkmcnt(4)
    ds_read_b64_tr_b16 a[40:41], v16 offset:16384
    ds_read_b64_tr_b16 a[42:43], v16 offset:18432
    v_mfma_f32_16x16x32_bf16 v[108:111], a[28:31], a[160:163], v[108:111]
    s_add_u32 s74, s74, 172032
    s_xor_b32 s76, s76, s90
    ds_read_b64_tr_b16 a[44:45], v17 offset:16384
    v_mfma_f32_16x16x32_bf16 v[124:127], a[28:31], a[164:167], v[124:127]
    s_xor_b32 s89, s89, s90
    ds_read_b64_tr_b16 a[46:47], v17 offset:18432
    ds_read_b64_tr_b16 a[48:49], v18 offset:16384
    v_mfma_f32_16x16x32_bf16 v[56:59], a[164:167], a[32:35], v[56:59]
    s_add_u32 s77, s86, s85
    ds_read_b64_tr_b16 a[50:51], v18 offset:18432
    ds_read_b64_tr_b16 a[52:53], v19 offset:16384
    v_mfma_f32_16x16x32_bf16 v[48:51], a[160:163], a[32:35], v[48:51]
    s_waitcnt lgkmcnt(7)
    s_add_u32 m0, s77, 0
    ds_read_b64_tr_b16 a[54:55], v19 offset:18432
    v_mfma_f32_16x16x32_bf16 v[52:55], a[160:163], a[36:39], v[52:55]
    s_add_u32 s82, s73, 0
    ds_read_b64_tr_b16 a[56:57], v20 offset:16384
    ds_read_b64_tr_b16 a[58:59], v20 offset:18432
    v_mfma_f32_16x16x32_bf16 v[60:63], a[164:167], a[36:39], v[60:63]
    ds_read_b64_tr_b16 a[60:61], v21 offset:16384
    v_mfma_f32_16x16x32_bf16 v[32:35], a[224:227], a[168:171], v[32:35]
    buffer_load_dwordx4 v3, s[40:43], s82 offen lds
    v_mfma_f32_16x16x32_bf16 v[36:39], a[224:227], a[172:175], v[36:39]
    s_waitcnt lgkmcnt(7)
    s_add_u32 m0, s77, 8192
    ds_read_b64_tr_b16 a[62:63], v21 offset:18432
    v_mfma_f32_16x16x32_bf16 v[132:135], a[40:43], a[172:175], v[132:135]
    ds_read_b64_tr_b16 a[0:1], v22 offset:16384
    ds_read_b64_tr_b16 a[2:3], v22 offset:18432
    v_mfma_f32_16x16x32_bf16 v[128:131], a[40:43], a[168:171], v[128:131]
    s_add_u32 s82, s73, 131072
    v_mfma_f32_16x16x32_bf16 a[72:75], a[44:47], a[168:171], a[72:75]
    ds_read_b64_tr_b16 a[4:5], v23 offset:16384
    ds_read_b64_tr_b16 a[6:7], v23 offset:18432
    v_mfma_f32_16x16x32_bf16 a[76:79], a[44:47], a[172:175], a[76:79]
    s_waitcnt lgkmcnt(8)
    ds_read_b64_tr_b16 a[8:9], v16 offset:16640
    v_mfma_f32_16x16x32_bf16 a[84:87], a[48:51], a[172:175], a[84:87]
    buffer_load_dwordx4 v3, s[40:43], s82 offen lds
    v_mfma_f32_16x16x32_bf16 a[80:83], a[48:51], a[168:171], a[80:83]
    s_add_u32 m0, s77, 16384
    s_add_u32 s82, s73, 262144
    ds_read_b64_tr_b16 a[10:11], v16 offset:18688
    v_mfma_f32_16x16x32_bf16 a[88:91], a[52:55], a[168:171], a[88:91]
    ds_read_b64_tr_b16 a[12:13], v17 offset:16640
    ds_read_b64_tr_b16 a[14:15], v17 offset:18688
    v_mfma_f32_16x16x32_bf16 a[92:95], a[52:55], a[172:175], a[92:95]
    s_waitcnt lgkmcnt(8)
    ds_read_b64_tr_b16 a[16:17], v18 offset:16640
    v_mfma_f32_16x16x32_bf16 v[164:167], a[56:59], a[172:175], v[164:167]
    buffer_load_dwordx4 v3, s[40:43], s82 offen lds
    v_mfma_f32_16x16x32_bf16 v[160:163], a[56:59], a[168:171], v[160:163]
    s_add_u32 m0, s77, 24576
    s_add_u32 s82, s73, 393216
    ds_read_b64_tr_b16 a[18:19], v18 offset:18688
    v_mfma_f32_16x16x32_bf16 a[104:107], a[60:63], a[168:171], a[104:107]
    ds_read_b64_tr_b16 a[20:21], v19 offset:16640
    ds_read_b64_tr_b16 a[22:23], v19 offset:18688
    v_mfma_f32_16x16x32_bf16 a[108:111], a[60:63], a[172:175], a[108:111]
    s_waitcnt lgkmcnt(8)
    ds_read_b64_tr_b16 a[24:25], v20 offset:16640
    v_accvgpr_read_b32 v136, a72
    v_mfma_f32_16x16x32_bf16 a[116:119], a[0:3], a[172:175], a[116:119]
    buffer_load_dwordx4 v3, s[40:43], s82 offen lds
    v_mfma_f32_16x16x32_bf16 a[112:115], a[0:3], a[168:171], a[112:115]
    s_add_u32 m0, s77, 2048
    ds_read_b64_tr_b16 a[26:27], v20 offset:18688
    v_accvgpr_read_b32 v137, a73
    v_mfma_f32_16x16x32_bf16 a[120:123], a[4:7], a[168:171], a[120:123]
    s_add_u32 s82, s73, 32768
    ds_read_b64_tr_b16 a[28:29], v21 offset:16640
    v_accvgpr_read_b32 v138, a74
    v_mfma_f32_16x16x32_bf16 a[124:127], a[4:7], a[172:175], a[124:127]
    s_waitcnt lgkmcnt(7)
    ds_read_b64_tr_b16 a[30:31], v21 offset:18688
    v_accvgpr_read_b32 v139, a75
    v_mfma_f32_16x16x32_bf16 v[196:199], a[8:11], a[172:175], v[196:199]
    ds_read_b64_tr_b16 a[32:33], v22 offset:16640
    v_accvgpr_read_b32 v140, a76
    v_mfma_f32_16x16x32_bf16 v[192:195], a[8:11], a[168:171], v[192:195]
    buffer_load_dwordx4 v3, s[40:43], s82 offen lds
    v_mfma_f32_16x16x32_bf16 a[136:139], a[12:15], a[168:171], a[136:139]
    s_add_u32 m0, s77, 10240
    ds_read_b64_tr_b16 a[34:35], v22 offset:18688
    v_accvgpr_read_b32 v141, a77
    v_mfma_f32_16x16x32_bf16 a[140:143], a[12:15], a[172:175], a[140:143]
    s_waitcnt lgkmcnt(6)
    ds_read_b64_tr_b16 a[36:37], v23 offset:16640
    v_accvgpr_read_b32 v142, a78
    v_mfma_f32_16x16x32_bf16 a[148:151], a[16:19], a[172:175], a[148:151]
    s_add_u32 s82, s73, 163840
    ds_read_b64_tr_b16 a[38:39], v23 offset:18688
    v_accvgpr_read_b32 v143, a79
    v_mfma_f32_16x16x32_bf16 a[144:147], a[16:19], a[168:171], a[144:147]
    ds_read_b64_tr_b16 a[40:41], v10 offset:8192
    v_accvgpr_read_b32 v168, a104
    v_mfma_f32_16x16x32_bf16 v[40:43], a[20:23], a[168:171], v[40:43]
    buffer_load_dwordx4 v3, s[40:43], s82 offen lds
    v_mfma_f32_16x16x32_bf16 v[44:47], a[20:23], a[172:175], v[44:47]
    s_waitcnt lgkmcnt(5)
    ds_read_b64_tr_b16 a[42:43], v10 offset:9216
    v_accvgpr_read_b32 v169, a105
    v_mfma_f32_16x16x32_bf16 v[68:71], a[24:27], a[172:175], v[68:71]
    s_add_u32 m0, s77, 18432
    ds_read_b64_tr_b16 a[44:45], v11 offset:8192
    v_accvgpr_read_b32 v170, a106
    v_mfma_f32_16x16x32_bf16 v[64:67], a[24:27], a[168:171], v[64:67]
    s_add_u32 s82, s73, 294912
    ds_read_b64_tr_b16 a[46:47], v11 offset:9216
    v_accvgpr_read_b32 v171, a107
    v_mfma_f32_16x16x32_bf16 v[72:75], a[28:31], a[168:171], v[72:75]
    buffer_load_dwordx4 v3, s[40:43], s82 offen lds
    v_accvgpr_read_b32 v172, a108
    v_mfma_f32_16x16x32_bf16 v[76:79], a[28:31], a[172:175], v[76:79]
    s_waitcnt lgkmcnt(4)
    ds_read_b64_tr_b16 a[48:49], v12 offset:8192
    v_accvgpr_read_b32 v173, a109
    v_mfma_f32_16x16x32_bf16 v[84:87], a[32:35], a[172:175], v[84:87]
    s_add_u32 m0, s77, 26624
    ds_read_b64_tr_b16 a[50:51], v12 offset:9216
    v_accvgpr_read_b32 v174, a110
    v_mfma_f32_16x16x32_bf16 v[80:83], a[32:35], a[168:171], v[80:83]
    s_add_u32 s82, s73, 425984
    ds_read_b64_tr_b16 a[52:53], v13 offset:8192
    v_accvgpr_read_b32 v175, a111
    v_mfma_f32_16x16x32_bf16 v[88:91], a[36:39], a[168:171], v[88:91]
    ds_read_b64_tr_b16 a[54:55], v13 offset:9216
    v_accvgpr_read_b32 v200, a136
    v_mfma_f32_16x16x32_bf16 v[92:95], a[36:39], a[172:175], v[92:95]
    s_waitcnt lgkmcnt(4)
    ds_read_b64_tr_b16 a[56:57], v14 offset:8192
    ds_read_b64_tr_b16 a[58:59], v14 offset:9216
    ds_read_b64_tr_b16 a[60:61], v15 offset:8192
    ds_read_b64_tr_b16 a[62:63], v15 offset:9216
    v_accvgpr_read_b32 v201, a137
    v_mfma_f32_16x16x32_bf16 v[112:115], a[40:43], a[172:175], v[112:115]
    buffer_load_dwordx4 v3, s[40:43], s82 offen lds
    v_mfma_f32_16x16x32_bf16 v[96:99], a[40:43], a[168:171], v[96:99]
    s_add_u32 s73, s73, 524288
    s_add_u32 s86, s86, s90
    s_cmp_eq_u32 s86, 163840
    s_cselect_b32 s86, 65536, s86
    v_accvgpr_read_b32 v202, a138
    v_accvgpr_read_b32 v203, a139
    v_mfma_f32_16x16x32_bf16 v[100:103], a[44:47], a[168:171], v[100:103]
    v_xor_b32 v8, 0x8000, v8
    v_accvgpr_read_b32 v204, a140
    v_mfma_f32_16x16x32_bf16 v[116:119], a[44:47], a[172:175], v[116:119]
    s_waitcnt vmcnt(8) lgkmcnt(0)
    s_barrier
    v_xor_b32 v9, 0x8000, v9
    v_mfma_f32_16x16x32_bf16 v[120:123], a[48:51], a[172:175], v[120:123]
    v_xor_b32 v10, 0x8000, v10
    v_xor_b32 v11, 0x8000, v11
    v_xor_b32 v12, 0x8000, v12
    v_xor_b32 v13, 0x8000, v13
    v_xor_b32 v14, 0x8000, v14
    v_xor_b32 v15, 0x8000, v15
    v_add_u32 v16, 0x8000, v16
    v_add_u32 v17, 0x8000, v17
    v_add_u32 v18, 0x8000, v18
    v_add_u32 v19, 0x8000, v19
    v_add_u32 v20, 0x8000, v20
    v_add_u32 v21, 0x8000, v21
    v_add_u32 v22, 0x8000, v22
    v_add_u32 v23, 0x8000, v23
    v_accvgpr_read_b32 v205, a141
    v_accvgpr_read_b32 v206, a142
    v_mfma_f32_16x16x32_bf16 v[104:107], a[48:51], a[168:171], v[104:107]
    v_readfirstlane_b32 s83, v25
    v_mov_b32 v26, 1
    s_cmp_lt_u32 s83, 32
    s_cbranch_scc1 F_sp1_7
F_sp1r_8:
    buffer_atomic_add v26, v24, s[48:51], s101 offen sc1
    v_mfma_f32_16x16x32_bf16 v[108:111], a[52:55], a[168:171], v[108:111]
    ds_read_b128 a[160:163], v8 offset:0
    v_accvgpr_read_b32 v207, a143
    v_mfma_f32_16x16x32_bf16 v[124:127], a[52:55], a[172:175], v[124:127]
    ds_read_b128 a[164:167], v8 offset:2048
    ds_read_b64_tr_b16 a[0:1], v16 offset:0
    v_mfma_f32_16x16x32_bf16 v[56:59], a[172:175], a[56:59], v[56:59]
    ds_read_b64_tr_b16 a[2:3], v16 offset:2048
    ds_read_b64_tr_b16 a[4:5], v17 offset:0
    v_mfma_f32_16x16x32_bf16 v[48:51], a[168:171], a[56:59], v[48:51]
    ds_read_b64_tr_b16 a[6:7], v17 offset:2048
    ds_read_b64_tr_b16 a[8:9], v18 offset:0
    v_mfma_f32_16x16x32_bf16 v[52:55], a[168:171], a[60:63], v[52:55]
    ds_read_b64_tr_b16 a[10:11], v18 offset:2048
    v_mfma_f32_16x16x32_bf16 v[60:63], a[172:175], a[60:63], v[60:63]
    s_waitcnt lgkmcnt(4)
    v_mfma_f32_16x16x32_bf16 v[32:35], a[220:223], a[160:163], v[32:35]
    s_add_u32 m0, s76, 0
    ds_read_b64_tr_b16 a[12:13], v19 offset:0
    ds_read_b64_tr_b16 a[14:15], v19 offset:2048
    v_mfma_f32_16x16x32_bf16 v[36:39], a[220:223], a[164:167], v[36:39]
    ds_read_b64_tr_b16 a[16:17], v20 offset:0
    ds_read_b64_tr_b16 a[18:19], v20 offset:2048
    v_mfma_f32_16x16x32_bf16 v[132:135], a[0:3], a[164:167], v[132:135]
    s_add_u32 s81, s72, 0
    ds_read_b64_tr_b16 a[20:21], v21 offset:0
    ds_read_b64_tr_b16 a[22:23], v21 offset:2048
    v_mfma_f32_16x16x32_bf16 v[128:131], a[0:3], a[160:163], v[128:131]
    s_waitcnt lgkmcnt(6)
    s_and_b32 s83, s2, 63
    ds_read_b64_tr_b16 a[24:25], v22 offset:0
    v_mfma_f32_16x16x32_bf16 v[136:139], a[4:7], a[160:163], v[136:139]
    buffer_load_dwordx4 v4, s[36:39], s81 offen lds
    v_mfma_f32_16x16x32_bf16 v[140:143], a[4:7], a[164:167], v[140:143]
    s_add_u32 m0, s76, 4096
    ds_read_b64_tr_b16 a[26:27], v22 offset:2048
    ds_read_b64_tr_b16 a[28:29], v23 offset:0
    v_mfma_f32_16x16x32_bf16 a[84:87], a[8:11], a[164:167], a[84:87]
    s_lshr_b32 s84, s2, 7
    ds_read_b64_tr_b16 a[30:31], v23 offset:2048
    ds_read_b64_tr_b16 a[32:33], v16 offset:256
    v_mfma_f32_16x16x32_bf16 a[80:83], a[8:11], a[160:163], a[80:83]
    s_waitcnt lgkmcnt(7)
    s_add_u32 s81, s72, 28672
    ds_read_b64_tr_b16 a[34:35], v16 offset:2304
    v_mfma_f32_16x16x32_bf16 a[88:91], a[12:15], a[160:163], a[88:91]
    buffer_load_dwordx4 v4, s[36:39], s81 offen lds
    v_mfma_f32_16x16x32_bf16 a[92:95], a[12:15], a[164:167], a[92:95]
    s_lshl_b32 s84, s84, 6
    ds_read_b64_tr_b16 a[36:37], v17 offset:256
    ds_read_b64_tr_b16 a[38:39], v17 offset:2304
    v_mfma_f32_16x16x32_bf16 v[164:167], a[16:19], a[164:167], v[164:167]
    s_add_u32 m0, s76, 8192
    s_add_u32 s81, s72, 57344
    ds_read_b64_tr_b16 a[40:41], v18 offset:256
    v_mfma_f32_16x16x32_bf16 v[160:163], a[16:19], a[160:163], v[160:163]
    s_waitcnt lgkmcnt(7)
    ds_read_b64_tr_b16 a[42:43], v18 offset:2304
    v_mfma_f32_16x16x32_bf16 v[168:171], a[20:23], a[160:163], v[168:171]
    s_or_b32 s83, s83, s84
    ds_read_b64_tr_b16 a[44:45], v19 offset:256
    ds_read_b64_tr_b16 a[46:47], v19 offset:2304
    v_mfma_f32_16x16x32_bf16 v[172:175], a[20:23], a[164:167], v[172:175]
    buffer_load_dwordx4 v4, s[36:39], s81 offen lds
    v_mfma_f32_16x16x32_bf16 a[116:119], a[24:27], a[164:167], a[116:119]
    s_add_u32 m0, s76, 12288
    ds_read_b64_tr_b16 a[48:49], v20 offset:256
    ds_read_b64_tr_b16 a[50:51], v20 offset:2304
    v_mfma_f32_16x16x32_bf16 a[112:115], a[24:27], a[160:163], a[112:115]
    s_waitcnt lgkmcnt(8)
    s_add_u32 s81, s72, 86016
    s_lshl_b32 s83, s83, 2
    v_mfma_f32_16x16x32_bf16 a[120:123], a[28:31], a[160:163], a[120:123]
    ds_read_b64_tr_b16 a[52:53], v21 offset:256
    v_accvgpr_read_b32 v144, a80
    v_mfma_f32_16x16x32_bf16 a[124:127], a[28:31], a[164:167], a[124:127]
    s_add_u32 s83, s83, s60
    ds_read_b64_tr_b16 a[54:55], v21 offset:2304
    v_accvgpr_read_b32 v145, a81
    v_mfma_f32_16x16x32_bf16 v[196:199], a[32:35], a[164:167], v[196:199]
    buffer_load_dwordx4 v4, s[36:39], s81 offen lds
    v_mfma_f32_16x16x32_bf16 v[192:195], a[32:35], a[160:163], v[192:195]
    s_waitcnt lgkmcnt(6)
    s_add_u32 m0, s89, 16384
    v_accvgpr_read_b32 v146, a82
    v_mfma_f32_16x16x32_bf16 v[200:203], a[36:39], a[160:163], v[200:203]
    s_add_u32 s81, s74, 0
    ds_read_b64_tr_b16 a[56:57], v22 offset:256
    v_accvgpr_read_b32 v147, a83
    v_mfma_f32_16x16x32_bf16 v[204:207], a[36:39], a[164:167], v[204:207]
    s_mul_hi_u32 s84, s83, 613566757
    ds_read_b64_tr_b16 a[58:59], v22 offset:2304
    v_accvgpr_read_b32 v148, a84
    v_mfma_f32_16x16x32_bf16 a[148:151], a[40:43], a[164:167], a[148:151]
    s_mul_i32 s16, s84, 27776
    ds_read_b64_tr_b16 a[60:61], v23 offset:256
    v_accvgpr_read_b32 v149, a85
    v_mfma_f32_16x16x32_bf16 a[144:147], a[40:43], a[160:163], a[144:147]
    s_waitcnt lgkmcnt(5)
    ds_read_b64_tr_b16 a[62:63], v23 offset:2304
    v_accvgpr_read_b32 v150, a86
    v_mfma_f32_16x16x32_bf16 v[40:43], a[44:47], a[160:163], v[40:43]
    buffer_load_dwordx4 v6, s[44:47], s81 offen lds
    v_mfma_f32_16x16x32_bf16 v[44:47], a[44:47], a[164:167], v[44:47]
    s_add_u32 m0, s89, 20480
    ds_read_b64_tr_b16 a[0:1], v10 offset:0
    v_accvgpr_read_b32 v151, a87
    v_mfma_f32_16x16x32_bf16 v[68:71], a[48:51], a[164:167], v[68:71]
    s_add_u32 s81, s74, 43008
    ds_read_b64_tr_b16 a[2:3], v10 offset:1024
    v_accvgpr_read_b32 v176, a112
    v_mfma_f32_16x16x32_bf16 v[64:67], a[48:51], a[160:163], v[64:67]
    s_waitcnt lgkmcnt(4)
    ds_read_b64_tr_b16 a[4:5], v11 offset:0
    v_accvgpr_read_b32 v177, a113
    v_mfma_f32_16x16x32_bf16 v[72:75], a[52:55], a[160:163], v[72:75]
    s_lshl_b32 s84, s83, 7
    ds_read_b64_tr_b16 a[6:7], v11 offset:1024
    v_accvgpr_read_b32 v178, a114
    v_mfma_f32_16x16x32_bf16 v[76:79], a[52:55], a[164:167], v[76:79]
    buffer_load_dwordx4 v6, s[44:47], s81 offen lds
    v_mfma_f32_16x16x32_bf16 v[84:87], a[56:59], a[164:167], v[84:87]
    s_add_u32 m0, s89, 24576
    s_add_u32 s16, s16, s84
    ds_read_b64_tr_b16 a[8:9], v12 offset:0
    ds_read_b64_tr_b16 a[10:11], v12 offset:1024
    v_accvgpr_read_b32 v179, a115
    v_mfma_f32_16x16x32_bf16 v[80:83], a[56:59], a[160:163], v[80:83]
    s_waitcnt lgkmcnt(4)
    ds_read_b64_tr_b16 a[12:13], v13 offset:0
    v_accvgpr_read_b32 v180, a116
    v_mfma_f32_16x16x32_bf16 v[88:91], a[60:63], a[160:163], v[88:91]
    s_add_u32 s81, s74, 86016
    ds_read_b64_tr_b16 a[14:15], v13 offset:1024
    v_accvgpr_read_b32 v181, a117
    v_mfma_f32_16x16x32_bf16 v[92:95], a[60:63], a[164:167], v[92:95]
    s_add_u32 s17, s16, 14336
    buffer_load_dwordx4 v6, s[44:47], s81 offen lds
    v_accvgpr_read_b32 v182, a118
    v_mfma_f32_16x16x32_bf16 v[112:115], a[0:3], a[164:167], v[112:115]
    s_add_u32 m0, s89, 28672
    ds_read_b64_tr_b16 a[16:17], v14 offset:0
    ds_read_b64_tr_b16 a[18:19], v14 offset:1024
    v_accvgpr_read_b32 v183, a119
    v_mfma_f32_16x16x32_bf16 v[96:99], a[0:3], a[160:163], v[96:99]
    s_waitcnt lgkmcnt(4)
    ds_read_b64_tr_b16 a[20:21], v15 offset:0
    v_accvgpr_read_b32 v208, a144
    v_mfma_f32_16x16x32_bf16 v[100:103], a[4:7], a[160:163], v[100:103]
    s_add_u32 s81, s74, 129024
    ds_read_b64_tr_b16 a[22:23], v15 offset:1024
    v_accvgpr_read_b32 v209, a145
    v_mfma_f32_16x16x32_bf16 v[116:119], a[4:7], a[164:167], v[116:119]
    buffer_load_dwordx4 v6, s[44:47], s81 offen lds
    v_accvgpr_read_b32 v210, a146
    v_accvgpr_read_b32 v211, a147
    v_mfma_f32_16x16x32_bf16 v[120:123], a[8:11], a[164:167], v[120:123]
    s_add_u32 s72, s72, 128
    ds_read_b128 a[168:171], v9 offset:0
    ds_read_b128 a[172:175], v9 offset:2048
    v_mfma_f32_16x16x32_bf16 v[104:107], a[8:11], a[160:163], v[104:107]
    s_waitcnt lgkmcnt(4)
    s_add_u32 s83, s83, 512
    v_accvgpr_read_b32 v212, a148
    v_mfma_f32_16x16x32_bf16 v[108:111], a[12:15], a[160:163], v[108:111]
    s_add_u32 s74, s74, 172032
    ds_read_b64_tr_b16 a[24:25], v16 offset:16384
    ds_read_b64_tr_b16 a[26:27], v16 offset:18432
    v_accvgpr_read_b32 v213, a149
    v_mfma_f32_16x16x32_bf16 v[124:127], a[12:15], a[164:167], v[124:127]
    s_xor_b32 s76, s76, s90
    ds_read_b64_tr_b16 a[28:29], v17 offset:16384
    v_accvgpr_read_b32 v214, a150
    v_mfma_f32_16x16x32_bf16 v[56:59], a[164:167], a[16:19], v[56:59]
    s_mul_hi_u32 s84, s83, 613566757
    ds_read_b64_tr_b16 a[30:31], v17 offset:18432
    v_accvgpr_read_b32 v215, a151
    v_mfma_f32_16x16x32_bf16 v[48:51], a[160:163], a[16:19], v[48:51]
    s_waitcnt lgkmcnt(4)
    s_xor_b32 s89, s89, s90
    ds_read_b64_tr_b16 a[32:33], v18 offset:16384
    v_mfma_f32_16x16x32_bf16 v[52:55], a[160:163], a[20:23], v[52:55]
    s_add_u32 s77, s86, s85
    s_mul_i32 s24, s84, 27776
    ds_read_b64_tr_b16 a[34:35], v18 offset:18432
    v_mfma_f32_16x16x32_bf16 v[60:63], a[164:167], a[20:23], v[60:63]
    s_add_u32 m0, s77, 0
    ds_read_b64_tr_b16 a[36:37], v19 offset:16384
    ds_read_b64_tr_b16 a[38:39], v19 offset:18432
    v_mfma_f32_16x16x32_bf16 v[32:35], a[216:219], a[168:171], v[32:35]
    s_add_u32 s82, s73, 0
    s_mul_i32 s25, s84, 24192
    ds_read_b64_tr_b16 a[40:41], v20 offset:16384
    v_mfma_f32_16x16x32_bf16 v[36:39], a[216:219], a[172:175], v[36:39]
    s_waitcnt lgkmcnt(5)
    ds_read_b64_tr_b16 a[42:43], v20 offset:18432
    ds_read_b64_tr_b16 a[44:45], v21 offset:16384
    v_mfma_f32_16x16x32_bf16 v[132:135], a[24:27], a[172:175], v[132:135]
    buffer_load_dwordx4 v3, s[40:43], s82 offen lds
    v_mfma_f32_16x16x32_bf16 v[128:131], a[24:27], a[168:171], v[128:131]
    s_add_u32 m0, s77, 8192
    s_sub_u32 s25, s25, 3211264
    ds_read_b64_tr_b16 a[46:47], v21 offset:18432
    v_mfma_f32_16x16x32_bf16 v[136:139], a[28:31], a[168:171], v[136:139]
    s_add_u32 s82, s73, 131072
    ds_read_b64_tr_b16 a[48:49], v22 offset:16384
    ds_read_b64_tr_b16 a[50:51], v22 offset:18432
    v_mfma_f32_16x16x32_bf16 v[140:143], a[28:31], a[172:175], v[140:143]
    s_waitcnt lgkmcnt(6)
    s_mov_b64 s[28:29], s[18:19]
    ds_read_b64_tr_b16 a[52:53], v23 offset:16384
    v_mfma_f32_16x16x32_bf16 v[148:151], a[32:35], a[172:175], v[148:151]
    buffer_load_dwordx4 v3, s[40:43], s82 offen lds
    v_mfma_f32_16x16x32_bf16 v[144:147], a[32:35], a[168:171], v[144:147]
    s_add_u32 m0, s77, 16384
    ds_read_b64_tr_b16 a[54:55], v23 offset:18432
    ds_read_b64_tr_b16 a[56:57], v16 offset:16640
    v_mfma_f32_16x16x32_bf16 a[88:91], a[36:39], a[168:171], a[88:91]
    s_add_u32 s82, s73, 262144
    s_mov_b32 s30, 3670016
    ds_read_b64_tr_b16 a[58:59], v16 offset:18688
    v_mfma_f32_16x16x32_bf16 a[92:95], a[36:39], a[172:175], a[92:95]
    s_waitcnt lgkmcnt(6)
    ds_read_b64_tr_b16 a[60:61], v17 offset:16640
    ds_read_b64_tr_b16 a[62:63], v17 offset:18688
    v_mfma_f32_16x16x32_bf16 v[164:167], a[40:43], a[172:175], v[164:167]
    buffer_load_dwordx4 v3, s[40:43], s82 offen lds
    v_mfma_f32_16x16x32_bf16 v[160:163], a[40:43], a[168:171], v[160:163]
    s_add_u32 m0, s77, 24576
    ds_read_b64_tr_b16 a[0:1], v18 offset:16640
    ds_read_b64_tr_b16 a[2:3], v18 offset:18688
    v_mfma_f32_16x16x32_bf16 v[168:171], a[44:47], a[168:171], v[168:171]
    s_cmp_ge_u32 s84, 128
    s_cselect_b32 s24, s25, s24
    s_cselect_b64 s[32:33], s[0:1], s[18:19]
    s_cselect_b32 s34, 401408, s30
    v_mfma_f32_16x16x32_bf16 v[172:175], a[44:47], a[172:175], v[172:175]
    s_waitcnt lgkmcnt(6)
    s_add_u32 s82, s73, 393216
    ds_read_b64_tr_b16 a[4:5], v19 offset:16640
    v_mfma_f32_16x16x32_bf16 v[180:183], a[48:51], a[172:175], v[180:183]
    s_lshl_b32 s84, s83, 7
    ds_read_b64_tr_b16 a[6:7], v19 offset:18688
    ds_read_b64_tr_b16 a[8:9], v20 offset:16640
    v_mfma_f32_16x16x32_bf16 v[176:179], a[48:51], a[168:171], v[176:179]
    buffer_load_dwordx4 v3, s[40:43], s82 offen lds
    v_mfma_f32_16x16x32_bf16 a[120:123], a[52:55], a[168:171], a[120:123]
    s_add_u32 m0, s77, 2048
    s_add_u32 s82, s73, 32768
    ds_read_b64_tr_b16 a[10:11], v20 offset:18688
    v_mfma_f32_16x16x32_bf16 a[124:127], a[52:55], a[172:175], a[124:127]
    s_waitcnt lgkmcnt(6)
    s_add_u32 s24, s24, s84
    ds_read_b64_tr_b16 a[12:13], v21 offset:16640
    v_mfma_f32_16x16x32_bf16 v[196:199], a[56:59], a[172:175], v[196:199]
    s_add_u32 s25, s24, 14336
    ds_read_b64_tr_b16 a[14:15], v21 offset:18688
    v_accvgpr_read_b32 v152, a88
    v_mfma_f32_16x16x32_bf16 v[192:195], a[56:59], a[168:171], v[192:195]
    buffer_load_dwordx4 v3, s[40:43], s82 offen lds
    v_mfma_f32_16x16x32_bf16 v[200:203], a[60:63], a[168:171], v[200:203]
    s_add_u32 m0, s77, 10240
    ds_read_b64_tr_b16 a[16:17], v22 offset:16640
    v_accvgpr_read_b32 v153, a89
    v_mfma_f32_16x16x32_bf16 v[204:207], a[60:63], a[172:175], v[204:207]
    s_waitcnt lgkmcnt(5)
    ds_read_b64_tr_b16 a[18:19], v22 offset:18688
    v_accvgpr_read_b32 v154, a90
    v_mfma_f32_16x16x32_bf16 v[212:215], a[0:3], a[172:175], v[212:215]
    s_add_u32 s82, s73, 163840
    ds_read_b64_tr_b16 a[20:21], v23 offset:16640
    v_accvgpr_read_b32 v155, a91
    v_mfma_f32_16x16x32_bf16 v[208:211], a[0:3], a[168:171], v[208:211]
    ds_read_b64_tr_b16 a[22:23], v23 offset:18688
    v_accvgpr_read_b32 v156, a92
    v_mfma_f32_16x16x32_bf16 v[40:43], a[4:7], a[168:171], v[40:43]
    buffer_load_dwordx4 v3, s[40:43], s82 offen lds
    v_mfma_f32_16x16x32_bf16 v[44:47], a[4:7], a[172:175], v[44:47]
    s_waitcnt lgkmcnt(4)
    ds_read_b64_tr_b16 a[24:25], v10 offset:8192
    ds_read_b64_tr_b16 a[26:27], v10 offset:9216
    v_accvgpr_read_b32 v157, a93
    v_mfma_f32_16x16x32_bf16 v[68:71], a[8:11], a[172:175], v[68:71]
    s_cmp_eq_u32 s65, 1
    s_cselect_b32 s30, 0, s30
    s_cselect_b32 s34, 0, s34
    v_mfma_f32_16x16x32_bf16 v[64:67], a[8:11], a[168:171], v[64:67]
    s_add_u32 m0, s77, 18432
    ds_read_b64_tr_b16 a[28:29], v11 offset:8192
    v_accvgpr_read_b32 v158, a94
    v_mfma_f32_16x16x32_bf16 v[72:75], a[12:15], a[168:171], v[72:75]
    s_add_u32 s82, s73, 294912
    ds_read_b64_tr_b16 a[30:31], v11 offset:9216
    buffer_load_dwordx4 v3, s[40:43], s82 offen lds
    v_accvgpr_read_b32 v159, a95
    v_mfma_f32_16x16x32_bf16 v[76:79], a[12:15], a[172:175], v[76:79]
    s_waitcnt lgkmcnt(4)
    v_accvgpr_read_b32 v184, a120
    v_lshrrev_b32 v30, 4, v0
    v_mfma_f32_16x16x32_bf16 v[84:87], a[16:19], a[172:175], v[84:87]
    s_add_u32 m0, s77, 26624
    ds_read_b64_tr_b16 a[32:33], v12 offset:8192
    ds_read_b64_tr_b16 a[34:35], v12 offset:9216
    v_accvgpr_read_b32 v185, a121
    v_mfma_f32_16x16x32_bf16 v[80:83], a[16:19], a[168:171], v[80:83]
    s_add_u32 s82, s73, 425984
    ds_read_b64_tr_b16 a[36:37], v13 offset:8192
    ds_read_b64_tr_b16 a[38:39], v13 offset:9216
    v_accvgpr_read_b32 v186, a122
    v_mfma_f32_16x16x32_bf16 v[88:91], a[20:23], a[168:171], v[88:91]
    v_accvgpr_read_b32 v187, a123
    v_mul_u32_u24 v30, 3584, v30
    v_mfma_f32_16x16x32_bf16 v[92:95], a[20:23], a[172:175], v[92:95]
    s_waitcnt lgkmcnt(4)
    ds_read_b64_tr_b16 a[40:41], v14 offset:8192
    ds_read_b64_tr_b16 a[42:43], v14 offset:9216
    ds_read_b64_tr_b16 a[44:45], v15 offset:8192
    ds_read_b64_tr_b16 a[46:47], v15 offset:9216
    v_accvgpr_read_b32 v188, a124
    v_mfma_f32_16x16x32_bf16 v[112:115], a[24:27], a[172:175], v[112:115]
    buffer_load_dwordx4 v3, s[40:43], s82 offen lds
    v_accvgpr_read_b32 v189, a125
    v_mfma_f32_16x16x32_bf16 v[96:99], a[24:27], a[168:171], v[96:99]
    s_add_u32 s73, s73, 524288
    s_add_u32 s86, s86, s90
    s_cmp_eq_u32 s86, 163840
    s_cselect_b32 s86, 65536, s86
    v_accvgpr_read_b32 v190, a126
    v_and_b32 v29, 15, v0
    v_lshl_add_u32 v30, v29, 3, v30
    v_mfma_f32_16x16x32_bf16 v[100:103], a[28:31], a[168:171], v[100:103]
    v_xor_b32 v8, 0x8000, v8
    v_accvgpr_read_b32 v191, a127
    v_mfma_f32_16x16x32_bf16 v[116:119], a[28:31], a[172:175], v[116:119]
    s_waitcnt vmcnt(8) lgkmcnt(0)
    s_barrier
    v_xor_b32 v9, 0x8000, v9
    v_mfma_f32_16x16x32_bf16 v[120:123], a[32:35], a[172:175], v[120:123]
    v_xor_b32 v10, 0x8000, v10
    v_xor_b32 v11, 0x8000, v11
    v_xor_b32 v12, 0x8000, v12
    v_xor_b32 v13, 0x8000, v13
    v_xor_b32 v14, 0x8000, v14
    v_xor_b32 v15, 0x8000, v15
    v_add_u32 v16, 0xffff0000, v16
    v_add_u32 v17, 0xffff0000, v17
    v_add_u32 v18, 0xffff0000, v18
    v_add_u32 v19, 0xffff0000, v19
    v_add_u32 v20, 0xffff0000, v20
    v_add_u32 v21, 0xffff0000, v21
    v_add_u32 v22, 0xffff0000, v22
    v_add_u32 v23, 0xffff0000, v23
    v_mfma_f32_16x16x32_bf16 v[104:107], a[32:35], a[168:171], v[104:107]
    ds_read_b128 a[160:163], v8 offset:0
    ds_read_b128 a[164:167], v8 offset:2048
    v_mfma_f32_16x16x32_bf16 v[108:111], a[36:39], a[168:171], v[108:111]
    ds_read_b64_tr_b16 a[48:49], v16 offset:0
    v_mfma_f32_16x16x32_bf16 v[124:127], a[36:39], a[172:175], v[124:127]
    ds_read_b64_tr_b16 a[50:51], v16 offset:2048
    ds_read_b64_tr_b16 a[52:53], v17 offset:0
    v_mfma_f32_16x16x32_bf16 v[56:59], a[172:175], a[40:43], v[56:59]
    ds_read_b64_tr_b16 a[54:55], v17 offset:2048
    v_mfma_f32_16x16x32_bf16 v[48:51], a[168:171], a[40:43], v[48:51]
    ds_read_b64_tr_b16 a[56:57], v18 offset:0
    ds_read_b64_tr_b16 a[58:59], v18 offset:2048
    v_mfma_f32_16x16x32_bf16 v[52:55], a[168:171], a[44:47], v[52:55]
    v_mfma_f32_16x16x32_bf16 v[60:63], a[172:175], a[44:47], v[60:63]
    s_waitcnt lgkmcnt(4)
    v_mfma_f32_16x16x32_bf16 v[32:35], a[212:215], a[160:163], v[32:35]
    ds_read_b64_tr_b16 a[60:61], v19 offset:0
    ds_read_b64_tr_b16 a[62:63], v19 offset:2048
    v_mfma_f32_16x16x32_bf16 v[36:39], a[212:215], a[164:167], v[36:39]
    s_add_u32 m0, s76, 0
    ds_read_b64_tr_b16 a[0:1], v20 offset:0
    ds_read_b64_tr_b16 a[2:3], v20 offset:2048
    v_mfma_f32_16x16x32_bf16 v[132:135], a[48:51], a[164:167], v[132:135]
    ds_read_b64_tr_b16 a[4:5], v21 offset:0
    ds_read_b64_tr_b16 a[6:7], v21 offset:2048
    v_mfma_f32_16x16x32_bf16 v[128:131], a[48:51], a[160:163], v[128:131]
    s_waitcnt lgkmcnt(6)
    s_add_u32 s81, s72, 0
    ds_read_b64_tr_b16 a[8:9], v22 offset:0
    v_mfma_f32_16x16x32_bf16 v[136:139], a[52:55], a[160:163], v[136:139]
    ds_read_b64_tr_b16 a[10:11], v22 offset:2048
    ds_read_b64_tr_b16 a[12:13], v23 offset:0
    v_mfma_f32_16x16x32_bf16 v[140:143], a[52:55], a[164:167], v[140:143]
    ds_read_b64_tr_b16 a[14:15], v23 offset:2048
    v_mfma_f32_16x16x32_bf16 v[148:151], a[56:59], a[164:167], v[148:151]
    ds_read_b64_tr_b16 a[16:17], v16 offset:256
    ds_read_b64_tr_b16 a[18:19], v16 offset:2304
    v_mfma_f32_16x16x32_bf16 v[144:147], a[56:59], a[160:163], v[144:147]
    s_waitcnt lgkmcnt(8)
    ds_read_b64_tr_b16 a[20:21], v17 offset:256
    v_mfma_f32_16x16x32_bf16 v[152:155], a[60:63], a[160:163], v[152:155]
    buffer_load_dwordx4 v4, s[36:39], s81 offen lds
    v_mfma_f32_16x16x32_bf16 v[156:159], a[60:63], a[164:167], v[156:159]
    s_add_u32 m0, s76, 4096
    ds_read_b64_tr_b16 a[22:23], v17 offset:2304
    v_mfma_f32_16x16x32_bf16 v[164:167], a[0:3], a[164:167], v[164:167]
    ds_read_b64_tr_b16 a[24:25], v18 offset:256
    ds_read_b64_tr_b16 a[26:27], v18 offset:2304
    v_mfma_f32_16x16x32_bf16 v[160:163], a[0:3], a[160:163], v[160:163]
    s_waitcnt lgkmcnt(8)
    s_add_u32 s81, s72, 28672
    v_mfma_f32_16x16x32_bf16 v[168:171], a[4:7], a[160:163], v[168:171]
    ds_read_b64_tr_b16 a[28:29], v19 offset:256
    ds_read_b64_tr_b16 a[30:31], v19 offset:2304
    v_mfma_f32_16x16x32_bf16 v[172:175], a[4:7], a[164:167], v[172:175]
    buffer_load_dwordx4 v4, s[36:39], s81 offen lds
    v_mfma_f32_16x16x32_bf16 v[180:183], a[8:11], a[164:167], v[180:183]
    ds_read_b64_tr_b16 a[32:33], v20 offset:256
    ds_read_b64_tr_b16 a[34:35], v20 offset:2304
    v_mfma_f32_16x16x32_bf16 v[176:179], a[8:11], a[160:163], v[176:179]
    s_waitcnt lgkmcnt(8)
    v_mfma_f32_16x16x32_bf16 v[184:187], a[12:15], a[160:163], v[184:187]
    ds_read_b64_tr_b16 a[36:37], v21 offset:256
    ds_read_b64_tr_b16 a[38:39], v21 offset:2304
    v_mfma_f32_16x16x32_bf16 v[188:191], a[12:15], a[164:167], v[188:191]
    s_add_u32 m0, s76, 8192
    v_mfma_f32_16x16x32_bf16 v[196:199], a[16:19], a[164:167], v[196:199]
    ds_read_b64_tr_b16 a[40:41], v22 offset:256
    ds_read_b64_tr_b16 a[42:43], v22 offset:2304
    v_mfma_f32_16x16x32_bf16 v[192:195], a[16:19], a[160:163], v[192:195]
    s_waitcnt lgkmcnt(8)
    s_add_u32 s81, s72, 57344
    v_mfma_f32_16x16x32_bf16 v[200:203], a[20:23], a[160:163], v[200:203]
    ds_read_b64_tr_b16 a[44:45], v23 offset:256
    ds_read_b64_tr_b16 a[46:47], v23 offset:2304
    v_mfma_f32_16x16x32_bf16 v[204:207], a[20:23], a[164:167], v[204:207]
    ds_read_b64_tr_b16 a[48:49], v10 offset:0
    v_mfma_f32_16x16x32_bf16 v[212:215], a[24:27], a[164:167], v[212:215]
    buffer_load_dwordx4 v4, s[36:39], s81 offen lds
    v_mfma_f32_16x16x32_bf16 v[208:211], a[24:27], a[160:163], v[208:211]
    s_waitcnt lgkmcnt(7)
    ds_read_b64_tr_b16 a[50:51], v10 offset:1024
    v_mfma_f32_16x16x32_bf16 v[40:43], a[28:31], a[160:163], v[40:43]
    ds_read_b64_tr_b16 a[52:53], v11 offset:0
    ds_read_b64_tr_b16 a[54:55], v11 offset:1024
    v_mfma_f32_16x16x32_bf16 v[44:47], a[28:31], a[164:167], v[44:47]
    s_add_u32 m0, s76, 12288
    v_mfma_f32_16x16x32_bf16 v[68:71], a[32:35], a[164:167], v[68:71]
    ds_read_b64_tr_b16 a[56:57], v12 offset:0
    ds_read_b64_tr_b16 a[58:59], v12 offset:1024
    v_mfma_f32_16x16x32_bf16 v[64:67], a[32:35], a[160:163], v[64:67]
    s_waitcnt lgkmcnt(8)
    s_add_u32 s81, s72, 86016
    v_mfma_f32_16x16x32_bf16 v[72:75], a[36:39], a[160:163], v[72:75]
    ds_read_b64_tr_b16 a[60:61], v13 offset:0
    ds_read_b64_tr_b16 a[62:63], v13 offset:1024
    v_mfma_f32_16x16x32_bf16 v[76:79], a[36:39], a[164:167], v[76:79]
    ds_read_b64_tr_b16 a[0:1], v14 offset:0
    v_mfma_f32_16x16x32_bf16 v[84:87], a[40:43], a[164:167], v[84:87]
    buffer_load_dwordx4 v4, s[36:39], s81 offen lds
    v_mfma_f32_16x16x32_bf16 v[80:83], a[40:43], a[160:163], v[80:83]
    s_waitcnt lgkmcnt(7)
    ds_read_b64_tr_b16 a[2:3], v14 offset:1024
    v_mfma_f32_16x16x32_bf16 v[88:91], a[44:47], a[160:163], v[88:91]
    ds_read_b64_tr_b16 a[4:5], v15 offset:0
    ds_read_b64_tr_b16 a[6:7], v15 offset:1024
    v_mfma_f32_16x16x32_bf16 v[92:95], a[44:47], a[164:167], v[92:95]
    s_add_u32 m0, s89, 16384
    v_mfma_f32_16x16x32_bf16 v[112:115], a[48:51], a[164:167], v[112:115]
    ds_read_b128 a[168:171], v9 offset:0
    ds_read_b128 a[172:175], v9 offset:2048
    v_mfma_f32_16x16x32_bf16 v[96:99], a[48:51], a[160:163], v[96:99]
    s_waitcnt lgkmcnt(8)
    s_add_u32 s81, s74, 0
    v_mfma_f32_16x16x32_bf16 v[100:103], a[52:55], a[160:163], v[100:103]
    ds_read_b64_tr_b16 a[8:9], v16 offset:16384
    ds_read_b64_tr_b16 a[10:11], v16 offset:18432
    v_mfma_f32_16x16x32_bf16 v[116:119], a[52:55], a[164:167], v[116:119]
    ds_read_b64_tr_b16 a[12:13], v17 offset:16384
    v_mfma_f32_16x16x32_bf16 v[120:123], a[56:59], a[164:167], v[120:123]
    buffer_load_dwordx4 v6, s[44:47], s81 offen lds
    v_mfma_f32_16x16x32_bf16 v[104:107], a[56:59], a[160:163], v[104:107]
    s_waitcnt lgkmcnt(7)
    ds_read_b64_tr_b16 a[14:15], v17 offset:18432
    v_mfma_f32_16x16x32_bf16 v[108:111], a[60:63], a[160:163], v[108:111]
    s_add_u32 m0, s89, 20480
    ds_read_b64_tr_b16 a[16:17], v18 offset:16384
    ds_read_b64_tr_b16 a[18:19], v18 offset:18432
    v_mfma_f32_16x16x32_bf16 v[124:127], a[60:63], a[164:167], v[124:127]
    v_mfma_f32_16x16x32_bf16 v[56:59], a[164:167], a[0:3], v[56:59]
    ds_read_b64_tr_b16 a[20:21], v19 offset:16384
    ds_read_b64_tr_b16 a[22:23], v19 offset:18432
    v_mfma_f32_16x16x32_bf16 v[48:51], a[160:163], a[0:3], v[48:51]
    s_waitcnt lgkmcnt(8)
    s_add_u32 s81, s74, 43008
    v_mfma_f32_16x16x32_bf16 v[52:55], a[160:163], a[4:7], v[52:55]
    ds_read_b64_tr_b16 a[24:25], v20 offset:16384
    ds_read_b64_tr_b16 a[26:27], v20 offset:18432
    v_mfma_f32_16x16x32_bf16 v[60:63], a[164:167], a[4:7], v[60:63]
    ds_read_b64_tr_b16 a[28:29], v21 offset:16384
    v_mfma_f32_16x16x32_bf16 v[32:35], a[208:211], a[168:171], v[32:35]
    buffer_load_dwordx4 v6, s[44:47], s81 offen lds
    v_mfma_f32_16x16x32_bf16 v[36:39], a[208:211], a[172:175], v[36:39]
    s_waitcnt lgkmcnt(7)
    ds_read_b64_tr_b16 a[30:31], v21 offset:18432
    v_mfma_f32_16x16x32_bf16 v[132:135], a[8:11], a[172:175], v[132:135]
    s_add_u32 m0, s89, 24576
    ds_read_b64_tr_b16 a[32:33], v22 offset:16384
    ds_read_b64_tr_b16 a[34:35], v22 offset:18432
    v_mfma_f32_16x16x32_bf16 v[128:131], a[8:11], a[168:171], v[128:131]
    v_mfma_f32_16x16x32_bf16 v[136:139], a[12:15], a[168:171], v[136:139]
    ds_read_b64_tr_b16 a[36:37], v23 offset:16384
    ds_read_b64_tr_b16 a[38:39], v23 offset:18432
    v_mfma_f32_16x16x32_bf16 v[140:143], a[12:15], a[172:175], v[140:143]
    s_waitcnt lgkmcnt(8)
    s_add_u32 s81, s74, 86016
    v_mfma_f32_16x16x32_bf16 v[148:151], a[16:19], a[172:175], v[148:151]
    ds_read_b64_tr_b16 a[40:41], v16 offset:16640
    ds_read_b64_tr_b16 a[42:43], v16 offset:18688
    v_mfma_f32_16x16x32_bf16 v[144:147], a[16:19], a[168:171], v[144:147]
    ds_read_b64_tr_b16 a[44:45], v17 offset:16640
    v_mfma_f32_16x16x32_bf16 v[152:155], a[20:23], a[168:171], v[152:155]
    buffer_load_dwordx4 v6, s[44:47], s81 offen lds
    v_mfma_f32_16x16x32_bf16 v[156:159], a[20:23], a[172:175], v[156:159]
    s_waitcnt lgkmcnt(7)
    ds_read_b64_tr_b16 a[46:47], v17 offset:18688
    v_mfma_f32_16x16x32_bf16 v[164:167], a[24:27], a[172:175], v[164:167]
    s_add_u32 m0, s89, 28672
    ds_read_b64_tr_b16 a[48:49], v18 offset:16640
    ds_read_b64_tr_b16 a[50:51], v18 offset:18688
    v_mfma_f32_16x16x32_bf16 v[160:163], a[24:27], a[168:171], v[160:163]
    v_mfma_f32_16x16x32_bf16 v[168:171], a[28:31], a[168:171], v[168:171]
    ds_read_b64_tr_b16 a[52:53], v19 offset:16640
    ds_read_b64_tr_b16 a[54:55], v19 offset:18688
    v_mfma_f32_16x16x32_bf16 v[172:175], a[28:31], a[172:175], v[172:175]
    s_waitcnt lgkmcnt(8)
    s_add_u32 s81, s74, 129024
    v_mfma_f32_16x16x32_bf16 v[180:183], a[32:35], a[172:175], v[180:183]
    ds_read_b64_tr_b16 a[56:57], v20 offset:16640
    ds_read_b64_tr_b16 a[58:59], v20 offset:18688
    v_mfma_f32_16x16x32_bf16 v[176:179], a[32:35], a[168:171], v[176:179]
    ds_read_b64_tr_b16 a[60:61], v21 offset:16640
    v_mfma_f32_16x16x32_bf16 v[184:187], a[36:39], a[168:171], v[184:187]
    buffer_load_dwordx4 v6, s[44:47], s81 offen lds
    v_mfma_f32_16x16x32_bf16 v[188:191], a[36:39], a[172:175], v[188:191]
    s_waitcnt lgkmcnt(7)
    ds_read_b64_tr_b16 a[62:63], v21 offset:18688
    v_mfma_f32_16x16x32_bf16 v[196:199], a[40:43], a[172:175], v[196:199]
    s_add_u32 s72, s72, 128
    ds_read_b64_tr_b16 a[0:1], v22 offset:16640
    ds_read_b64_tr_b16 a[2:3], v22 offset:18688
    v_mfma_f32_16x16x32_bf16 v[192:195], a[40:43], a[168:171], v[192:195]
    v_mfma_f32_16x16x32_bf16 v[200:203], a[44:47], a[168:171], v[200:203]
    ds_read_b64_tr_b16 a[4:5], v23 offset:16640
    ds_read_b64_tr_b16 a[6:7], v23 offset:18688
    v_mfma_f32_16x16x32_bf16 v[204:207], a[44:47], a[172:175], v[204:207]
    s_waitcnt lgkmcnt(8)
    s_add_u32 s74, s74, 172032
    v_mfma_f32_16x16x32_bf16 v[212:215], a[48:51], a[172:175], v[212:215]
    ds_read_b64_tr_b16 a[8:9], v10 offset:8192
    ds_read_b64_tr_b16 a[10:11], v10 offset:9216
    v_mfma_f32_16x16x32_bf16 v[208:211], a[48:51], a[168:171], v[208:211]
    v_mfma_f32_16x16x32_bf16 v[40:43], a[52:55], a[168:171], v[40:43]
    s_xor_b32 s76, s76, s90
    ds_read_b64_tr_b16 a[12:13], v11 offset:8192
    ds_read_b64_tr_b16 a[14:15], v11 offset:9216
    v_mfma_f32_16x16x32_bf16 v[44:47], a[52:55], a[172:175], v[44:47]
    s_waitcnt lgkmcnt(8)
    v_mfma_f32_16x16x32_bf16 v[68:71], a[56:59], a[172:175], v[68:71]
    s_xor_b32 s89, s89, s90
    ds_read_b64_tr_b16 a[16:17], v12 offset:8192
    ds_read_b64_tr_b16 a[18:19], v12 offset:9216
    v_mfma_f32_16x16x32_bf16 v[64:67], a[56:59], a[168:171], v[64:67]
    v_mfma_f32_16x16x32_bf16 v[72:75], a[60:63], a[168:171], v[72:75]
    ds_read_b64_tr_b16 a[20:21], v13 offset:8192
    ds_read_b64_tr_b16 a[22:23], v13 offset:9216
    v_mfma_f32_16x16x32_bf16 v[76:79], a[60:63], a[172:175], v[76:79]
    s_waitcnt lgkmcnt(8)
    v_mov_b32 v25, 0
    v_mfma_f32_16x16x32_bf16 v[84:87], a[0:3], a[172:175], v[84:87]
    ds_read_b64_tr_b16 a[24:25], v14 offset:8192
    buffer_load_dword v25, v25, s[48:51], s101 offen sc1
    v_mfma_f32_16x16x32_bf16 v[80:83], a[0:3], a[168:171], v[80:83]
    ds_read_b64_tr_b16 a[26:27], v14 offset:9216
    v_mfma_f32_16x16x32_bf16 v[88:91], a[4:7], a[168:171], v[88:91]
    ds_read_b64_tr_b16 a[28:29], v15 offset:8192
    ds_read_b64_tr_b16 a[30:31], v15 offset:9216
    v_mfma_f32_16x16x32_bf16 v[92:95], a[4:7], a[172:175], v[92:95]
    s_waitcnt lgkmcnt(8)
    v_mfma_f32_16x16x32_bf16 v[112:115], a[8:11], a[172:175], v[112:115]
    v_xor_b32 v8, 0x8000, v8
    v_xor_b32 v9, 0x8000, v9
    v_mfma_f32_16x16x32_bf16 v[96:99], a[8:11], a[168:171], v[96:99]
    v_xor_b32 v10, 0x8000, v10
    v_xor_b32 v11, 0x8000, v11
    v_mfma_f32_16x16x32_bf16 v[100:103], a[12:15], a[168:171], v[100:103]
    v_xor_b32 v12, 0x8000, v12
    v_xor_b32 v13, 0x8000, v13
    v_mfma_f32_16x16x32_bf16 v[116:119], a[12:15], a[172:175], v[116:119]
    s_waitcnt vmcnt(1) lgkmcnt(0)
    s_barrier
    v_xor_b32 v14, 0x8000, v14
    v_mfma_f32_16x16x32_bf16 v[120:123], a[16:19], a[172:175], v[120:123]
    v_xor_b32 v15, 0x8000, v15
    v_add_u32 v16, 0x8000, v16
    v_add_u32 v17, 0x8000, v17
    v_add_u32 v18, 0x8000, v18
    v_add_u32 v19, 0x8000, v19
    v_add_u32 v20, 0x8000, v20
    v_add_u32 v21, 0x8000, v21
    v_add_u32 v22, 0x8000, v22
    v_add_u32 v23, 0x8000, v23
    v_mfma_f32_16x16x32_bf16 v[104:107], a[16:19], a[168:171], v[104:107]
    ds_read_b128 a[160:163], v8 offset:0
    ds_read_b128 a[164:167], v8 offset:2048
    v_mfma_f32_16x16x32_bf16 v[108:111], a[20:23], a[168:171], v[108:111]
    ds_read_b128 a[176:179], v9 offset:0
    v_mfma_f32_16x16x32_bf16 v[124:127], a[20:23], a[172:175], v[124:127]
    ds_read_b128 a[180:183], v9 offset:2048
    ds_read_b64_tr_b16 a[32:33], v16 offset:0
    v_mfma_f32_16x16x32_bf16 v[56:59], a[172:175], a[24:27], v[56:59]
    ds_read_b64_tr_b16 a[34:35], v16 offset:2048
    v_mov_b32 v26, 0x3db8aa3b
    v_mfma_f32_16x16x32_bf16 v[48:51], a[168:171], a[24:27], v[48:51]
    v_mov_b32 v27, v26
    v_mov_b32 v28, 0x3e8b97f6
    v_mfma_f32_16x16x32_bf16 v[52:55], a[168:171], a[28:31], v[52:55]
    ds_read_b64_tr_b16 a[36:37], v16 offset:16384
    v_mov_b32 v29, v28
    v_mfma_f32_16x16x32_bf16 v[60:63], a[172:175], a[28:31], v[60:63]
    ds_read_b64_tr_b16 a[38:39], v16 offset:18432
    ds_read_b64_tr_b16 a[40:41], v17 offset:0
    ds_read_b64_tr_b16 a[42:43], v17 offset:2048
    v_cmp_gt_u32 vcc, 48, v0
    s_lshl_b32 s75, s91, 13
    s_add_u32 s75, s75, 33554432
    s_add_u32 s79, s75, 8192
    s_lshl_b32 s91, s91, 10
    s_waitcnt lgkmcnt(6)
    v_mfma_f32_16x16x32_bf16 v[32:35], a[204:207], a[160:163], v[32:35]
    ds_read_b64_tr_b16 a[44:45], v17 offset:16384
    ds_read_b64_tr_b16 a[46:47], v17 offset:18432
    v_mfma_f32_16x16x32_bf16 v[36:39], a[204:207], a[164:167], v[36:39]
    ds_read_b64_tr_b16 a[48:49], v18 offset:0
    ds_read_b64_tr_b16 a[50:51], v18 offset:2048
    v_mfma_f32_16x16x32_bf16 v[32:35], a[200:203], a[176:179], v[32:35]
    ds_read_b64_tr_b16 a[52:53], v18 offset:16384
    ds_read_b64_tr_b16 a[54:55], v18 offset:18432
    v_mfma_f32_16x16x32_bf16 v[36:39], a[200:203], a[180:183], v[36:39]
    s_waitcnt lgkmcnt(8)
    v_mfma_f32_16x16x32_bf16 v[132:135], a[32:35], a[164:167], v[132:135]
    ds_read_b64_tr_b16 a[56:57], v19 offset:0
    ds_read_b64_tr_b16 a[58:59], v19 offset:2048
    v_mfma_f32_16x16x32_bf16 v[128:131], a[32:35], a[160:163], v[128:131]
    v_mfma_f32_16x16x32_bf16 v[132:135], a[36:39], a[180:183], v[132:135]
    ds_read_b64_tr_b16 a[60:61], v19 offset:16384
    ds_read_b64_tr_b16 a[62:63], v19 offset:18432
    v_mfma_f32_16x16x32_bf16 v[128:131], a[36:39], a[176:179], v[128:131]
    s_waitcnt lgkmcnt(8)
    v_mfma_f32_16x16x32_bf16 v[136:139], a[40:43], a[160:163], v[136:139]
    ds_read_b64_tr_b16 a[0:1], v20 offset:0
    ds_read_b64_tr_b16 a[2:3], v20 offset:2048
    v_mfma_f32_16x16x32_bf16 v[140:143], a[40:43], a[164:167], v[140:143]
    v_mfma_f32_16x16x32_bf16 v[136:139], a[44:47], a[176:179], v[136:139]
    ds_read_b64_tr_b16 a[4:5], v20 offset:16384
    ds_read_b64_tr_b16 a[6:7], v20 offset:18432
    v_mfma_f32_16x16x32_bf16 v[140:143], a[44:47], a[180:183], v[140:143]
    s_waitcnt lgkmcnt(8)
    v_mfma_f32_16x16x32_bf16 v[148:151], a[48:51], a[164:167], v[148:151]
    ds_read_b64_tr_b16 a[8:9], v21 offset:0
    ds_read_b64_tr_b16 a[10:11], v21 offset:2048
    v_mfma_f32_16x16x32_bf16 v[144:147], a[48:51], a[160:163], v[144:147]
    v_mfma_f32_16x16x32_bf16 v[148:151], a[52:55], a[180:183], v[148:151]
    ds_read_b64_tr_b16 a[12:13], v21 offset:16384
    ds_read_b64_tr_b16 a[14:15], v21 offset:18432
    v_mfma_f32_16x16x32_bf16 v[144:147], a[52:55], a[176:179], v[144:147]
    s_waitcnt lgkmcnt(8)
    ds_read_b64_tr_b16 a[16:17], v22 offset:0
    v_mfma_f32_16x16x32_bf16 v[152:155], a[56:59], a[160:163], v[152:155]
    s_waitcnt vmcnt(0)
    v_readfirstlane_b32 s83, v25
    s_nop 0
    s_cmp_lg_u32 s83, 16
    s_cbranch_scc1 F_sp2_9
F_sp2r_10:
    v_mfma_f32_16x16x32_bf16 v[156:159], a[56:59], a[164:167], v[156:159]
    s_add_u32 m0, s66, 32768
    s_nop 0
    ds_read_b64_tr_b16 a[18:19], v22 offset:2048
    v_mfma_f32_16x16x32_bf16 v[152:155], a[60:63], a[176:179], v[152:155]
    ds_read_b64_tr_b16 a[20:21], v22 offset:16384
    ds_read_b64_tr_b16 a[22:23], v22 offset:18432
    v_mfma_f32_16x16x32_bf16 v[156:159], a[60:63], a[180:183], v[156:159]
    s_waitcnt lgkmcnt(8)
    v_pk_mul_f32 v[128:129], v[128:129], v[26:27]
    v_mfma_f32_16x16x32_bf16 v[164:167], a[0:3], a[164:167], v[164:167]
    v_pk_mul_f32 v[130:131], v[130:131], v[26:27]
    v_mfma_f32_16x16x32_bf16 v[160:163], a[0:3], a[160:163], v[160:163]
    buffer_load_dwordx4 v2, s[8:11], s27 offen offset:0 sc1 lds
    buffer_load_dwordx4 v2, s[8:11], s27 offen offset:1024 sc1 lds
    v_mfma_f32_16x16x32_bf16 v[164:167], a[4:7], a[180:183], v[164:167]
    v_pk_mul_f32 v[136:137], v[136:137], v[26:27]
    v_mfma_f32_16x16x32_bf16 v[160:163], a[4:7], a[176:179], v[160:163]
    s_waitcnt lgkmcnt(4)
    ds_read_b64_tr_b16 a[24:25], v23 offset:0
    ds_read_b64_tr_b16 a[26:27], v23 offset:2048
    v_mfma_f32_16x16x32_bf16 v[168:171], a[8:11], a[160:163], v[168:171]
    buffer_load_dwordx4 v2, s[8:11], s27 offen offset:2048 sc1 lds
    v_pk_mul_f32 v[138:139], v[138:139], v[26:27]
    v_pk_mul_f32 v[132:133], v[132:133], v[26:27]
    v_pk_mul_f32 v[134:135], v[134:135], v[26:27]
    v_mfma_f32_16x16x32_bf16 v[172:175], a[8:11], a[164:167], v[172:175]
    v_pk_mul_f32 v[140:141], v[140:141], v[26:27]
    v_pk_mul_f32 v[142:143], v[142:143], v[26:27]
    v_cvt_pk_bf16_f32 v128, v128, v129
    v_mfma_f32_16x16x32_bf16 v[168:171], a[12:15], a[176:179], v[168:171]
    ds_read_b64_tr_b16 a[28:29], v23 offset:16384
    ds_read_b64_tr_b16 a[30:31], v23 offset:18432
    v_cvt_pk_bf16_f32 v129, v130, v131
    v_cvt_pk_bf16_f32 v130, v136, v137
    v_cvt_pk_bf16_f32 v131, v138, v139
    v_mfma_f32_16x16x32_bf16 v[172:175], a[12:15], a[180:183], v[172:175]
    s_waitcnt lgkmcnt(4)
    v_accvgpr_write_b32 a64, v128
    v_accvgpr_write_b32 a65, v129
    v_accvgpr_write_b32 a66, v130
    v_mfma_f32_16x16x32_bf16 v[180:183], a[16:19], a[164:167], v[180:183]
    ds_read_b64_tr_b16 a[32:33], v16 offset:256
    ds_read_b64_tr_b16 a[34:35], v16 offset:2304
    v_accvgpr_write_b32 a67, v131
    buffer_store_dwordx4 v[128:131], v1, s[20:23], s75 offen offset:0 sc1
    v_cvt_pk_bf16_f32 v132, v132, v133
    v_mfma_f32_16x16x32_bf16 v[176:179], a[16:19], a[160:163], v[176:179]
    buffer_load_dwordx4 v2, s[8:11], s27 offen offset:3072 sc1 lds
    v_cvt_pk_bf16_f32 v133, v134, v135
    v_cvt_pk_bf16_f32 v134, v140, v141
    v_cvt_pk_bf16_f32 v135, v142, v143
    v_mfma_f32_16x16x32_bf16 v[180:183], a[20:23], a[180:183], v[180:183]
    s_add_u32 m0, s66, 36864
    s_nop 0
    ds_read_b64_tr_b16 a[36:37], v16 offset:16640
    ds_read_b64_tr_b16 a[38:39], v16 offset:18688
    v_accvgpr_write_b32 a68, v132
    v_accvgpr_write_b32 a69, v133
    v_accvgpr_write_b32 a70, v134
    v_mfma_f32_16x16x32_bf16 v[176:179], a[20:23], a[176:179], v[176:179]
    s_waitcnt lgkmcnt(4)
    buffer_load_dwordx4 v5, s[8:11], s27 offen offset:0 sc1 lds
    buffer_load_dwordx4 v5, s[8:11], s27 offen offset:1024 sc1 lds
    v_accvgpr_write_b32 a71, v135
    buffer_store_dwordx4 v[132:135], v1, s[20:23], s79 offen offset:0 sc1
    v_pk_mul_f32 v[144:145], v[144:145], v[26:27]
    v_mfma_f32_16x16x32_bf16 v[184:187], a[24:27], a[160:163], v[184:187]
    ds_read_b64_tr_b16 a[40:41], v17 offset:256
    ds_read_b64_tr_b16 a[42:43], v17 offset:2304
    v_pk_mul_f32 v[146:147], v[146:147], v[26:27]
    v_pk_mul_f32 v[152:153], v[152:153], v[26:27]
    v_pk_mul_f32 v[154:155], v[154:155], v[26:27]
    v_mfma_f32_16x16x32_bf16 v[188:191], a[24:27], a[164:167], v[188:191]
    buffer_load_dwordx4 v5, s[8:11], s27 offen offset:2048 sc1 lds
    v_pk_mul_f32 v[148:149], v[148:149], v[26:27]
    v_pk_mul_f32 v[150:151], v[150:151], v[26:27]
    v_pk_mul_f32 v[156:157], v[156:157], v[26:27]
    v_mfma_f32_16x16x32_bf16 v[184:187], a[28:31], a[176:179], v[184:187]
    ds_read_b64_tr_b16 a[44:45], v17 offset:16640
    ds_read_b64_tr_b16 a[46:47], v17 offset:18688
    v_pk_mul_f32 v[158:159], v[158:159], v[26:27]
    v_cvt_pk_bf16_f32 v144, v144, v145
    v_cvt_pk_bf16_f32 v145, v146, v147
    v_mfma_f32_16x16x32_bf16 v[188:191], a[28:31], a[180:183], v[188:191]
    s_waitcnt lgkmcnt(4)
    v_cvt_pk_bf16_f32 v146, v152, v153
    v_cvt_pk_bf16_f32 v147, v154, v155
    v_accvgpr_write_b32 a72, v144
    v_mfma_f32_16x16x32_bf16 v[196:199], a[32:35], a[164:167], v[196:199]
    ds_read_b64_tr_b16 a[48:49], v18 offset:256
    ds_read_b64_tr_b16 a[50:51], v18 offset:2304
    buffer_load_dwordx4 v5, s[8:11], s27 offen offset:3072 sc1 lds
    v_accvgpr_write_b32 a73, v145
    v_accvgpr_write_b32 a74, v146
    v_accvgpr_write_b32 a75, v147
    v_mfma_f32_16x16x32_bf16 v[192:195], a[32:35], a[160:163], v[192:195]
    buffer_store_dwordx4 v[144:147], v1, s[20:23], s75 offen offset:1024 sc1
    v_cvt_pk_bf16_f32 v148, v148, v149
    v_mfma_f32_16x16x32_bf16 v[196:199], a[36:39], a[180:183], v[196:199]
    ds_read_b64_tr_b16 a[52:53], v18 offset:16640
    ds_read_b64_tr_b16 a[54:55], v18 offset:18688
    buffer_load_dwordx2 v[216:217], v30, s[28:31], s16 offen offset:0
    v_cvt_pk_bf16_f32 v149, v150, v151
    v_cvt_pk_bf16_f32 v150, v156, v157
    v_cvt_pk_bf16_f32 v151, v158, v159
    v_mfma_f32_16x16x32_bf16 v[192:195], a[36:39], a[176:179], v[192:195]
    s_waitcnt lgkmcnt(4)
    v_accvgpr_write_b32 a76, v148
    v_accvgpr_write_b32 a77, v149
    v_accvgpr_write_b32 a78, v150
    v_mfma_f32_16x16x32_bf16 v[200:203], a[40:43], a[160:163], v[200:203]
    ds_read_b64_tr_b16 a[56:57], v19 offset:256
    ds_read_b64_tr_b16 a[58:59], v19 offset:2304
    v_accvgpr_write_b32 a79, v151
    buffer_store_dwordx4 v[148:151], v1, s[20:23], s79 offen offset:1024 sc1
    v_pk_mul_f32 v[160:161], v[160:161], v[26:27]
    v_pk_mul_f32 v[162:163], v[162:163], v[26:27]
    v_mfma_f32_16x16x32_bf16 v[204:207], a[40:43], a[164:167], v[204:207]
    v_pk_mul_f32 v[168:169], v[168:169], v[26:27]
    v_pk_mul_f32 v[170:171], v[170:171], v[26:27]
    v_pk_mul_f32 v[164:165], v[164:165], v[26:27]
    v_mfma_f32_16x16x32_bf16 v[200:203], a[44:47], a[176:179], v[200:203]
    ds_read_b64_tr_b16 a[60:61], v19 offset:16640
    ds_read_b64_tr_b16 a[62:63], v19 offset:18688
    buffer_load_dwordx2 v[218:219], v30, s[28:31], s16 offen offset:896
    v_pk_mul_f32 v[166:167], v[166:167], v[26:27]
    v_pk_mul_f32 v[172:173], v[172:173], v[26:27]
    v_mfma_f32_16x16x32_bf16 v[204:207], a[44:47], a[180:183], v[204:207]
    s_waitcnt lgkmcnt(4)
    v_pk_mul_f32 v[174:175], v[174:175], v[26:27]
    v_cvt_pk_bf16_f32 v160, v160, v161
    v_cvt_pk_bf16_f32 v161, v162, v163
    v_mfma_f32_16x16x32_bf16 v[212:215], a[48:51], a[164:167], v[212:215]
    ds_read_b64_tr_b16 a[0:1], v20 offset:256
    ds_read_b64_tr_b16 a[2:3], v20 offset:2304
    buffer_load_dwordx2 v[220:221], v30, s[28:31], s16 offen offset:1792
    v_cvt_pk_bf16_f32 v162, v168, v169
    v_cvt_pk_bf16_f32 v163, v170, v171
    v_accvgpr_write_b32 a80, v160
    v_mfma_f32_16x16x32_bf16 v[208:211], a[48:51], a[160:163], v[208:211]
    v_accvgpr_write_b32 a81, v161
    v_accvgpr_write_b32 a82, v162
    v_accvgpr_write_b32 a83, v163
    v_mfma_f32_16x16x32_bf16 v[212:215], a[52:55], a[180:183], v[212:215]
    ds_read_b64_tr_b16 a[4:5], v20 offset:16640
    ds_read_b64_tr_b16 a[6:7], v20 offset:18688
    buffer_store_dwordx4 v[160:163], v1, s[20:23], s75 offen offset:2048 sc1
    v_cvt_pk_bf16_f32 v164, v164, v165
    v_cvt_pk_bf16_f32 v165, v166, v167
    v_mfma_f32_16x16x32_bf16 v[208:211], a[52:55], a[176:179], v[208:211]
    s_waitcnt lgkmcnt(4)
    v_cvt_pk_bf16_f32 v166, v172, v173
    v_cvt_pk_bf16_f32 v167, v174, v175
    v_accvgpr_write_b32 a84, v164
    v_mfma_f32_16x16x32_bf16 v[40:43], a[56:59], a[160:163], v[40:43]
    ds_read_b64_tr_b16 a[8:9], v21 offset:256
    ds_read_b64_tr_b16 a[10:11], v21 offset:2304
    v_accvgpr_write_b32 a85, v165
    v_accvgpr_write_b32 a86, v166
    v_accvgpr_write_b32 a87, v167
    v_mfma_f32_16x16x32_bf16 v[44:47], a[56:59], a[164:167], v[44:47]
    buffer_store_dwordx4 v[164:167], v1, s[20:23], s79 offen offset:2048 sc1
    v_pk_mul_f32 v[176:177], v[176:177], v[26:27]
    v_pk_mul_f32 v[178:179], v[178:179], v[26:27]
    v_mfma_f32_16x16x32_bf16 v[40:43], a[60:63], a[176:179], v[40:43]
    ds_read_b64_tr_b16 a[12:13], v21 offset:16640
    ds_read_b64_tr_b16 a[14:15], v21 offset:18688
    v_pk_mul_f32 v[184:185], v[184:185], v[26:27]
    v_pk_mul_f32 v[186:187], v[186:187], v[26:27]
    v_pk_mul_f32 v[180:181], v[180:181], v[26:27]
    v_pk_mul_f32 v[182:183], v[182:183], v[26:27]
    v_pk_mul_f32 v[188:189], v[188:189], v[26:27]
    v_pk_mul_f32 v[190:191], v[190:191], v[26:27]
    v_mfma_f32_16x16x32_bf16 v[44:47], a[60:63], a[180:183], v[44:47]
    s_waitcnt lgkmcnt(4)
    buffer_load_dwordx2 v[222:223], v30, s[28:31], s16 offen offset:2688
    buffer_load_dwordx2 v[224:225], v30, s[28:31], s17 offen offset:0
    v_mfma_f32_16x16x32_bf16 v[68:71], a[0:3], a[164:167], v[68:71]
    ds_read_b64_tr_b16 a[16:17], v22 offset:256
    ds_read_b64_tr_b16 a[18:19], v22 offset:2304
    v_cvt_pk_bf16_f32 v176, v176, v177
    v_cvt_pk_bf16_f32 v177, v178, v179
    v_cvt_pk_bf16_f32 v178, v184, v185
    v_mfma_f32_16x16x32_bf16 v[64:67], a[0:3], a[160:163], v[64:67]
    buffer_load_dwordx2 v[226:227], v30, s[28:31], s17 offen offset:896
    v_cvt_pk_bf16_f32 v179, v186, v187
    v_accvgpr_write_b32 a88, v176
    v_accvgpr_write_b32 a89, v177
    v_mfma_f32_16x16x32_bf16 v[68:71], a[4:7], a[180:183], v[68:71]
    ds_read_b64_tr_b16 a[20:21], v22 offset:16640
    ds_read_b64_tr_b16 a[22:23], v22 offset:18688
    v_accvgpr_write_b32 a90, v178
    v_accvgpr_write_b32 a91, v179
    buffer_store_dwordx4 v[176:179], v1, s[20:23], s75 offen offset:3072 sc1
    v_mfma_f32_16x16x32_bf16 v[64:67], a[4:7], a[176:179], v[64:67]
    s_waitcnt lgkmcnt(4)
    v_cvt_pk_bf16_f32 v180, v180, v181
    v_cvt_pk_bf16_f32 v181, v182, v183
    v_cvt_pk_bf16_f32 v182, v188, v189
    v_mfma_f32_16x16x32_bf16 v[72:75], a[8:11], a[160:163], v[72:75]
    ds_read_b64_tr_b16 a[24:25], v23 offset:256
    ds_read_b64_tr_b16 a[26:27], v23 offset:2304
    buffer_load_dwordx2 v[228:229], v30, s[28:31], s17 offen offset:1792
    v_cvt_pk_bf16_f32 v183, v190, v191
    v_accvgpr_write_b32 a92, v180
    v_mfma_f32_16x16x32_bf16 v[76:79], a[8:11], a[164:167], v[76:79]
    v_accvgpr_write_b32 a93, v181
    v_accvgpr_write_b32 a94, v182
    v_accvgpr_write_b32 a95, v183
    v_mfma_f32_16x16x32_bf16 v[72:75], a[12:15], a[176:179], v[72:75]
    ds_read_b64_tr_b16 a[28:29], v23 offset:16640
    ds_read_b64_tr_b16 a[30:31], v23 offset:18688
    buffer_load_dwordx2 v[230:231], v30, s[28:31], s17 offen offset:2688
    buffer_store_dwordx4 v[180:183], v1, s[20:23], s79 offen offset:3072 sc1
    v_pk_mul_f32 v[192:193], v[192:193], v[26:27]
    v_pk_mul_f32 v[194:195], v[194:195], v[26:27]
    v_pk_mul_f32 v[200:201], v[200:201], v[26:27]
    v_mfma_f32_16x16x32_bf16 v[76:79], a[12:15], a[180:183], v[76:79]
    s_waitcnt lgkmcnt(4)
    v_pk_mul_f32 v[202:203], v[202:203], v[26:27]
    v_pk_mul_f32 v[196:197], v[196:197], v[26:27]
    v_pk_mul_f32 v[198:199], v[198:199], v[26:27]
    v_mfma_f32_16x16x32_bf16 v[84:87], a[16:19], a[164:167], v[84:87]
    ds_read_b64_tr_b16 a[32:33], v10 offset:0
    ds_read_b64_tr_b16 a[34:35], v10 offset:1024
    v_pk_mul_f32 v[204:205], v[204:205], v[26:27]
    v_pk_mul_f32 v[206:207], v[206:207], v[26:27]
    v_cvt_pk_bf16_f32 v192, v192, v193
    v_mfma_f32_16x16x32_bf16 v[80:83], a[16:19], a[160:163], v[80:83]
    buffer_load_dwordx2 v[232:233], v30, s[32:35], s24 offen offset:0
    v_cvt_pk_bf16_f32 v193, v194, v195
    v_cvt_pk_bf16_f32 v194, v200, v201
    v_cvt_pk_bf16_f32 v195, v202, v203
    v_mfma_f32_16x16x32_bf16 v[84:87], a[20:23], a[180:183], v[84:87]
    ds_read_b64_tr_b16 a[36:37], v10 offset:8192
    ds_read_b64_tr_b16 a[38:39], v10 offset:9216
    v_accvgpr_write_b32 a96, v192
    v_accvgpr_write_b32 a97, v193
    v_accvgpr_write_b32 a98, v194
    v_mfma_f32_16x16x32_bf16 v[80:83], a[20:23], a[176:179], v[80:83]
    s_waitcnt lgkmcnt(4)
    v_accvgpr_write_b32 a99, v195
    s_add_u32 s75, s75, 4096
    buffer_store_dwordx4 v[192:195], v1, s[20:23], s75 offen offset:0 sc1
    v_cvt_pk_bf16_f32 v196, v196, v197
    v_mfma_f32_16x16x32_bf16 v[88:91], a[24:27], a[160:163], v[88:91]
    ds_read_b64_tr_b16 a[40:41], v11 offset:0
    ds_read_b64_tr_b16 a[42:43], v11 offset:1024
    buffer_load_dwordx2 v[234:235], v30, s[32:35], s24 offen offset:896
    v_cvt_pk_bf16_f32 v197, v198, v199
    v_cvt_pk_bf16_f32 v198, v204, v205
    v_cvt_pk_bf16_f32 v199, v206, v207
    v_mfma_f32_16x16x32_bf16 v[92:95], a[24:27], a[164:167], v[92:95]
    v_accvgpr_write_b32 a100, v196
    v_accvgpr_write_b32 a101, v197
    v_accvgpr_write_b32 a102, v198
    v_mfma_f32_16x16x32_bf16 v[88:91], a[28:31], a[176:179], v[88:91]
    ds_read_b64_tr_b16 a[44:45], v11 offset:8192
    ds_read_b64_tr_b16 a[46:47], v11 offset:9216
    buffer_load_dwordx2 v[236:237], v30, s[32:35], s24 offen offset:1792
    v_accvgpr_write_b32 a103, v199
    s_add_u32 s79, s79, 4096
    buffer_store_dwordx4 v[196:199], v1, s[20:23], s79 offen offset:0 sc1
    v_mfma_f32_16x16x32_bf16 v[92:95], a[28:31], a[180:183], v[92:95]
    s_waitcnt lgkmcnt(4)
    v_pk_mul_f32 v[208:209], v[208:209], v[26:27]
    v_pk_mul_f32 v[210:211], v[210:211], v[26:27]
    v_pk_mul_f32 v[40:41], v[40:41], v[26:27]
    v_mfma_f32_16x16x32_bf16 v[112:115], a[32:35], a[164:167], v[112:115]
    ds_read_b64_tr_b16 a[48:49], v12 offset:0
    ds_read_b64_tr_b16 a[50:51], v12 offset:1024
    v_pk_mul_f32 v[42:43], v[42:43], v[26:27]
    v_pk_mul_f32 v[212:213], v[212:213], v[26:27]
    v_pk_mul_f32 v[214:215], v[214:215], v[26:27]
    v_mfma_f32_16x16x32_bf16 v[96:99], a[32:35], a[160:163], v[96:99]
    v_pk_mul_f32 v[44:45], v[44:45], v[26:27]
    v_pk_mul_f32 v[46:47], v[46:47], v[26:27]
    v_cvt_pk_bf16_f32 v208, v208, v209
    v_mfma_f32_16x16x32_bf16 v[112:115], a[36:39], a[180:183], v[112:115]
    ds_read_b64_tr_b16 a[52:53], v12 offset:8192
    ds_read_b64_tr_b16 a[54:55], v12 offset:9216
    v_cvt_pk_bf16_f32 v209, v210, v211
    v_cvt_pk_bf16_f32 v210, v40, v41
    v_cvt_pk_bf16_f32 v211, v42, v43
    v_mfma_f32_16x16x32_bf16 v[96:99], a[36:39], a[176:179], v[96:99]
    s_waitcnt lgkmcnt(4)
    v_accvgpr_write_b32 a104, v208
    v_accvgpr_write_b32 a105, v209
    v_accvgpr_write_b32 a106, v210
    v_mfma_f32_16x16x32_bf16 v[100:103], a[40:43], a[160:163], v[100:103]
    ds_read_b64_tr_b16 a[56:57], v13 offset:0
    ds_read_b64_tr_b16 a[58:59], v13 offset:1024
    v_accvgpr_write_b32 a107, v211
    buffer_store_dwordx4 v[208:211], v1, s[20:23], s75 offen offset:1024 sc1
    v_cvt_pk_bf16_f32 v212, v212, v213
    v_cvt_pk_bf16_f32 v213, v214, v215
    v_cvt_pk_bf16_f32 v214, v44, v45
    v_cvt_pk_bf16_f32 v215, v46, v47
    v_mfma_f32_16x16x32_bf16 v[116:119], a[40:43], a[164:167], v[116:119]
    buffer_load_dwordx2 v[238:239], v30, s[32:35], s24 offen offset:2688
    buffer_load_dwordx2 v[240:241], v30, s[32:35], s25 offen offset:0
    v_mfma_f32_16x16x32_bf16 v[100:103], a[44:47], a[176:179], v[100:103]
    ds_read_b64_tr_b16 a[60:61], v13 offset:8192
    ds_read_b64_tr_b16 a[62:63], v13 offset:9216
    v_accvgpr_write_b32 a108, v212
    v_accvgpr_write_b32 a109, v213
    v_accvgpr_write_b32 a110, v214
    v_mfma_f32_16x16x32_bf16 v[116:119], a[44:47], a[180:183], v[116:119]
    s_waitcnt lgkmcnt(4)
    buffer_load_dwordx2 v[242:243], v30, s[32:35], s25 offen offset:896
    v_accvgpr_write_b32 a111, v215
    buffer_store_dwordx4 v[212:215], v1, s[20:23], s79 offen offset:1024 sc1
    v_pk_mul_f32 v[64:65], v[64:65], v[26:27]
    v_mfma_f32_16x16x32_bf16 v[120:123], a[48:51], a[164:167], v[120:123]
    ds_read_b64_tr_b16 a[0:1], v14 offset:0
    ds_read_b64_tr_b16 a[2:3], v14 offset:1024
    v_pk_mul_f32 v[66:67], v[66:67], v[26:27]
    v_pk_mul_f32 v[72:73], v[72:73], v[26:27]
    v_pk_mul_f32 v[74:75], v[74:75], v[26:27]
    v_mfma_f32_16x16x32_bf16 v[104:107], a[48:51], a[160:163], v[104:107]
    buffer_load_dwordx2 v[244:245], v30, s[32:35], s25 offen offset:1792
    v_pk_mul_f32 v[68:69], v[68:69], v[26:27]
    v_pk_mul_f32 v[70:71], v[70:71], v[26:27]
    v_pk_mul_f32 v[76:77], v[76:77], v[26:27]
    v_mfma_f32_16x16x32_bf16 v[120:123], a[52:55], a[180:183], v[120:123]
    ds_read_b64_tr_b16 a[4:5], v14 offset:8192
    ds_read_b64_tr_b16 a[6:7], v14 offset:9216
    ds_read_b64_tr_b16 a[8:9], v15 offset:0
    ds_read_b64_tr_b16 a[10:11], v15 offset:1024
    ds_read_b64_tr_b16 a[12:13], v15 offset:8192
    ds_read_b64_tr_b16 a[14:15], v15 offset:9216
    v_pk_mul_f32 v[78:79], v[78:79], v[26:27]
    v_cvt_pk_bf16_f32 v64, v64, v65
    v_cvt_pk_bf16_f32 v65, v66, v67
    v_mfma_f32_16x16x32_bf16 v[104:107], a[52:55], a[176:179], v[104:107]
    s_waitcnt lgkmcnt(8)
    v_cvt_pk_bf16_f32 v66, v72, v73
    v_cvt_pk_bf16_f32 v67, v74, v75
    v_accvgpr_write_b32 a112, v64
    v_mfma_f32_16x16x32_bf16 v[108:111], a[56:59], a[160:163], v[108:111]
    buffer_load_dwordx2 v[246:247], v30, s[32:35], s25 offen offset:2688
    v_accvgpr_write_b32 a113, v65
    v_accvgpr_write_b32 a114, v66
    v_accvgpr_write_b32 a115, v67
    v_mfma_f32_16x16x32_bf16 v[124:127], a[56:59], a[164:167], v[124:127]
    buffer_store_dwordx4 v[64:67], v1, s[20:23], s75 offen offset:2048 sc1
    v_cvt_pk_bf16_f32 v68, v68, v69
    v_mfma_f32_16x16x32_bf16 v[108:111], a[60:63], a[176:179], v[108:111]
    v_cvt_pk_bf16_f32 v69, v70, v71
    v_cvt_pk_bf16_f32 v70, v76, v77
    v_cvt_pk_bf16_f32 v71, v78, v79
    v_mfma_f32_16x16x32_bf16 v[124:127], a[60:63], a[180:183], v[124:127]
    s_waitcnt vmcnt(27) lgkmcnt(0)
    s_barrier
    v_accvgpr_write_b32 a116, v68
    v_accvgpr_write_b32 a117, v69
    v_accvgpr_write_b32 a118, v70
    v_mfma_f32_16x16x32_bf16 v[56:59], a[164:167], a[0:3], v[56:59]
    v_accvgpr_write_b32 a119, v71
    buffer_store_dwordx4 v[68:71], v1, s[20:23], s79 offen offset:2048 sc1
    v_pk_mul_f32 v[80:81], v[80:81], v[26:27]
    v_pk_mul_f32 v[82:83], v[82:83], v[26:27]
    v_mfma_f32_16x16x32_bf16 v[48:51], a[160:163], a[0:3], v[48:51]
    s_add_u32 m0, s66, 0
    s_nop 0
    v_pk_mul_f32 v[88:89], v[88:89], v[26:27]
    v_pk_mul_f32 v[90:91], v[90:91], v[26:27]
    v_pk_mul_f32 v[84:85], v[84:85], v[26:27]
    v_mfma_f32_16x16x32_bf16 v[56:59], a[180:183], a[4:7], v[56:59]
    buffer_load_dwordx4 v2, s[8:11], s26 offen offset:0 sc1 lds
    buffer_load_dwordx4 v2, s[8:11], s26 offen offset:1024 sc1 lds
    buffer_load_dwordx4 v2, s[8:11], s26 offen offset:2048 sc1 lds
    v_pk_mul_f32 v[86:87], v[86:87], v[26:27]
    v_pk_mul_f32 v[92:93], v[92:93], v[26:27]
    v_mfma_f32_16x16x32_bf16 v[48:51], a[176:179], a[4:7], v[48:51]
    v_pk_mul_f32 v[94:95], v[94:95], v[26:27]
    v_cvt_pk_bf16_f32 v80, v80, v81
    v_cvt_pk_bf16_f32 v81, v82, v83
    v_mfma_f32_16x16x32_bf16 v[52:55], a[160:163], a[8:11], v[52:55]
    v_cvt_pk_bf16_f32 v82, v88, v89
    v_cvt_pk_bf16_f32 v83, v90, v91
    v_accvgpr_write_b32 a120, v80
    v_mfma_f32_16x16x32_bf16 v[60:63], a[164:167], a[8:11], v[60:63]
    v_accvgpr_write_b32 a121, v81
    v_accvgpr_write_b32 a122, v82
    v_accvgpr_write_b32 a123, v83
    v_mfma_f32_16x16x32_bf16 v[52:55], a[176:179], a[12:15], v[52:55]
    buffer_store_dwordx4 v[80:83], v1, s[20:23], s75 offen offset:3072 sc1
    v_cvt_pk_bf16_f32 v84, v84, v85
    v_cvt_pk_bf16_f32 v85, v86, v87
    v_cvt_pk_bf16_f32 v86, v92, v93
    v_cvt_pk_bf16_f32 v87, v94, v95
    v_accvgpr_write_b32 a124, v84
    v_accvgpr_write_b32 a125, v85
    v_accvgpr_write_b32 a126, v86
    v_accvgpr_write_b32 a127, v87
    v_mfma_f32_16x16x32_bf16 v[60:63], a[180:183], a[12:15], v[60:63]
    buffer_store_dwordx4 v[84:87], v1, s[20:23], s79 offen offset:3072 sc1
    buffer_load_dwordx4 v2, s[8:11], s26 offen offset:3072 sc1 lds
    s_add_u32 m0, s66, 4096
    s_nop 0
    buffer_load_dwordx4 v5, s[8:11], s26 offen offset:0 sc1 lds
    buffer_load_dwordx4 v5, s[8:11], s26 offen offset:1024 sc1 lds
    buffer_load_dwordx4 v5, s[8:11], s26 offen offset:2048 sc1 lds
    buffer_load_dwordx4 v5, s[8:11], s26 offen offset:3072 sc1 lds
    v_mul_f32 v32, 0xbfb8aa3b, v32
    v_mul_f32 v33, 0xbfb8aa3b, v36
    v_exp_f32 v32, v32
    v_exp_f32 v33, v33
    v_mov_b32 v34, v28
    v_add_f32 v32, 1.0, v32
    v_add_f32 v33, 1.0, v33
    v_rcp_f32 v32, v32
    v_rcp_f32 v33, v33
    s_lshl_b32 s81, s60, 13
    s_add_u32 s28, s81, 0x8000
    s_add_u32 s32, s81, 65536
    s_add_u32 s29, s32, 0x8000
    s_add_u32 s31, s32, 98304
    v_subrev_u32 v26, s81, v1
    v_add_u32 v3, 0x8000, v1
    v_mov_b32 v7, 0xf149f2ca
    v_mov_b32 v29, 0
    v_mov_b64 v[30:31], 0
    s_mov_b32 s34, 0
    s_lshl_b32 s33, s4, 1
    s_mov_b32 s72, s26
    s_add_u32 s26, s26, s90
    s_cmp_eq_u32 s26, s3
    s_cselect_b32 s26, 0, s26
    v_and_b32 v8, 15, v0
    v_lshrrev_b32 v28, 4, v0
    v_lshlrev_b32 v28, 2, v28
    v_sub_u32 v28, v8, v28
    s_lshl_b32 s81, s60, 5
    v_add_u32 v27, s81, v28
    v_cmp_eq_u32 vcc, 0, v0
    v_mov_b32 v24, 1073741824
    s_xor_b32 s44, s100, 8192
    v_cndmask_b32 v24, v24, 0, vcc
    s_and_b32 s81, s2, 63
    s_lshr_b32 s82, s2, 7
    s_lshl_b32 s82, s82, 6
    s_or_b32 s81, s81, s82
    s_lshl_b32 s81, s81, 2
    s_add_u32 s46, s81, s60
    s_mul_i32 s35, s46, 17408
    s_add_u32 s35, s35, 83886080
    s_add_u32 s81, s88, 1
    s_sub_u32 s82, 23, s81
    s_cmp_ge_u32 s81, 8
    s_cselect_b32 s82, s82, s81
    s_lshl_b32 s82, s82, 10
    s_add_u32 s45, s101, s82
    s_sub_u32 s45, s45, 8
    s_cmp_eq_u32 s81, 16
    s_cselect_b32 s45, 1073741824, s45
    s_cmp_lg_u32 s60, 3
    s_cselect_b32 s45, 1073741824, s45
    s_or_b32 s81, s65, s60
    s_cselect_b32 s79, 1073741824, 0
    s_add_u32 s79, s79, 57671700
    s_mov_b32 s80, 57671700
    v_mov_b64 v[40:41], 0
    v_mov_b64 v[42:43], 0
    v_mov_b64 v[44:45], 0
    v_mov_b64 v[46:47], 0
    s_cmp_eq_u32 s65, 1
    s_cbranch_scc1 F2_A_19
    s_mul_hi_u32 s47, s46, 613566757
    s_mul_i32 s81, s47, 7
    s_sub_u32 s81, s46, s81
    s_mul_i32 s74, s81, 144
    s_add_u32 s74, s74, s47
    s_lshl_b32 s74, s74, 12
    s_add_u32 s74, s74, 104857600
    s_cmp_ge_u32 s46, 1008
    s_cselect_b32 s74, 1073741824, s74
    s_add_u32 s46, s46, 512
    s_mul_hi_u32 s47, s46, 613566757
    s_mul_i32 s81, s47, 7
    s_sub_u32 s81, s46, s81
    s_mul_i32 s75, s81, 144
    s_add_u32 s75, s75, s47
    s_lshl_b32 s75, s75, 12
    s_add_u32 s75, s75, 104857600
    s_cmp_ge_u32 s46, 1008
    s_cselect_b32 s75, 1073741824, s75
    s_cmp_lg_u32 s7, 1
    s_cbranch_scc1 F2_np_20
    v_accvgpr_mov_b32 a128, a64
    v_accvgpr_mov_b32 a129, a65
    v_accvgpr_mov_b32 a130, a66
    v_accvgpr_mov_b32 a131, a67
    v_accvgpr_mov_b32 a132, a68
    v_accvgpr_mov_b32 a133, a69
    v_accvgpr_mov_b32 a134, a70
    v_accvgpr_mov_b32 a135, a71
    v_accvgpr_mov_b32 a136, a72
    v_accvgpr_mov_b32 a137, a73
    v_accvgpr_mov_b32 a138, a74
    v_accvgpr_mov_b32 a139, a75
    v_accvgpr_mov_b32 a140, a76
    v_accvgpr_mov_b32 a141, a77
    v_accvgpr_mov_b32 a142, a78
    v_accvgpr_mov_b32 a143, a79
    v_accvgpr_mov_b32 a144, a80
    v_accvgpr_mov_b32 a145, a81
    v_accvgpr_mov_b32 a146, a82
    v_accvgpr_mov_b32 a147, a83
    v_accvgpr_mov_b32 a148, a84
    v_accvgpr_mov_b32 a149, a85
    v_accvgpr_mov_b32 a150, a86
    v_accvgpr_mov_b32 a151, a87
    v_accvgpr_mov_b32 a152, a88
    v_accvgpr_mov_b32 a153, a89
    v_accvgpr_mov_b32 a154, a90
    v_accvgpr_mov_b32 a155, a91
    v_accvgpr_mov_b32 a156, a92
    v_accvgpr_mov_b32 a157, a93
    v_accvgpr_mov_b32 a158, a94
    v_accvgpr_mov_b32 a159, a95
    v_accvgpr_mov_b32 a160, a96
    v_accvgpr_mov_b32 a161, a97
    v_accvgpr_mov_b32 a162, a98
    v_accvgpr_mov_b32 a163, a99
    v_accvgpr_mov_b32 a164, a100
    v_accvgpr_mov_b32 a165, a101
    v_accvgpr_mov_b32 a166, a102
    v_accvgpr_mov_b32 a167, a103
    v_accvgpr_mov_b32 a168, a104
    v_accvgpr_mov_b32 a169, a105
    v_accvgpr_mov_b32 a170, a106
    v_accvgpr_mov_b32 a171, a107
    v_accvgpr_mov_b32 a172, a108
    v_accvgpr_mov_b32 a173, a109
    v_accvgpr_mov_b32 a174, a110
    v_accvgpr_mov_b32 a175, a111
    v_accvgpr_mov_b32 a176, a112
    v_accvgpr_mov_b32 a177, a113
    v_accvgpr_mov_b32 a178, a114
    v_accvgpr_mov_b32 a179, a115
    v_accvgpr_mov_b32 a180, a116
    v_accvgpr_mov_b32 a181, a117
    v_accvgpr_mov_b32 a182, a118
    v_accvgpr_mov_b32 a183, a119
    v_accvgpr_mov_b32 a184, a120
    v_accvgpr_mov_b32 a185, a121
    v_accvgpr_mov_b32 a186, a122
    v_accvgpr_mov_b32 a187, a123
    v_accvgpr_mov_b32 a188, a124
    v_accvgpr_mov_b32 a189, a125
    v_accvgpr_mov_b32 a190, a126
    v_accvgpr_mov_b32 a191, a127
F2_pq_21:
    s_add_u32 s78, s78, 1
    s_cmp_gt_u32 s78, 0x40000
    s_cbranch_scc1 F2_pqx_23
    buffer_load_dword v30, v29, s[48:51], s100 offen offset:8 sc1
    s_waitcnt vmcnt(0)
    v_readfirstlane_b32 s81, v30
    s_nop 3
    s_cmp_lg_u32 s81, 4
    s_cbranch_scc1 F2_pq_21
F2_pqx_23:
    s_lshl_b32 s83, s64, 7
    s_lshl_b32 s84, s4, 3
    s_add_u32 s83, s83, s84
    s_lshl_b32 s84, s60, 1
    s_add_u32 s83, s83, s84
    s_lshl_b32 s83, s83, 13
    s_add_u32 s83, s83, 33554432
    buffer_load_dwordx4 a[64:67], v1, s[48:51], s83 offen offset:0 sc1
    buffer_load_dwordx4 a[72:75], v1, s[48:51], s83 offen offset:1024 sc1
    buffer_load_dwordx4 a[80:83], v1, s[48:51], s83 offen offset:2048 sc1
    buffer_load_dwordx4 a[88:91], v1, s[48:51], s83 offen offset:3072 sc1
    s_add_u32 s83, s83, 4096
    buffer_load_dwordx4 a[96:99], v1, s[48:51], s83 offen offset:0 sc1
    buffer_load_dwordx4 a[104:107], v1, s[48:51], s83 offen offset:1024 sc1
    buffer_load_dwordx4 a[112:115], v1, s[48:51], s83 offen offset:2048 sc1
    buffer_load_dwordx4 a[120:123], v1, s[48:51], s83 offen offset:3072 sc1
    s_add_u32 s83, s83, 4096
    buffer_load_dwordx4 a[68:71], v1, s[48:51], s83 offen offset:0 sc1
    buffer_load_dwordx4 a[76:79], v1, s[48:51], s83 offen offset:1024 sc1
    buffer_load_dwordx4 a[84:87], v1, s[48:51], s83 offen offset:2048 sc1
    buffer_load_dwordx4 a[92:95], v1, s[48:51], s83 offen offset:3072 sc1
    s_add_u32 s83, s83, 4096
    buffer_load_dwordx4 a[100:103], v1, s[48:51], s83 offen offset:0 sc1
    buffer_load_dwordx4 a[108:111], v1, s[48:51], s83 offen offset:1024 sc1
    buffer_load_dwordx4 a[116:119], v1, s[48:51], s83 offen offset:2048 sc1
    buffer_load_dwordx4 a[124:127], v1, s[48:51], s83 offen offset:3072 sc1
    s_add_u32 s83, s83, 4096
    s_branch F2_np2_22
F2_np_20:
    s_waitcnt vmcnt(12)
F2_np2_22:
    s_mov_b32 s83, 0x05040100
    s_mov_b32 s84, 0x07060302
    v_perm_b32 v184, v218, v216, s83
    v_perm_b32 v185, v222, v220, s83
    v_perm_b32 v186, v226, v224, s83
    v_perm_b32 v187, v230, v228, s83
    v_perm_b32 v188, v218, v216, s84
    v_perm_b32 v189, v222, v220, s84
    v_perm_b32 v190, v226, v224, s84
    v_perm_b32 v191, v230, v228, s84
    v_perm_b32 v192, v219, v217, s83
    v_perm_b32 v193, v223, v221, s83
    v_perm_b32 v194, v227, v225, s83
    v_perm_b32 v195, v231, v229, s83
    v_perm_b32 v196, v219, v217, s84
    v_perm_b32 v197, v223, v221, s84
    v_perm_b32 v198, v227, v225, s84
    v_perm_b32 v199, v231, v229, s84
    v_perm_b32 v200, v234, v232, s83
    v_perm_b32 v201, v238, v236, s83
    v_perm_b32 v202, v242, v240, s83
    v_perm_b32 v203, v246, v244, s83
    v_perm_b32 v204, v234, v232, s84
    v_perm_b32 v205, v238, v236, s84
    v_perm_b32 v206, v242, v240, s84
    v_perm_b32 v207, v246, v244, s84
    v_perm_b32 v208, v235, v233, s83
    v_perm_b32 v209, v239, v237, s83
    v_perm_b32 v210, v243, v241, s83
    v_perm_b32 v211, v247, v245, s83
    v_perm_b32 v212, v235, v233, s84
    v_perm_b32 v213, v239, v237, s84
    v_perm_b32 v214, v243, v241, s84
    v_perm_b32 v215, v247, v245, s84
    buffer_store_dwordx4 v[184:187], v1, s[48:51], s74 offen offset:0 sc1
    buffer_store_dwordx4 v[188:191], v1, s[48:51], s74 offen offset:1024 sc1
    buffer_store_dwordx4 v[192:195], v1, s[48:51], s74 offen offset:2048 sc1
    buffer_store_dwordx4 v[196:199], v1, s[48:51], s74 offen offset:3072 sc1
    buffer_store_dwordx4 v[200:203], v1, s[48:51], s75 offen offset:0 sc1
    buffer_store_dwordx4 v[204:207], v1, s[48:51], s75 offen offset:1024 sc1
    buffer_store_dwordx4 v[208:211], v1, s[48:51], s75 offen offset:2048 sc1
    buffer_store_dwordx4 v[212:215], v1, s[48:51], s75 offen offset:3072 sc1
    s_waitcnt vmcnt(8)
F2_A_19:
    v_mov_b32 v8, 1
    s_cmp_eq_u32 s7, 2
    s_cselect_b32 s81, s44, 1073741824
    ds_read_b128 a[0:3], v3 offset:0
    ds_read_b128 a[4:7], v3 offset:1024
    ds_read_b128 a[8:11], v3 offset:2048
    ds_read_b128 a[12:15], v3 offset:3072
    ds_read_b128 a[16:19], v3 offset:4096
    ds_read_b128 a[20:23], v3 offset:5120
    ds_read_b128 a[24:27], v3 offset:6144
    ds_read_b128 a[28:31], v3 offset:7168
    ds_read_b128 a[32:35], v3 offset:8192
    ds_read_b128 a[36:39], v3 offset:9216
    ds_read_b128 a[40:43], v3 offset:10240
    ds_read_b128 a[44:47], v3 offset:11264
    s_waitcnt lgkmcnt(8)
    v_mfma_f32_16x16x32_bf16 v[64:67], a[0:3], a[64:67], v[40:43]
    s_and_b32 s25, s2, 1
    v_mov_b64 v[128:129], 0
    v_mfma_f32_16x16x32_bf16 v[64:67], a[4:7], a[72:75], v[64:67]
    ds_read_b128 a[48:51], v3 offset:12288
    v_mov_b64 v[130:131], 0
    v_mfma_f32_16x16x32_bf16 v[68:71], a[4:7], a[76:79], v[44:47]
    s_lshl_b32 s25, s25, 2
    v_mov_b64 v[132:133], 0
    v_mfma_f32_16x16x32_bf16 v[68:71], a[0:3], a[68:71], v[68:71]
    ds_read_b128 a[52:55], v3 offset:13312
    v_mov_b64 v[134:135], 0
    v_mfma_f32_16x16x32_bf16 v[68:71], a[8:11], a[84:87], v[68:71]
    s_lshr_b32 s87, s2, 6
    v_mov_b64 v[136:137], 0
    v_mfma_f32_16x16x32_bf16 v[68:71], a[12:15], a[92:95], v[68:71]
    ds_read_b128 a[56:59], v3 offset:14336
    v_mov_b64 v[138:139], 0
    v_mfma_f32_16x16x32_bf16 v[64:67], a[12:15], a[88:91], v[64:67]
    s_add_u32 s17, s25, s87
    v_mov_b64 v[140:141], 0
    v_mfma_f32_16x16x32_bf16 v[64:67], a[8:11], a[80:83], v[64:67]
    s_waitcnt lgkmcnt(7)
    s_add_u32 s25, s25, s63
    ds_read_b128 a[60:63], v3 offset:15360
    v_mov_b64 v[142:143], 0
    v_mfma_f32_16x16x32_bf16 v[64:67], a[16:19], a[96:99], v[64:67]
    s_waitcnt vmcnt(5)
    v_mov_b64 v[144:145], 0
    v_mfma_f32_16x16x32_bf16 v[64:67], a[20:23], a[104:107], v[64:67]
    ds_read_b128 a[0:3], v3 offset:16384
    buffer_atomic_add v8, v24, s[48:51], s81 offen offset:8 sc1
    v_mov_b64 v[146:147], 0
    v_mfma_f32_16x16x32_bf16 v[68:71], a[20:23], a[108:111], v[68:71]
    s_cmp_eq_u32 s87, 3
    s_cselect_b32 s17, 3, s17
    s_cselect_b32 s16, s25, s63
    v_mfma_f32_16x16x32_bf16 v[68:71], a[16:19], a[100:103], v[68:71]
    s_add_u32 s83, s91, 52428800
    s_add_u32 s84, s91, 54525952
    v_mov_b64 v[148:149], 0
    v_mfma_f32_16x16x32_bf16 v[68:71], a[24:27], a[116:119], v[68:71]
    s_bfe_u32 s25, s2, 131073
    ds_read_b128 a[4:7], v3 offset:17408
    v_mov_b64 v[150:151], 0
    v_mfma_f32_16x16x32_bf16 v[68:71], a[28:31], a[124:127], v[68:71]
    s_lshl_b32 s25, s25, 3
    v_mov_b64 v[152:153], 0
    v_cmp_gt_u32 vcc, 48, v0
    v_mfma_f32_16x16x32_bf16 v[64:67], a[28:31], a[120:123], v[64:67]
    v_cvt_pk_bf16_f32 v120, v120, v121
    v_cvt_pk_bf16_f32 v121, v122, v123
    v_mfma_f32_16x16x32_bf16 v[64:67], a[24:27], a[112:115], v[64:67]
    s_waitcnt lgkmcnt(6)
    s_add_u32 s16, s16, s25
    ds_read_b128 a[8:11], v3 offset:18432
    v_mov_b64 v[154:155], 0
    v_mfma_f32_16x16x32_bf16 v[72:75], a[32:35], a[64:67], v[40:43]
    v_mov_b64 v[156:157], 0
    v_cvt_pk_bf16_f32 v122, v124, v125
    v_mfma_f32_16x16x32_bf16 v[72:75], a[36:39], a[72:75], v[72:75]
    ds_read_b128 a[12:15], v3 offset:19456
    ds_read_b128 a[16:19], v3 offset:20480
    v_cvt_pk_bf16_f32 v123, v126, v127
    v_mfma_f32_16x16x32_bf16 v[76:79], a[36:39], a[76:79], v[44:47]
    v_mov_b64 v[158:159], 0
    v_mov_b64 v[160:161], 0
    v_mfma_f32_16x16x32_bf16 v[76:79], a[32:35], a[68:71], v[76:79]
    ds_read_b128 a[20:23], v3 offset:21504
    buffer_store_dwordx4 v[120:123], v1, s[48:51], s83 offen offset:1024 sc1
    v_accvgpr_write_b32 a208, v120
    v_mfma_f32_16x16x32_bf16 v[76:79], a[40:43], a[84:87], v[76:79]
    s_cmp_ge_u32 s2, 224
    s_cselect_b32 s87, 1, 0
    v_accvgpr_write_b32 a209, v121
    v_mfma_f32_16x16x32_bf16 v[76:79], a[44:47], a[92:95], v[76:79]
    s_mul_i32 s25, s60, 147456
    ds_read_b128 a[24:27], v3 offset:22528
    v_mov_b64 v[162:163], 0
    v_accvgpr_write_b32 a210, v122
    v_mfma_f32_16x16x32_bf16 v[72:75], a[44:47], a[88:91], v[72:75]
    s_mul_i32 s18, s17, 589824
    v_mov_b64 v[164:165], 0
    v_accvgpr_write_b32 a211, v123
    v_cvt_pk_bf16_f32 v48, v48, v49
    v_mfma_f32_16x16x32_bf16 v[72:75], a[40:43], a[80:83], v[72:75]
    s_waitcnt lgkmcnt(7)
    s_add_u32 s18, s18, s25
    ds_read_b128 a[28:31], v3 offset:23552
    v_mov_b64 v[166:167], 0
    v_cvt_pk_bf16_f32 v49, v50, v51
    v_mfma_f32_16x16x32_bf16 v[72:75], a[48:51], a[96:99], v[72:75]
    s_add_u32 s18, s18, 104857600
    v_mov_b64 v[168:169], 0
    v_cvt_pk_bf16_f32 v50, v56, v57
    v_mfma_f32_16x16x32_bf16 v[72:75], a[52:55], a[104:107], v[72:75]
    ds_read_b128 a[32:35], v3 offset:24576
    v_mov_b64 v[170:171], 0
    v_cvt_pk_bf16_f32 v51, v58, v59
    buffer_store_dwordx4 v[48:51], v1, s[48:51], s84 offen offset:0 sc1
    v_mfma_f32_16x16x32_bf16 v[76:79], a[52:55], a[108:111], v[76:79]
    s_mul_i32 s19, s16, 589824
    v_mov_b64 v[172:173], 0
    v_accvgpr_write_b32 a212, v48
    v_mfma_f32_16x16x32_bf16 v[76:79], a[48:51], a[100:103], v[76:79]
    s_add_u32 s19, s19, s25
    ds_read_b128 a[36:39], v3 offset:25600
    v_mov_b64 v[174:175], 0
    v_accvgpr_write_b32 a213, v49
    v_mfma_f32_16x16x32_bf16 v[76:79], a[56:59], a[116:119], v[76:79]
    v_mov_b64 v[176:177], 0
    v_accvgpr_write_b32 a214, v50
    v_accvgpr_write_b32 a215, v51
    v_mfma_f32_16x16x32_bf16 v[76:79], a[60:63], a[124:127], v[76:79]
    s_add_u32 s19, s19, 58720256
    ds_read_b128 a[40:43], v3 offset:26624
    v_mov_b64 v[178:179], 0
    v_accvgpr_write_b32 a220, v48
    v_mfma_f32_16x16x32_bf16 v[72:75], a[60:63], a[120:123], v[72:75]
    v_mov_b64 v[180:181], 0
    v_accvgpr_write_b32 a221, v49
    v_cvt_pk_bf16_f32 v52, v52, v53
    v_cvt_pk_bf16_f32 v53, v54, v55
    v_cvt_pk_bf16_f32 v54, v60, v61
    v_cvt_pk_bf16_f32 v55, v62, v63
    buffer_store_dwordx4 v[52:55], v1, s[48:51], s84 offen offset:1024 sc1
    v_mfma_f32_16x16x32_bf16 v[72:75], a[56:59], a[112:115], v[72:75]
    s_waitcnt lgkmcnt(7)
    s_mov_b32 s85, 1073741824
    v_mov_b64 v[182:183], 0
    v_mov_b64 v[184:185], 0
    v_mfma_f32_16x16x32_bf16 v[80:83], a[0:3], a[64:67], v[40:43]
    v_mov_b64 v[186:187], 0
    v_mov_b64 v[188:189], 0
    v_mfma_f32_16x16x32_bf16 v[80:83], a[4:7], a[72:75], v[80:83]
    ds_read_b128 a[44:47], v3 offset:27648
    ds_read_b128 a[48:51], v3 offset:28672
    v_accvgpr_write_b32 a216, v52
    v_mfma_f32_16x16x32_bf16 v[84:87], a[4:7], a[76:79], v[44:47]
    s_add_u32 m0, s66, 131072
    s_nop 0
    v_mov_b64 v[190:191], 0
    v_mfma_f32_16x16x32_bf16 v[84:87], a[0:3], a[68:71], v[84:87]
    ds_read_b128 a[52:55], v3 offset:29696
    buffer_load_dwordx4 v2, s[12:15], s27 offen offset:0 sc1 lds
    buffer_load_dwordx4 v2, s[12:15], s27 offen offset:1024 sc1 lds
    v_mov_b64 v[192:193], 0
    v_accvgpr_write_b32 a217, v53
    v_mfma_f32_16x16x32_bf16 v[84:87], a[8:11], a[84:87], v[84:87]
    buffer_load_dwordx4 v2, s[12:15], s27 offen offset:2048 sc1 lds
    buffer_load_dwordx4 v2, s[12:15], s27 offen offset:3072 sc1 lds
    v_accvgpr_write_b32 a218, v54
    v_accvgpr_write_b32 a219, v55
    v_lshlrev_b32 v25, 7, v0
    v_mfma_f32_16x16x32_bf16 v[84:87], a[12:15], a[92:95], v[84:87]
    s_lshr_b32 s86, s2, 7
    ds_read_b128 a[56:59], v3 offset:30720
    v_mov_b64 v[194:195], 0
    v_accvgpr_write_b32 a224, v52
    v_mfma_f32_16x16x32_bf16 v[80:83], a[12:15], a[88:91], v[80:83]
    s_lshl_b32 s86, s86, 3
    v_mov_b64 v[196:197], 0
    v_accvgpr_write_b32 a225, v53
    v_cvt_pk_bf16_f32 v104, v104, v105
    v_mfma_f32_16x16x32_bf16 v[80:83], a[8:11], a[80:83], v[80:83]
    s_waitcnt lgkmcnt(7)
    s_add_u32 s86, s86, s63
    ds_read_b128 a[60:63], v3 offset:31744
    v_mov_b64 v[198:199], 0
    v_cvt_pk_bf16_f32 v105, v106, v107
    v_mfma_f32_16x16x32_bf16 v[80:83], a[16:19], a[96:99], v[80:83]
    s_lshl_b32 s86, s86, 2
    v_mov_b64 v[200:201], 0
    v_cvt_pk_bf16_f32 v106, v108, v109
    v_cvt_pk_bf16_f32 v107, v110, v111
    v_mfma_f32_16x16x32_bf16 v[80:83], a[20:23], a[104:107], v[80:83]
    s_add_u32 m0, s66, 135168
    s_nop 0
    v_mov_b64 v[202:203], 0
    v_accvgpr_write_b32 a204, v104
    v_mfma_f32_16x16x32_bf16 v[84:87], a[20:23], a[108:111], v[84:87]
    s_add_u32 s86, s86, s60
    v_mov_b64 v[204:205], 0
    v_accvgpr_write_b32 a205, v105
    v_accvgpr_write_b32 a206, v106
    v_mfma_f32_16x16x32_bf16 v[84:87], a[16:19], a[100:103], v[84:87]
    s_lshl_b32 s86, s86, 13
    v_mov_b64 v[206:207], 0
    v_accvgpr_write_b32 a207, v107
    v_mfma_f32_16x16x32_bf16 v[84:87], a[24:27], a[116:119], v[84:87]
    s_add_u32 s86, s86, 104857600
    v_mov_b64 v[208:209], 0
    v_mul_f32 v96, v34, v96
    v_mul_f32 v97, v34, v97
    v_mul_f32 v98, v34, v98
    v_mul_f32 v99, v34, v99
    v_mul_f32 v100, v34, v100
    v_mfma_f32_16x16x32_bf16 v[84:87], a[28:31], a[124:127], v[84:87]
    buffer_load_dwordx4 v5, s[12:15], s27 offen offset:0 sc1 lds
    buffer_load_dwordx4 v5, s[12:15], s27 offen offset:1024 sc1 lds
    buffer_load_dwordx4 v5, s[12:15], s27 offen offset:2048 sc1 lds
    v_mov_b64 v[210:211], 0
    v_mfma_f32_16x16x32_bf16 v[80:83], a[28:31], a[120:123], v[80:83]
    buffer_load_dwordx4 v5, s[12:15], s27 offen offset:3072 sc1 lds
    v_xor_b32 v3, 0x8000, v3
    v_mov_b64 v[212:213], 0
    v_mfma_f32_16x16x32_bf16 v[80:83], a[24:27], a[112:115], v[80:83]
    s_waitcnt lgkmcnt(4)
    s_cmp_lg_u32 s87, 0
    s_cselect_b32 s18, 1073741824, s18
    v_mov_b64 v[214:215], 0
    v_mul_f32 v101, v34, v101
    v_mfma_f32_16x16x32_bf16 v[88:91], a[32:35], a[64:67], v[40:43]
    s_add_u32 m0, s66, 65536
    s_nop 0
    v_mov_b64 v[216:217], 0
    v_mul_f32 v102, v34, v102
    v_mul_f32 v103, v34, v103
    v_mfma_f32_16x16x32_bf16 v[88:91], a[36:39], a[72:75], v[88:91]
    s_sub_u32 s24, s6, 1
    v_mov_b64 v[218:219], 0
    v_cvt_pk_bf16_f32 v96, v96, v97
    v_mfma_f32_16x16x32_bf16 v[92:95], a[36:39], a[76:79], v[44:47]
    buffer_load_dwordx4 v2, s[12:15], s72 offen offset:0 sc1 lds
    v_mov_b64 v[220:221], 0
    v_cvt_pk_bf16_f32 v97, v98, v99
    v_cvt_pk_bf16_f32 v98, v100, v101
    v_mfma_f32_16x16x32_bf16 v[92:95], a[32:35], a[68:71], v[92:95]
    v_mov_b64 v[222:223], 0
    v_cvt_pk_bf16_f32 v99, v102, v103
    v_cndmask_b32 v98, 0, v98, vcc
    v_mfma_f32_16x16x32_bf16 v[92:95], a[40:43], a[84:87], v[92:95]
    v_mov_b64 v[224:225], 0
    v_cndmask_b32 v99, 0, v99, vcc
    v_mfma_f32_16x16x32_bf16 v[92:95], a[44:47], a[92:95], v[92:95]
    v_mov_b64 v[226:227], 0
    v_accvgpr_write_b32 a192, v96
    v_accvgpr_write_b32 a193, v97
    v_accvgpr_write_b32 a194, v98
    v_accvgpr_write_b32 a195, v99
    v_mul_f32 v112, v34, v112
    v_mfma_f32_16x16x32_bf16 v[88:91], a[44:47], a[88:91], v[88:91]
    s_cmp_eq_u32 s7, 1
    s_cselect_b32 s24, s6, s24
    s_cmp_eq_u32 s65, 5
    s_cselect_b32 s24, -2, s24
    v_mov_b64 v[228:229], 0
    v_mfma_f32_16x16x32_bf16 v[88:91], a[40:43], a[80:83], v[88:91]
    s_waitcnt lgkmcnt(0)
    buffer_load_dwordx4 v2, s[12:15], s72 offen offset:1024 sc1 lds
    buffer_load_dwordx4 v2, s[12:15], s72 offen offset:2048 sc1 lds
    v_mov_b64 v[230:231], 0
    v_mfma_f32_16x16x32_bf16 v[88:91], a[48:51], a[96:99], v[88:91]
    s_lshl_b32 s75, s88, 1
    v_mov_b64 v[232:233], 0
    v_mul_f32 v113, v34, v113
    v_mfma_f32_16x16x32_bf16 v[88:91], a[52:55], a[104:107], v[88:91]
    s_add_u32 s75, s75, s61
    v_mov_b64 v[234:235], 0
    v_mul_f32 v114, v34, v114
    v_mul_f32 v115, v34, v115
    v_mul_f32 v116, v34, v116
    v_mfma_f32_16x16x32_bf16 v[92:95], a[52:55], a[108:111], v[92:95]
    buffer_load_dwordx4 v2, s[12:15], s72 offen offset:3072 sc1 lds
    v_mov_b64 v[236:237], 0
    v_mfma_f32_16x16x32_bf16 v[92:95], a[48:51], a[100:103], v[92:95]
    s_mul_i32 s74, s75, 589824
    v_mov_b64 v[238:239], 0
    v_mul_f32 v117, v34, v117
    v_mul_f32 v118, v34, v118
    v_mul_f32 v119, v34, v119
    v_mfma_f32_16x16x32_bf16 v[92:95], a[56:59], a[116:119], v[92:95]
    s_add_u32 m0, s66, 69632
    s_nop 0
    v_mov_b64 v[240:241], 0
    v_mfma_f32_16x16x32_bf16 v[92:95], a[60:63], a[124:127], v[92:95]
    buffer_load_dwordx4 v5, s[12:15], s72 offen offset:0 sc1 lds
    buffer_load_dwordx4 v5, s[12:15], s72 offen offset:1024 sc1 lds
    buffer_load_dwordx4 v5, s[12:15], s72 offen offset:2048 sc1 lds
    buffer_load_dwordx4 v5, s[12:15], s72 offen offset:3072 sc1 lds
    v_mov_b64 v[242:243], 0
    v_cvt_pk_bf16_f32 v112, v112, v113
    v_cvt_pk_bf16_f32 v113, v114, v115
    v_mfma_f32_16x16x32_bf16 v[88:91], a[60:63], a[120:123], v[88:91]
    s_lshl_b32 s25, s62, 11
    v_mov_b64 v[244:245], 0
    v_cvt_pk_bf16_f32 v114, v116, v117
    v_mfma_f32_16x16x32_bf16 v[88:91], a[56:59], a[112:115], v[88:91]
    s_add_u32 s74, s74, s25
    s_add_u32 s74, s74, 58720256
    v_mov_b64 v[246:247], 0
    v_mov_b64 v[248:249], 0
    v_mov_b64 v[250:251], 0
    v_mov_b64 v[252:253], 0
    v_mov_b64 v[254:255], 0
    v_cvt_pk_bf16_f32 v115, v118, v119
    v_cndmask_b32 v114, 0, v114, vcc
    v_cndmask_b32 v115, 0, v115, vcc
    v_accvgpr_write_b32 a196, v112
    v_accvgpr_write_b32 a197, v113
    v_accvgpr_write_b32 a198, v114
    v_accvgpr_write_b32 a199, v115
    s_waitcnt vmcnt(16) lgkmcnt(0)
    buffer_atomic_add v8, v24, s[48:51], s45 offen sc1
    s_barrier
F2_first_14:
    ds_read_b128 a[0:3], v3 offset:0
    ds_read_b128 a[4:7], v3 offset:1024
    ds_read_b128 a[8:11], v3 offset:2048
    ds_read_b128 a[12:15], v3 offset:3072
    ds_read_b128 a[16:19], v3 offset:4096
    ds_read_b128 a[20:23], v3 offset:5120
    ds_read_b128 a[24:27], v3 offset:6144
    ds_read_b128 a[28:31], v3 offset:7168
    s_cmp_lt_u32 s5, s33
    s_cbranch_scc1 F2_nm0_17
    s_sub_u32 s81, s5, s33
    s_lshl_b32 s81, s81, 6
    v_subrev_u32 v6, s81, v27
    v_cmp_gt_i32 s[36:37], -16, v6
    v_cmp_gt_i32 s[38:39], -15, v6
    v_cmp_gt_i32 s[40:41], -14, v6
    v_cmp_gt_i32 s[42:43], -13, v6
    s_nop 0
    v_cndmask_b32 v68, v68, v7, s[36:37]
    v_cndmask_b32 v69, v69, v7, s[38:39]
    v_cndmask_b32 v70, v70, v7, s[40:41]
    v_cndmask_b32 v71, v71, v7, s[42:43]
    v_cmp_gt_i32 s[36:37], 0, v6
    v_cmp_gt_i32 s[38:39], 1, v6
    v_cmp_gt_i32 s[40:41], 2, v6
    v_cmp_gt_i32 s[42:43], 3, v6
    s_nop 0
    v_cndmask_b32 v64, v64, v7, s[36:37]
    v_cndmask_b32 v76, v76, v7, s[36:37]
    v_cndmask_b32 v65, v65, v7, s[38:39]
    v_cndmask_b32 v77, v77, v7, s[38:39]
    v_cndmask_b32 v66, v66, v7, s[40:41]
    v_cndmask_b32 v78, v78, v7, s[40:41]
    v_cndmask_b32 v67, v67, v7, s[42:43]
    v_cndmask_b32 v79, v79, v7, s[42:43]
    v_cmp_gt_i32 s[36:37], 16, v6
    v_cmp_gt_i32 s[38:39], 17, v6
    v_cmp_gt_i32 s[40:41], 18, v6
    v_cmp_gt_i32 s[42:43], 19, v6
    s_nop 0
    v_cndmask_b32 v72, v72, v7, s[36:37]
    v_cndmask_b32 v84, v84, v7, s[36:37]
    v_cndmask_b32 v73, v73, v7, s[38:39]
    v_cndmask_b32 v85, v85, v7, s[38:39]
    v_cndmask_b32 v74, v74, v7, s[40:41]
    v_cndmask_b32 v86, v86, v7, s[40:41]
    v_cndmask_b32 v75, v75, v7, s[42:43]
    v_cndmask_b32 v87, v87, v7, s[42:43]
    v_cmp_gt_i32 s[36:37], 32, v6
    v_cmp_gt_i32 s[38:39], 33, v6
    v_cmp_gt_i32 s[40:41], 34, v6
    v_cmp_gt_i32 s[42:43], 35, v6
    s_nop 0
    v_cndmask_b32 v80, v80, v7, s[36:37]
    v_cndmask_b32 v92, v92, v7, s[36:37]
    v_cndmask_b32 v81, v81, v7, s[38:39]
    v_cndmask_b32 v93, v93, v7, s[38:39]
    v_cndmask_b32 v82, v82, v7, s[40:41]
    v_cndmask_b32 v94, v94, v7, s[40:41]
    v_cndmask_b32 v83, v83, v7, s[42:43]
    v_cndmask_b32 v95, v95, v7, s[42:43]
    v_cmp_gt_i32 s[36:37], 48, v6
    v_cmp_gt_i32 s[38:39], 49, v6
    v_cmp_gt_i32 s[40:41], 50, v6
    v_cmp_gt_i32 s[42:43], 51, v6
    s_nop 0
    v_cndmask_b32 v88, v88, v7, s[36:37]
    v_cndmask_b32 v89, v89, v7, s[38:39]
    v_cndmask_b32 v90, v90, v7, s[40:41]
    v_cndmask_b32 v91, v91, v7, s[42:43]
F2_nm0_17:
    v_max3_f32 v8, v64, v65, v66
    v_max3_f32 v8, v8, v67, v72
    v_max3_f32 v8, v8, v73, v74
    v_max3_f32 v8, v8, v75, v80
    v_max3_f32 v8, v8, v81, v82
    v_max3_f32 v8, v8, v83, v88
    v_max3_f32 v8, v8, v89, v90
    v_max_f32 v8, v8, v91
    v_mov_b32 v10, v8
    s_nop 1
    v_permlane16_swap_b32 v8, v10
    s_nop 1
    v_max_f32 v8, v8, v10
    v_mov_b32 v10, v8
    s_nop 1
    v_permlane32_swap_b32 v8, v10
    s_nop 1
    v_max_f32 v8, v8, v10
    v_sub_f32 v40, v40, v8
    v_sub_f32 v41, v41, v8
    v_sub_f32 v42, v42, v8
    v_sub_f32 v43, v43, v8
    v_sub_f32 v96, v64, v8
    v_sub_f32 v97, v65, v8
    v_sub_f32 v98, v66, v8
    v_sub_f32 v99, v67, v8
    v_sub_f32 v104, v72, v8
    v_sub_f32 v105, v73, v8
    v_sub_f32 v106, v74, v8
    v_sub_f32 v107, v75, v8
    v_sub_f32 v112, v80, v8
    v_sub_f32 v113, v81, v8
    v_sub_f32 v114, v82, v8
    v_sub_f32 v115, v83, v8
    v_sub_f32 v120, v88, v8
    v_sub_f32 v121, v89, v8
    v_sub_f32 v122, v90, v8
    v_sub_f32 v123, v91, v8
    v_exp_f32 v96, v96
    v_exp_f32 v97, v97
    v_exp_f32 v98, v98
    v_exp_f32 v99, v99
    v_exp_f32 v104, v104
    v_exp_f32 v105, v105
    v_exp_f32 v106, v106
    v_exp_f32 v107, v107
    v_exp_f32 v112, v112
    v_exp_f32 v113, v113
    v_exp_f32 v114, v114
    v_exp_f32 v115, v115
    v_exp_f32 v120, v120
    v_exp_f32 v121, v121
    v_exp_f32 v122, v122
    v_exp_f32 v123, v123
    s_nop 0
    v_add_f32 v34, v96, v97
    v_add_f32 v34, v34, v98
    v_add_f32 v34, v34, v99
    v_add_f32 v34, v34, v104
    v_add_f32 v34, v34, v105
    v_add_f32 v34, v34, v106
    v_add_f32 v34, v34, v107
    v_add_f32 v34, v34, v112
    v_add_f32 v34, v34, v113
    v_add_f32 v34, v34, v114
    v_add_f32 v34, v34, v115
    v_add_f32 v34, v34, v120
    v_add_f32 v34, v34, v121
    v_add_f32 v34, v34, v122
    v_add_f32 v34, v34, v123
    v_max3_f32 v9, v68, v69, v70
    v_max3_f32 v9, v9, v71, v76
    v_max3_f32 v9, v9, v77, v78
    v_max3_f32 v9, v9, v79, v84
    v_max3_f32 v9, v9, v85, v86
    v_max3_f32 v9, v9, v87, v92
    v_max3_f32 v9, v9, v93, v94
    v_max_f32 v9, v9, v95
    v_mov_b32 v10, v9
    s_nop 1
    v_permlane16_swap_b32 v9, v10
    s_nop 1
    v_max_f32 v9, v9, v10
    v_mov_b32 v10, v9
    s_nop 1
    v_permlane32_swap_b32 v9, v10
    s_nop 1
    v_max_f32 v9, v9, v10
    v_sub_f32 v44, v44, v9
    v_sub_f32 v45, v45, v9
    v_sub_f32 v46, v46, v9
    v_sub_f32 v47, v47, v9
    v_sub_f32 v100, v68, v9
    v_sub_f32 v101, v69, v9
    v_sub_f32 v102, v70, v9
    v_sub_f32 v103, v71, v9
    v_sub_f32 v108, v76, v9
    v_sub_f32 v109, v77, v9
    v_sub_f32 v110, v78, v9
    v_sub_f32 v111, v79, v9
    v_sub_f32 v116, v84, v9
    v_sub_f32 v117, v85, v9
    v_sub_f32 v118, v86, v9
    v_sub_f32 v119, v87, v9
    v_sub_f32 v124, v92, v9
    v_sub_f32 v125, v93, v9
    v_sub_f32 v126, v94, v9
    v_sub_f32 v127, v95, v9
    v_exp_f32 v100, v100
    v_exp_f32 v101, v101
    v_exp_f32 v102, v102
    v_exp_f32 v103, v103
    v_exp_f32 v108, v108
    v_exp_f32 v109, v109
    v_exp_f32 v110, v110
    v_exp_f32 v111, v111
    v_exp_f32 v116, v116
    v_exp_f32 v117, v117
    v_exp_f32 v118, v118
    v_exp_f32 v119, v119
    v_exp_f32 v124, v124
    v_exp_f32 v125, v125
    v_exp_f32 v126, v126
    v_exp_f32 v127, v127
    s_nop 0
    v_add_f32 v36, v100, v101
    v_add_f32 v36, v36, v102
    v_add_f32 v36, v36, v103
    v_add_f32 v36, v36, v108
    v_add_f32 v36, v36, v109
    v_add_f32 v36, v36, v110
    v_add_f32 v36, v36, v111
    v_add_f32 v36, v36, v116
    v_add_f32 v36, v36, v117
    v_add_f32 v36, v36, v118
    v_add_f32 v36, v36, v119
    v_add_f32 v36, v36, v124
    v_add_f32 v36, v36, v125
    v_add_f32 v36, v36, v126
    v_add_f32 v36, v36, v127
    v_mov_b32 v38, 0
    v_mov_b32 v39, 0
    v_mov_b32 v9, 1
    s_cmp_eq_u32 s34, 0
    s_waitcnt vmcnt(9)
    s_barrier
    buffer_atomic_add v9, v24, s[48:51], s79 offen sc1
    s_mov_b32 s79, 1073741824
    s_cbranch_scc1 F2_back_16
    s_mov_b32 s34, 0
    s_waitcnt vmcnt(0)
    buffer_atomic_add v9, v24, s[48:51], s44 offen sc1
    s_branch F2_back_16
F_sp1_7:
    s_add_u32 s78, s78, 1
    s_cmp_gt_u32 s78, 0x40000
    s_cbranch_scc1 F_sp1r_8
    v_mov_b32 v25, 0
    buffer_load_dword v25, v25, s[68:71], 0 offen sc1
    s_waitcnt vmcnt(0)
    v_readfirstlane_b32 s83, v25
    s_nop 3
    s_cmp_lt_u32 s83, 32
    s_cbranch_scc1 F_sp1_7
    s_branch F_sp1r_8
F_sp2_9:
    s_add_u32 s78, s78, 1
    s_cmp_gt_u32 s78, 0x40000
    s_cbranch_scc1 F_sp2r_10
    v_mov_b32 v25, 0
    buffer_load_dword v25, v25, s[48:51], s101 offen sc1
    s_waitcnt vmcnt(0)
    v_readfirstlane_b32 s83, v25
    s_nop 3
    s_cmp_lg_u32 s83, 16
    s_cbranch_scc1 F_sp2_9
    s_branch F_sp2r_10
F2_slow_15:
    v_max3_f32 v8, v64, v65, v66
    v_max3_f32 v8, v8, v67, v72
    v_max3_f32 v8, v8, v73, v74
    v_max3_f32 v8, v8, v75, v80
    v_max3_f32 v8, v8, v81, v82
    v_max3_f32 v8, v8, v83, v88
    v_max3_f32 v8, v8, v89, v90
    v_max_f32 v8, v8, v91
    v_mov_b32 v10, v8
    s_nop 1
    v_permlane16_swap_b32 v8, v10
    s_nop 1
    v_max_f32 v8, v8, v10
    v_mov_b32 v10, v8
    s_nop 1
    v_permlane32_swap_b32 v8, v10
    s_nop 1
    v_max_f32 v8, v8, v10
    v_max_f32 v8, 0, v8
    v_sub_f32 v40, v40, v8
    v_sub_f32 v41, v41, v8
    v_sub_f32 v42, v42, v8
    v_sub_f32 v43, v43, v8
    v_sub_f32 v12, 0, v8
    v_exp_f32 v12, v12
    s_nop 0
    v_mul_f32 v38, v38, v12
    v_mul_f32 v128, v128, v12
    v_mul_f32 v129, v129, v12
    v_mul_f32 v130, v130, v12
    v_mul_f32 v131, v131, v12
    v_mul_f32 v136, v136, v12
    v_mul_f32 v137, v137, v12
    v_mul_f32 v138, v138, v12
    v_mul_f32 v139, v139, v12
    v_mul_f32 v144, v144, v12
    v_mul_f32 v145, v145, v12
    v_mul_f32 v146, v146, v12
    v_mul_f32 v147, v147, v12
    v_mul_f32 v152, v152, v12
    v_mul_f32 v153, v153, v12
    v_mul_f32 v154, v154, v12
    v_mul_f32 v155, v155, v12
    v_mul_f32 v160, v160, v12
    v_mul_f32 v161, v161, v12
    v_mul_f32 v162, v162, v12
    v_mul_f32 v163, v163, v12
    v_mul_f32 v168, v168, v12
    v_mul_f32 v169, v169, v12
    v_mul_f32 v170, v170, v12
    v_mul_f32 v171, v171, v12
    v_mul_f32 v176, v176, v12
    v_mul_f32 v177, v177, v12
    v_mul_f32 v178, v178, v12
    v_mul_f32 v179, v179, v12
    v_mul_f32 v184, v184, v12
    v_mul_f32 v185, v185, v12
    v_mul_f32 v186, v186, v12
    v_mul_f32 v187, v187, v12
    v_mul_f32 v192, v192, v12
    v_mul_f32 v193, v193, v12
    v_mul_f32 v194, v194, v12
    v_mul_f32 v195, v195, v12
    v_mul_f32 v200, v200, v12
    v_mul_f32 v201, v201, v12
    v_mul_f32 v202, v202, v12
    v_mul_f32 v203, v203, v12
    v_mul_f32 v208, v208, v12
    v_mul_f32 v209, v209, v12
    v_mul_f32 v210, v210, v12
    v_mul_f32 v211, v211, v12
    v_mul_f32 v216, v216, v12
    v_mul_f32 v217, v217, v12
    v_mul_f32 v218, v218, v12
    v_mul_f32 v219, v219, v12
    v_mul_f32 v224, v224, v12
    v_mul_f32 v225, v225, v12
    v_mul_f32 v226, v226, v12
    v_mul_f32 v227, v227, v12
    v_mul_f32 v232, v232, v12
    v_mul_f32 v233, v233, v12
    v_mul_f32 v234, v234, v12
    v_mul_f32 v235, v235, v12
    v_mul_f32 v240, v240, v12
    v_mul_f32 v241, v241, v12
    v_mul_f32 v242, v242, v12
    v_mul_f32 v243, v243, v12
    v_mul_f32 v248, v248, v12
    v_mul_f32 v249, v249, v12
    v_mul_f32 v250, v250, v12
    v_mul_f32 v251, v251, v12
    v_sub_f32 v96, v64, v8
    v_sub_f32 v97, v65, v8
    v_sub_f32 v98, v66, v8
    v_sub_f32 v99, v67, v8
    v_sub_f32 v104, v72, v8
    v_sub_f32 v105, v73, v8
    v_sub_f32 v106, v74, v8
    v_sub_f32 v107, v75, v8
    v_sub_f32 v112, v80, v8
    v_sub_f32 v113, v81, v8
    v_sub_f32 v114, v82, v8
    v_sub_f32 v115, v83, v8
    v_sub_f32 v120, v88, v8
    v_sub_f32 v121, v89, v8
    v_sub_f32 v122, v90, v8
    v_sub_f32 v123, v91, v8
    v_exp_f32 v96, v96
    v_exp_f32 v97, v97
    v_exp_f32 v98, v98
    v_exp_f32 v99, v99
    v_exp_f32 v104, v104
    v_exp_f32 v105, v105
    v_exp_f32 v106, v106
    v_exp_f32 v107, v107
    v_exp_f32 v112, v112
    v_exp_f32 v113, v113
    v_exp_f32 v114, v114
    v_exp_f32 v115, v115
    v_exp_f32 v120, v120
    v_exp_f32 v121, v121
    v_exp_f32 v122, v122
    v_exp_f32 v123, v123
    s_nop 0
    v_add_f32 v34, v96, v97
    v_add_f32 v34, v34, v98
    v_add_f32 v34, v34, v99
    v_add_f32 v34, v34, v104
    v_add_f32 v34, v34, v105
    v_add_f32 v34, v34, v106
    v_add_f32 v34, v34, v107
    v_add_f32 v34, v34, v112
    v_add_f32 v34, v34, v113
    v_add_f32 v34, v34, v114
    v_add_f32 v34, v34, v115
    v_add_f32 v34, v34, v120
    v_add_f32 v34, v34, v121
    v_add_f32 v34, v34, v122
    v_add_f32 v34, v34, v123
    v_max3_f32 v9, v68, v69, v70
    v_max3_f32 v9, v9, v71, v76
    v_max3_f32 v9, v9, v77, v78
    v_max3_f32 v9, v9, v79, v84
    v_max3_f32 v9, v9, v85, v86
    v_max3_f32 v9, v9, v87, v92
    v_max3_f32 v9, v9, v93, v94
    v_max_f32 v9, v9, v95
    v_mov_b32 v10, v9
    s_nop 1
    v_permlane16_swap_b32 v9, v10
    s_nop 1
    v_max_f32 v9, v9, v10
    v_mov_b32 v10, v9
    s_nop 1
    v_permlane32_swap_b32 v9, v10
    s_nop 1
    v_max_f32 v9, v9, v10
    v_max_f32 v9, 0, v9
    v_sub_f32 v44, v44, v9
    v_sub_f32 v45, v45, v9
    v_sub_f32 v46, v46, v9
    v_sub_f32 v47, v47, v9
    v_sub_f32 v13, 0, v9
    v_exp_f32 v13, v13
    s_nop 0
    v_mul_f32 v39, v39, v13
    v_mul_f32 v132, v132, v13
    v_mul_f32 v133, v133, v13
    v_mul_f32 v134, v134, v13
    v_mul_f32 v135, v135, v13
    v_mul_f32 v140, v140, v13
    v_mul_f32 v141, v141, v13
    v_mul_f32 v142, v142, v13
    v_mul_f32 v143, v143, v13
    v_mul_f32 v148, v148, v13
    v_mul_f32 v149, v149, v13
    v_mul_f32 v150, v150, v13
    v_mul_f32 v151, v151, v13
    v_mul_f32 v156, v156, v13
    v_mul_f32 v157, v157, v13
    v_mul_f32 v158, v158, v13
    v_mul_f32 v159, v159, v13
    v_mul_f32 v164, v164, v13
    v_mul_f32 v165, v165, v13
    v_mul_f32 v166, v166, v13
    v_mul_f32 v167, v167, v13
    v_mul_f32 v172, v172, v13
    v_mul_f32 v173, v173, v13
    v_mul_f32 v174, v174, v13
    v_mul_f32 v175, v175, v13
    v_mul_f32 v180, v180, v13
    v_mul_f32 v181, v181, v13
    v_mul_f32 v182, v182, v13
    v_mul_f32 v183, v183, v13
    v_mul_f32 v188, v188, v13
    v_mul_f32 v189, v189, v13
    v_mul_f32 v190, v190, v13
    v_mul_f32 v191, v191, v13
    v_mul_f32 v196, v196, v13
    v_mul_f32 v197, v197, v13
    v_mul_f32 v198, v198, v13
    v_mul_f32 v199, v199, v13
    v_mul_f32 v204, v204, v13
    v_mul_f32 v205, v205, v13
    v_mul_f32 v206, v206, v13
    v_mul_f32 v207, v207, v13
    v_mul_f32 v212, v212, v13
    v_mul_f32 v213, v213, v13
    v_mul_f32 v214, v214, v13
    v_mul_f32 v215, v215, v13
    v_mul_f32 v220, v220, v13
    v_mul_f32 v221, v221, v13
    v_mul_f32 v222, v222, v13
    v_mul_f32 v223, v223, v13
    v_mul_f32 v228, v228, v13
    v_mul_f32 v229, v229, v13
    v_mul_f32 v230, v230, v13
    v_mul_f32 v231, v231, v13
    v_mul_f32 v236, v236, v13
    v_mul_f32 v237, v237, v13
    v_mul_f32 v238, v238, v13
    v_mul_f32 v239, v239, v13
    v_mul_f32 v244, v244, v13
    v_mul_f32 v245, v245, v13
    v_mul_f32 v246, v246, v13
    v_mul_f32 v247, v247, v13
    v_mul_f32 v252, v252, v13
    v_mul_f32 v253, v253, v13
    v_mul_f32 v254, v254, v13
    v_mul_f32 v255, v255, v13
    v_sub_f32 v100, v68, v9
    v_sub_f32 v101, v69, v9
    v_sub_f32 v102, v70, v9
    v_sub_f32 v103, v71, v9
    v_sub_f32 v108, v76, v9
    v_sub_f32 v109, v77, v9
    v_sub_f32 v110, v78, v9
    v_sub_f32 v111, v79, v9
    v_sub_f32 v116, v84, v9
    v_sub_f32 v117, v85, v9
    v_sub_f32 v118, v86, v9
    v_sub_f32 v119, v87, v9
    v_sub_f32 v124, v92, v9
    v_sub_f32 v125, v93, v9
    v_sub_f32 v126, v94, v9
    v_sub_f32 v127, v95, v9
    v_exp_f32 v100, v100
    v_exp_f32 v101, v101
    v_exp_f32 v102, v102
    v_exp_f32 v103, v103
    v_exp_f32 v108, v108
    v_exp_f32 v109, v109
    v_exp_f32 v110, v110
    v_exp_f32 v111, v111
    v_exp_f32 v116, v116
    v_exp_f32 v117, v117
    v_exp_f32 v118, v118
    v_exp_f32 v119, v119
    v_exp_f32 v124, v124
    v_exp_f32 v125, v125
    v_exp_f32 v126, v126
    v_exp_f32 v127, v127
    s_nop 0
    v_add_f32 v36, v100, v101
    v_add_f32 v36, v36, v102
    v_add_f32 v36, v36, v103
    v_add_f32 v36, v36, v108
    v_add_f32 v36, v36, v109
    v_add_f32 v36, v36, v110
    v_add_f32 v36, v36, v111
    v_add_f32 v36, v36, v116
    v_add_f32 v36, v36, v117
    v_add_f32 v36, v36, v118
    v_add_f32 v36, v36, v119
    v_add_f32 v36, v36, v124
    v_add_f32 v36, v36, v125
    v_add_f32 v36, v36, v126
    v_add_f32 v36, v36, v127
    s_branch F2_back_16
F2_mask_25:
    s_nop 7
    s_sub_u32 s81, s5, s33
    s_lshl_b32 s81, s81, 6
    v_subrev_u32 v6, s81, v27
    v_cmp_gt_i32 s[36:37], -16, v6
    v_cmp_gt_i32 s[38:39], -15, v6
    v_cmp_gt_i32 s[40:41], -14, v6
    v_cmp_gt_i32 s[42:43], -13, v6
    s_nop 0
    v_cndmask_b32 v68, v68, v7, s[36:37]
    v_cndmask_b32 v69, v69, v7, s[38:39]
    v_cndmask_b32 v70, v70, v7, s[40:41]
    v_cndmask_b32 v71, v71, v7, s[42:43]
    v_cmp_gt_i32 s[36:37], 0, v6
    v_cmp_gt_i32 s[38:39], 1, v6
    v_cmp_gt_i32 s[40:41], 2, v6
    v_cmp_gt_i32 s[42:43], 3, v6
    s_nop 0
    v_cndmask_b32 v64, v64, v7, s[36:37]
    v_cndmask_b32 v76, v76, v7, s[36:37]
    v_cndmask_b32 v65, v65, v7, s[38:39]
    v_cndmask_b32 v77, v77, v7, s[38:39]
    v_cndmask_b32 v66, v66, v7, s[40:41]
    v_cndmask_b32 v78, v78, v7, s[40:41]
    v_cndmask_b32 v67, v67, v7, s[42:43]
    v_cndmask_b32 v79, v79, v7, s[42:43]
    v_cmp_gt_i32 s[36:37], 16, v6
    v_cmp_gt_i32 s[38:39], 17, v6
    v_cmp_gt_i32 s[40:41], 18, v6
    v_cmp_gt_i32 s[42:43], 19, v6
    s_nop 0
    v_cndmask_b32 v72, v72, v7, s[36:37]
    v_cndmask_b32 v84, v84, v7, s[36:37]
    v_cndmask_b32 v73, v73, v7, s[38:39]
    v_cndmask_b32 v85, v85, v7, s[38:39]
    v_cndmask_b32 v74, v74, v7, s[40:41]
    v_cndmask_b32 v86, v86, v7, s[40:41]
    v_cndmask_b32 v75, v75, v7, s[42:43]
    v_cndmask_b32 v87, v87, v7, s[42:43]
    v_cmp_gt_i32 s[36:37], 32, v6
    v_cmp_gt_i32 s[38:39], 33, v6
    v_cmp_gt_i32 s[40:41], 34, v6
    v_cmp_gt_i32 s[42:43], 35, v6
    s_nop 0
    v_cndmask_b32 v80, v80, v7, s[36:37]
    v_cndmask_b32 v92, v92, v7, s[36:37]
    v_cndmask_b32 v81, v81, v7, s[38:39]
    v_cndmask_b32 v93, v93, v7, s[38:39]
    v_cndmask_b32 v82, v82, v7, s[40:41]
    v_cndmask_b32 v94, v94, v7, s[40:41]
    v_cndmask_b32 v83, v83, v7, s[42:43]
    v_cndmask_b32 v95, v95, v7, s[42:43]
    v_cmp_gt_i32 s[36:37], 48, v6
    v_cmp_gt_i32 s[38:39], 49, v6
    v_cmp_gt_i32 s[40:41], 50, v6
    v_cmp_gt_i32 s[42:43], 51, v6
    s_nop 0
    v_cndmask_b32 v88, v88, v7, s[36:37]
    v_cndmask_b32 v89, v89, v7, s[38:39]
    v_cndmask_b32 v90, v90, v7, s[40:41]
    v_cndmask_b32 v91, v91, v7, s[42:43]
.p2align 6
F2_loop_11:
    s_waitcnt lgkmcnt(8)
    v_mfma_f32_16x16x32_bf16 v[128:131], a[0:3], v[48:51], v[128:131]
    v_exp_f32 v96, v64
    v_mfma_f32_16x16x32_bf16 v[128:131], a[4:7], v[56:59], v[128:131]
    v_exp_f32 v97, v65
    v_mfma_f32_16x16x32_bf16 v[132:135], a[4:7], v[60:63], v[132:135]
    ds_read_b128 a[48:51], v4 offset:6144
    ds_read_b128 a[52:55], v4 offset:22528
    v_mfma_f32_16x16x32_bf16 v[132:135], a[0:3], v[52:55], v[132:135]
    v_exp_f32 v98, v66
    v_mfma_f32_16x16x32_bf16 v[140:143], a[8:11], v[52:55], v[140:143]
    v_exp_f32 v99, v67
    v_mfma_f32_16x16x32_bf16 v[140:143], a[12:15], v[60:63], v[140:143]
    ds_read_b128 a[56:59], v4 offset:7168
    v_add_f32 v34, v96, v98
    v_mfma_f32_16x16x32_bf16 v[136:139], a[12:15], v[56:59], v[136:139]
    v_exp_f32 v100, v68
    v_mfma_f32_16x16x32_bf16 v[136:139], a[8:11], v[48:51], v[136:139]
    s_waitcnt lgkmcnt(7)
    ds_read_b128 a[60:63], v4 offset:23552
    v_add_f32 v35, v97, v99
    v_mfma_f32_16x16x32_bf16 v[144:147], a[16:19], v[48:51], v[144:147]
    v_exp_f32 v101, v69
    v_mfma_f32_16x16x32_bf16 v[144:147], a[20:23], v[56:59], v[144:147]
    v_exp_f32 v102, v70
    v_mfma_f32_16x16x32_bf16 v[148:151], a[20:23], v[60:63], v[148:151]
    v_exp_f32 v103, v71
    v_mfma_f32_16x16x32_bf16 v[148:151], a[16:19], v[52:55], v[148:151]
    ds_read_b128 a[0:3], v4 offset:8192
    v_add_f32 v36, v100, v102
    v_mfma_f32_16x16x32_bf16 v[156:159], a[24:27], v[52:55], v[156:159]
    v_exp_f32 v104, v72
    v_mfma_f32_16x16x32_bf16 v[156:159], a[28:31], v[60:63], v[156:159]
    ds_read_b128 a[4:7], v4 offset:24576
    v_add_f32 v37, v101, v103
    v_mfma_f32_16x16x32_bf16 v[152:155], a[28:31], v[56:59], v[152:155]
    v_exp_f32 v105, v73
    v_mfma_f32_16x16x32_bf16 v[152:155], a[24:27], v[48:51], v[152:155]
    s_waitcnt lgkmcnt(6)
    ds_read_b128 a[8:11], v4 offset:9216
    v_add_f32 v34, v34, v104
    v_mfma_f32_16x16x32_bf16 v[160:163], a[32:35], v[48:51], v[160:163]
    v_exp_f32 v106, v74
    v_mfma_f32_16x16x32_bf16 v[160:163], a[36:39], v[56:59], v[160:163]
    ds_read_b128 a[12:15], v4 offset:25600
    v_add_f32 v35, v35, v105
    v_mfma_f32_16x16x32_bf16 v[164:167], a[36:39], v[60:63], v[164:167]
    v_exp_f32 v107, v75
    v_mfma_f32_16x16x32_bf16 v[164:167], a[32:35], v[52:55], v[164:167]
    ds_read_b128 a[16:19], v4 offset:10240
    v_add_f32 v34, v34, v106
    v_mfma_f32_16x16x32_bf16 v[172:175], a[40:43], v[52:55], v[172:175]
    v_exp_f32 v108, v76
    v_mfma_f32_16x16x32_bf16 v[172:175], a[44:47], v[60:63], v[172:175]
    ds_read_b128 a[20:23], v4 offset:26624
    v_add_f32 v35, v35, v107
    v_mfma_f32_16x16x32_bf16 v[168:171], a[44:47], v[56:59], v[168:171]
    v_exp_f32 v109, v77
    v_mfma_f32_16x16x32_bf16 v[168:171], a[40:43], v[48:51], v[168:171]
    s_waitcnt lgkmcnt(6)
    ds_read_b128 a[24:27], v4 offset:11264
    v_add_f32 v36, v36, v108
    v_mfma_f32_16x16x32_bf16 v[176:179], a[48:51], v[48:51], v[176:179]
    v_exp_f32 v110, v78
    v_mfma_f32_16x16x32_bf16 v[176:179], a[52:55], v[56:59], v[176:179]
    ds_read_b128 a[28:31], v4 offset:27648
    v_add_f32 v37, v37, v109
    v_mfma_f32_16x16x32_bf16 v[180:183], a[52:55], v[60:63], v[180:183]
    v_exp_f32 v111, v79
    v_mfma_f32_16x16x32_bf16 v[180:183], a[48:51], v[52:55], v[180:183]
    ds_read_b128 a[32:35], v4 offset:12288
    v_add_f32 v36, v36, v110
    v_mfma_f32_16x16x32_bf16 v[188:191], a[56:59], v[52:55], v[188:191]
    v_exp_f32 v112, v80
    v_mfma_f32_16x16x32_bf16 v[188:191], a[60:63], v[60:63], v[188:191]
    ds_read_b128 a[36:39], v4 offset:28672
    v_add_f32 v37, v37, v111
    v_mfma_f32_16x16x32_bf16 v[184:187], a[60:63], v[56:59], v[184:187]
    v_exp_f32 v113, v81
    v_mfma_f32_16x16x32_bf16 v[184:187], a[56:59], v[48:51], v[184:187]
    s_waitcnt lgkmcnt(6)
    ds_read_b128 a[40:43], v4 offset:13312
    v_add_f32 v34, v34, v112
    v_mfma_f32_16x16x32_bf16 v[192:195], a[0:3], v[48:51], v[192:195]
    v_exp_f32 v114, v82
    v_mfma_f32_16x16x32_bf16 v[192:195], a[4:7], v[56:59], v[192:195]
    ds_read_b128 a[44:47], v4 offset:29696
    v_add_f32 v35, v35, v113
    v_mfma_f32_16x16x32_bf16 v[196:199], a[4:7], v[60:63], v[196:199]
    v_exp_f32 v115, v83
    v_mfma_f32_16x16x32_bf16 v[196:199], a[0:3], v[52:55], v[196:199]
    ds_read_b128 a[48:51], v4 offset:14336
    v_add_f32 v34, v34, v114
    v_mfma_f32_16x16x32_bf16 v[204:207], a[8:11], v[52:55], v[204:207]
    v_exp_f32 v116, v84
    v_mfma_f32_16x16x32_bf16 v[204:207], a[12:15], v[60:63], v[204:207]
    ds_read_b128 a[52:55], v4 offset:30720
    v_add_f32 v35, v35, v115
    v_mfma_f32_16x16x32_bf16 v[200:203], a[12:15], v[56:59], v[200:203]
    v_exp_f32 v117, v85
    v_mfma_f32_16x16x32_bf16 v[200:203], a[8:11], v[48:51], v[200:203]
    s_waitcnt lgkmcnt(6)
    ds_read_b128 a[56:59], v4 offset:15360
    v_add_f32 v36, v36, v116
    v_mfma_f32_16x16x32_bf16 v[208:211], a[16:19], v[48:51], v[208:211]
    v_exp_f32 v118, v86
    v_mfma_f32_16x16x32_bf16 v[208:211], a[20:23], v[56:59], v[208:211]
    ds_read_b128 a[60:63], v4 offset:31744
    v_add_f32 v37, v37, v117
    v_mfma_f32_16x16x32_bf16 v[212:215], a[20:23], v[60:63], v[212:215]
    v_exp_f32 v119, v87
    v_mfma_f32_16x16x32_bf16 v[212:215], a[16:19], v[52:55], v[212:215]
    v_add_f32 v36, v36, v118
    v_mfma_f32_16x16x32_bf16 v[220:223], a[24:27], v[52:55], v[220:223]
    v_exp_f32 v120, v88
    v_mfma_f32_16x16x32_bf16 v[220:223], a[28:31], v[60:63], v[220:223]
    v_add_f32 v37, v37, v119
    v_mfma_f32_16x16x32_bf16 v[216:219], a[28:31], v[56:59], v[216:219]
    v_exp_f32 v121, v89
    v_mfma_f32_16x16x32_bf16 v[216:219], a[24:27], v[48:51], v[216:219]
    s_waitcnt vmcnt(9) lgkmcnt(0)
    s_barrier
    v_add_f32 v34, v34, v120
    v_mfma_f32_16x16x32_bf16 v[224:227], a[32:35], v[48:51], v[224:227]
    v_exp_f32 v122, v90
    v_mfma_f32_16x16x32_bf16 v[224:227], a[36:39], v[56:59], v[224:227]
    ds_read_b128 a[0:3], v3 offset:0
    v_add_f32 v35, v35, v121
    v_mfma_f32_16x16x32_bf16 v[228:231], a[36:39], v[60:63], v[228:231]
    v_exp_f32 v123, v91
    v_mfma_f32_16x16x32_bf16 v[228:231], a[32:35], v[52:55], v[228:231]
    ds_read_b128 a[4:7], v3 offset:1024
    v_add_f32 v34, v34, v122
    v_mfma_f32_16x16x32_bf16 v[236:239], a[40:43], v[52:55], v[236:239]
    v_exp_f32 v124, v92
    v_mfma_f32_16x16x32_bf16 v[236:239], a[44:47], v[60:63], v[236:239]
    ds_read_b128 a[8:11], v3 offset:2048
    v_add_f32 v35, v35, v123
    v_mfma_f32_16x16x32_bf16 v[232:235], a[44:47], v[56:59], v[232:235]
    v_exp_f32 v125, v93
    v_mfma_f32_16x16x32_bf16 v[232:235], a[40:43], v[48:51], v[232:235]
    ds_read_b128 a[12:15], v3 offset:3072
    v_add_f32 v36, v36, v124
    v_mfma_f32_16x16x32_bf16 v[240:243], a[48:51], v[48:51], v[240:243]
    v_exp_f32 v126, v94
    v_mfma_f32_16x16x32_bf16 v[240:243], a[52:55], v[56:59], v[240:243]
    v_add_f32 v37, v37, v125
    v_exp_f32 v127, v95
    v_add_f32 v36, v36, v126
    v_mfma_f32_16x16x32_bf16 v[244:247], a[52:55], v[60:63], v[244:247]
    ds_read_b128 a[16:19], v3 offset:4096
    v_add_f32 v34, v34, v35
    v_mfma_f32_16x16x32_bf16 v[244:247], a[48:51], v[52:55], v[244:247]
    ds_read_b128 a[20:23], v3 offset:5120
    v_add_f32 v37, v37, v127
    v_mfma_f32_16x16x32_bf16 v[252:255], a[56:59], v[52:55], v[252:255]
    v_add_f32 v36, v36, v37
    v_max_f32 v8, v34, v36
    v_mfma_f32_16x16x32_bf16 v[252:255], a[60:63], v[60:63], v[252:255]
    s_cmp_eq_u32 s5, s24
    ds_read_b128 a[24:27], v3 offset:6144
    v_cmp_nge_f32 vcc, 0x44800000, v8
    v_mfma_f32_16x16x32_bf16 v[248:251], a[60:63], v[56:59], v[248:251]
    s_cselect_b64 s[36:37], -1, vcc
    ds_read_b128 a[28:31], v3 offset:7168
    v_mfma_f32_16x16x32_bf16 v[248:251], a[56:59], v[48:51], v[248:251]
    s_cmp_lg_u64 s[36:37], 0
    s_cbranch_scc1 F2_sp_26
F2_qk_12:
    s_waitcnt lgkmcnt(4)
    v_mfma_f32_16x16x32_bf16 v[64:67], a[0:3], a[64:67], v[40:43]
    ds_read_b128 a[32:35], v3 offset:8192
    v_mfma_f32_16x16x32_bf16 v[64:67], a[4:7], a[72:75], v[64:67]
    s_mov_b32 m0, s28
    ds_read_b128 a[36:39], v3 offset:9216
    v_add_f32 v38, v38, v34
    v_mfma_f32_16x16x32_bf16 v[68:71], a[4:7], a[76:79], v[44:47]
    ds_read_b128 a[40:43], v3 offset:10240
    v_mfma_f32_16x16x32_bf16 v[68:71], a[0:3], a[68:71], v[68:71]
    ds_read_b128 a[44:47], v3 offset:11264
    v_add_f32 v39, v39, v36
    v_mfma_f32_16x16x32_bf16 v[68:71], a[8:11], a[84:87], v[68:71]
    buffer_load_dwordx4 v2, s[8:11], s26 offen offset:0 sc1 lds
    v_mfma_f32_16x16x32_bf16 v[68:71], a[12:15], a[92:95], v[68:71]
    s_add_u32 s30, s29, s90
    ds_read_b128 a[48:51], v3 offset:12288
    ds_read_b128 a[52:55], v3 offset:13312
    v_mfma_f32_16x16x32_bf16 v[64:67], a[12:15], a[88:91], v[64:67]
    buffer_load_dwordx4 v2, s[8:11], s26 offen offset:1024 sc1 lds
    v_mfma_f32_16x16x32_bf16 v[64:67], a[8:11], a[80:83], v[64:67]
    s_waitcnt lgkmcnt(6)
    ds_read_b128 a[56:59], v3 offset:14336
    ds_read_b128 a[60:63], v3 offset:15360
    v_mfma_f32_16x16x32_bf16 v[64:67], a[16:19], a[96:99], v[64:67]
    s_cmp_eq_u32 s30, s31
    s_cselect_b32 s30, s32, s30
    ds_read_b128 a[0:3], v3 offset:16384
    v_mfma_f32_16x16x32_bf16 v[64:67], a[20:23], a[104:107], v[64:67]
    buffer_load_dwordx4 v2, s[8:11], s26 offen offset:2048 sc1 lds
    v_mfma_f32_16x16x32_bf16 v[68:71], a[20:23], a[108:111], v[68:71]
    ds_read_b128 a[4:7], v3 offset:17408
    v_add_u32 v4, s30, v26
    v_mfma_f32_16x16x32_bf16 v[68:71], a[16:19], a[100:103], v[68:71]
    buffer_load_dwordx4 v2, s[8:11], s26 offen offset:3072 sc1 lds
    v_mfma_f32_16x16x32_bf16 v[68:71], a[24:27], a[116:119], v[68:71]
    v_cvt_pk_bf16_f32 v48, v96, v97
    v_mfma_f32_16x16x32_bf16 v[68:71], a[28:31], a[124:127], v[68:71]
    s_add_u32 m0, s28, 4096
    ds_read_b128 a[8:11], v3 offset:18432
    v_cvt_pk_bf16_f32 v49, v98, v99
    v_mfma_f32_16x16x32_bf16 v[64:67], a[28:31], a[120:123], v[64:67]
    v_mfma_f32_16x16x32_bf16 v[64:67], a[24:27], a[112:115], v[64:67]
    s_waitcnt lgkmcnt(7)
    ds_read_b128 a[12:15], v3 offset:19456
    v_mfma_f32_16x16x32_bf16 v[72:75], a[32:35], a[64:67], v[40:43]
    ds_read_b128 a[16:19], v3 offset:20480
    v_cvt_pk_bf16_f32 v50, v104, v105
    v_mfma_f32_16x16x32_bf16 v[72:75], a[36:39], a[72:75], v[72:75]
    buffer_load_dwordx4 v5, s[8:11], s26 offen offset:0 sc1 lds
    v_mfma_f32_16x16x32_bf16 v[76:79], a[36:39], a[76:79], v[44:47]
    ds_read_b128 a[20:23], v3 offset:21504
    v_cvt_pk_bf16_f32 v51, v106, v107
    v_mfma_f32_16x16x32_bf16 v[76:79], a[32:35], a[68:71], v[76:79]
    buffer_load_dwordx4 v5, s[8:11], s26 offen offset:1024 sc1 lds
    v_mfma_f32_16x16x32_bf16 v[76:79], a[40:43], a[84:87], v[76:79]
    ds_read_b128 a[24:27], v3 offset:22528
    v_cvt_pk_bf16_f32 v52, v100, v101
    v_mfma_f32_16x16x32_bf16 v[76:79], a[44:47], a[92:95], v[76:79]
    buffer_load_dwordx4 v5, s[8:11], s26 offen offset:2048 sc1 lds
    v_mfma_f32_16x16x32_bf16 v[72:75], a[44:47], a[88:91], v[72:75]
    v_cvt_pk_bf16_f32 v53, v102, v103
    v_mfma_f32_16x16x32_bf16 v[72:75], a[40:43], a[80:83], v[72:75]
    s_waitcnt lgkmcnt(7)
    ds_read_b128 a[28:31], v3 offset:23552
    v_mfma_f32_16x16x32_bf16 v[72:75], a[48:51], a[96:99], v[72:75]
    buffer_load_dwordx4 v5, s[8:11], s26 offen offset:3072 sc1 lds
    v_mfma_f32_16x16x32_bf16 v[72:75], a[52:55], a[104:107], v[72:75]
    ds_read_b128 a[32:35], v3 offset:24576
    v_cvt_pk_bf16_f32 v54, v108, v109
    v_mfma_f32_16x16x32_bf16 v[76:79], a[52:55], a[108:111], v[76:79]
    s_xor_b32 s28, s28, s90
    v_cvt_pk_bf16_f32 v55, v110, v111
    v_mfma_f32_16x16x32_bf16 v[76:79], a[48:51], a[100:103], v[76:79]
    ds_read_b128 a[36:39], v3 offset:25600
    v_mfma_f32_16x16x32_bf16 v[76:79], a[56:59], a[116:119], v[76:79]
    s_mov_b32 m0, s29
    v_cvt_pk_bf16_f32 v56, v112, v113
    v_mfma_f32_16x16x32_bf16 v[76:79], a[60:63], a[124:127], v[76:79]
    ds_read_b128 a[40:43], v3 offset:26624
    v_mfma_f32_16x16x32_bf16 v[72:75], a[60:63], a[120:123], v[72:75]
    buffer_load_dwordx4 v2, s[12:15], s26 offen offset:0 sc1 lds
    v_mfma_f32_16x16x32_bf16 v[72:75], a[56:59], a[112:115], v[72:75]
    s_waitcnt lgkmcnt(7)
    ds_read_b128 a[44:47], v3 offset:27648
    v_cvt_pk_bf16_f32 v57, v114, v115
    v_mfma_f32_16x16x32_bf16 v[80:83], a[0:3], a[64:67], v[40:43]
    buffer_load_dwordx4 v2, s[12:15], s26 offen offset:1024 sc1 lds
    v_mfma_f32_16x16x32_bf16 v[80:83], a[4:7], a[72:75], v[80:83]
    ds_read_b128 a[48:51], v3 offset:28672
    v_cvt_pk_bf16_f32 v58, v120, v121
    v_mfma_f32_16x16x32_bf16 v[84:87], a[4:7], a[76:79], v[44:47]
    v_mfma_f32_16x16x32_bf16 v[84:87], a[0:3], a[68:71], v[84:87]
    ds_read_b128 a[52:55], v3 offset:29696
    v_cvt_pk_bf16_f32 v59, v122, v123
    v_mfma_f32_16x16x32_bf16 v[84:87], a[8:11], a[84:87], v[84:87]
    buffer_load_dwordx4 v2, s[12:15], s26 offen offset:2048 sc1 lds
    v_mfma_f32_16x16x32_bf16 v[84:87], a[12:15], a[92:95], v[84:87]
    ds_read_b128 a[56:59], v3 offset:30720
    v_cvt_pk_bf16_f32 v60, v116, v117
    v_mfma_f32_16x16x32_bf16 v[80:83], a[12:15], a[88:91], v[80:83]
    buffer_load_dwordx4 v2, s[12:15], s26 offen offset:3072 sc1 lds
    v_mfma_f32_16x16x32_bf16 v[80:83], a[8:11], a[80:83], v[80:83]
    s_waitcnt lgkmcnt(7)
    ds_read_b128 a[60:63], v3 offset:31744
    v_cvt_pk_bf16_f32 v61, v118, v119
    v_mfma_f32_16x16x32_bf16 v[80:83], a[16:19], a[96:99], v[80:83]
    s_add_u32 m0, s29, 4096
    v_mfma_f32_16x16x32_bf16 v[80:83], a[20:23], a[104:107], v[80:83]
    v_xor_b32 v3, 0x8000, v3
    v_cvt_pk_bf16_f32 v62, v124, v125
    v_mfma_f32_16x16x32_bf16 v[84:87], a[20:23], a[108:111], v[84:87]
    ds_read_b128 a[0:3], v4 offset:0
    ds_read_b128 a[4:7], v4 offset:16384
    v_mfma_f32_16x16x32_bf16 v[84:87], a[16:19], a[100:103], v[84:87]
    buffer_load_dwordx4 v5, s[12:15], s26 offen offset:0 sc1 lds
    v_mfma_f32_16x16x32_bf16 v[84:87], a[24:27], a[116:119], v[84:87]
    v_cvt_pk_bf16_f32 v63, v126, v127
    v_mfma_f32_16x16x32_bf16 v[84:87], a[28:31], a[124:127], v[84:87]
    ds_read_b128 a[8:11], v4 offset:1024
    v_mfma_f32_16x16x32_bf16 v[80:83], a[28:31], a[120:123], v[80:83]
    buffer_load_dwordx4 v5, s[12:15], s26 offen offset:1024 sc1 lds
    v_mfma_f32_16x16x32_bf16 v[80:83], a[24:27], a[112:115], v[80:83]
    s_waitcnt lgkmcnt(7)
    ds_read_b128 a[12:15], v4 offset:17408
    v_mfma_f32_16x16x32_bf16 v[88:91], a[32:35], a[64:67], v[40:43]
    buffer_load_dwordx4 v5, s[12:15], s26 offen offset:2048 sc1 lds
    v_mfma_f32_16x16x32_bf16 v[88:91], a[36:39], a[72:75], v[88:91]
    ds_read_b128 a[16:19], v4 offset:2048
    v_mfma_f32_16x16x32_bf16 v[92:95], a[36:39], a[76:79], v[44:47]
    s_add_u32 s5, s5, 1
    ds_read_b128 a[20:23], v4 offset:18432
    v_mfma_f32_16x16x32_bf16 v[92:95], a[32:35], a[68:71], v[92:95]
    buffer_load_dwordx4 v5, s[12:15], s26 offen offset:3072 sc1 lds
    v_mfma_f32_16x16x32_bf16 v[92:95], a[40:43], a[84:87], v[92:95]
    v_mfma_f32_16x16x32_bf16 v[92:95], a[44:47], a[92:95], v[92:95]
    s_mov_b32 s29, s30
    ds_read_b128 a[24:27], v4 offset:3072
    v_mfma_f32_16x16x32_bf16 v[88:91], a[44:47], a[88:91], v[88:91]
    v_mfma_f32_16x16x32_bf16 v[88:91], a[40:43], a[80:83], v[88:91]
    s_waitcnt lgkmcnt(7)
    s_add_u32 s26, s26, s90
    ds_read_b128 a[28:31], v4 offset:19456
    v_mfma_f32_16x16x32_bf16 v[88:91], a[48:51], a[96:99], v[88:91]
    v_mfma_f32_16x16x32_bf16 v[88:91], a[52:55], a[104:107], v[88:91]
    ds_read_b128 a[32:35], v4 offset:4096
    v_mfma_f32_16x16x32_bf16 v[92:95], a[52:55], a[108:111], v[92:95]
    s_cmp_eq_u32 s26, s3
    s_cselect_b32 s26, 0, s26
    v_mfma_f32_16x16x32_bf16 v[92:95], a[48:51], a[100:103], v[92:95]
    ds_read_b128 a[36:39], v4 offset:20480
    v_mfma_f32_16x16x32_bf16 v[92:95], a[56:59], a[116:119], v[92:95]
    buffer_load_dwordx2 v[30:31], v29, s[48:51], s100 offen sc1
    v_mfma_f32_16x16x32_bf16 v[92:95], a[60:63], a[124:127], v[92:95]
    ds_read_b128 a[40:43], v4 offset:5120
    v_mfma_f32_16x16x32_bf16 v[88:91], a[60:63], a[120:123], v[88:91]
    v_mfma_f32_16x16x32_bf16 v[88:91], a[56:59], a[112:115], v[88:91]
    s_cmp_lt_u32 s5, s33
    ds_read_b128 a[44:47], v4 offset:21504
    s_cbranch_scc1 F2_loop_11
    s_branch F2_mask_25
F2_sp_26:
    s_cbranch_vccnz F2_slow_15
F2_back_16:
    s_cmp_lg_u32 s5, s24
    s_cbranch_scc1 F2_qk_12
F2_dis_24:
    s_cmp_eq_u32 s5, s6
    s_cbranch_scc1 F2_tail_13
    s_add_u32 s81, s5, 1
    s_cmp_eq_u32 s81, s6
    s_cbranch_scc1 F2_e1_27
    s_cmp_eq_u32 s5, 0
    s_cbranch_scc1 F2_w1_28
    buffer_load_dword v23, v29, s[48:51], s80 offen sc1
    s_mov_b32 s24, 0
    s_branch F2_qk_12
F2_w1_28:
    s_sub_u32 s24, s6, 1
F2_wc_30:
    v_readfirstlane_b32 s81, v23
    s_nop 3
    s_cmp_eq_u32 s81, 128
    s_cbranch_scc1 F2_wd_31
    s_add_u32 s78, s78, 1
    s_cmp_gt_u32 s78, 0x40000
    s_cbranch_scc1 F2_wd_31
    buffer_load_dword v23, v29, s[48:51], s80 offen sc1
    s_waitcnt vmcnt(0)
    s_branch F2_wc_30
F2_wd_31:
    s_mov_b32 s85, s86
    s_branch F2_qk_12
F2_e1_27:
    s_mov_b32 s24, s6
    s_cmp_eq_u32 s88, 0
    s_cselect_b32 s82, 1, 0
    s_or_b32 s82, s82, s60
    s_lshl_b32 s83, s7, 1
F2_hs_33:
    s_waitcnt vmcnt(0)
    v_readfirstlane_b32 s46, v30
    v_readfirstlane_b32 s47, v31
    s_nop 1
    s_or_b32 s47, s47, s82
    s_cmp_eq_u32 s46, s83
    s_cselect_b32 s47, s47, 0
    s_cmp_lg_u32 s47, 0
    s_cbranch_scc1 F2_h_32
    s_add_u32 s78, s78, 1
    s_cmp_gt_u32 s78, 0x40000
    s_cbranch_scc1 F2_h_32
    buffer_load_dwordx2 v[30:31], v29, s[48:51], s100 offen sc1
    s_branch F2_hs_33
F2_h_32:
    s_add_u32 s83, s91, 52427776
    s_add_u32 s84, s91, 54523904
    s_or_b32 s81, s88, s60
    s_cselect_b32 s83, s83, 1073741824
    s_cselect_b32 s84, s84, 1073741824
    s_cmp_eq_u32 s7, 2
    s_cselect_b32 s35, s35, 1073741824
    s_mov_b32 s22, s28
    s_mov_b32 s23, s29
    s_xor_b32 s20, s28, s90
    s_waitcnt lgkmcnt(4)
    v_mfma_f32_16x16x32_bf16 v[64:67], a[0:3], a[64:67], v[40:43]
    ds_read_b128 a[32:35], v3 offset:8192
    v_add_f32 v38, v38, v34
    v_mfma_f32_16x16x32_bf16 v[64:67], a[4:7], a[72:75], v[64:67]
    buffer_load_dword v23, v29, s[48:51], s80 offen sc1
    v_mfma_f32_16x16x32_bf16 v[68:71], a[4:7], a[76:79], v[44:47]
    s_add_u32 s81, s35, 16384
    ds_read_b128 a[36:39], v3 offset:9216
    ds_read_b128 a[40:43], v3 offset:10240
    v_mfma_f32_16x16x32_bf16 v[68:71], a[0:3], a[68:71], v[68:71]
    ds_read_b128 a[44:47], v3 offset:11264
    v_add_f32 v39, v39, v36
    v_mfma_f32_16x16x32_bf16 v[68:71], a[8:11], a[84:87], v[68:71]
    s_add_u32 s30, s29, s90
    ds_read_b128 a[48:51], v3 offset:12288
    ds_read_b128 a[52:55], v3 offset:13312
    v_mfma_f32_16x16x32_bf16 v[68:71], a[12:15], a[92:95], v[68:71]
    buffer_load_dwordx4 v[14:17], v1, s[48:51], s81 offen sc1
    v_mfma_f32_16x16x32_bf16 v[64:67], a[12:15], a[88:91], v[64:67]
    s_add_u32 m0, s22, 0
    ds_read_b128 a[56:59], v3 offset:14336
    v_mfma_f32_16x16x32_bf16 v[64:67], a[8:11], a[80:83], v[64:67]
    s_waitcnt lgkmcnt(7)
    ds_read_b128 a[60:63], v3 offset:15360
    v_mfma_f32_16x16x32_bf16 v[64:67], a[16:19], a[96:99], v[64:67]
    s_add_u32 s81, s35, 0
    s_cmp_eq_u32 s30, s31
    s_cselect_b32 s30, s32, s30
    v_mfma_f32_16x16x32_bf16 v[64:67], a[20:23], a[104:107], v[64:67]
    ds_read_b128 a[0:3], v3 offset:16384
    v_add_u32 v4, s30, v26
    v_mfma_f32_16x16x32_bf16 v[68:71], a[20:23], a[108:111], v[68:71]
    buffer_load_dwordx4 v1, s[48:51], s81 offen offset:0 sc1 lds
    v_mfma_f32_16x16x32_bf16 v[68:71], a[16:19], a[100:103], v[68:71]
    ds_read_b128 a[4:7], v3 offset:17408
    v_cvt_pk_bf16_f32 v48, v96, v97
    v_mfma_f32_16x16x32_bf16 v[68:71], a[24:27], a[116:119], v[68:71]
    buffer_load_dwordx4 v1, s[48:51], s81 offen offset:1024 sc1 lds
    v_mfma_f32_16x16x32_bf16 v[68:71], a[28:31], a[124:127], v[68:71]
    ds_read_b128 a[8:11], v3 offset:18432
    v_cvt_pk_bf16_f32 v49, v98, v99
    v_mfma_f32_16x16x32_bf16 v[64:67], a[28:31], a[120:123], v[64:67]
    buffer_load_dwordx4 v1, s[48:51], s81 offen offset:2048 sc1 lds
    v_mfma_f32_16x16x32_bf16 v[64:67], a[24:27], a[112:115], v[64:67]
    s_waitcnt lgkmcnt(7)
    ds_read_b128 a[12:15], v3 offset:19456
    v_mfma_f32_16x16x32_bf16 v[72:75], a[32:35], a[64:67], v[40:43]
    ds_read_b128 a[16:19], v3 offset:20480
    v_cvt_pk_bf16_f32 v50, v104, v105
    v_mfma_f32_16x16x32_bf16 v[72:75], a[36:39], a[72:75], v[72:75]
    buffer_load_dwordx4 v1, s[48:51], s81 offen offset:3072 sc1 lds
    v_mfma_f32_16x16x32_bf16 v[76:79], a[36:39], a[76:79], v[44:47]
    s_add_u32 m0, s22, 4096
    v_cvt_pk_bf16_f32 v51, v106, v107
    v_mfma_f32_16x16x32_bf16 v[76:79], a[32:35], a[68:71], v[76:79]
    ds_read_b128 a[20:23], v3 offset:21504
    v_mfma_f32_16x16x32_bf16 v[76:79], a[40:43], a[84:87], v[76:79]
    s_add_u32 s81, s35, 4096
    v_cvt_pk_bf16_f32 v52, v100, v101
    v_mfma_f32_16x16x32_bf16 v[76:79], a[44:47], a[92:95], v[76:79]
    ds_read_b128 a[24:27], v3 offset:22528
    v_cvt_pk_bf16_f32 v53, v102, v103
    v_mfma_f32_16x16x32_bf16 v[72:75], a[44:47], a[88:91], v[72:75]
    buffer_load_dwordx4 v1, s[48:51], s81 offen offset:0 sc1 lds
    v_mfma_f32_16x16x32_bf16 v[72:75], a[40:43], a[80:83], v[72:75]
    s_waitcnt lgkmcnt(7)
    ds_read_b128 a[28:31], v3 offset:23552
    v_mfma_f32_16x16x32_bf16 v[72:75], a[48:51], a[96:99], v[72:75]
    buffer_load_dwordx4 v1, s[48:51], s81 offen offset:1024 sc1 lds
    v_mfma_f32_16x16x32_bf16 v[72:75], a[52:55], a[104:107], v[72:75]
    ds_read_b128 a[32:35], v3 offset:24576
    v_cvt_pk_bf16_f32 v54, v108, v109
    v_mfma_f32_16x16x32_bf16 v[76:79], a[52:55], a[108:111], v[76:79]
    buffer_load_dwordx4 v1, s[48:51], s81 offen offset:2048 sc1 lds
    v_mfma_f32_16x16x32_bf16 v[76:79], a[48:51], a[100:103], v[76:79]
    ds_read_b128 a[36:39], v3 offset:25600
    v_cvt_pk_bf16_f32 v55, v110, v111
    v_mfma_f32_16x16x32_bf16 v[76:79], a[56:59], a[116:119], v[76:79]
    buffer_load_dwordx4 v1, s[48:51], s81 offen offset:3072 sc1 lds
    v_mfma_f32_16x16x32_bf16 v[76:79], a[60:63], a[124:127], v[76:79]
    ds_read_b128 a[40:43], v3 offset:26624
    v_cvt_pk_bf16_f32 v56, v112, v113
    v_mfma_f32_16x16x32_bf16 v[72:75], a[60:63], a[120:123], v[72:75]
    s_add_u32 m0, s23, 0
    v_mfma_f32_16x16x32_bf16 v[72:75], a[56:59], a[112:115], v[72:75]
    s_waitcnt lgkmcnt(7)
    ds_read_b128 a[44:47], v3 offset:27648
    v_cvt_pk_bf16_f32 v57, v114, v115
    v_mfma_f32_16x16x32_bf16 v[80:83], a[0:3], a[64:67], v[40:43]
    s_add_u32 s81, s35, 8192
    v_mfma_f32_16x16x32_bf16 v[80:83], a[4:7], a[72:75], v[80:83]
    ds_read_b128 a[48:51], v3 offset:28672
    v_cvt_pk_bf16_f32 v58, v120, v121
    v_mfma_f32_16x16x32_bf16 v[84:87], a[4:7], a[76:79], v[44:47]
    buffer_load_dwordx4 v1, s[48:51], s81 offen offset:0 sc1 lds
    v_mfma_f32_16x16x32_bf16 v[84:87], a[0:3], a[68:71], v[84:87]
    ds_read_b128 a[52:55], v3 offset:29696
    v_cvt_pk_bf16_f32 v59, v122, v123
    v_mfma_f32_16x16x32_bf16 v[84:87], a[8:11], a[84:87], v[84:87]
    buffer_load_dwordx4 v1, s[48:51], s81 offen offset:1024 sc1 lds
    v_mfma_f32_16x16x32_bf16 v[84:87], a[12:15], a[92:95], v[84:87]
    ds_read_b128 a[56:59], v3 offset:30720
    v_cvt_pk_bf16_f32 v60, v116, v117
    v_mfma_f32_16x16x32_bf16 v[80:83], a[12:15], a[88:91], v[80:83]
    buffer_load_dwordx4 v1, s[48:51], s81 offen offset:2048 sc1 lds
    v_mfma_f32_16x16x32_bf16 v[80:83], a[8:11], a[80:83], v[80:83]
    s_waitcnt lgkmcnt(7)
    ds_read_b128 a[60:63], v3 offset:31744
    v_cvt_pk_bf16_f32 v61, v118, v119
    v_mfma_f32_16x16x32_bf16 v[80:83], a[16:19], a[96:99], v[80:83]
    buffer_load_dwordx4 v1, s[48:51], s81 offen offset:3072 sc1 lds
    v_mfma_f32_16x16x32_bf16 v[80:83], a[20:23], a[104:107], v[80:83]
    s_add_u32 m0, s23, 4096
    v_xor_b32 v3, 0x8000, v3
    v_cvt_pk_bf16_f32 v62, v124, v125
    v_mfma_f32_16x16x32_bf16 v[84:87], a[20:23], a[108:111], v[84:87]
    ds_read_b128 a[0:3], v4 offset:0
    v_mfma_f32_16x16x32_bf16 v[84:87], a[16:19], a[100:103], v[84:87]
    s_add_u32 s81, s35, 12288
    ds_read_b128 a[4:7], v4 offset:16384
    v_cvt_pk_bf16_f32 v63, v126, v127
    v_mfma_f32_16x16x32_bf16 v[84:87], a[24:27], a[116:119], v[84:87]
    v_mfma_f32_16x16x32_bf16 v[84:87], a[28:31], a[124:127], v[84:87]
    ds_read_b128 a[8:11], v4 offset:1024
    v_mfma_f32_16x16x32_bf16 v[80:83], a[28:31], a[120:123], v[80:83]
    buffer_load_dwordx4 v1, s[48:51], s81 offen offset:0 sc1 lds
    v_mfma_f32_16x16x32_bf16 v[80:83], a[24:27], a[112:115], v[80:83]
    s_waitcnt lgkmcnt(7)
    ds_read_b128 a[12:15], v4 offset:17408
    v_mfma_f32_16x16x32_bf16 v[88:91], a[32:35], a[64:67], v[40:43]
    buffer_load_dwordx4 v1, s[48:51], s81 offen offset:1024 sc1 lds
    v_mfma_f32_16x16x32_bf16 v[88:91], a[36:39], a[72:75], v[88:91]
    buffer_load_dwordx4 v1, s[48:51], s81 offen offset:2048 sc1 lds
    v_mfma_f32_16x16x32_bf16 v[92:95], a[36:39], a[76:79], v[44:47]
    s_add_u32 s5, s5, 1
    ds_read_b128 a[16:19], v4 offset:2048
    ds_read_b128 a[20:23], v4 offset:18432
    v_mfma_f32_16x16x32_bf16 v[92:95], a[32:35], a[68:71], v[92:95]
    buffer_load_dwordx4 v1, s[48:51], s81 offen offset:3072 sc1 lds
    v_mfma_f32_16x16x32_bf16 v[92:95], a[40:43], a[84:87], v[92:95]
    ds_read_b128 a[24:27], v4 offset:3072
    v_mfma_f32_16x16x32_bf16 v[92:95], a[44:47], a[92:95], v[92:95]
    buffer_load_dwordx4 a[200:203], v1, s[48:51], s83 offen sc1
    v_mfma_f32_16x16x32_bf16 v[88:91], a[44:47], a[88:91], v[88:91]
    buffer_load_dwordx2 a[222:223], v1, s[48:51], s84 offen offset:8 sc1
    v_mfma_f32_16x16x32_bf16 v[88:91], a[40:43], a[80:83], v[88:91]
    s_waitcnt lgkmcnt(7)
    ds_read_b128 a[28:31], v4 offset:19456
    v_mfma_f32_16x16x32_bf16 v[88:91], a[48:51], a[96:99], v[88:91]
    ds_read_b128 a[32:35], v4 offset:4096
    v_mfma_f32_16x16x32_bf16 v[88:91], a[52:55], a[104:107], v[88:91]
    buffer_load_dwordx2 a[226:227], v1, s[48:51], s84 offen offset:1032 sc1
    v_mfma_f32_16x16x32_bf16 v[92:95], a[52:55], a[108:111], v[92:95]
    v_mfma_f32_16x16x32_bf16 v[92:95], a[48:51], a[100:103], v[92:95]
    s_mov_b32 s29, s30
    ds_read_b128 a[36:39], v4 offset:20480
    v_mfma_f32_16x16x32_bf16 v[92:95], a[56:59], a[116:119], v[92:95]
    v_mfma_f32_16x16x32_bf16 v[92:95], a[60:63], a[124:127], v[92:95]
    s_mov_b32 s21, s30
    ds_read_b128 a[40:43], v4 offset:5120
    v_mfma_f32_16x16x32_bf16 v[88:91], a[60:63], a[120:123], v[88:91]
    v_mfma_f32_16x16x32_bf16 v[88:91], a[56:59], a[112:115], v[88:91]
    s_cmp_lt_u32 s5, s33
    ds_read_b128 a[44:47], v4 offset:21504
    s_cbranch_scc1 F2_loop_11
    s_branch F2_mask_25
F2_tail_13:
    s_add_u32 s30, s29, s90
    s_cmp_eq_u32 s30, s31
    s_cselect_b32 s30, s32, s30
    v_add_u32 v4, s30, v26
    s_cmp_eq_u32 s7, 1
    s_cbranch_scc1 K2_t1_34
    ds_read_b128 a[0:3], v4 offset:0
    ds_read_b128 a[4:7], v4 offset:16384
    ds_read_b128 a[8:11], v4 offset:1024
    ds_read_b128 a[12:15], v4 offset:17408
    ds_read_b128 a[16:19], v4 offset:2048
    ds_read_b128 a[20:23], v4 offset:18432
    ds_read_b128 a[24:27], v4 offset:3072
    ds_read_b128 a[28:31], v4 offset:19456
    ds_read_b128 a[32:35], v4 offset:4096
    ds_read_b128 a[36:39], v4 offset:20480
    ds_read_b128 a[40:43], v4 offset:5120
    ds_read_b128 a[44:47], v4 offset:21504
    v_add_f32 v38, v38, v34
    v_add_f32 v39, v39, v36
    v_cvt_pk_bf16_f32 v48, v96, v97
    v_cvt_pk_bf16_f32 v49, v98, v99
    v_cvt_pk_bf16_f32 v50, v104, v105
    v_cvt_pk_bf16_f32 v51, v106, v107
    v_cvt_pk_bf16_f32 v52, v100, v101
    v_cvt_pk_bf16_f32 v53, v102, v103
    v_cvt_pk_bf16_f32 v54, v108, v109
    v_cvt_pk_bf16_f32 v55, v110, v111
    v_cvt_pk_bf16_f32 v56, v112, v113
    v_cvt_pk_bf16_f32 v57, v114, v115
    v_cvt_pk_bf16_f32 v58, v120, v121
    v_cvt_pk_bf16_f32 v59, v122, v123
    v_cvt_pk_bf16_f32 v60, v116, v117
    v_cvt_pk_bf16_f32 v61, v118, v119
    v_cvt_pk_bf16_f32 v62, v124, v125
    v_cvt_pk_bf16_f32 v63, v126, v127
    s_waitcnt vmcnt(0)
F2_wc2_38:
    v_readfirstlane_b32 s81, v23
    s_nop 3
    s_cmp_eq_u32 s81, 128
    s_cbranch_scc1 F2_wd2_39
    s_add_u32 s78, s78, 1
    s_cmp_gt_u32 s78, 0x40000
    s_cbranch_scc1 F2_wd2_39
    buffer_load_dword v23, v29, s[48:51], s80 offen sc1
    s_waitcnt vmcnt(0)
    s_branch F2_wc2_38
F2_wd2_39:
    s_lshl_b32 s81, s64, 15
    s_add_u32 s81, s81, s74
    s_mov_b32 s84, 0xffff0000
    s_cmp_eq_u32 s7, 0
    s_cbranch_scc1 K2_t0_35
    v_add_u32 v22, s22, v1
    v_add_u32 v23, s23, v1
    s_waitcnt lgkmcnt(8)
    v_mfma_f32_16x16x32_bf16 v[128:131], a[0:3], v[48:51], v[128:131]
    ds_read_b128 v[64:67], v22 offset:0
    v_min_f32 v8, v40, v14
    v_mfma_f32_16x16x32_bf16 v[128:131], a[4:7], v[56:59], v[128:131]
    s_add_u32 s25, s18, 20480
    ds_read_b128 a[48:51], v4 offset:6144
    ds_read_b128 v[96:99], v23 offset:0
    v_mfma_f32_16x16x32_bf16 v[132:135], a[4:7], v[60:63], v[132:135]
    ds_read_b128 v[68:71], v22 offset:1024
    v_sub_f32 v10, v8, v40
    v_mfma_f32_16x16x32_bf16 v[132:135], a[0:3], v[52:55], v[132:135]
    ds_read_b128 v[100:103], v23 offset:1024
    v_sub_f32 v18, v8, v14
    v_mfma_f32_16x16x32_bf16 v[140:143], a[8:11], v[52:55], v[140:143]
    v_exp_f32 v10, v10
    v_mfma_f32_16x16x32_bf16 v[140:143], a[12:15], v[60:63], v[140:143]
    ds_read_b128 a[52:55], v4 offset:22528
    ds_read_b128 a[56:59], v4 offset:7168
    ds_read_b128 v[72:75], v22 offset:2048
    v_mfma_f32_16x16x32_bf16 v[136:139], a[12:15], v[56:59], v[136:139]
    ds_read_b128 v[104:107], v23 offset:2048
    ds_read_b128 v[76:79], v22 offset:3072
    ds_read_b128 v[108:111], v23 offset:3072
    v_mfma_f32_16x16x32_bf16 v[136:139], a[8:11], v[48:51], v[136:139]
    s_waitcnt lgkmcnt(15)
    ds_read_b128 a[60:63], v4 offset:23552
    v_exp_f32 v18, v18
    s_nop 0
    v_mul_f32 v38, v38, v10
    v_mfma_f32_16x16x32_bf16 v[144:147], a[16:19], v[48:51], v[144:147]
    buffer_load_dwordx4 a[64:67], v1, s[48:51], s25 offen offset:0 sc1
    buffer_load_dwordx4 a[68:71], v1, s[48:51], s25 offen offset:1024 sc1
    v_mfma_f32_16x16x32_bf16 v[144:147], a[20:23], v[56:59], v[144:147]
    ds_read_b128 a[0:3], v4 offset:8192
    ds_read_b128 v[80:83], v22 offset:4096
    ds_read_b128 v[112:115], v23 offset:4096
    ds_read_b128 v[84:87], v22 offset:5120
    ds_read_b128 v[116:119], v23 offset:5120
    ds_read_b128 v[88:91], v22 offset:6144
    ds_read_b128 v[120:123], v23 offset:6144
    v_fmac_f32 v38, v16, v18
    v_mfma_f32_16x16x32_bf16 v[148:151], a[20:23], v[60:63], v[148:151]
    ds_read_b128 v[92:95], v22 offset:7168
    ds_read_b128 v[124:127], v23 offset:7168
    v_mov_b32 v8, v38
    s_nop 1
    v_mfma_f32_16x16x32_bf16 v[148:151], a[16:19], v[52:55], v[148:151]
    ds_read_b128 a[4:7], v4 offset:24576
    v_permlane16_swap_b32 v38, v8
    s_nop 1
    v_add_f32 v38, v38, v8
    v_mfma_f32_16x16x32_bf16 v[156:159], a[24:27], v[52:55], v[156:159]
    v_mov_b32 v8, v38
    s_nop 1
    v_mfma_f32_16x16x32_bf16 v[156:159], a[28:31], v[60:63], v[156:159]
    ds_read_b128 a[8:11], v4 offset:9216
    v_permlane32_swap_b32 v38, v8
    s_nop 1
    v_mfma_f32_16x16x32_bf16 v[152:155], a[28:31], v[56:59], v[152:155]
    buffer_load_dwordx4 a[72:75], v1, s[48:51], s25 offen offset:2048 sc1
    buffer_load_dwordx4 a[76:79], v1, s[48:51], s25 offen offset:3072 sc1
    v_add_f32 v38, v38, v8
    v_mfma_f32_16x16x32_bf16 v[152:155], a[24:27], v[48:51], v[152:155]
    s_waitcnt lgkmcnt(0)
    ds_read_b128 a[12:15], v4 offset:25600
    v_rcp_f32 v38, v38
    s_nop 0
    v_mfma_f32_16x16x32_bf16 v[160:163], a[32:35], v[48:51], v[160:163]
    v_mul_f32 v38, v38, v32
    v_mul_f32 v10, v10, v38
    v_mfma_f32_16x16x32_bf16 v[160:163], a[36:39], v[56:59], v[160:163]
    s_add_u32 s25, s18, 24576
    ds_read_b128 a[16:19], v4 offset:10240
    v_mul_f32 v18, v18, v38
    v_mov_b32 v11, v10
    v_mfma_f32_16x16x32_bf16 v[164:167], a[36:39], v[60:63], v[164:167]
    v_mov_b32 v19, v18
    v_min_f32 v8, v44, v15
    v_mfma_f32_16x16x32_bf16 v[164:167], a[32:35], v[52:55], v[164:167]
    ds_read_b128 a[20:23], v4 offset:26624
    v_sub_f32 v12, v8, v44
    v_sub_f32 v20, v8, v15
    v_mfma_f32_16x16x32_bf16 v[172:175], a[40:43], v[52:55], v[172:175]
    v_exp_f32 v12, v12
    v_mfma_f32_16x16x32_bf16 v[172:175], a[44:47], v[60:63], v[172:175]
    ds_read_b128 a[24:27], v4 offset:11264
    v_exp_f32 v20, v20
    s_nop 0
    v_mfma_f32_16x16x32_bf16 v[168:171], a[44:47], v[56:59], v[168:171]
    v_mul_f32 v39, v39, v12
    v_fmac_f32 v39, v17, v20
    v_mfma_f32_16x16x32_bf16 v[168:171], a[40:43], v[48:51], v[168:171]
    ds_read_b128 a[28:31], v4 offset:27648
    v_mov_b32 v8, v39
    s_nop 1
    v_mfma_f32_16x16x32_bf16 v[176:179], a[48:51], v[48:51], v[176:179]
    buffer_load_dwordx4 a[80:83], v1, s[48:51], s25 offen offset:0 sc1
    buffer_load_dwordx4 a[84:87], v1, s[48:51], s25 offen offset:1024 sc1
    v_mfma_f32_16x16x32_bf16 v[176:179], a[52:55], v[56:59], v[176:179]
    ds_read_b128 a[32:35], v4 offset:12288
    v_permlane16_swap_b32 v39, v8
    s_nop 1
    v_add_f32 v39, v39, v8
    v_mfma_f32_16x16x32_bf16 v[180:183], a[52:55], v[60:63], v[180:183]
    v_mov_b32 v8, v39
    s_nop 1
    v_mfma_f32_16x16x32_bf16 v[180:183], a[48:51], v[52:55], v[180:183]
    ds_read_b128 a[36:39], v4 offset:28672
    v_permlane32_swap_b32 v39, v8
    s_nop 1
    v_mfma_f32_16x16x32_bf16 v[188:191], a[56:59], v[52:55], v[188:191]
    buffer_load_dwordx4 a[88:91], v1, s[48:51], s25 offen offset:2048 sc1
    v_add_f32 v39, v39, v8
    v_mfma_f32_16x16x32_bf16 v[188:191], a[60:63], v[60:63], v[188:191]
    ds_read_b128 a[40:43], v4 offset:13312
    v_rcp_f32 v39, v39
    s_nop 0
    v_mfma_f32_16x16x32_bf16 v[184:187], a[60:63], v[56:59], v[184:187]
    buffer_load_dwordx4 a[92:95], v1, s[48:51], s25 offen offset:3072 sc1
    v_mul_f32 v39, v39, v33
    v_mul_f32 v12, v12, v39
    v_mfma_f32_16x16x32_bf16 v[184:187], a[56:59], v[48:51], v[184:187]
    ds_read_b128 a[44:47], v4 offset:29696
    v_mul_f32 v20, v20, v39
    v_mov_b32 v13, v12
    v_mfma_f32_16x16x32_bf16 v[192:195], a[0:3], v[48:51], v[192:195]
    v_mov_b32 v21, v20
    v_lshlrev_b32 v8, 16, v64
    v_mfma_f32_16x16x32_bf16 v[192:195], a[4:7], v[56:59], v[192:195]
    s_add_u32 s25, s18, 28672
    ds_read_b128 a[48:51], v4 offset:14336
    v_and_b32 v9, s84, v64
    v_pk_mul_f32 v[128:129], v[128:129], v[10:11]
    v_mfma_f32_16x16x32_bf16 v[196:199], a[4:7], v[60:63], v[196:199]
    v_pk_fma_f32 v[128:129], v[8:9], v[18:19], v[128:129]
    v_lshlrev_b32 v14, 16, v65
    v_mfma_f32_16x16x32_bf16 v[196:199], a[0:3], v[52:55], v[196:199]
    s_waitcnt lgkmcnt(9)
    ds_read_b128 a[52:55], v4 offset:30720
    v_and_b32 v15, s84, v65
    v_pk_mul_f32 v[130:131], v[130:131], v[10:11]
    v_mfma_f32_16x16x32_bf16 v[204:207], a[8:11], v[52:55], v[204:207]
    buffer_load_dwordx4 a[96:99], v1, s[48:51], s25 offen offset:0 sc1
    v_pk_fma_f32 v[130:131], v[14:15], v[18:19], v[130:131]
    v_lshlrev_b32 v8, 16, v66
    v_mfma_f32_16x16x32_bf16 v[204:207], a[12:15], v[60:63], v[204:207]
    ds_read_b128 a[56:59], v4 offset:15360
    v_and_b32 v9, s84, v66
    v_pk_mul_f32 v[136:137], v[136:137], v[10:11]
    v_mfma_f32_16x16x32_bf16 v[200:203], a[12:15], v[56:59], v[200:203]
    v_pk_fma_f32 v[136:137], v[8:9], v[18:19], v[136:137]
    v_lshlrev_b32 v14, 16, v67
    v_mfma_f32_16x16x32_bf16 v[200:203], a[8:11], v[48:51], v[200:203]
    s_waitcnt lgkmcnt(7)
    ds_read_b128 a[60:63], v4 offset:31744
    v_and_b32 v15, s84, v67
    v_pk_mul_f32 v[138:139], v[138:139], v[10:11]
    v_mfma_f32_16x16x32_bf16 v[208:211], a[16:19], v[48:51], v[208:211]
    buffer_load_dwordx4 a[100:103], v1, s[48:51], s25 offen offset:1024 sc1
    v_pk_fma_f32 v[138:139], v[14:15], v[18:19], v[138:139]
    v_cvt_pk_bf16_f32 v128, v128, v129
    v_mfma_f32_16x16x32_bf16 v[208:211], a[20:23], v[56:59], v[208:211]
    v_cvt_pk_bf16_f32 v129, v130, v131
    v_cvt_pk_bf16_f32 v130, v136, v137
    v_mfma_f32_16x16x32_bf16 v[212:215], a[20:23], v[60:63], v[212:215]
    v_cvt_pk_bf16_f32 v131, v138, v139
    s_add_u32 s82, s81, 0
    v_mfma_f32_16x16x32_bf16 v[212:215], a[16:19], v[52:55], v[212:215]
    buffer_store_dwordx4 v[128:131], v1, s[48:51], s82 offen offset:0 sc1
    buffer_load_dwordx4 a[104:107], v1, s[48:51], s25 offen offset:2048 sc1
    v_mfma_f32_16x16x32_bf16 v[220:223], a[24:27], v[52:55], v[220:223]
    v_lshlrev_b32 v8, 16, v96
    v_and_b32 v9, s84, v96
    v_mfma_f32_16x16x32_bf16 v[220:223], a[28:31], v[60:63], v[220:223]
    v_pk_mul_f32 v[132:133], v[132:133], v[12:13]
    v_pk_fma_f32 v[132:133], v[8:9], v[20:21], v[132:133]
    v_mfma_f32_16x16x32_bf16 v[216:219], a[28:31], v[56:59], v[216:219]
    buffer_load_dwordx4 a[108:111], v1, s[48:51], s25 offen offset:3072 sc1
    v_lshlrev_b32 v14, 16, v97
    v_and_b32 v15, s84, v97
    v_mfma_f32_16x16x32_bf16 v[216:219], a[24:27], v[48:51], v[216:219]
    s_waitcnt lgkmcnt(4)
    v_pk_mul_f32 v[134:135], v[134:135], v[12:13]
    v_pk_fma_f32 v[134:135], v[14:15], v[20:21], v[134:135]
    v_mfma_f32_16x16x32_bf16 v[224:227], a[32:35], v[48:51], v[224:227]
    v_lshlrev_b32 v8, 16, v98
    v_and_b32 v9, s84, v98
    v_mfma_f32_16x16x32_bf16 v[224:227], a[36:39], v[56:59], v[224:227]
    s_add_u32 s25, s18, 32768
    v_pk_mul_f32 v[140:141], v[140:141], v[12:13]
    v_pk_fma_f32 v[140:141], v[8:9], v[20:21], v[140:141]
    v_mfma_f32_16x16x32_bf16 v[228:231], a[36:39], v[60:63], v[228:231]
    v_lshlrev_b32 v14, 16, v99
    v_and_b32 v15, s84, v99
    v_mfma_f32_16x16x32_bf16 v[228:231], a[32:35], v[52:55], v[228:231]
    v_pk_mul_f32 v[142:143], v[142:143], v[12:13]
    v_pk_fma_f32 v[142:143], v[14:15], v[20:21], v[142:143]
    v_mfma_f32_16x16x32_bf16 v[236:239], a[40:43], v[52:55], v[236:239]
    buffer_load_dwordx4 a[112:115], v1, s[48:51], s25 offen offset:0 sc1
    v_cvt_pk_bf16_f32 v132, v132, v133
    v_cvt_pk_bf16_f32 v133, v134, v135
    v_mfma_f32_16x16x32_bf16 v[236:239], a[44:47], v[60:63], v[236:239]
    v_cvt_pk_bf16_f32 v134, v140, v141
    v_cvt_pk_bf16_f32 v135, v142, v143
    v_mfma_f32_16x16x32_bf16 v[232:235], a[44:47], v[56:59], v[232:235]
    buffer_store_dwordx4 v[132:135], v1, s[48:51], s82 offen offset:1024 sc1
    v_mfma_f32_16x16x32_bf16 v[232:235], a[40:43], v[48:51], v[232:235]
    s_waitcnt lgkmcnt(0)
    v_lshlrev_b32 v8, 16, v68
    v_and_b32 v9, s84, v68
    v_mfma_f32_16x16x32_bf16 v[240:243], a[48:51], v[48:51], v[240:243]
    buffer_load_dwordx4 a[116:119], v1, s[48:51], s25 offen offset:1024 sc1
    v_pk_mul_f32 v[144:145], v[144:145], v[10:11]
    v_pk_fma_f32 v[144:145], v[8:9], v[18:19], v[144:145]
    v_mfma_f32_16x16x32_bf16 v[240:243], a[52:55], v[56:59], v[240:243]
    v_lshlrev_b32 v14, 16, v69
    v_and_b32 v15, s84, v69
    v_mfma_f32_16x16x32_bf16 v[244:247], a[52:55], v[60:63], v[244:247]
    v_pk_mul_f32 v[146:147], v[146:147], v[10:11]
    v_pk_fma_f32 v[146:147], v[14:15], v[18:19], v[146:147]
    v_mfma_f32_16x16x32_bf16 v[244:247], a[48:51], v[52:55], v[244:247]
    buffer_load_dwordx4 a[120:123], v1, s[48:51], s25 offen offset:2048 sc1
    v_lshlrev_b32 v8, 16, v70
    v_and_b32 v9, s84, v70
    v_mfma_f32_16x16x32_bf16 v[252:255], a[56:59], v[52:55], v[252:255]
    v_pk_mul_f32 v[152:153], v[152:153], v[10:11]
    v_pk_fma_f32 v[152:153], v[8:9], v[18:19], v[152:153]
    v_mfma_f32_16x16x32_bf16 v[252:255], a[60:63], v[60:63], v[252:255]
    v_lshlrev_b32 v14, 16, v71
    v_and_b32 v15, s84, v71
    v_mfma_f32_16x16x32_bf16 v[248:251], a[60:63], v[56:59], v[248:251]
    buffer_load_dwordx4 a[124:127], v1, s[48:51], s25 offen offset:3072 sc1
    v_pk_mul_f32 v[154:155], v[154:155], v[10:11]
    v_pk_fma_f32 v[154:155], v[14:15], v[18:19], v[154:155]
    v_mfma_f32_16x16x32_bf16 v[248:251], a[56:59], v[48:51], v[248:251]
    v_cvt_pk_bf16_f32 v144, v144, v145
    v_cvt_pk_bf16_f32 v145, v146, v147
    v_cvt_pk_bf16_f32 v146, v152, v153
    v_cvt_pk_bf16_f32 v147, v154, v155
    s_add_u32 s82, s81, 4096
    buffer_store_dwordx4 v[144:147], v1, s[48:51], s82 offen offset:0 sc1
    v_lshlrev_b32 v8, 16, v100
    v_and_b32 v9, s84, v100
    s_nop 7
    v_pk_mul_f32 v[148:149], v[148:149], v[12:13]
    v_pk_fma_f32 v[148:149], v[8:9], v[20:21], v[148:149]
    v_lshlrev_b32 v14, 16, v101
    v_and_b32 v15, s84, v101
    v_pk_mul_f32 v[150:151], v[150:151], v[12:13]
    v_pk_fma_f32 v[150:151], v[14:15], v[20:21], v[150:151]
    v_lshlrev_b32 v8, 16, v102
    v_and_b32 v9, s84, v102
    v_pk_mul_f32 v[156:157], v[156:157], v[12:13]
    v_pk_fma_f32 v[156:157], v[8:9], v[20:21], v[156:157]
    v_lshlrev_b32 v14, 16, v103
    v_and_b32 v15, s84, v103
    v_pk_mul_f32 v[158:159], v[158:159], v[12:13]
    v_pk_fma_f32 v[158:159], v[14:15], v[20:21], v[158:159]
    v_cvt_pk_bf16_f32 v148, v148, v149
    v_cvt_pk_bf16_f32 v149, v150, v151
    v_cvt_pk_bf16_f32 v150, v156, v157
    v_cvt_pk_bf16_f32 v151, v158, v159
    buffer_store_dwordx4 v[148:151], v1, s[48:51], s82 offen offset:1024 sc1
    v_lshlrev_b32 v8, 16, v72
    v_and_b32 v9, s84, v72
    v_pk_mul_f32 v[160:161], v[160:161], v[10:11]
    v_pk_fma_f32 v[160:161], v[8:9], v[18:19], v[160:161]
    v_lshlrev_b32 v14, 16, v73
    v_and_b32 v15, s84, v73
    v_pk_mul_f32 v[162:163], v[162:163], v[10:11]
    v_pk_fma_f32 v[162:163], v[14:15], v[18:19], v[162:163]
    v_lshlrev_b32 v8, 16, v74
    v_and_b32 v9, s84, v74
    v_pk_mul_f32 v[168:169], v[168:169], v[10:11]
    v_pk_fma_f32 v[168:169], v[8:9], v[18:19], v[168:169]
    v_lshlrev_b32 v14, 16, v75
    v_and_b32 v15, s84, v75
    v_pk_mul_f32 v[170:171], v[170:171], v[10:11]
    v_pk_fma_f32 v[170:171], v[14:15], v[18:19], v[170:171]
    v_cvt_pk_bf16_f32 v160, v160, v161
    v_cvt_pk_bf16_f32 v161, v162, v163
    v_cvt_pk_bf16_f32 v162, v168, v169
    v_cvt_pk_bf16_f32 v163, v170, v171
    s_add_u32 s82, s81, 8192
    buffer_store_dwordx4 v[160:163], v1, s[48:51], s82 offen offset:0 sc1
    v_lshlrev_b32 v8, 16, v104
    v_and_b32 v9, s84, v104
    v_pk_mul_f32 v[164:165], v[164:165], v[12:13]
    v_pk_fma_f32 v[164:165], v[8:9], v[20:21], v[164:165]
    v_lshlrev_b32 v14, 16, v105
    v_and_b32 v15, s84, v105
    v_pk_mul_f32 v[166:167], v[166:167], v[12:13]
    v_pk_fma_f32 v[166:167], v[14:15], v[20:21], v[166:167]
    v_lshlrev_b32 v8, 16, v106
    v_and_b32 v9, s84, v106
    v_pk_mul_f32 v[172:173], v[172:173], v[12:13]
    v_pk_fma_f32 v[172:173], v[8:9], v[20:21], v[172:173]
    v_lshlrev_b32 v14, 16, v107
    v_and_b32 v15, s84, v107
    v_pk_mul_f32 v[174:175], v[174:175], v[12:13]
    v_pk_fma_f32 v[174:175], v[14:15], v[20:21], v[174:175]
    v_cvt_pk_bf16_f32 v164, v164, v165
    v_cvt_pk_bf16_f32 v165, v166, v167
    v_cvt_pk_bf16_f32 v166, v172, v173
    v_cvt_pk_bf16_f32 v167, v174, v175
    buffer_store_dwordx4 v[164:167], v1, s[48:51], s82 offen offset:1024 sc1
    v_lshlrev_b32 v8, 16, v76
    v_and_b32 v9, s84, v76
    v_pk_mul_f32 v[176:177], v[176:177], v[10:11]
    v_pk_fma_f32 v[176:177], v[8:9], v[18:19], v[176:177]
    v_lshlrev_b32 v14, 16, v77
    v_and_b32 v15, s84, v77
    v_pk_mul_f32 v[178:179], v[178:179], v[10:11]
    v_pk_fma_f32 v[178:179], v[14:15], v[18:19], v[178:179]
    v_lshlrev_b32 v8, 16, v78
    v_and_b32 v9, s84, v78
    v_pk_mul_f32 v[184:185], v[184:185], v[10:11]
    v_pk_fma_f32 v[184:185], v[8:9], v[18:19], v[184:185]
    v_lshlrev_b32 v14, 16, v79
    v_and_b32 v15, s84, v79
    v_pk_mul_f32 v[186:187], v[186:187], v[10:11]
    v_pk_fma_f32 v[186:187], v[14:15], v[18:19], v[186:187]
    v_cvt_pk_bf16_f32 v176, v176, v177
    v_cvt_pk_bf16_f32 v177, v178, v179
    v_cvt_pk_bf16_f32 v178, v184, v185
    v_cvt_pk_bf16_f32 v179, v186, v187
    s_add_u32 s82, s81, 12288
    buffer_store_dwordx4 v[176:179], v1, s[48:51], s82 offen offset:0 sc1
    v_lshlrev_b32 v8, 16, v108
    v_and_b32 v9, s84, v108
    v_pk_mul_f32 v[180:181], v[180:181], v[12:13]
    v_pk_fma_f32 v[180:181], v[8:9], v[20:21], v[180:181]
    v_lshlrev_b32 v14, 16, v109
    v_and_b32 v15, s84, v109
    v_pk_mul_f32 v[182:183], v[182:183], v[12:13]
    v_pk_fma_f32 v[182:183], v[14:15], v[20:21], v[182:183]
    v_lshlrev_b32 v8, 16, v110
    v_and_b32 v9, s84, v110
    v_pk_mul_f32 v[188:189], v[188:189], v[12:13]
    v_pk_fma_f32 v[188:189], v[8:9], v[20:21], v[188:189]
    v_lshlrev_b32 v14, 16, v111
    v_and_b32 v15, s84, v111
    v_pk_mul_f32 v[190:191], v[190:191], v[12:13]
    v_pk_fma_f32 v[190:191], v[14:15], v[20:21], v[190:191]
    v_cvt_pk_bf16_f32 v180, v180, v181
    v_cvt_pk_bf16_f32 v181, v182, v183
    v_cvt_pk_bf16_f32 v182, v188, v189
    v_cvt_pk_bf16_f32 v183, v190, v191
    buffer_store_dwordx4 v[180:183], v1, s[48:51], s82 offen offset:1024 sc1
    v_lshlrev_b32 v8, 16, v80
    v_and_b32 v9, s84, v80
    v_pk_mul_f32 v[192:193], v[192:193], v[10:11]
    v_pk_fma_f32 v[192:193], v[8:9], v[18:19], v[192:193]
    v_lshlrev_b32 v14, 16, v81
    v_and_b32 v15, s84, v81
    v_pk_mul_f32 v[194:195], v[194:195], v[10:11]
    v_pk_fma_f32 v[194:195], v[14:15], v[18:19], v[194:195]
    v_lshlrev_b32 v8, 16, v82
    v_and_b32 v9, s84, v82
    v_pk_mul_f32 v[200:201], v[200:201], v[10:11]
    v_pk_fma_f32 v[200:201], v[8:9], v[18:19], v[200:201]
    v_lshlrev_b32 v14, 16, v83
    v_and_b32 v15, s84, v83
    v_pk_mul_f32 v[202:203], v[202:203], v[10:11]
    v_pk_fma_f32 v[202:203], v[14:15], v[18:19], v[202:203]
    v_cvt_pk_bf16_f32 v192, v192, v193
    v_cvt_pk_bf16_f32 v193, v194, v195
    v_cvt_pk_bf16_f32 v194, v200, v201
    v_cvt_pk_bf16_f32 v195, v202, v203
    s_add_u32 s82, s81, 16384
    buffer_store_dwordx4 v[192:195], v1, s[48:51], s82 offen offset:0 sc1
    v_lshlrev_b32 v8, 16, v112
    v_and_b32 v9, s84, v112
    v_pk_mul_f32 v[196:197], v[196:197], v[12:13]
    v_pk_fma_f32 v[196:197], v[8:9], v[20:21], v[196:197]
    v_lshlrev_b32 v14, 16, v113
    v_and_b32 v15, s84, v113
    v_pk_mul_f32 v[198:199], v[198:199], v[12:13]
    v_pk_fma_f32 v[198:199], v[14:15], v[20:21], v[198:199]
    v_lshlrev_b32 v8, 16, v114
    v_and_b32 v9, s84, v114
    v_pk_mul_f32 v[204:205], v[204:205], v[12:13]
    v_pk_fma_f32 v[204:205], v[8:9], v[20:21], v[204:205]
    v_lshlrev_b32 v14, 16, v115
    v_and_b32 v15, s84, v115
    v_pk_mul_f32 v[206:207], v[206:207], v[12:13]
    v_pk_fma_f32 v[206:207], v[14:15], v[20:21], v[206:207]
    v_cvt_pk_bf16_f32 v196, v196, v197
    v_cvt_pk_bf16_f32 v197, v198, v199
    v_cvt_pk_bf16_f32 v198, v204, v205
    v_cvt_pk_bf16_f32 v199, v206, v207
    buffer_store_dwordx4 v[196:199], v1, s[48:51], s82 offen offset:1024 sc1
    v_lshlrev_b32 v8, 16, v84
    v_and_b32 v9, s84, v84
    v_pk_mul_f32 v[208:209], v[208:209], v[10:11]
    v_pk_fma_f32 v[208:209], v[8:9], v[18:19], v[208:209]
    v_lshlrev_b32 v14, 16, v85
    v_and_b32 v15, s84, v85
    v_pk_mul_f32 v[210:211], v[210:211], v[10:11]
    v_pk_fma_f32 v[210:211], v[14:15], v[18:19], v[210:211]
    v_lshlrev_b32 v8, 16, v86
    v_and_b32 v9, s84, v86
    v_pk_mul_f32 v[216:217], v[216:217], v[10:11]
    v_pk_fma_f32 v[216:217], v[8:9], v[18:19], v[216:217]
    v_lshlrev_b32 v14, 16, v87
    v_and_b32 v15, s84, v87
    v_pk_mul_f32 v[218:219], v[218:219], v[10:11]
    v_pk_fma_f32 v[218:219], v[14:15], v[18:19], v[218:219]
    v_cvt_pk_bf16_f32 v208, v208, v209
    v_cvt_pk_bf16_f32 v209, v210, v211
    v_cvt_pk_bf16_f32 v210, v216, v217
    v_cvt_pk_bf16_f32 v211, v218, v219
    s_add_u32 s82, s81, 20480
    buffer_store_dwordx4 v[208:211], v1, s[48:51], s82 offen offset:0 sc1
    v_lshlrev_b32 v8, 16, v116
    v_and_b32 v9, s84, v116
    v_pk_mul_f32 v[212:213], v[212:213], v[12:13]
    v_pk_fma_f32 v[212:213], v[8:9], v[20:21], v[212:213]
    v_lshlrev_b32 v14, 16, v117
    v_and_b32 v15, s84, v117
    v_pk_mul_f32 v[214:215], v[214:215], v[12:13]
    v_pk_fma_f32 v[214:215], v[14:15], v[20:21], v[214:215]
    v_lshlrev_b32 v8, 16, v118
    v_and_b32 v9, s84, v118
    v_pk_mul_f32 v[220:221], v[220:221], v[12:13]
    v_pk_fma_f32 v[220:221], v[8:9], v[20:21], v[220:221]
    v_lshlrev_b32 v14, 16, v119
    v_and_b32 v15, s84, v119
    v_pk_mul_f32 v[222:223], v[222:223], v[12:13]
    v_pk_fma_f32 v[222:223], v[14:15], v[20:21], v[222:223]
    v_cvt_pk_bf16_f32 v212, v212, v213
    v_cvt_pk_bf16_f32 v213, v214, v215
    v_cvt_pk_bf16_f32 v214, v220, v221
    v_cvt_pk_bf16_f32 v215, v222, v223
    buffer_store_dwordx4 v[212:215], v1, s[48:51], s82 offen offset:1024 sc1
    v_lshlrev_b32 v8, 16, v88
    v_and_b32 v9, s84, v88
    v_pk_mul_f32 v[224:225], v[224:225], v[10:11]
    v_pk_fma_f32 v[224:225], v[8:9], v[18:19], v[224:225]
    v_lshlrev_b32 v14, 16, v89
    v_and_b32 v15, s84, v89
    v_pk_mul_f32 v[226:227], v[226:227], v[10:11]
    v_pk_fma_f32 v[226:227], v[14:15], v[18:19], v[226:227]
    v_lshlrev_b32 v8, 16, v90
    v_and_b32 v9, s84, v90
    v_pk_mul_f32 v[232:233], v[232:233], v[10:11]
    v_pk_fma_f32 v[232:233], v[8:9], v[18:19], v[232:233]
    v_lshlrev_b32 v14, 16, v91
    v_and_b32 v15, s84, v91
    v_pk_mul_f32 v[234:235], v[234:235], v[10:11]
    v_pk_fma_f32 v[234:235], v[14:15], v[18:19], v[234:235]
    v_cvt_pk_bf16_f32 v224, v224, v225
    v_cvt_pk_bf16_f32 v225, v226, v227
    v_cvt_pk_bf16_f32 v226, v232, v233
    v_cvt_pk_bf16_f32 v227, v234, v235
    s_add_u32 s82, s81, 24576
    buffer_store_dwordx4 v[224:227], v1, s[48:51], s82 offen offset:0 sc1
    v_lshlrev_b32 v8, 16, v120
    v_and_b32 v9, s84, v120
    v_pk_mul_f32 v[228:229], v[228:229], v[12:13]
    v_pk_fma_f32 v[228:229], v[8:9], v[20:21], v[228:229]
    v_lshlrev_b32 v14, 16, v121
    v_and_b32 v15, s84, v121
    v_pk_mul_f32 v[230:231], v[230:231], v[12:13]
    v_pk_fma_f32 v[230:231], v[14:15], v[20:21], v[230:231]
    v_lshlrev_b32 v8, 16, v122
    v_and_b32 v9, s84, v122
    v_pk_mul_f32 v[236:237], v[236:237], v[12:13]
    v_pk_fma_f32 v[236:237], v[8:9], v[20:21], v[236:237]
    v_lshlrev_b32 v14, 16, v123
    v_and_b32 v15, s84, v123
    v_pk_mul_f32 v[238:239], v[238:239], v[12:13]
    v_pk_fma_f32 v[238:239], v[14:15], v[20:21], v[238:239]
    v_cvt_pk_bf16_f32 v228, v228, v229
    v_cvt_pk_bf16_f32 v229, v230, v231
    v_cvt_pk_bf16_f32 v230, v236, v237
    v_cvt_pk_bf16_f32 v231, v238, v239
    buffer_store_dwordx4 v[228:231], v1, s[48:51], s82 offen offset:1024 sc1
    v_lshlrev_b32 v8, 16, v92
    v_and_b32 v9, s84, v92
    v_pk_mul_f32 v[240:241], v[240:241], v[10:11]
    v_pk_fma_f32 v[240:241], v[8:9], v[18:19], v[240:241]
    v_lshlrev_b32 v14, 16, v93
    v_and_b32 v15, s84, v93
    v_pk_mul_f32 v[242:243], v[242:243], v[10:11]
    v_pk_fma_f32 v[242:243], v[14:15], v[18:19], v[242:243]
    v_lshlrev_b32 v8, 16, v94
    v_and_b32 v9, s84, v94
    v_pk_mul_f32 v[248:249], v[248:249], v[10:11]
    v_pk_fma_f32 v[248:249], v[8:9], v[18:19], v[248:249]
    v_lshlrev_b32 v14, 16, v95
    v_and_b32 v15, s84, v95
    v_pk_mul_f32 v[250:251], v[250:251], v[10:11]
    v_pk_fma_f32 v[250:251], v[14:15], v[18:19], v[250:251]
    v_cvt_pk_bf16_f32 v240, v240, v241
    v_cvt_pk_bf16_f32 v241, v242, v243
    v_cvt_pk_bf16_f32 v242, v248, v249
    v_cvt_pk_bf16_f32 v243, v250, v251
    s_add_u32 s82, s81, 28672
    buffer_store_dwordx4 v[240:243], v1, s[48:51], s82 offen offset:0 sc1
    v_lshlrev_b32 v8, 16, v124
    v_and_b32 v9, s84, v124
    v_pk_mul_f32 v[244:245], v[244:245], v[12:13]
    v_pk_fma_f32 v[244:245], v[8:9], v[20:21], v[244:245]
    v_lshlrev_b32 v14, 16, v125
    v_and_b32 v15, s84, v125
    v_pk_mul_f32 v[246:247], v[246:247], v[12:13]
    v_pk_fma_f32 v[246:247], v[14:15], v[20:21], v[246:247]
    v_lshlrev_b32 v8, 16, v126
    v_and_b32 v9, s84, v126
    v_pk_mul_f32 v[252:253], v[252:253], v[12:13]
    v_pk_fma_f32 v[252:253], v[8:9], v[20:21], v[252:253]
    v_lshlrev_b32 v14, 16, v127
    v_and_b32 v15, s84, v127
    v_pk_mul_f32 v[254:255], v[254:255], v[12:13]
    v_pk_fma_f32 v[254:255], v[14:15], v[20:21], v[254:255]
    v_cvt_pk_bf16_f32 v244, v244, v245
    v_cvt_pk_bf16_f32 v245, v246, v247
    v_cvt_pk_bf16_f32 v246, v252, v253
    v_cvt_pk_bf16_f32 v247, v254, v255
    buffer_store_dwordx4 v[244:247], v1, s[48:51], s82 offen offset:1024 sc1
    s_branch F2_bt_37
K2_t0_35:
    s_waitcnt lgkmcnt(8)
    v_mfma_f32_16x16x32_bf16 v[128:131], a[0:3], v[48:51], v[128:131]
    v_mov_b32 v8, v38
    s_nop 1
    v_mfma_f32_16x16x32_bf16 v[128:131], a[4:7], v[56:59], v[128:131]
    s_add_u32 s25, s18, 20480
    ds_read_b128 a[48:51], v4 offset:6144
    v_mfma_f32_16x16x32_bf16 v[132:135], a[4:7], v[60:63], v[132:135]
    v_permlane16_swap_b32 v38, v8
    s_nop 1
    v_mfma_f32_16x16x32_bf16 v[132:135], a[0:3], v[52:55], v[132:135]
    ds_read_b128 a[52:55], v4 offset:22528
    v_add_f32 v38, v38, v8
    v_mfma_f32_16x16x32_bf16 v[140:143], a[8:11], v[52:55], v[140:143]
    v_mov_b32 v8, v38
    s_nop 1
    v_mfma_f32_16x16x32_bf16 v[140:143], a[12:15], v[60:63], v[140:143]
    buffer_load_dwordx4 a[64:67], v1, s[48:51], s25 offen offset:0 sc1
    v_mfma_f32_16x16x32_bf16 v[136:139], a[12:15], v[56:59], v[136:139]
    v_permlane32_swap_b32 v38, v8
    s_nop 1
    v_mfma_f32_16x16x32_bf16 v[136:139], a[8:11], v[48:51], v[136:139]
    s_waitcnt lgkmcnt(6)
    ds_read_b128 a[56:59], v4 offset:7168
    v_add_f32 v38, v38, v8
    v_mfma_f32_16x16x32_bf16 v[144:147], a[16:19], v[48:51], v[144:147]
    v_rcp_f32 v38, v38
    s_nop 0
    v_mfma_f32_16x16x32_bf16 v[144:147], a[20:23], v[56:59], v[144:147]
    ds_read_b128 a[60:63], v4 offset:23552
    ds_read_b128 a[0:3], v4 offset:8192
    v_mul_f32 v38, v38, v32
    v_mfma_f32_16x16x32_bf16 v[148:151], a[20:23], v[60:63], v[148:151]
    v_mov_b32 v10, v38
    v_mov_b32 v11, v38
    v_mfma_f32_16x16x32_bf16 v[148:151], a[16:19], v[52:55], v[148:151]
    ds_read_b128 a[4:7], v4 offset:24576
    buffer_load_dwordx4 a[68:71], v1, s[48:51], s25 offen offset:1024 sc1
    v_mfma_f32_16x16x32_bf16 v[156:159], a[24:27], v[52:55], v[156:159]
    v_mov_b32 v8, v39
    s_nop 1
    v_mfma_f32_16x16x32_bf16 v[156:159], a[28:31], v[60:63], v[156:159]
    ds_read_b128 a[8:11], v4 offset:9216
    v_permlane16_swap_b32 v39, v8
    s_nop 1
    v_mfma_f32_16x16x32_bf16 v[152:155], a[28:31], v[56:59], v[152:155]
    buffer_load_dwordx4 a[72:75], v1, s[48:51], s25 offen offset:2048 sc1
    v_add_f32 v39, v39, v8
    v_mfma_f32_16x16x32_bf16 v[152:155], a[24:27], v[48:51], v[152:155]
    s_waitcnt lgkmcnt(7)
    ds_read_b128 a[12:15], v4 offset:25600
    v_mov_b32 v8, v39
    s_nop 1
    v_mfma_f32_16x16x32_bf16 v[160:163], a[32:35], v[48:51], v[160:163]
    v_permlane32_swap_b32 v39, v8
    s_nop 1
    v_mfma_f32_16x16x32_bf16 v[160:163], a[36:39], v[56:59], v[160:163]
    ds_read_b128 a[16:19], v4 offset:10240
    buffer_load_dwordx4 a[76:79], v1, s[48:51], s25 offen offset:3072 sc1
    v_add_f32 v39, v39, v8
    v_mfma_f32_16x16x32_bf16 v[164:167], a[36:39], v[60:63], v[164:167]
    s_add_u32 s25, s18, 24576
    v_rcp_f32 v39, v39
    s_nop 0
    v_mfma_f32_16x16x32_bf16 v[164:167], a[32:35], v[52:55], v[164:167]
    ds_read_b128 a[20:23], v4 offset:26624
    v_mul_f32 v39, v39, v33
    v_mov_b32 v12, v39
    v_mfma_f32_16x16x32_bf16 v[172:175], a[40:43], v[52:55], v[172:175]
    v_mov_b32 v13, v39
    v_pk_mul_f32 v[128:129], v[128:129], v[10:11]
    v_mfma_f32_16x16x32_bf16 v[172:175], a[44:47], v[60:63], v[172:175]
    ds_read_b128 a[24:27], v4 offset:11264
    v_pk_mul_f32 v[130:131], v[130:131], v[10:11]
    v_pk_mul_f32 v[136:137], v[136:137], v[10:11]
    v_mfma_f32_16x16x32_bf16 v[168:171], a[44:47], v[56:59], v[168:171]
    v_pk_mul_f32 v[138:139], v[138:139], v[10:11]
    v_cvt_pk_bf16_f32 v128, v128, v129
    v_mfma_f32_16x16x32_bf16 v[168:171], a[40:43], v[48:51], v[168:171]
    s_waitcnt lgkmcnt(7)
    ds_read_b128 a[28:31], v4 offset:27648
    v_cvt_pk_bf16_f32 v129, v130, v131
    v_cvt_pk_bf16_f32 v130, v136, v137
    v_mfma_f32_16x16x32_bf16 v[176:179], a[48:51], v[48:51], v[176:179]
    buffer_load_dwordx4 a[80:83], v1, s[48:51], s25 offen offset:0 sc1
    buffer_load_dwordx4 a[84:87], v1, s[48:51], s25 offen offset:1024 sc1
    v_cvt_pk_bf16_f32 v131, v138, v139
    s_add_u32 s82, s81, 0
    v_mfma_f32_16x16x32_bf16 v[176:179], a[52:55], v[56:59], v[176:179]
    ds_read_b128 a[32:35], v4 offset:12288
    buffer_store_dwordx4 v[128:131], v1, s[48:51], s82 offen offset:0 sc1
    v_mfma_f32_16x16x32_bf16 v[180:183], a[52:55], v[60:63], v[180:183]
    v_pk_mul_f32 v[132:133], v[132:133], v[12:13]
    v_pk_mul_f32 v[134:135], v[134:135], v[12:13]
    v_mfma_f32_16x16x32_bf16 v[180:183], a[48:51], v[52:55], v[180:183]
    ds_read_b128 a[36:39], v4 offset:28672
    buffer_load_dwordx4 a[88:91], v1, s[48:51], s25 offen offset:2048 sc1
    v_pk_mul_f32 v[140:141], v[140:141], v[12:13]
    v_pk_mul_f32 v[142:143], v[142:143], v[12:13]
    v_mfma_f32_16x16x32_bf16 v[188:191], a[56:59], v[52:55], v[188:191]
    v_cvt_pk_bf16_f32 v132, v132, v133
    v_cvt_pk_bf16_f32 v133, v134, v135
    v_mfma_f32_16x16x32_bf16 v[188:191], a[60:63], v[60:63], v[188:191]
    ds_read_b128 a[40:43], v4 offset:13312
    v_cvt_pk_bf16_f32 v134, v140, v141
    v_cvt_pk_bf16_f32 v135, v142, v143
    v_mfma_f32_16x16x32_bf16 v[184:187], a[60:63], v[56:59], v[184:187]
    buffer_store_dwordx4 v[132:135], v1, s[48:51], s82 offen offset:1024 sc1
    buffer_load_dwordx4 a[92:95], v1, s[48:51], s25 offen offset:3072 sc1
    v_mfma_f32_16x16x32_bf16 v[184:187], a[56:59], v[48:51], v[184:187]
    s_waitcnt lgkmcnt(7)
    ds_read_b128 a[44:47], v4 offset:29696
    v_pk_mul_f32 v[144:145], v[144:145], v[10:11]
    v_pk_mul_f32 v[146:147], v[146:147], v[10:11]
    v_mfma_f32_16x16x32_bf16 v[192:195], a[0:3], v[48:51], v[192:195]
    v_pk_mul_f32 v[152:153], v[152:153], v[10:11]
    v_pk_mul_f32 v[154:155], v[154:155], v[10:11]
    v_mfma_f32_16x16x32_bf16 v[192:195], a[4:7], v[56:59], v[192:195]
    s_add_u32 s25, s18, 28672
    v_cvt_pk_bf16_f32 v144, v144, v145
    v_cvt_pk_bf16_f32 v145, v146, v147
    v_mfma_f32_16x16x32_bf16 v[196:199], a[4:7], v[60:63], v[196:199]
    v_cvt_pk_bf16_f32 v146, v152, v153
    v_cvt_pk_bf16_f32 v147, v154, v155
    v_mfma_f32_16x16x32_bf16 v[196:199], a[0:3], v[52:55], v[196:199]
    s_add_u32 s82, s81, 4096
    ds_read_b128 a[48:51], v4 offset:14336
    ds_read_b128 a[52:55], v4 offset:30720
    v_mfma_f32_16x16x32_bf16 v[204:207], a[8:11], v[52:55], v[204:207]
    buffer_store_dwordx4 v[144:147], v1, s[48:51], s82 offen offset:0 sc1
    v_pk_mul_f32 v[148:149], v[148:149], v[12:13]
    v_mfma_f32_16x16x32_bf16 v[204:207], a[12:15], v[60:63], v[204:207]
    ds_read_b128 a[56:59], v4 offset:15360
    v_pk_mul_f32 v[150:151], v[150:151], v[12:13]
    v_pk_mul_f32 v[156:157], v[156:157], v[12:13]
    v_mfma_f32_16x16x32_bf16 v[200:203], a[12:15], v[56:59], v[200:203]
    v_pk_mul_f32 v[158:159], v[158:159], v[12:13]
    v_cvt_pk_bf16_f32 v148, v148, v149
    v_mfma_f32_16x16x32_bf16 v[200:203], a[8:11], v[48:51], v[200:203]
    s_waitcnt lgkmcnt(7)
    ds_read_b128 a[60:63], v4 offset:31744
    v_cvt_pk_bf16_f32 v149, v150, v151
    v_cvt_pk_bf16_f32 v150, v156, v157
    v_mfma_f32_16x16x32_bf16 v[208:211], a[16:19], v[48:51], v[208:211]
    buffer_load_dwordx4 a[96:99], v1, s[48:51], s25 offen offset:0 sc1
    buffer_load_dwordx4 a[100:103], v1, s[48:51], s25 offen offset:1024 sc1
    v_cvt_pk_bf16_f32 v151, v158, v159
    v_mfma_f32_16x16x32_bf16 v[208:211], a[20:23], v[56:59], v[208:211]
    buffer_store_dwordx4 v[148:151], v1, s[48:51], s82 offen offset:1024 sc1
    v_pk_mul_f32 v[160:161], v[160:161], v[10:11]
    v_mfma_f32_16x16x32_bf16 v[212:215], a[20:23], v[60:63], v[212:215]
    v_pk_mul_f32 v[162:163], v[162:163], v[10:11]
    v_pk_mul_f32 v[168:169], v[168:169], v[10:11]
    v_mfma_f32_16x16x32_bf16 v[212:215], a[16:19], v[52:55], v[212:215]
    buffer_load_dwordx4 a[104:107], v1, s[48:51], s25 offen offset:2048 sc1
    v_pk_mul_f32 v[170:171], v[170:171], v[10:11]
    v_cvt_pk_bf16_f32 v160, v160, v161
    v_mfma_f32_16x16x32_bf16 v[220:223], a[24:27], v[52:55], v[220:223]
    v_cvt_pk_bf16_f32 v161, v162, v163
    v_cvt_pk_bf16_f32 v162, v168, v169
    v_mfma_f32_16x16x32_bf16 v[220:223], a[28:31], v[60:63], v[220:223]
    v_cvt_pk_bf16_f32 v163, v170, v171
    s_add_u32 s82, s81, 8192
    v_mfma_f32_16x16x32_bf16 v[216:219], a[28:31], v[56:59], v[216:219]
    buffer_store_dwordx4 v[160:163], v1, s[48:51], s82 offen offset:0 sc1
    buffer_load_dwordx4 a[108:111], v1, s[48:51], s25 offen offset:3072 sc1
    v_mfma_f32_16x16x32_bf16 v[216:219], a[24:27], v[48:51], v[216:219]
    s_waitcnt lgkmcnt(4)
    v_pk_mul_f32 v[164:165], v[164:165], v[12:13]
    v_pk_mul_f32 v[166:167], v[166:167], v[12:13]
    v_mfma_f32_16x16x32_bf16 v[224:227], a[32:35], v[48:51], v[224:227]
    v_pk_mul_f32 v[172:173], v[172:173], v[12:13]
    v_pk_mul_f32 v[174:175], v[174:175], v[12:13]
    v_mfma_f32_16x16x32_bf16 v[224:227], a[36:39], v[56:59], v[224:227]
    s_add_u32 s25, s18, 32768
    v_cvt_pk_bf16_f32 v164, v164, v165
    v_cvt_pk_bf16_f32 v165, v166, v167
    v_mfma_f32_16x16x32_bf16 v[228:231], a[36:39], v[60:63], v[228:231]
    v_cvt_pk_bf16_f32 v166, v172, v173
    v_cvt_pk_bf16_f32 v167, v174, v175
    v_mfma_f32_16x16x32_bf16 v[228:231], a[32:35], v[52:55], v[228:231]
    buffer_store_dwordx4 v[164:167], v1, s[48:51], s82 offen offset:1024 sc1
    v_mfma_f32_16x16x32_bf16 v[236:239], a[40:43], v[52:55], v[236:239]
    v_pk_mul_f32 v[176:177], v[176:177], v[10:11]
    v_pk_mul_f32 v[178:179], v[178:179], v[10:11]
    v_mfma_f32_16x16x32_bf16 v[236:239], a[44:47], v[60:63], v[236:239]
    v_pk_mul_f32 v[184:185], v[184:185], v[10:11]
    v_pk_mul_f32 v[186:187], v[186:187], v[10:11]
    v_mfma_f32_16x16x32_bf16 v[232:235], a[44:47], v[56:59], v[232:235]
    v_cvt_pk_bf16_f32 v176, v176, v177
    v_cvt_pk_bf16_f32 v177, v178, v179
    v_mfma_f32_16x16x32_bf16 v[232:235], a[40:43], v[48:51], v[232:235]
    s_waitcnt lgkmcnt(0)
    v_cvt_pk_bf16_f32 v178, v184, v185
    v_cvt_pk_bf16_f32 v179, v186, v187
    v_mfma_f32_16x16x32_bf16 v[240:243], a[48:51], v[48:51], v[240:243]
    s_add_u32 s82, s81, 12288
    buffer_load_dwordx4 a[112:115], v1, s[48:51], s25 offen offset:0 sc1
    buffer_load_dwordx4 a[116:119], v1, s[48:51], s25 offen offset:1024 sc1
    v_mfma_f32_16x16x32_bf16 v[240:243], a[52:55], v[56:59], v[240:243]
    buffer_store_dwordx4 v[176:179], v1, s[48:51], s82 offen offset:0 sc1
    v_pk_mul_f32 v[180:181], v[180:181], v[12:13]
    v_mfma_f32_16x16x32_bf16 v[244:247], a[52:55], v[60:63], v[244:247]
    v_pk_mul_f32 v[182:183], v[182:183], v[12:13]
    v_pk_mul_f32 v[188:189], v[188:189], v[12:13]
    v_mfma_f32_16x16x32_bf16 v[244:247], a[48:51], v[52:55], v[244:247]
    v_pk_mul_f32 v[190:191], v[190:191], v[12:13]
    v_cvt_pk_bf16_f32 v180, v180, v181
    v_mfma_f32_16x16x32_bf16 v[252:255], a[56:59], v[52:55], v[252:255]
    v_cvt_pk_bf16_f32 v181, v182, v183
    v_cvt_pk_bf16_f32 v182, v188, v189
    v_mfma_f32_16x16x32_bf16 v[252:255], a[60:63], v[60:63], v[252:255]
    buffer_load_dwordx4 a[120:123], v1, s[48:51], s25 offen offset:2048 sc1
    v_cvt_pk_bf16_f32 v183, v190, v191
    v_mfma_f32_16x16x32_bf16 v[248:251], a[60:63], v[56:59], v[248:251]
    buffer_store_dwordx4 v[180:183], v1, s[48:51], s82 offen offset:1024 sc1
    buffer_load_dwordx4 a[124:127], v1, s[48:51], s25 offen offset:3072 sc1
    v_pk_mul_f32 v[192:193], v[192:193], v[10:11]
    v_mfma_f32_16x16x32_bf16 v[248:251], a[56:59], v[48:51], v[248:251]
    v_pk_mul_f32 v[194:195], v[194:195], v[10:11]
    v_pk_mul_f32 v[200:201], v[200:201], v[10:11]
    v_pk_mul_f32 v[202:203], v[202:203], v[10:11]
    v_cvt_pk_bf16_f32 v192, v192, v193
    v_cvt_pk_bf16_f32 v193, v194, v195
    v_cvt_pk_bf16_f32 v194, v200, v201
    v_cvt_pk_bf16_f32 v195, v202, v203
    s_add_u32 s82, s81, 16384
    s_nop 7
    buffer_store_dwordx4 v[192:195], v1, s[48:51], s82 offen offset:0 sc1
    v_pk_mul_f32 v[196:197], v[196:197], v[12:13]
    v_pk_mul_f32 v[198:199], v[198:199], v[12:13]
    v_pk_mul_f32 v[204:205], v[204:205], v[12:13]
    v_pk_mul_f32 v[206:207], v[206:207], v[12:13]
    v_cvt_pk_bf16_f32 v196, v196, v197
    v_cvt_pk_bf16_f32 v197, v198, v199
    v_cvt_pk_bf16_f32 v198, v204, v205
    v_cvt_pk_bf16_f32 v199, v206, v207
    buffer_store_dwordx4 v[196:199], v1, s[48:51], s82 offen offset:1024 sc1
    v_pk_mul_f32 v[208:209], v[208:209], v[10:11]
    v_pk_mul_f32 v[210:211], v[210:211], v[10:11]
    v_pk_mul_f32 v[216:217], v[216:217], v[10:11]
    v_pk_mul_f32 v[218:219], v[218:219], v[10:11]
    v_cvt_pk_bf16_f32 v208, v208, v209
    v_cvt_pk_bf16_f32 v209, v210, v211
    v_cvt_pk_bf16_f32 v210, v216, v217
    v_cvt_pk_bf16_f32 v211, v218, v219
    s_add_u32 s82, s81, 20480
    buffer_store_dwordx4 v[208:211], v1, s[48:51], s82 offen offset:0 sc1
    v_pk_mul_f32 v[212:213], v[212:213], v[12:13]
    v_pk_mul_f32 v[214:215], v[214:215], v[12:13]
    v_pk_mul_f32 v[220:221], v[220:221], v[12:13]
    v_pk_mul_f32 v[222:223], v[222:223], v[12:13]
    v_cvt_pk_bf16_f32 v212, v212, v213
    v_cvt_pk_bf16_f32 v213, v214, v215
    v_cvt_pk_bf16_f32 v214, v220, v221
    v_cvt_pk_bf16_f32 v215, v222, v223
    buffer_store_dwordx4 v[212:215], v1, s[48:51], s82 offen offset:1024 sc1
    v_pk_mul_f32 v[224:225], v[224:225], v[10:11]
    v_pk_mul_f32 v[226:227], v[226:227], v[10:11]
    v_pk_mul_f32 v[232:233], v[232:233], v[10:11]
    v_pk_mul_f32 v[234:235], v[234:235], v[10:11]
    v_cvt_pk_bf16_f32 v224, v224, v225
    v_cvt_pk_bf16_f32 v225, v226, v227
    v_cvt_pk_bf16_f32 v226, v232, v233
    v_cvt_pk_bf16_f32 v227, v234, v235
    s_add_u32 s82, s81, 24576
    buffer_store_dwordx4 v[224:227], v1, s[48:51], s82 offen offset:0 sc1
    v_pk_mul_f32 v[228:229], v[228:229], v[12:13]
    v_pk_mul_f32 v[230:231], v[230:231], v[12:13]
    v_pk_mul_f32 v[236:237], v[236:237], v[12:13]
    v_pk_mul_f32 v[238:239], v[238:239], v[12:13]
    v_cvt_pk_bf16_f32 v228, v228, v229
    v_cvt_pk_bf16_f32 v229, v230, v231
    v_cvt_pk_bf16_f32 v230, v236, v237
    v_cvt_pk_bf16_f32 v231, v238, v239
    buffer_store_dwordx4 v[228:231], v1, s[48:51], s82 offen offset:1024 sc1
    v_pk_mul_f32 v[240:241], v[240:241], v[10:11]
    v_pk_mul_f32 v[242:243], v[242:243], v[10:11]
    v_pk_mul_f32 v[248:249], v[248:249], v[10:11]
    v_pk_mul_f32 v[250:251], v[250:251], v[10:11]
    v_cvt_pk_bf16_f32 v240, v240, v241
    v_cvt_pk_bf16_f32 v241, v242, v243
    v_cvt_pk_bf16_f32 v242, v248, v249
    v_cvt_pk_bf16_f32 v243, v250, v251
    s_add_u32 s82, s81, 28672
    buffer_store_dwordx4 v[240:243], v1, s[48:51], s82 offen offset:0 sc1
    v_pk_mul_f32 v[244:245], v[244:245], v[12:13]
    v_pk_mul_f32 v[246:247], v[246:247], v[12:13]
    v_pk_mul_f32 v[252:253], v[252:253], v[12:13]
    v_pk_mul_f32 v[254:255], v[254:255], v[12:13]
    v_cvt_pk_bf16_f32 v244, v244, v245
    v_cvt_pk_bf16_f32 v245, v246, v247
    v_cvt_pk_bf16_f32 v246, v252, v253
    v_cvt_pk_bf16_f32 v247, v254, v255
    buffer_store_dwordx4 v[244:247], v1, s[48:51], s82 offen offset:1024 sc1
    s_branch F2_bt_37
K2_t1_34:
    ds_read_b128 a[0:3], v4 offset:0
    ds_read_b128 a[4:7], v4 offset:16384
    ds_read_b128 a[8:11], v4 offset:1024
    ds_read_b128 a[12:15], v4 offset:17408
    ds_read_b128 a[16:19], v4 offset:2048
    ds_read_b128 a[20:23], v4 offset:18432
    ds_read_b128 a[24:27], v4 offset:3072
    ds_read_b128 a[28:31], v4 offset:19456
    ds_read_b128 a[32:35], v4 offset:4096
    ds_read_b128 a[36:39], v4 offset:20480
    ds_read_b128 a[40:43], v4 offset:5120
    ds_read_b128 a[44:47], v4 offset:21504
    v_add_f32 v38, v38, v34
    v_add_f32 v39, v39, v36
    v_cvt_pk_bf16_f32 v48, v96, v97
    v_cvt_pk_bf16_f32 v49, v98, v99
    v_cvt_pk_bf16_f32 v50, v104, v105
    v_cvt_pk_bf16_f32 v51, v106, v107
    v_cvt_pk_bf16_f32 v52, v100, v101
    v_cvt_pk_bf16_f32 v53, v102, v103
    v_cvt_pk_bf16_f32 v54, v108, v109
    v_cvt_pk_bf16_f32 v55, v110, v111
    v_cvt_pk_bf16_f32 v56, v112, v113
    v_cvt_pk_bf16_f32 v57, v114, v115
    v_cvt_pk_bf16_f32 v58, v120, v121
    v_cvt_pk_bf16_f32 v59, v122, v123
    v_cvt_pk_bf16_f32 v60, v116, v117
    v_cvt_pk_bf16_f32 v61, v118, v119
    v_cvt_pk_bf16_f32 v62, v124, v125
    v_cvt_pk_bf16_f32 v63, v126, v127
    s_mov_b32 s4, s63
    s_lshl_b32 s10, s63, 16
    s_add_u32 s10, s10, 0x10000
    s_mov_b32 s14, s10
    s_waitcnt lgkmcnt(8)
    v_mfma_f32_16x16x32_bf16 v[128:131], a[0:3], v[48:51], v[128:131]
    v_accvgpr_mov_b32 a64, a128
    v_mfma_f32_16x16x32_bf16 v[128:131], a[4:7], v[56:59], v[128:131]
    ds_read_b128 a[48:51], v4 offset:6144
    s_mov_b32 m0, s28
    s_nop 0
    v_accvgpr_mov_b32 a65, a129
    v_mfma_f32_16x16x32_bf16 v[132:135], a[4:7], v[60:63], v[132:135]
    v_accvgpr_mov_b32 a66, a130
    v_mfma_f32_16x16x32_bf16 v[132:135], a[0:3], v[52:55], v[132:135]
    ds_read_b128 a[52:55], v4 offset:22528
    v_accvgpr_mov_b32 a67, a131
    v_accvgpr_mov_b32 a68, a132
    v_mfma_f32_16x16x32_bf16 v[140:143], a[8:11], v[52:55], v[140:143]
    buffer_load_dwordx4 v2, s[8:11], s26 offen offset:0 sc1 lds
    v_mfma_f32_16x16x32_bf16 v[140:143], a[12:15], v[60:63], v[140:143]
    ds_read_b128 a[56:59], v4 offset:7168
    v_accvgpr_mov_b32 a69, a133
    v_mfma_f32_16x16x32_bf16 v[136:139], a[12:15], v[56:59], v[136:139]
    v_accvgpr_mov_b32 a70, a134
    v_accvgpr_mov_b32 a71, a135
    v_mfma_f32_16x16x32_bf16 v[136:139], a[8:11], v[48:51], v[136:139]
    s_waitcnt lgkmcnt(7)
    ds_read_b128 a[60:63], v4 offset:23552
    buffer_load_dwordx4 v2, s[8:11], s26 offen offset:1024 sc1 lds
    v_mfma_f32_16x16x32_bf16 v[144:147], a[16:19], v[48:51], v[144:147]
    v_accvgpr_mov_b32 a72, a136
    v_accvgpr_mov_b32 a73, a137
    v_mfma_f32_16x16x32_bf16 v[144:147], a[20:23], v[56:59], v[144:147]
    ds_read_b128 a[0:3], v4 offset:8192
    buffer_load_dwordx4 v2, s[8:11], s26 offen offset:2048 sc1 lds
    v_mfma_f32_16x16x32_bf16 v[148:151], a[20:23], v[60:63], v[148:151]
    v_accvgpr_mov_b32 a74, a138
    v_mfma_f32_16x16x32_bf16 v[148:151], a[16:19], v[52:55], v[148:151]
    ds_read_b128 a[4:7], v4 offset:24576
    v_accvgpr_mov_b32 a75, a139
    v_accvgpr_mov_b32 a76, a140
    v_mfma_f32_16x16x32_bf16 v[156:159], a[24:27], v[52:55], v[156:159]
    buffer_load_dwordx4 v2, s[8:11], s26 offen offset:3072 sc1 lds
    v_mfma_f32_16x16x32_bf16 v[156:159], a[28:31], v[60:63], v[156:159]
    ds_read_b128 a[8:11], v4 offset:9216
    v_accvgpr_mov_b32 a77, a141
    v_mfma_f32_16x16x32_bf16 v[152:155], a[28:31], v[56:59], v[152:155]
    s_add_u32 m0, s28, 4096
    s_nop 0
    v_accvgpr_mov_b32 a78, a142
    v_mfma_f32_16x16x32_bf16 v[152:155], a[24:27], v[48:51], v[152:155]
    s_waitcnt lgkmcnt(7)
    ds_read_b128 a[12:15], v4 offset:25600
    v_accvgpr_mov_b32 a79, a143
    v_mfma_f32_16x16x32_bf16 v[160:163], a[32:35], v[48:51], v[160:163]
    v_accvgpr_mov_b32 a80, a144
    v_accvgpr_mov_b32 a81, a145
    v_mfma_f32_16x16x32_bf16 v[160:163], a[36:39], v[56:59], v[160:163]
    ds_read_b128 a[16:19], v4 offset:10240
    buffer_load_dwordx4 v5, s[8:11], s26 offen offset:0 sc1 lds
    v_mfma_f32_16x16x32_bf16 v[164:167], a[36:39], v[60:63], v[164:167]
    v_accvgpr_mov_b32 a82, a146
    v_mfma_f32_16x16x32_bf16 v[164:167], a[32:35], v[52:55], v[164:167]
    ds_read_b128 a[20:23], v4 offset:26624
    v_accvgpr_mov_b32 a83, a147
    v_accvgpr_mov_b32 a84, a148
    v_mfma_f32_16x16x32_bf16 v[172:175], a[40:43], v[52:55], v[172:175]
    buffer_load_dwordx4 v5, s[8:11], s26 offen offset:1024 sc1 lds
    v_mfma_f32_16x16x32_bf16 v[172:175], a[44:47], v[60:63], v[172:175]
    ds_read_b128 a[24:27], v4 offset:11264
    v_accvgpr_mov_b32 a85, a149
    v_accvgpr_mov_b32 a86, a150
    v_mfma_f32_16x16x32_bf16 v[168:171], a[44:47], v[56:59], v[168:171]
    buffer_load_dwordx4 v5, s[8:11], s26 offen offset:2048 sc1 lds
    v_mfma_f32_16x16x32_bf16 v[168:171], a[40:43], v[48:51], v[168:171]
    s_waitcnt lgkmcnt(7)
    ds_read_b128 a[28:31], v4 offset:27648
    v_accvgpr_mov_b32 a87, a151
    v_mfma_f32_16x16x32_bf16 v[176:179], a[48:51], v[48:51], v[176:179]
    v_accvgpr_mov_b32 a88, a152
    v_accvgpr_mov_b32 a89, a153
    v_mfma_f32_16x16x32_bf16 v[176:179], a[52:55], v[56:59], v[176:179]
    ds_read_b128 a[32:35], v4 offset:12288
    buffer_load_dwordx4 v5, s[8:11], s26 offen offset:3072 sc1 lds
    v_mfma_f32_16x16x32_bf16 v[180:183], a[52:55], v[60:63], v[180:183]
    v_accvgpr_mov_b32 a90, a154
    v_mfma_f32_16x16x32_bf16 v[180:183], a[48:51], v[52:55], v[180:183]
    ds_read_b128 a[36:39], v4 offset:28672
    s_xor_b32 s28, s28, s90
    v_accvgpr_mov_b32 a91, a155
    v_mfma_f32_16x16x32_bf16 v[188:191], a[56:59], v[52:55], v[188:191]
    v_accvgpr_mov_b32 a92, a156
    v_mfma_f32_16x16x32_bf16 v[188:191], a[60:63], v[60:63], v[188:191]
    ds_read_b128 a[40:43], v4 offset:13312
    v_accvgpr_mov_b32 a93, a157
    v_mfma_f32_16x16x32_bf16 v[184:187], a[60:63], v[56:59], v[184:187]
    s_mov_b32 m0, s29
    s_nop 0
    v_accvgpr_mov_b32 a94, a158
    v_mfma_f32_16x16x32_bf16 v[184:187], a[56:59], v[48:51], v[184:187]
    s_waitcnt lgkmcnt(7)
    ds_read_b128 a[44:47], v4 offset:29696
    v_accvgpr_mov_b32 a95, a159
    v_mfma_f32_16x16x32_bf16 v[192:195], a[0:3], v[48:51], v[192:195]
    v_accvgpr_mov_b32 a96, a160
    v_accvgpr_mov_b32 a97, a161
    v_mfma_f32_16x16x32_bf16 v[192:195], a[4:7], v[56:59], v[192:195]
    ds_read_b128 a[48:51], v4 offset:14336
    buffer_load_dwordx4 v2, s[12:15], s26 offen offset:0 sc1 lds
    v_mfma_f32_16x16x32_bf16 v[196:199], a[4:7], v[60:63], v[196:199]
    v_accvgpr_mov_b32 a98, a162
    v_accvgpr_mov_b32 a99, a163
    v_mfma_f32_16x16x32_bf16 v[196:199], a[0:3], v[52:55], v[196:199]
    ds_read_b128 a[52:55], v4 offset:30720
    buffer_load_dwordx4 v2, s[12:15], s26 offen offset:1024 sc1 lds
    v_mfma_f32_16x16x32_bf16 v[204:207], a[8:11], v[52:55], v[204:207]
    v_accvgpr_mov_b32 a100, a164
    v_mfma_f32_16x16x32_bf16 v[204:207], a[12:15], v[60:63], v[204:207]
    ds_read_b128 a[56:59], v4 offset:15360
    v_accvgpr_mov_b32 a101, a165
    v_accvgpr_mov_b32 a102, a166
    v_mfma_f32_16x16x32_bf16 v[200:203], a[12:15], v[56:59], v[200:203]
    buffer_load_dwordx4 v2, s[12:15], s26 offen offset:2048 sc1 lds
    v_mfma_f32_16x16x32_bf16 v[200:203], a[8:11], v[48:51], v[200:203]
    s_waitcnt lgkmcnt(7)
    ds_read_b128 a[60:63], v4 offset:31744
    v_accvgpr_mov_b32 a103, a167
    v_mfma_f32_16x16x32_bf16 v[208:211], a[16:19], v[48:51], v[208:211]
    v_accvgpr_mov_b32 a104, a168
    v_accvgpr_mov_b32 a105, a169
    v_mfma_f32_16x16x32_bf16 v[208:211], a[20:23], v[56:59], v[208:211]
    buffer_load_dwordx4 v2, s[12:15], s26 offen offset:3072 sc1 lds
    v_mfma_f32_16x16x32_bf16 v[212:215], a[20:23], v[60:63], v[212:215]
    v_accvgpr_mov_b32 a106, a170
    v_mfma_f32_16x16x32_bf16 v[212:215], a[16:19], v[52:55], v[212:215]
    s_add_u32 m0, s29, 4096
    s_nop 0
    v_accvgpr_mov_b32 a107, a171
    v_mfma_f32_16x16x32_bf16 v[220:223], a[24:27], v[52:55], v[220:223]
    v_accvgpr_mov_b32 a108, a172
    v_mfma_f32_16x16x32_bf16 v[220:223], a[28:31], v[60:63], v[220:223]
    v_accvgpr_mov_b32 a109, a173
    v_accvgpr_mov_b32 a110, a174
    v_mfma_f32_16x16x32_bf16 v[216:219], a[28:31], v[56:59], v[216:219]
    buffer_load_dwordx4 v5, s[12:15], s26 offen offset:0 sc1 lds
    v_mfma_f32_16x16x32_bf16 v[216:219], a[24:27], v[48:51], v[216:219]
    s_waitcnt lgkmcnt(4)
    v_accvgpr_mov_b32 a111, a175
    v_mfma_f32_16x16x32_bf16 v[224:227], a[32:35], v[48:51], v[224:227]
    v_accvgpr_mov_b32 a112, a176
    v_accvgpr_mov_b32 a113, a177
    v_mfma_f32_16x16x32_bf16 v[224:227], a[36:39], v[56:59], v[224:227]
    buffer_load_dwordx4 v5, s[12:15], s26 offen offset:1024 sc1 lds
    v_mfma_f32_16x16x32_bf16 v[228:231], a[36:39], v[60:63], v[228:231]
    v_accvgpr_mov_b32 a114, a178
    v_accvgpr_mov_b32 a115, a179
    v_mfma_f32_16x16x32_bf16 v[228:231], a[32:35], v[52:55], v[228:231]
    buffer_load_dwordx4 v5, s[12:15], s26 offen offset:2048 sc1 lds
    v_mfma_f32_16x16x32_bf16 v[236:239], a[40:43], v[52:55], v[236:239]
    v_accvgpr_mov_b32 a116, a180
    v_mfma_f32_16x16x32_bf16 v[236:239], a[44:47], v[60:63], v[236:239]
    v_accvgpr_mov_b32 a117, a181
    v_accvgpr_mov_b32 a118, a182
    v_mfma_f32_16x16x32_bf16 v[232:235], a[44:47], v[56:59], v[232:235]
    buffer_load_dwordx4 v5, s[12:15], s26 offen offset:3072 sc1 lds
    v_mfma_f32_16x16x32_bf16 v[232:235], a[40:43], v[48:51], v[232:235]
    s_waitcnt lgkmcnt(0)
    v_accvgpr_mov_b32 a119, a183
    v_mfma_f32_16x16x32_bf16 v[240:243], a[48:51], v[48:51], v[240:243]
    s_mov_b32 s29, s30
    v_accvgpr_mov_b32 a120, a184
    v_mfma_f32_16x16x32_bf16 v[240:243], a[52:55], v[56:59], v[240:243]
    v_accvgpr_mov_b32 a121, a185
    v_mfma_f32_16x16x32_bf16 v[244:247], a[52:55], v[60:63], v[244:247]
    v_accvgpr_mov_b32 a122, a186
    v_mfma_f32_16x16x32_bf16 v[244:247], a[48:51], v[52:55], v[244:247]
    s_add_u32 s26, s26, s90
    v_accvgpr_mov_b32 a123, a187
    v_mfma_f32_16x16x32_bf16 v[252:255], a[56:59], v[52:55], v[252:255]
    v_accvgpr_mov_b32 a124, a188
    v_mfma_f32_16x16x32_bf16 v[252:255], a[60:63], v[60:63], v[252:255]
    s_cmp_eq_u32 s26, s3
    s_cselect_b32 s26, 0, s26
    v_accvgpr_mov_b32 a125, a189
    v_mfma_f32_16x16x32_bf16 v[248:251], a[60:63], v[56:59], v[248:251]
    v_accvgpr_mov_b32 a126, a190
    v_mfma_f32_16x16x32_bf16 v[248:251], a[56:59], v[48:51], v[248:251]
    v_accvgpr_mov_b32 a127, a191
    v_mov_b32 v8, v40
    v_mov_b32 v9, v44
    v_mov_b32 v10, v38
    v_mov_b32 v11, v39
    v_mov_b32 v40, 0
    v_mov_b32 v41, 0
    v_mov_b32 v42, 0
    v_mov_b32 v43, 0
    v_mov_b32 v44, 0
    v_mov_b32 v45, 0
    v_mov_b32 v46, 0
    v_mov_b32 v47, 0
    s_mov_b32 s34, 1
    s_mov_b32 s7, 0
    s_mov_b32 s5, 0
    s_lshl_b32 s33, s4, 1
    s_add_u32 s6, s33, 1
    s_mov_b32 s24, s33
    s_add_u32 s83, s35, 16384
    buffer_store_dwordx4 v[8:11], v1, s[48:51], s83 offen sc1
    s_waitcnt vmcnt(17)
    s_barrier
    ds_read_b128 a[0:3], v3 offset:0
    ds_read_b128 a[4:7], v3 offset:1024
    ds_read_b128 a[8:11], v3 offset:2048
    ds_read_b128 a[12:15], v3 offset:3072
    ds_read_b128 a[16:19], v3 offset:4096
    ds_read_b128 a[20:23], v3 offset:5120
    ds_read_b128 a[24:27], v3 offset:6144
    ds_read_b128 a[28:31], v3 offset:7168
    ds_read_b128 a[32:35], v3 offset:8192
    ds_read_b128 a[36:39], v3 offset:9216
    ds_read_b128 a[40:43], v3 offset:10240
    ds_read_b128 a[44:47], v3 offset:11264
    s_waitcnt lgkmcnt(8)
    v_mfma_f32_16x16x32_bf16 v[64:67], a[0:3], a[64:67], v[40:43]
    v_cvt_pk_bf16_f32 v128, v128, v129
    v_cvt_pk_bf16_f32 v129, v130, v131
    v_mfma_f32_16x16x32_bf16 v[64:67], a[4:7], a[72:75], v[64:67]
    ds_read_b128 a[48:51], v3 offset:12288
    v_cvt_pk_bf16_f32 v130, v136, v137
    v_mfma_f32_16x16x32_bf16 v[68:71], a[4:7], a[76:79], v[44:47]
    v_cvt_pk_bf16_f32 v131, v138, v139
    s_add_u32 s83, s35, 0
    v_mfma_f32_16x16x32_bf16 v[68:71], a[0:3], a[68:71], v[68:71]
    buffer_store_dwordx4 v[128:131], v1, s[48:51], s83 offen offset:0 sc1
    v_mfma_f32_16x16x32_bf16 v[68:71], a[8:11], a[84:87], v[68:71]
    v_cvt_pk_bf16_f32 v144, v144, v145
    v_cvt_pk_bf16_f32 v145, v146, v147
    v_mfma_f32_16x16x32_bf16 v[68:71], a[12:15], a[92:95], v[68:71]
    ds_read_b128 a[52:55], v3 offset:13312
    v_cvt_pk_bf16_f32 v146, v152, v153
    v_mfma_f32_16x16x32_bf16 v[64:67], a[12:15], a[88:91], v[64:67]
    ds_read_b128 a[56:59], v3 offset:14336
    v_cvt_pk_bf16_f32 v147, v154, v155
    v_mfma_f32_16x16x32_bf16 v[64:67], a[8:11], a[80:83], v[64:67]
    s_waitcnt lgkmcnt(7)
    ds_read_b128 a[60:63], v3 offset:15360
    buffer_store_dwordx4 v[144:147], v1, s[48:51], s83 offen offset:1024 sc1
    v_mfma_f32_16x16x32_bf16 v[64:67], a[16:19], a[96:99], v[64:67]
    v_mov_b64 v[136:137], 0
    v_mov_b64 v[138:139], 0
    v_mfma_f32_16x16x32_bf16 v[64:67], a[20:23], a[104:107], v[64:67]
    ds_read_b128 a[0:3], v3 offset:16384
    v_mov_b64 v[128:129], 0
    v_mov_b64 v[130:131], 0
    v_mfma_f32_16x16x32_bf16 v[68:71], a[20:23], a[108:111], v[68:71]
    v_cvt_pk_bf16_f32 v160, v160, v161
    v_cvt_pk_bf16_f32 v161, v162, v163
    v_mfma_f32_16x16x32_bf16 v[68:71], a[16:19], a[100:103], v[68:71]
    ds_read_b128 a[4:7], v3 offset:17408
    v_cvt_pk_bf16_f32 v162, v168, v169
    v_cvt_pk_bf16_f32 v163, v170, v171
    buffer_store_dwordx4 v[160:163], v1, s[48:51], s83 offen offset:2048 sc1
    v_mfma_f32_16x16x32_bf16 v[68:71], a[24:27], a[116:119], v[68:71]
    v_mov_b64 v[152:153], 0
    v_mov_b64 v[154:155], 0
    v_mfma_f32_16x16x32_bf16 v[68:71], a[28:31], a[124:127], v[68:71]
    ds_read_b128 a[8:11], v3 offset:18432
    v_mov_b64 v[144:145], 0
    v_mov_b64 v[146:147], 0
    v_mfma_f32_16x16x32_bf16 v[64:67], a[28:31], a[120:123], v[64:67]
    v_cvt_pk_bf16_f32 v176, v176, v177
    v_cvt_pk_bf16_f32 v177, v178, v179
    v_cvt_pk_bf16_f32 v178, v184, v185
    v_mfma_f32_16x16x32_bf16 v[64:67], a[24:27], a[112:115], v[64:67]
    s_waitcnt lgkmcnt(7)
    ds_read_b128 a[12:15], v3 offset:19456
    v_cvt_pk_bf16_f32 v179, v186, v187
    buffer_store_dwordx4 v[176:179], v1, s[48:51], s83 offen offset:3072 sc1
    v_mfma_f32_16x16x32_bf16 v[72:75], a[32:35], a[64:67], v[40:43]
    v_mov_b64 v[168:169], 0
    v_mov_b64 v[170:171], 0
    v_mfma_f32_16x16x32_bf16 v[72:75], a[36:39], a[72:75], v[72:75]
    ds_read_b128 a[16:19], v3 offset:20480
    v_mov_b64 v[160:161], 0
    v_mov_b64 v[162:163], 0
    v_cvt_pk_bf16_f32 v192, v192, v193
    v_mfma_f32_16x16x32_bf16 v[76:79], a[36:39], a[76:79], v[44:47]
    v_cvt_pk_bf16_f32 v193, v194, v195
    v_cvt_pk_bf16_f32 v194, v200, v201
    v_mfma_f32_16x16x32_bf16 v[76:79], a[32:35], a[68:71], v[76:79]
    ds_read_b128 a[20:23], v3 offset:21504
    v_cvt_pk_bf16_f32 v195, v202, v203
    s_add_u32 s83, s35, 4096
    v_mfma_f32_16x16x32_bf16 v[76:79], a[40:43], a[84:87], v[76:79]
    buffer_store_dwordx4 v[192:195], v1, s[48:51], s83 offen offset:0 sc1
    v_mov_b64 v[184:185], 0
    v_mov_b64 v[186:187], 0
    v_mfma_f32_16x16x32_bf16 v[76:79], a[44:47], a[92:95], v[76:79]
    ds_read_b128 a[24:27], v3 offset:22528
    v_mov_b64 v[176:177], 0
    v_mov_b64 v[178:179], 0
    v_mfma_f32_16x16x32_bf16 v[72:75], a[44:47], a[88:91], v[72:75]
    v_cvt_pk_bf16_f32 v208, v208, v209
    v_cvt_pk_bf16_f32 v209, v210, v211
    v_mfma_f32_16x16x32_bf16 v[72:75], a[40:43], a[80:83], v[72:75]
    s_waitcnt lgkmcnt(7)
    ds_read_b128 a[28:31], v3 offset:23552
    v_cvt_pk_bf16_f32 v210, v216, v217
    v_cvt_pk_bf16_f32 v211, v218, v219
    buffer_store_dwordx4 v[208:211], v1, s[48:51], s83 offen offset:1024 sc1
    v_mfma_f32_16x16x32_bf16 v[72:75], a[48:51], a[96:99], v[72:75]
    v_mov_b64 v[200:201], 0
    v_mov_b64 v[202:203], 0
    v_mfma_f32_16x16x32_bf16 v[72:75], a[52:55], a[104:107], v[72:75]
    ds_read_b128 a[32:35], v3 offset:24576
    v_mov_b64 v[192:193], 0
    v_mov_b64 v[194:195], 0
    v_mfma_f32_16x16x32_bf16 v[76:79], a[52:55], a[108:111], v[76:79]
    v_cvt_pk_bf16_f32 v224, v224, v225
    v_cvt_pk_bf16_f32 v225, v226, v227
    v_cvt_pk_bf16_f32 v226, v232, v233
    v_mfma_f32_16x16x32_bf16 v[76:79], a[48:51], a[100:103], v[76:79]
    ds_read_b128 a[36:39], v3 offset:25600
    v_cvt_pk_bf16_f32 v227, v234, v235
    buffer_store_dwordx4 v[224:227], v1, s[48:51], s83 offen offset:2048 sc1
    v_mfma_f32_16x16x32_bf16 v[76:79], a[56:59], a[116:119], v[76:79]
    v_mov_b64 v[216:217], 0
    v_mov_b64 v[218:219], 0
    v_mfma_f32_16x16x32_bf16 v[76:79], a[60:63], a[124:127], v[76:79]
    ds_read_b128 a[40:43], v3 offset:26624
    v_mov_b64 v[208:209], 0
    v_mov_b64 v[210:211], 0
    v_cvt_pk_bf16_f32 v240, v240, v241
    v_mfma_f32_16x16x32_bf16 v[72:75], a[60:63], a[120:123], v[72:75]
    v_cvt_pk_bf16_f32 v241, v242, v243
    v_cvt_pk_bf16_f32 v242, v248, v249
    v_mfma_f32_16x16x32_bf16 v[72:75], a[56:59], a[112:115], v[72:75]
    s_waitcnt lgkmcnt(7)
    ds_read_b128 a[44:47], v3 offset:27648
    v_cvt_pk_bf16_f32 v243, v250, v251
    buffer_store_dwordx4 v[240:243], v1, s[48:51], s83 offen offset:3072 sc1
    v_mfma_f32_16x16x32_bf16 v[80:83], a[0:3], a[64:67], v[40:43]
    v_mov_b64 v[232:233], 0
    v_mov_b64 v[234:235], 0
    v_mov_b64 v[224:225], 0
    v_mfma_f32_16x16x32_bf16 v[80:83], a[4:7], a[72:75], v[80:83]
    ds_read_b128 a[48:51], v3 offset:28672
    v_mov_b64 v[226:227], 0
    v_cvt_pk_bf16_f32 v132, v132, v133
    v_mfma_f32_16x16x32_bf16 v[84:87], a[4:7], a[76:79], v[44:47]
    v_cvt_pk_bf16_f32 v133, v134, v135
    v_cvt_pk_bf16_f32 v134, v140, v141
    v_mfma_f32_16x16x32_bf16 v[84:87], a[0:3], a[68:71], v[84:87]
    ds_read_b128 a[52:55], v3 offset:29696
    v_cvt_pk_bf16_f32 v135, v142, v143
    s_add_u32 s83, s35, 8192
    buffer_store_dwordx4 v[132:135], v1, s[48:51], s83 offen offset:0 sc1
    v_mfma_f32_16x16x32_bf16 v[84:87], a[8:11], a[84:87], v[84:87]
    v_mov_b64 v[248:249], 0
    v_mov_b64 v[250:251], 0
    v_mfma_f32_16x16x32_bf16 v[84:87], a[12:15], a[92:95], v[84:87]
    ds_read_b128 a[56:59], v3 offset:30720
    v_mov_b64 v[240:241], 0
    v_mov_b64 v[242:243], 0
    v_mfma_f32_16x16x32_bf16 v[80:83], a[12:15], a[88:91], v[80:83]
    v_cvt_pk_bf16_f32 v148, v148, v149
    v_cvt_pk_bf16_f32 v149, v150, v151
    v_cvt_pk_bf16_f32 v150, v156, v157
    v_mfma_f32_16x16x32_bf16 v[80:83], a[8:11], a[80:83], v[80:83]
    s_waitcnt lgkmcnt(7)
    ds_read_b128 a[60:63], v3 offset:31744
    v_cvt_pk_bf16_f32 v151, v158, v159
    buffer_store_dwordx4 v[148:151], v1, s[48:51], s83 offen offset:1024 sc1
    v_mfma_f32_16x16x32_bf16 v[80:83], a[16:19], a[96:99], v[80:83]
    v_mov_b64 v[140:141], 0
    v_mov_b64 v[142:143], 0
    v_mfma_f32_16x16x32_bf16 v[80:83], a[20:23], a[104:107], v[80:83]
    v_mov_b64 v[132:133], 0
    v_mov_b64 v[134:135], 0
    v_cvt_pk_bf16_f32 v164, v164, v165
    v_mfma_f32_16x16x32_bf16 v[84:87], a[20:23], a[108:111], v[84:87]
    v_cvt_pk_bf16_f32 v165, v166, v167
    v_cvt_pk_bf16_f32 v166, v172, v173
    v_mfma_f32_16x16x32_bf16 v[84:87], a[16:19], a[100:103], v[84:87]
    v_cvt_pk_bf16_f32 v167, v174, v175
    buffer_store_dwordx4 v[164:167], v1, s[48:51], s83 offen offset:2048 sc1
    v_mfma_f32_16x16x32_bf16 v[84:87], a[24:27], a[116:119], v[84:87]
    v_mov_b64 v[156:157], 0
    v_mov_b64 v[158:159], 0
    v_mov_b64 v[148:149], 0
    v_mfma_f32_16x16x32_bf16 v[84:87], a[28:31], a[124:127], v[84:87]
    v_mov_b64 v[150:151], 0
    v_cvt_pk_bf16_f32 v180, v180, v181
    v_mfma_f32_16x16x32_bf16 v[80:83], a[28:31], a[120:123], v[80:83]
    v_xor_b32 v3, 0x8000, v3
    v_cvt_pk_bf16_f32 v181, v182, v183
    v_cvt_pk_bf16_f32 v182, v188, v189
    v_mfma_f32_16x16x32_bf16 v[80:83], a[24:27], a[112:115], v[80:83]
    s_waitcnt lgkmcnt(4)
    v_cvt_pk_bf16_f32 v183, v190, v191
    buffer_store_dwordx4 v[180:183], v1, s[48:51], s83 offen offset:3072 sc1
    v_mov_b64 v[172:173], 0
    v_mfma_f32_16x16x32_bf16 v[88:91], a[32:35], a[64:67], v[40:43]
    v_mov_b64 v[174:175], 0
    v_mov_b64 v[164:165], 0
    v_mfma_f32_16x16x32_bf16 v[88:91], a[36:39], a[72:75], v[88:91]
    v_mov_b64 v[166:167], 0
    v_cvt_pk_bf16_f32 v196, v196, v197
    v_mfma_f32_16x16x32_bf16 v[92:95], a[36:39], a[76:79], v[44:47]
    v_cvt_pk_bf16_f32 v197, v198, v199
    v_cvt_pk_bf16_f32 v198, v204, v205
    v_cvt_pk_bf16_f32 v199, v206, v207
    v_mfma_f32_16x16x32_bf16 v[92:95], a[32:35], a[68:71], v[92:95]
    s_add_u32 s83, s35, 12288
    buffer_store_dwordx4 v[196:199], v1, s[48:51], s83 offen offset:0 sc1
    v_mfma_f32_16x16x32_bf16 v[92:95], a[40:43], a[84:87], v[92:95]
    v_mov_b64 v[188:189], 0
    v_mov_b64 v[190:191], 0
    v_mfma_f32_16x16x32_bf16 v[92:95], a[44:47], a[92:95], v[92:95]
    v_mov_b64 v[180:181], 0
    v_mov_b64 v[182:183], 0
    v_cvt_pk_bf16_f32 v212, v212, v213
    v_mfma_f32_16x16x32_bf16 v[88:91], a[44:47], a[88:91], v[88:91]
    v_cvt_pk_bf16_f32 v213, v214, v215
    v_cvt_pk_bf16_f32 v214, v220, v221
    v_mfma_f32_16x16x32_bf16 v[88:91], a[40:43], a[80:83], v[88:91]
    s_waitcnt lgkmcnt(0)
    v_cvt_pk_bf16_f32 v215, v222, v223
    buffer_store_dwordx4 v[212:215], v1, s[48:51], s83 offen offset:1024 sc1
    v_mfma_f32_16x16x32_bf16 v[88:91], a[48:51], a[96:99], v[88:91]
    v_mov_b64 v[204:205], 0
    v_mov_b64 v[206:207], 0
    v_mov_b64 v[196:197], 0
    v_mfma_f32_16x16x32_bf16 v[88:91], a[52:55], a[104:107], v[88:91]
    v_mov_b64 v[198:199], 0
    v_cvt_pk_bf16_f32 v228, v228, v229
    v_mfma_f32_16x16x32_bf16 v[92:95], a[52:55], a[108:111], v[92:95]
    v_cvt_pk_bf16_f32 v229, v230, v231
    v_cvt_pk_bf16_f32 v230, v236, v237
    v_mfma_f32_16x16x32_bf16 v[92:95], a[48:51], a[100:103], v[92:95]
    v_cvt_pk_bf16_f32 v231, v238, v239
    buffer_store_dwordx4 v[228:231], v1, s[48:51], s83 offen offset:2048 sc1
    v_mov_b64 v[220:221], 0
    v_mfma_f32_16x16x32_bf16 v[92:95], a[56:59], a[116:119], v[92:95]
    v_mov_b64 v[222:223], 0
    v_mov_b64 v[212:213], 0
    v_mfma_f32_16x16x32_bf16 v[92:95], a[60:63], a[124:127], v[92:95]
    v_mov_b64 v[214:215], 0
    v_cvt_pk_bf16_f32 v244, v244, v245
    v_mfma_f32_16x16x32_bf16 v[88:91], a[60:63], a[120:123], v[88:91]
    v_cvt_pk_bf16_f32 v245, v246, v247
    v_cvt_pk_bf16_f32 v246, v252, v253
    v_cvt_pk_bf16_f32 v247, v254, v255
    v_mfma_f32_16x16x32_bf16 v[88:91], a[56:59], a[112:115], v[88:91]
    buffer_store_dwordx4 v[244:247], v1, s[48:51], s83 offen offset:3072 sc1
    v_mov_b64 v[236:237], 0
    v_mov_b64 v[238:239], 0
    v_mov_b64 v[228:229], 0
    v_mov_b64 v[230:231], 0
    s_nop 1
    v_mov_b64 v[252:253], 0
    v_mov_b64 v[254:255], 0
    v_mov_b64 v[244:245], 0
    v_mov_b64 v[246:247], 0
    s_waitcnt vmcnt(17) lgkmcnt(0)
    s_barrier
    s_branch F2_first_14
F2_bt_37:
    v_mfma_f32_16x16x32_bf16 v[64:67], a[204:207], a[192:195], 0
    v_mfma_f32_16x16x32_bf16 v[68:71], a[200:203], a[192:195], 0
    v_mfma_f32_16x16x32_bf16 v[72:75], a[208:211], a[196:199], 0
    v_mfma_f32_16x16x32_bf16 v[76:79], a[204:207], a[196:199], 0
    v_subrev_u32 v10, 0, v28
    v_and_b32 v10, 0x80000001, v10
    v_bfrev_b32 v10, v10
    v_cmp_eq_u32 s[36:37], 0, v10
    v_cmp_eq_u32 s[66:67], 1, v10
    v_subrev_u32 v10, 1, v28
    v_and_b32 v10, 0x80000001, v10
    v_bfrev_b32 v10, v10
    v_cmp_eq_u32 s[38:39], 0, v10
    v_cmp_eq_u32 s[68:69], 1, v10
    v_subrev_u32 v10, 2, v28
    v_and_b32 v10, 0x80000001, v10
    v_bfrev_b32 v10, v10
    v_cmp_eq_u32 s[40:41], 0, v10
    v_cmp_eq_u32 s[70:71], 1, v10
    v_subrev_u32 v10, 3, v28
    v_and_b32 v10, 0x80000001, v10
    v_bfrev_b32 v10, v10
    v_cmp_eq_u32 s[42:43], 0, v10
    v_cmp_eq_u32 s[72:73], 1, v10
    v_cmp_gt_u32 vcc, 48, v0
    s_nop 0
    v_cndmask_b32 v72, v7, v72, s[36:37]
    v_cndmask_b32 v76, v7, v76, s[66:67]
    v_cndmask_b32 v73, v7, v73, s[38:39]
    v_cndmask_b32 v77, v7, v77, s[68:69]
    v_cndmask_b32 v74, v7, v74, s[40:41]
    v_cndmask_b32 v78, v7, v78, s[70:71]
    v_cndmask_b32 v75, v7, v75, s[42:43]
    v_cndmask_b32 v79, v7, v79, s[72:73]
    v_max3_f32 v9, v72, v73, v74
    v_max3_f32 v9, v9, v75, v76
    v_max3_f32 v9, v9, v77, v78
    v_max_f32 v9, v9, v79
    s_or_b32 s81, s88, s60
    s_cselect_b64 s[66:67], s[66:67], 0
    s_cselect_b64 s[68:69], s[68:69], 0
    s_cselect_b64 s[70:71], s[70:71], 0
    s_cselect_b64 s[72:73], s[72:73], 0
    v_cndmask_b32 v64, v7, v64, s[36:37]
    v_cndmask_b32 v68, v7, v68, s[66:67]
    v_cndmask_b32 v65, v7, v65, s[38:39]
    v_cndmask_b32 v69, v7, v69, s[68:69]
    v_cndmask_b32 v66, v7, v66, s[40:41]
    v_cndmask_b32 v70, v7, v70, s[70:71]
    v_cndmask_b32 v67, v7, v67, s[42:43]
    v_cndmask_b32 v71, v7, v71, s[72:73]
    v_max3_f32 v8, v64, v65, v66
    v_max3_f32 v8, v8, v67, v68
    v_max3_f32 v8, v8, v69, v70
    v_max_f32 v8, v8, v71
    v_mov_b32 v12, v8
    v_mov_b32 v13, v9
    s_nop 1
    v_permlane16_swap_b32 v8, v12
    v_permlane16_swap_b32 v9, v13
    s_nop 1
    v_max_f32 v8, v8, v12
    v_max_f32 v9, v9, v13
    v_mov_b32 v12, v8
    v_mov_b32 v13, v9
    s_nop 1
    v_permlane32_swap_b32 v8, v12
    v_permlane32_swap_b32 v9, v13
    s_nop 1
    v_max_f32 v8, v8, v12
    v_max_f32 v9, v9, v13
    v_sub_f32 v64, v64, v8
    v_sub_f32 v65, v65, v8
    v_sub_f32 v66, v66, v8
    v_sub_f32 v67, v67, v8
    v_sub_f32 v68, v68, v8
    v_sub_f32 v69, v69, v8
    v_sub_f32 v70, v70, v8
    v_sub_f32 v71, v71, v8
    v_exp_f32 v64, v64
    v_exp_f32 v65, v65
    v_exp_f32 v66, v66
    v_exp_f32 v67, v67
    v_exp_f32 v68, v68
    v_exp_f32 v69, v69
    v_exp_f32 v70, v70
    v_exp_f32 v71, v71
    v_sub_f32 v72, v72, v9
    v_sub_f32 v73, v73, v9
    v_sub_f32 v74, v74, v9
    v_sub_f32 v75, v75, v9
    v_sub_f32 v76, v76, v9
    v_sub_f32 v77, v77, v9
    v_sub_f32 v78, v78, v9
    v_sub_f32 v79, v79, v9
    v_exp_f32 v72, v72
    v_exp_f32 v73, v73
    v_exp_f32 v74, v74
    v_exp_f32 v75, v75
    v_exp_f32 v76, v76
    v_exp_f32 v77, v77
    v_exp_f32 v78, v78
    v_exp_f32 v79, v79
    v_cvt_pk_bf16_f32 v96, v64, v65
    v_cvt_pk_bf16_f32 v97, v66, v67
    v_cvt_pk_bf16_f32 v98, v68, v69
    v_cvt_pk_bf16_f32 v99, v70, v71
    v_add_f32 v16, v64, v65
    v_add_f32 v16, v16, v66
    v_add_f32 v16, v16, v67
    v_add_f32 v16, v16, v68
    v_add_f32 v16, v16, v69
    v_add_f32 v16, v16, v70
    v_add_f32 v16, v16, v71
    v_mfma_f32_16x16x32_bf16 v[64:67], a[220:223], v[96:99], 0
    v_mfma_f32_16x16x32_bf16 v[68:71], a[224:227], v[96:99], 0
    v_cvt_pk_bf16_f32 v100, v76, v77
    v_cvt_pk_bf16_f32 v101, v78, v79
    v_cvt_pk_bf16_f32 v102, v72, v73
    v_cvt_pk_bf16_f32 v103, v74, v75
    v_add_f32 v17, v72, v73
    v_add_f32 v17, v17, v74
    v_add_f32 v17, v17, v75
    v_add_f32 v17, v17, v76
    v_add_f32 v17, v17, v77
    v_add_f32 v17, v17, v78
    v_add_f32 v17, v17, v79
    v_mfma_f32_16x16x32_bf16 v[72:75], a[212:215], v[100:103], 0
    v_mfma_f32_16x16x32_bf16 v[76:79], a[216:219], v[100:103], 0
    v_mov_b32 v12, v16
    v_mov_b32 v13, v17
    s_nop 1
    v_permlane16_swap_b32 v16, v12
    v_permlane16_swap_b32 v17, v13
    s_nop 1
    v_add_f32 v16, v16, v12
    v_add_f32 v17, v17, v13
    v_mov_b32 v12, v16
    v_mov_b32 v13, v17
    s_nop 1
    v_permlane32_swap_b32 v16, v12
    v_permlane32_swap_b32 v17, v13
    s_nop 1
    v_add_f32 v16, v16, v12
    v_add_f32 v17, v17, v13
    v_rcp_f32 v16, v16
    v_sub_f32 v32, 1.0, v32
    v_mul_f32 v16, v16, v32
    v_rcp_f32 v17, v17
    v_sub_f32 v33, 1.0, v33
    v_mul_f32 v17, v17, v33
    s_lshl_b32 s81, s64, 12
    s_add_u32 s81, s81, s74
    s_add_u32 s81, s81, 524288
    v_mul_f32 v64, v64, v16
    v_mul_f32 v65, v65, v16
    v_mul_f32 v66, v66, v16
    v_mul_f32 v67, v67, v16
    v_mul_f32 v68, v68, v16
    v_mul_f32 v69, v69, v16
    v_mul_f32 v70, v70, v16
    v_mul_f32 v71, v71, v16
    v_cvt_pk_bf16_f32 v64, v64, v65
    v_cvt_pk_bf16_f32 v65, v66, v67
    v_cvt_pk_bf16_f32 v66, v68, v69
    v_cvt_pk_bf16_f32 v67, v70, v71
    v_cndmask_b32 v66, 0, v66, vcc
    v_cndmask_b32 v67, 0, v67, vcc
    buffer_store_dwordx4 v[64:67], v1, s[48:51], s81 offen offset:0 sc1
    v_mul_f32 v72, v72, v17
    v_mul_f32 v73, v73, v17
    v_mul_f32 v74, v74, v17
    v_mul_f32 v75, v75, v17
    v_mul_f32 v76, v76, v17
    v_mul_f32 v77, v77, v17
    v_mul_f32 v78, v78, v17
    v_mul_f32 v79, v79, v17
    v_cvt_pk_bf16_f32 v72, v72, v73
    v_cvt_pk_bf16_f32 v73, v74, v75
    v_cvt_pk_bf16_f32 v74, v76, v77
    v_cvt_pk_bf16_f32 v75, v78, v79
    v_cndmask_b32 v74, 0, v74, vcc
    v_cndmask_b32 v75, 0, v75, vcc
    buffer_store_dwordx4 v[72:75], v1, s[48:51], s81 offen offset:1024 sc1
    s_and_b32 s83, s75, 7
    s_lshr_b32 s84, s75, 3
    s_lshl_b32 s84, s84, 6
    s_or_b32 s83, s83, s84
    s_lshl_b32 s83, s83, 7
    s_add_u32 s83, s83, 57671696
    v_mov_b32 v8, 1
    s_cmp_eq_u32 s87, 0
    s_cbranch_scc1 F3_w_41
    s_waitcnt vmcnt(0)
    buffer_atomic_add v8, v24, s[48:51], s83 offen sc1
    s_branch K2_store_36
F3_w_41:
    v_mov_b32 v15, v29
    v_add_u32 v9, s20, v1
    v_add_u32 v10, s21, v1
    v_add_u32 v11, s22, v1
    v_add_u32 v12, s23, v1
    s_lshl_b32 s81, s60, 10
    v_add_u32 v2, s81, v1
    v_xor_b32 v3, 0x400, v2
    v_xor_b32 v4, 0x800, v2
    v_xor_b32 v5, 0xc00, v2
    s_and_b32 s82, s16, 7
    s_lshr_b32 s84, s16, 3
    s_lshl_b32 s84, s84, 6
    s_or_b32 s82, s82, s84
    s_lshl_b32 s82, s82, 7
    s_add_u32 s82, s82, 57671696
    s_waitcnt vmcnt(30)
    s_add_u32 s25, s18, 0
    buffer_load_dwordx4 a[128:131], v1, s[48:51], s25 offen offset:0 sc1
    buffer_load_dwordx4 a[132:135], v1, s[48:51], s25 offen offset:1024 sc1
    buffer_load_dwordx4 a[136:139], v1, s[48:51], s25 offen offset:2048 sc1
    buffer_load_dwordx4 a[140:143], v1, s[48:51], s25 offen offset:3072 sc1
    s_add_u32 s25, s18, 4096
    buffer_load_dwordx4 a[144:147], v1, s[48:51], s25 offen offset:0 sc1
    buffer_load_dwordx4 a[148:151], v1, s[48:51], s25 offen offset:1024 sc1
    buffer_load_dwordx4 a[152:155], v1, s[48:51], s25 offen offset:2048 sc1
    buffer_load_dwordx4 a[156:159], v1, s[48:51], s25 offen offset:3072 sc1
    s_waitcnt vmcnt(8)
    buffer_atomic_add v8, v24, s[48:51], s83 offen sc1
    s_add_u32 s25, s18, 8192
    buffer_load_dwordx4 a[160:163], v1, s[48:51], s25 offen offset:0 sc1
    buffer_load_dwordx4 a[164:167], v1, s[48:51], s25 offen offset:1024 sc1
    buffer_load_dwordx4 a[168:171], v1, s[48:51], s25 offen offset:2048 sc1
    buffer_load_dwordx4 a[172:175], v1, s[48:51], s25 offen offset:3072 sc1
    s_add_u32 s25, s18, 12288
    buffer_load_dwordx4 a[176:179], v1, s[48:51], s25 offen offset:0 sc1
    buffer_load_dwordx4 a[180:183], v1, s[48:51], s25 offen offset:1024 sc1
    buffer_load_dwordx4 a[184:187], v1, s[48:51], s25 offen offset:2048 sc1
    buffer_load_dwordx4 a[188:191], v1, s[48:51], s25 offen offset:3072 sc1
    s_waitcnt vmcnt(16)
    s_add_u32 s25, s18, 16384
    buffer_load_dwordx4 a[240:243], v1, s[48:51], s25 offen offset:0 sc1
    buffer_load_dwordx4 a[244:247], v1, s[48:51], s25 offen offset:1024 sc1
    buffer_load_dwordx4 a[248:251], v1, s[48:51], s25 offen offset:2048 sc1
    buffer_load_dwordx4 a[252:255], v1, s[48:51], s25 offen offset:3072 sc1
    s_add_u32 s25, s18, 36864
    buffer_load_dwordx4 a[0:3], v1, s[48:51], s25 offen offset:0 sc1
    buffer_load_dwordx4 a[4:7], v1, s[48:51], s25 offen offset:1024 sc1
    buffer_load_dwordx4 a[8:11], v1, s[48:51], s25 offen offset:2048 sc1
    buffer_load_dwordx4 a[12:15], v1, s[48:51], s25 offen offset:3072 sc1
    s_add_u32 s25, s18, 40960
    buffer_load_dwordx4 a[16:19], v1, s[48:51], s25 offen offset:0 sc1
    buffer_load_dwordx4 a[20:23], v1, s[48:51], s25 offen offset:1024 sc1
    buffer_load_dwordx4 a[24:27], v1, s[48:51], s25 offen offset:2048 sc1
    buffer_load_dwordx4 a[28:31], v1, s[48:51], s25 offen offset:3072 sc1
    s_add_u32 s25, s18, 45056
    buffer_load_dwordx4 a[32:35], v1, s[48:51], s25 offen offset:0 sc1
    buffer_load_dwordx4 a[36:39], v1, s[48:51], s25 offen offset:1024 sc1
    buffer_load_dwordx4 a[40:43], v1, s[48:51], s25 offen offset:2048 sc1
    buffer_load_dwordx4 a[44:47], v1, s[48:51], s25 offen offset:3072 sc1
    s_waitcnt vmcnt(16)
    s_add_u32 s25, s18, 49152
    buffer_load_dwordx4 a[48:51], v1, s[48:51], s25 offen offset:0 sc1
    buffer_load_dwordx4 a[52:55], v1, s[48:51], s25 offen offset:1024 sc1
    buffer_load_dwordx4 a[56:59], v1, s[48:51], s25 offen offset:2048 sc1
    buffer_load_dwordx4 a[60:63], v1, s[48:51], s25 offen offset:3072 sc1
    s_add_u32 s25, s18, 53248
    buffer_load_dwordx4 a[192:195], v1, s[48:51], s25 offen offset:0 sc1
    buffer_load_dwordx4 a[196:199], v1, s[48:51], s25 offen offset:1024 sc1
    buffer_load_dwordx4 a[200:203], v1, s[48:51], s25 offen offset:2048 sc1
    buffer_load_dwordx4 a[204:207], v1, s[48:51], s25 offen offset:3072 sc1
    s_add_u32 s25, s18, 57344
    buffer_load_dwordx4 a[208:211], v1, s[48:51], s25 offen offset:0 sc1
    buffer_load_dwordx4 a[212:215], v1, s[48:51], s25 offen offset:1024 sc1
    buffer_load_dwordx4 a[216:219], v1, s[48:51], s25 offen offset:2048 sc1
    buffer_load_dwordx4 a[220:223], v1, s[48:51], s25 offen offset:3072 sc1
    s_add_u32 s25, s18, 61440
    buffer_load_dwordx4 a[224:227], v1, s[48:51], s25 offen offset:0 sc1
    buffer_load_dwordx4 a[228:231], v1, s[48:51], s25 offen offset:1024 sc1
    buffer_load_dwordx4 a[232:235], v1, s[48:51], s25 offen offset:2048 sc1
    buffer_load_dwordx4 a[236:239], v1, s[48:51], s25 offen offset:3072 sc1
    s_waitcnt vmcnt(16)
    s_add_u32 s25, s18, 65536
    buffer_load_dwordx4 v[176:179], v1, s[48:51], s25 offen offset:0 sc1
    buffer_load_dwordx4 v[180:183], v1, s[48:51], s25 offen offset:1024 sc1
    buffer_load_dwordx4 v[184:187], v1, s[48:51], s25 offen offset:2048 sc1
    buffer_load_dwordx4 v[188:191], v1, s[48:51], s25 offen offset:3072 sc1
    s_add_u32 s25, s18, 69632
    buffer_load_dwordx4 v[192:195], v1, s[48:51], s25 offen offset:0 sc1
    buffer_load_dwordx4 v[196:199], v1, s[48:51], s25 offen offset:1024 sc1
    buffer_load_dwordx4 v[200:203], v1, s[48:51], s25 offen offset:2048 sc1
    buffer_load_dwordx4 v[204:207], v1, s[48:51], s25 offen offset:3072 sc1
    s_add_u32 s25, s18, 73728
    buffer_load_dwordx4 v[208:211], v1, s[48:51], s25 offen offset:0 sc1
    buffer_load_dwordx4 v[212:215], v1, s[48:51], s25 offen offset:1024 sc1
    buffer_load_dwordx4 v[216:219], v1, s[48:51], s25 offen offset:2048 sc1
    buffer_load_dwordx4 v[220:223], v1, s[48:51], s25 offen offset:3072 sc1
    s_add_u32 s25, s18, 77824
    buffer_load_dwordx4 v[224:227], v1, s[48:51], s25 offen offset:0 sc1
    buffer_load_dwordx4 v[228:231], v1, s[48:51], s25 offen offset:1024 sc1
    buffer_load_dwordx4 v[232:235], v1, s[48:51], s25 offen offset:2048 sc1
    buffer_load_dwordx4 v[236:239], v1, s[48:51], s25 offen offset:3072 sc1
    s_waitcnt vmcnt(16)
    s_add_u32 s25, s18, 81920
    buffer_load_dwordx4 v[240:243], v1, s[48:51], s25 offen offset:0 sc1
    buffer_load_dwordx4 v[244:247], v1, s[48:51], s25 offen offset:1024 sc1
    buffer_load_dwordx4 v[248:251], v1, s[48:51], s25 offen offset:2048 sc1
    buffer_load_dwordx4 v[252:255], v1, s[48:51], s25 offen offset:3072 sc1
    s_add_u32 m0, s20, 0
    s_add_u32 s25, s18, 86016
    buffer_load_dwordx4 v1, s[48:51], s25 offen offset:0 sc1 lds
    buffer_load_dwordx4 v1, s[48:51], s25 offen offset:1024 sc1 lds
    buffer_load_dwordx4 v1, s[48:51], s25 offen offset:2048 sc1 lds
    buffer_load_dwordx4 v1, s[48:51], s25 offen offset:3072 sc1 lds
    s_add_u32 m0, s20, 4096
    s_add_u32 s25, s18, 90112
    buffer_load_dwordx4 v1, s[48:51], s25 offen offset:0 sc1 lds
    buffer_load_dwordx4 v1, s[48:51], s25 offen offset:1024 sc1 lds
    buffer_load_dwordx4 v1, s[48:51], s25 offen offset:2048 sc1 lds
    buffer_load_dwordx4 v1, s[48:51], s25 offen offset:3072 sc1 lds
    s_add_u32 m0, s21, 0
    s_add_u32 s25, s18, 94208
    buffer_load_dwordx4 v1, s[48:51], s25 offen offset:0 sc1 lds
    buffer_load_dwordx4 v1, s[48:51], s25 offen offset:1024 sc1 lds
    buffer_load_dwordx4 v1, s[48:51], s25 offen offset:2048 sc1 lds
    buffer_load_dwordx4 v1, s[48:51], s25 offen offset:3072 sc1 lds
    s_waitcnt vmcnt(16)
    buffer_load_dword v14, v15, s[48:51], s82 offen sc1
    s_add_u32 m0, s21, 4096
    s_add_u32 s25, s18, 98304
    buffer_load_dwordx4 v1, s[48:51], s25 offen offset:0 sc1 lds
    buffer_load_dwordx4 v1, s[48:51], s25 offen offset:1024 sc1 lds
    buffer_load_dwordx4 v1, s[48:51], s25 offen offset:2048 sc1 lds
    buffer_load_dwordx4 v1, s[48:51], s25 offen offset:3072 sc1 lds
    s_add_u32 m0, s22, 0
    s_add_u32 s25, s18, 102400
    buffer_load_dwordx4 v1, s[48:51], s25 offen offset:0 sc1 lds
    buffer_load_dwordx4 v1, s[48:51], s25 offen offset:1024 sc1 lds
    buffer_load_dwordx4 v1, s[48:51], s25 offen offset:2048 sc1 lds
    buffer_load_dwordx4 v1, s[48:51], s25 offen offset:3072 sc1 lds
    s_add_u32 m0, s22, 4096
    s_add_u32 s25, s18, 106496
    buffer_load_dwordx4 v1, s[48:51], s25 offen offset:0 sc1 lds
    buffer_load_dwordx4 v1, s[48:51], s25 offen offset:1024 sc1 lds
    buffer_load_dwordx4 v1, s[48:51], s25 offen offset:2048 sc1 lds
    buffer_load_dwordx4 v1, s[48:51], s25 offen offset:3072 sc1 lds
    s_add_u32 m0, s23, 0
    s_add_u32 s25, s18, 110592
    buffer_load_dwordx4 v1, s[48:51], s25 offen offset:0 sc1 lds
    buffer_load_dwordx4 v1, s[48:51], s25 offen offset:1024 sc1 lds
    buffer_load_dwordx4 v1, s[48:51], s25 offen offset:2048 sc1 lds
    buffer_load_dwordx4 v1, s[48:51], s25 offen offset:3072 sc1 lds
    s_add_u32 m0, s23, 4096
    s_add_u32 s25, s18, 114688
    buffer_load_dwordx4 v1, s[48:51], s25 offen offset:0 sc1 lds
    buffer_load_dwordx4 v1, s[48:51], s25 offen offset:1024 sc1 lds
    buffer_load_dwordx4 v1, s[48:51], s25 offen offset:2048 sc1 lds
    buffer_load_dwordx4 v1, s[48:51], s25 offen offset:3072 sc1 lds
    s_waitcnt vmcnt(20)
    v_readfirstlane_b32 s81, v14
    s_nop 3
    s_cmp_eq_u32 s81, 32
    s_cbranch_scc1 F3_cx_44
F3_c_43:
    s_add_u32 s78, s78, 1
    s_cmp_gt_u32 s78, 0x40000
    s_cbranch_scc1 F3_cx_44
    buffer_load_dword v14, v15, s[48:51], s82 offen sc1
    s_waitcnt vmcnt(0)
    v_readfirstlane_b32 s81, v14
    s_nop 3
    s_cmp_lg_u32 s81, 32
    s_cbranch_scc1 F3_c_43
F3_cx_44:
    s_add_u32 s81, s19, 0
    buffer_load_dwordx4 v[80:83], v2, s[48:51], s81 offen sc1
    buffer_load_dwordx4 v[84:87], v3, s[48:51], s81 offen sc1
    buffer_load_dwordx4 v[88:91], v4, s[48:51], s81 offen sc1
    buffer_load_dwordx4 v[92:95], v5, s[48:51], s81 offen sc1
    s_add_u32 s81, s19, 4096
    buffer_load_dwordx4 v[96:99], v2, s[48:51], s81 offen sc1
    buffer_load_dwordx4 v[100:103], v3, s[48:51], s81 offen sc1
    buffer_load_dwordx4 v[104:107], v4, s[48:51], s81 offen sc1
    buffer_load_dwordx4 v[108:111], v5, s[48:51], s81 offen sc1
    s_add_u32 s81, s19, 8192
    buffer_load_dwordx4 v[112:115], v2, s[48:51], s81 offen sc1
    buffer_load_dwordx4 v[116:119], v3, s[48:51], s81 offen sc1
    buffer_load_dwordx4 v[120:123], v4, s[48:51], s81 offen sc1
    buffer_load_dwordx4 v[124:127], v5, s[48:51], s81 offen sc1
    s_add_u32 s81, s19, 12288
    buffer_load_dwordx4 v[128:131], v2, s[48:51], s81 offen sc1
    buffer_load_dwordx4 v[132:135], v3, s[48:51], s81 offen sc1
    buffer_load_dwordx4 v[136:139], v4, s[48:51], s81 offen sc1
    buffer_load_dwordx4 v[140:143], v5, s[48:51], s81 offen sc1
    s_add_u32 s81, s19, 16384
    buffer_load_dwordx4 v[144:147], v2, s[48:51], s81 offen sc1
    buffer_load_dwordx4 v[148:151], v3, s[48:51], s81 offen sc1
    buffer_load_dwordx4 v[152:155], v4, s[48:51], s81 offen sc1
    buffer_load_dwordx4 v[156:159], v5, s[48:51], s81 offen sc1
    s_add_u32 s81, s19, 20480
    buffer_load_dwordx4 v[160:163], v2, s[48:51], s81 offen sc1
    buffer_load_dwordx4 v[164:167], v3, s[48:51], s81 offen sc1
    buffer_load_dwordx4 v[168:171], v4, s[48:51], s81 offen sc1
    buffer_load_dwordx4 v[172:175], v5, s[48:51], s81 offen sc1
    s_waitcnt vmcnt(20)
    v_mfma_f32_16x16x32_bf16 v[16:19], a[128:131], v[80:83], 0
    v_mfma_f32_16x16x32_bf16 v[20:23], a[128:131], v[84:87], 0
    v_mfma_f32_16x16x32_bf16 v[24:27], a[128:131], v[88:91], 0
    v_mfma_f32_16x16x32_bf16 v[28:31], a[128:131], v[92:95], 0
    v_mfma_f32_16x16x32_bf16 v[44:47], a[132:135], v[92:95], 0
    v_mfma_f32_16x16x32_bf16 v[40:43], a[132:135], v[88:91], 0
    v_mfma_f32_16x16x32_bf16 v[36:39], a[132:135], v[84:87], 0
    v_mfma_f32_16x16x32_bf16 v[32:35], a[132:135], v[80:83], 0
    v_mfma_f32_16x16x32_bf16 v[48:51], a[136:139], v[80:83], 0
    v_mfma_f32_16x16x32_bf16 v[52:55], a[136:139], v[84:87], 0
    v_mfma_f32_16x16x32_bf16 v[56:59], a[136:139], v[88:91], 0
    v_mfma_f32_16x16x32_bf16 v[60:63], a[136:139], v[92:95], 0
    v_mfma_f32_16x16x32_bf16 v[76:79], a[140:143], v[92:95], 0
    v_mfma_f32_16x16x32_bf16 v[72:75], a[140:143], v[88:91], 0
    v_mfma_f32_16x16x32_bf16 v[68:71], a[140:143], v[84:87], 0
    v_mfma_f32_16x16x32_bf16 v[64:67], a[140:143], v[80:83], 0
    s_waitcnt vmcnt(16)
    v_mfma_f32_16x16x32_bf16 v[16:19], a[144:147], v[96:99], v[16:19]
    v_mfma_f32_16x16x32_bf16 v[20:23], a[144:147], v[100:103], v[20:23]
    s_add_u32 s81, s19, 24576
    v_mfma_f32_16x16x32_bf16 v[24:27], a[144:147], v[104:107], v[24:27]
    v_mfma_f32_16x16x32_bf16 v[28:31], a[144:147], v[108:111], v[28:31]
    v_mfma_f32_16x16x32_bf16 v[44:47], a[148:151], v[108:111], v[44:47]
    buffer_load_dwordx4 v[80:83], v2, s[48:51], s81 offen sc1
    v_mfma_f32_16x16x32_bf16 v[40:43], a[148:151], v[104:107], v[40:43]
    v_mfma_f32_16x16x32_bf16 v[36:39], a[148:151], v[100:103], v[36:39]
    v_mfma_f32_16x16x32_bf16 v[32:35], a[148:151], v[96:99], v[32:35]
    buffer_load_dwordx4 v[84:87], v3, s[48:51], s81 offen sc1
    v_mfma_f32_16x16x32_bf16 v[48:51], a[152:155], v[96:99], v[48:51]
    v_mfma_f32_16x16x32_bf16 v[52:55], a[152:155], v[100:103], v[52:55]
    v_mfma_f32_16x16x32_bf16 v[56:59], a[152:155], v[104:107], v[56:59]
    v_mfma_f32_16x16x32_bf16 v[60:63], a[152:155], v[108:111], v[60:63]
    buffer_load_dwordx4 v[88:91], v4, s[48:51], s81 offen sc1
    v_mfma_f32_16x16x32_bf16 v[76:79], a[156:159], v[108:111], v[76:79]
    v_mfma_f32_16x16x32_bf16 v[72:75], a[156:159], v[104:107], v[72:75]
    v_mfma_f32_16x16x32_bf16 v[68:71], a[156:159], v[100:103], v[68:71]
    buffer_load_dwordx4 v[92:95], v5, s[48:51], s81 offen sc1
    v_mfma_f32_16x16x32_bf16 v[64:67], a[156:159], v[96:99], v[64:67]
    s_waitcnt vmcnt(16)
    v_mfma_f32_16x16x32_bf16 v[16:19], a[160:163], v[112:115], v[16:19]
    s_add_u32 s81, s19, 28672
    v_mfma_f32_16x16x32_bf16 v[20:23], a[160:163], v[116:119], v[20:23]
    v_mfma_f32_16x16x32_bf16 v[24:27], a[160:163], v[120:123], v[24:27]
    buffer_load_dwordx4 v[96:99], v2, s[48:51], s81 offen sc1
    v_mfma_f32_16x16x32_bf16 v[28:31], a[160:163], v[124:127], v[28:31]
    buffer_load_dwordx4 v[100:103], v3, s[48:51], s81 offen sc1
    v_mfma_f32_16x16x32_bf16 v[44:47], a[164:167], v[124:127], v[44:47]
    v_mfma_f32_16x16x32_bf16 v[40:43], a[164:167], v[120:123], v[40:43]
    buffer_load_dwordx4 v[104:107], v4, s[48:51], s81 offen sc1
    v_mfma_f32_16x16x32_bf16 v[36:39], a[164:167], v[116:119], v[36:39]
    v_mfma_f32_16x16x32_bf16 v[32:35], a[164:167], v[112:115], v[32:35]
    buffer_load_dwordx4 v[108:111], v5, s[48:51], s81 offen sc1
    v_mfma_f32_16x16x32_bf16 v[48:51], a[168:171], v[112:115], v[48:51]
    s_add_u32 s25, s18, 118784
    v_mfma_f32_16x16x32_bf16 v[52:55], a[168:171], v[116:119], v[52:55]
    v_mfma_f32_16x16x32_bf16 v[56:59], a[168:171], v[120:123], v[56:59]
    buffer_load_dwordx4 a[128:131], v1, s[48:51], s25 offen offset:0 sc1
    v_mfma_f32_16x16x32_bf16 v[60:63], a[168:171], v[124:127], v[60:63]
    buffer_load_dwordx4 a[132:135], v1, s[48:51], s25 offen offset:1024 sc1
    v_mfma_f32_16x16x32_bf16 v[76:79], a[172:175], v[124:127], v[76:79]
    v_mfma_f32_16x16x32_bf16 v[72:75], a[172:175], v[120:123], v[72:75]
    buffer_load_dwordx4 a[136:139], v1, s[48:51], s25 offen offset:2048 sc1
    v_mfma_f32_16x16x32_bf16 v[68:71], a[172:175], v[116:119], v[68:71]
    v_mfma_f32_16x16x32_bf16 v[64:67], a[172:175], v[112:115], v[64:67]
    buffer_load_dwordx4 a[140:143], v1, s[48:51], s25 offen offset:3072 sc1
    s_waitcnt vmcnt(20)
    v_mfma_f32_16x16x32_bf16 v[16:19], a[176:179], v[128:131], v[16:19]
    v_mfma_f32_16x16x32_bf16 v[20:23], a[176:179], v[132:135], v[20:23]
    s_add_u32 s81, s19, 32768
    v_mfma_f32_16x16x32_bf16 v[24:27], a[176:179], v[136:139], v[24:27]
    v_mfma_f32_16x16x32_bf16 v[28:31], a[176:179], v[140:143], v[28:31]
    v_mfma_f32_16x16x32_bf16 v[44:47], a[180:183], v[140:143], v[44:47]
    buffer_load_dwordx4 v[112:115], v2, s[48:51], s81 offen sc1
    v_mfma_f32_16x16x32_bf16 v[40:43], a[180:183], v[136:139], v[40:43]
    v_mfma_f32_16x16x32_bf16 v[36:39], a[180:183], v[132:135], v[36:39]
    v_mfma_f32_16x16x32_bf16 v[32:35], a[180:183], v[128:131], v[32:35]
    buffer_load_dwordx4 v[116:119], v3, s[48:51], s81 offen sc1
    v_mfma_f32_16x16x32_bf16 v[48:51], a[184:187], v[128:131], v[48:51]
    v_mfma_f32_16x16x32_bf16 v[52:55], a[184:187], v[132:135], v[52:55]
    v_mfma_f32_16x16x32_bf16 v[56:59], a[184:187], v[136:139], v[56:59]
    v_mfma_f32_16x16x32_bf16 v[60:63], a[184:187], v[140:143], v[60:63]
    buffer_load_dwordx4 v[120:123], v4, s[48:51], s81 offen sc1
    v_mfma_f32_16x16x32_bf16 v[76:79], a[188:191], v[140:143], v[76:79]
    v_mfma_f32_16x16x32_bf16 v[72:75], a[188:191], v[136:139], v[72:75]
    v_mfma_f32_16x16x32_bf16 v[68:71], a[188:191], v[132:135], v[68:71]
    buffer_load_dwordx4 v[124:127], v5, s[48:51], s81 offen sc1
    v_mfma_f32_16x16x32_bf16 v[64:67], a[188:191], v[128:131], v[64:67]
    s_waitcnt vmcnt(20)
    v_mfma_f32_16x16x32_bf16 v[16:19], a[240:243], v[144:147], v[16:19]
    v_mfma_f32_16x16x32_bf16 v[20:23], a[240:243], v[148:151], v[20:23]
    s_add_u32 s81, s19, 36864
    v_mfma_f32_16x16x32_bf16 v[24:27], a[240:243], v[152:155], v[24:27]
    v_mfma_f32_16x16x32_bf16 v[28:31], a[240:243], v[156:159], v[28:31]
    v_mfma_f32_16x16x32_bf16 v[44:47], a[244:247], v[156:159], v[44:47]
    buffer_load_dwordx4 v[128:131], v2, s[48:51], s81 offen sc1
    v_mfma_f32_16x16x32_bf16 v[40:43], a[244:247], v[152:155], v[40:43]
    v_mfma_f32_16x16x32_bf16 v[36:39], a[244:247], v[148:151], v[36:39]
    v_mfma_f32_16x16x32_bf16 v[32:35], a[244:247], v[144:147], v[32:35]
    buffer_load_dwordx4 v[132:135], v3, s[48:51], s81 offen sc1
    v_mfma_f32_16x16x32_bf16 v[48:51], a[248:251], v[144:147], v[48:51]
    v_mfma_f32_16x16x32_bf16 v[52:55], a[248:251], v[148:151], v[52:55]
    v_mfma_f32_16x16x32_bf16 v[56:59], a[248:251], v[152:155], v[56:59]
    v_mfma_f32_16x16x32_bf16 v[60:63], a[248:251], v[156:159], v[60:63]
    buffer_load_dwordx4 v[136:139], v4, s[48:51], s81 offen sc1
    v_mfma_f32_16x16x32_bf16 v[76:79], a[252:255], v[156:159], v[76:79]
    v_mfma_f32_16x16x32_bf16 v[72:75], a[252:255], v[152:155], v[72:75]
    v_mfma_f32_16x16x32_bf16 v[68:71], a[252:255], v[148:151], v[68:71]
    buffer_load_dwordx4 v[140:143], v5, s[48:51], s81 offen sc1
    v_mfma_f32_16x16x32_bf16 v[64:67], a[252:255], v[144:147], v[64:67]
    s_waitcnt vmcnt(20)
    v_mfma_f32_16x16x32_bf16 v[16:19], a[64:67], v[160:163], v[16:19]
    s_add_u32 s81, s19, 40960
    v_mfma_f32_16x16x32_bf16 v[20:23], a[64:67], v[164:167], v[20:23]
    v_mfma_f32_16x16x32_bf16 v[24:27], a[64:67], v[168:171], v[24:27]
    buffer_load_dwordx4 v[144:147], v2, s[48:51], s81 offen sc1
    v_mfma_f32_16x16x32_bf16 v[28:31], a[64:67], v[172:175], v[28:31]
    buffer_load_dwordx4 v[148:151], v3, s[48:51], s81 offen sc1
    v_mfma_f32_16x16x32_bf16 v[44:47], a[68:71], v[172:175], v[44:47]
    v_mfma_f32_16x16x32_bf16 v[40:43], a[68:71], v[168:171], v[40:43]
    buffer_load_dwordx4 v[152:155], v4, s[48:51], s81 offen sc1
    v_mfma_f32_16x16x32_bf16 v[36:39], a[68:71], v[164:167], v[36:39]
    v_mfma_f32_16x16x32_bf16 v[32:35], a[68:71], v[160:163], v[32:35]
    buffer_load_dwordx4 v[156:159], v5, s[48:51], s81 offen sc1
    v_mfma_f32_16x16x32_bf16 v[48:51], a[72:75], v[160:163], v[48:51]
    s_add_u32 s25, s18, 122880
    v_mfma_f32_16x16x32_bf16 v[52:55], a[72:75], v[164:167], v[52:55]
    v_mfma_f32_16x16x32_bf16 v[56:59], a[72:75], v[168:171], v[56:59]
    buffer_load_dwordx4 a[144:147], v1, s[48:51], s25 offen offset:0 sc1
    v_mfma_f32_16x16x32_bf16 v[60:63], a[72:75], v[172:175], v[60:63]
    buffer_load_dwordx4 a[148:151], v1, s[48:51], s25 offen offset:1024 sc1
    v_mfma_f32_16x16x32_bf16 v[76:79], a[76:79], v[172:175], v[76:79]
    v_mfma_f32_16x16x32_bf16 v[72:75], a[76:79], v[168:171], v[72:75]
    buffer_load_dwordx4 a[152:155], v1, s[48:51], s25 offen offset:2048 sc1
    v_mfma_f32_16x16x32_bf16 v[68:71], a[76:79], v[164:167], v[68:71]
    v_mfma_f32_16x16x32_bf16 v[64:67], a[76:79], v[160:163], v[64:67]
    buffer_load_dwordx4 a[156:159], v1, s[48:51], s25 offen offset:3072 sc1
    s_waitcnt vmcnt(24)
    v_mfma_f32_16x16x32_bf16 v[16:19], a[80:83], v[80:83], v[16:19]
    v_mfma_f32_16x16x32_bf16 v[20:23], a[80:83], v[84:87], v[20:23]
    s_add_u32 s81, s19, 45056
    v_mfma_f32_16x16x32_bf16 v[24:27], a[80:83], v[88:91], v[24:27]
    v_mfma_f32_16x16x32_bf16 v[28:31], a[80:83], v[92:95], v[28:31]
    v_mfma_f32_16x16x32_bf16 v[44:47], a[84:87], v[92:95], v[44:47]
    buffer_load_dwordx4 v[160:163], v2, s[48:51], s81 offen sc1
    v_mfma_f32_16x16x32_bf16 v[40:43], a[84:87], v[88:91], v[40:43]
    v_mfma_f32_16x16x32_bf16 v[36:39], a[84:87], v[84:87], v[36:39]
    v_mfma_f32_16x16x32_bf16 v[32:35], a[84:87], v[80:83], v[32:35]
    buffer_load_dwordx4 v[164:167], v3, s[48:51], s81 offen sc1
    v_mfma_f32_16x16x32_bf16 v[48:51], a[88:91], v[80:83], v[48:51]
    v_mfma_f32_16x16x32_bf16 v[52:55], a[88:91], v[84:87], v[52:55]
    v_mfma_f32_16x16x32_bf16 v[56:59], a[88:91], v[88:91], v[56:59]
    v_mfma_f32_16x16x32_bf16 v[60:63], a[88:91], v[92:95], v[60:63]
    buffer_load_dwordx4 v[168:171], v4, s[48:51], s81 offen sc1
    v_mfma_f32_16x16x32_bf16 v[76:79], a[92:95], v[92:95], v[76:79]
    v_mfma_f32_16x16x32_bf16 v[72:75], a[92:95], v[88:91], v[72:75]
    v_mfma_f32_16x16x32_bf16 v[68:71], a[92:95], v[84:87], v[68:71]
    buffer_load_dwordx4 v[172:175], v5, s[48:51], s81 offen sc1
    v_mfma_f32_16x16x32_bf16 v[64:67], a[92:95], v[80:83], v[64:67]
    s_waitcnt vmcnt(24)
    v_mfma_f32_16x16x32_bf16 v[16:19], a[96:99], v[96:99], v[16:19]
    v_mfma_f32_16x16x32_bf16 v[20:23], a[96:99], v[100:103], v[20:23]
    s_add_u32 s81, s19, 49152
    v_mfma_f32_16x16x32_bf16 v[24:27], a[96:99], v[104:107], v[24:27]
    v_mfma_f32_16x16x32_bf16 v[28:31], a[96:99], v[108:111], v[28:31]
    v_mfma_f32_16x16x32_bf16 v[44:47], a[100:103], v[108:111], v[44:47]
    buffer_load_dwordx4 v[80:83], v2, s[48:51], s81 offen sc1
    v_mfma_f32_16x16x32_bf16 v[40:43], a[100:103], v[104:107], v[40:43]
    v_mfma_f32_16x16x32_bf16 v[36:39], a[100:103], v[100:103], v[36:39]
    v_mfma_f32_16x16x32_bf16 v[32:35], a[100:103], v[96:99], v[32:35]
    buffer_load_dwordx4 v[84:87], v3, s[48:51], s81 offen sc1
    v_mfma_f32_16x16x32_bf16 v[48:51], a[104:107], v[96:99], v[48:51]
    v_mfma_f32_16x16x32_bf16 v[52:55], a[104:107], v[100:103], v[52:55]
    v_mfma_f32_16x16x32_bf16 v[56:59], a[104:107], v[104:107], v[56:59]
    v_mfma_f32_16x16x32_bf16 v[60:63], a[104:107], v[108:111], v[60:63]
    buffer_load_dwordx4 v[88:91], v4, s[48:51], s81 offen sc1
    v_mfma_f32_16x16x32_bf16 v[76:79], a[108:111], v[108:111], v[76:79]
    v_mfma_f32_16x16x32_bf16 v[72:75], a[108:111], v[104:107], v[72:75]
    v_mfma_f32_16x16x32_bf16 v[68:71], a[108:111], v[100:103], v[68:71]
    buffer_load_dwordx4 v[92:95], v5, s[48:51], s81 offen sc1
    v_mfma_f32_16x16x32_bf16 v[64:67], a[108:111], v[96:99], v[64:67]
    s_waitcnt vmcnt(20)
    v_mfma_f32_16x16x32_bf16 v[16:19], a[112:115], v[112:115], v[16:19]
    s_add_u32 s81, s19, 53248
    v_mfma_f32_16x16x32_bf16 v[20:23], a[112:115], v[116:119], v[20:23]
    v_mfma_f32_16x16x32_bf16 v[24:27], a[112:115], v[120:123], v[24:27]
    buffer_load_dwordx4 v[96:99], v2, s[48:51], s81 offen sc1
    v_mfma_f32_16x16x32_bf16 v[28:31], a[112:115], v[124:127], v[28:31]
    buffer_load_dwordx4 v[100:103], v3, s[48:51], s81 offen sc1
    v_mfma_f32_16x16x32_bf16 v[44:47], a[116:119], v[124:127], v[44:47]
    v_mfma_f32_16x16x32_bf16 v[40:43], a[116:119], v[120:123], v[40:43]
    buffer_load_dwordx4 v[104:107], v4, s[48:51], s81 offen sc1
    v_mfma_f32_16x16x32_bf16 v[36:39], a[116:119], v[116:119], v[36:39]
    v_mfma_f32_16x16x32_bf16 v[32:35], a[116:119], v[112:115], v[32:35]
    buffer_load_dwordx4 v[108:111], v5, s[48:51], s81 offen sc1
    v_mfma_f32_16x16x32_bf16 v[48:51], a[120:123], v[112:115], v[48:51]
    s_add_u32 s25, s18, 126976
    v_mfma_f32_16x16x32_bf16 v[52:55], a[120:123], v[116:119], v[52:55]
    v_mfma_f32_16x16x32_bf16 v[56:59], a[120:123], v[120:123], v[56:59]
    buffer_load_dwordx4 a[160:163], v1, s[48:51], s25 offen offset:0 sc1
    v_mfma_f32_16x16x32_bf16 v[60:63], a[120:123], v[124:127], v[60:63]
    buffer_load_dwordx4 a[164:167], v1, s[48:51], s25 offen offset:1024 sc1
    v_mfma_f32_16x16x32_bf16 v[76:79], a[124:127], v[124:127], v[76:79]
    v_mfma_f32_16x16x32_bf16 v[72:75], a[124:127], v[120:123], v[72:75]
    buffer_load_dwordx4 a[168:171], v1, s[48:51], s25 offen offset:2048 sc1
    v_mfma_f32_16x16x32_bf16 v[68:71], a[124:127], v[116:119], v[68:71]
    v_mfma_f32_16x16x32_bf16 v[64:67], a[124:127], v[112:115], v[64:67]
    buffer_load_dwordx4 a[172:175], v1, s[48:51], s25 offen offset:3072 sc1
    s_waitcnt vmcnt(24)
    v_mfma_f32_16x16x32_bf16 v[16:19], a[0:3], v[128:131], v[16:19]
    v_mfma_f32_16x16x32_bf16 v[20:23], a[0:3], v[132:135], v[20:23]
    s_add_u32 s81, s19, 57344
    v_mfma_f32_16x16x32_bf16 v[24:27], a[0:3], v[136:139], v[24:27]
    v_mfma_f32_16x16x32_bf16 v[28:31], a[0:3], v[140:143], v[28:31]
    v_mfma_f32_16x16x32_bf16 v[44:47], a[4:7], v[140:143], v[44:47]
    buffer_load_dwordx4 v[112:115], v2, s[48:51], s81 offen sc1
    v_mfma_f32_16x16x32_bf16 v[40:43], a[4:7], v[136:139], v[40:43]
    v_mfma_f32_16x16x32_bf16 v[36:39], a[4:7], v[132:135], v[36:39]
    v_mfma_f32_16x16x32_bf16 v[32:35], a[4:7], v[128:131], v[32:35]
    buffer_load_dwordx4 v[116:119], v3, s[48:51], s81 offen sc1
    v_mfma_f32_16x16x32_bf16 v[48:51], a[8:11], v[128:131], v[48:51]
    v_mfma_f32_16x16x32_bf16 v[52:55], a[8:11], v[132:135], v[52:55]
    v_mfma_f32_16x16x32_bf16 v[56:59], a[8:11], v[136:139], v[56:59]
    v_mfma_f32_16x16x32_bf16 v[60:63], a[8:11], v[140:143], v[60:63]
    buffer_load_dwordx4 v[120:123], v4, s[48:51], s81 offen sc1
    v_mfma_f32_16x16x32_bf16 v[76:79], a[12:15], v[140:143], v[76:79]
    v_mfma_f32_16x16x32_bf16 v[72:75], a[12:15], v[136:139], v[72:75]
    v_mfma_f32_16x16x32_bf16 v[68:71], a[12:15], v[132:135], v[68:71]
    buffer_load_dwordx4 v[124:127], v5, s[48:51], s81 offen sc1
    v_mfma_f32_16x16x32_bf16 v[64:67], a[12:15], v[128:131], v[64:67]
    s_waitcnt vmcnt(24)
    v_mfma_f32_16x16x32_bf16 v[16:19], a[16:19], v[144:147], v[16:19]
    s_add_u32 s81, s19, 61440
    v_mfma_f32_16x16x32_bf16 v[20:23], a[16:19], v[148:151], v[20:23]
    v_mfma_f32_16x16x32_bf16 v[24:27], a[16:19], v[152:155], v[24:27]
    buffer_load_dwordx4 v[128:131], v2, s[48:51], s81 offen sc1
    v_mfma_f32_16x16x32_bf16 v[28:31], a[16:19], v[156:159], v[28:31]
    v_mfma_f32_16x16x32_bf16 v[44:47], a[20:23], v[156:159], v[44:47]
    buffer_load_dwordx4 v[132:135], v3, s[48:51], s81 offen sc1
    v_mfma_f32_16x16x32_bf16 v[40:43], a[20:23], v[152:155], v[40:43]
    v_mfma_f32_16x16x32_bf16 v[36:39], a[20:23], v[148:151], v[36:39]
    buffer_load_dwordx4 v[136:139], v4, s[48:51], s81 offen sc1
    v_mfma_f32_16x16x32_bf16 v[32:35], a[20:23], v[144:147], v[32:35]
    buffer_load_dwordx4 v[140:143], v5, s[48:51], s81 offen sc1
    v_mfma_f32_16x16x32_bf16 v[48:51], a[24:27], v[144:147], v[48:51]
    v_mfma_f32_16x16x32_bf16 v[52:55], a[24:27], v[148:151], v[52:55]
    ds_read_b128 a[96:99], v9 offset:0
    v_mfma_f32_16x16x32_bf16 v[56:59], a[24:27], v[152:155], v[56:59]
    v_mfma_f32_16x16x32_bf16 v[60:63], a[24:27], v[156:159], v[60:63]
    ds_read_b128 a[100:103], v9 offset:1024
    v_mfma_f32_16x16x32_bf16 v[76:79], a[28:31], v[156:159], v[76:79]
    v_mfma_f32_16x16x32_bf16 v[72:75], a[28:31], v[152:155], v[72:75]
    ds_read_b128 a[104:107], v9 offset:2048
    v_mfma_f32_16x16x32_bf16 v[68:71], a[28:31], v[148:151], v[68:71]
    v_mfma_f32_16x16x32_bf16 v[64:67], a[28:31], v[144:147], v[64:67]
    ds_read_b128 a[108:111], v9 offset:3072
    s_waitcnt vmcnt(20)
    v_mfma_f32_16x16x32_bf16 v[16:19], a[32:35], v[160:163], v[16:19]
    s_add_u32 s81, s19, 65536
    v_mfma_f32_16x16x32_bf16 v[20:23], a[32:35], v[164:167], v[20:23]
    buffer_load_dwordx4 v[144:147], v2, s[48:51], s81 offen sc1
    v_mfma_f32_16x16x32_bf16 v[24:27], a[32:35], v[168:171], v[24:27]
    buffer_load_dwordx4 v[148:151], v3, s[48:51], s81 offen sc1
    v_mfma_f32_16x16x32_bf16 v[28:31], a[32:35], v[172:175], v[28:31]
    buffer_load_dwordx4 v[152:155], v4, s[48:51], s81 offen sc1
    v_mfma_f32_16x16x32_bf16 v[44:47], a[36:39], v[172:175], v[44:47]
    v_mfma_f32_16x16x32_bf16 v[40:43], a[36:39], v[168:171], v[40:43]
    buffer_load_dwordx4 v[156:159], v5, s[48:51], s81 offen sc1
    v_mfma_f32_16x16x32_bf16 v[36:39], a[36:39], v[164:167], v[36:39]
    s_add_u32 s25, s18, 131072
    v_mfma_f32_16x16x32_bf16 v[32:35], a[36:39], v[160:163], v[32:35]
    buffer_load_dwordx4 a[176:179], v1, s[48:51], s25 offen offset:0 sc1
    v_mfma_f32_16x16x32_bf16 v[48:51], a[40:43], v[160:163], v[48:51]
    buffer_load_dwordx4 a[180:183], v1, s[48:51], s25 offen offset:1024 sc1
    v_mfma_f32_16x16x32_bf16 v[52:55], a[40:43], v[164:167], v[52:55]
    buffer_load_dwordx4 a[184:187], v1, s[48:51], s25 offen offset:2048 sc1
    v_mfma_f32_16x16x32_bf16 v[56:59], a[40:43], v[168:171], v[56:59]
    buffer_load_dwordx4 a[188:191], v1, s[48:51], s25 offen offset:3072 sc1
    v_mfma_f32_16x16x32_bf16 v[60:63], a[40:43], v[172:175], v[60:63]
    ds_read_b128 a[112:115], v9 offset:4096
    v_mfma_f32_16x16x32_bf16 v[76:79], a[44:47], v[172:175], v[76:79]
    v_mfma_f32_16x16x32_bf16 v[72:75], a[44:47], v[168:171], v[72:75]
    ds_read_b128 a[116:119], v9 offset:5120
    v_mfma_f32_16x16x32_bf16 v[68:71], a[44:47], v[164:167], v[68:71]
    ds_read_b128 a[120:123], v9 offset:6144
    v_mfma_f32_16x16x32_bf16 v[64:67], a[44:47], v[160:163], v[64:67]
    ds_read_b128 a[124:127], v9 offset:7168
    s_waitcnt vmcnt(24)
    v_mfma_f32_16x16x32_bf16 v[16:19], a[48:51], v[80:83], v[16:19]
    s_add_u32 s81, s19, 69632
    v_mfma_f32_16x16x32_bf16 v[20:23], a[48:51], v[84:87], v[20:23]
    v_mfma_f32_16x16x32_bf16 v[24:27], a[48:51], v[88:91], v[24:27]
    buffer_load_dwordx4 v[160:163], v2, s[48:51], s81 offen sc1
    v_mfma_f32_16x16x32_bf16 v[28:31], a[48:51], v[92:95], v[28:31]
    v_mfma_f32_16x16x32_bf16 v[44:47], a[52:55], v[92:95], v[44:47]
    buffer_load_dwordx4 v[164:167], v3, s[48:51], s81 offen sc1
    v_mfma_f32_16x16x32_bf16 v[40:43], a[52:55], v[88:91], v[40:43]
    v_mfma_f32_16x16x32_bf16 v[36:39], a[52:55], v[84:87], v[36:39]
    buffer_load_dwordx4 v[168:171], v4, s[48:51], s81 offen sc1
    v_mfma_f32_16x16x32_bf16 v[32:35], a[52:55], v[80:83], v[32:35]
    buffer_load_dwordx4 v[172:175], v5, s[48:51], s81 offen sc1
    v_mfma_f32_16x16x32_bf16 v[48:51], a[56:59], v[80:83], v[48:51]
    v_mfma_f32_16x16x32_bf16 v[52:55], a[56:59], v[84:87], v[52:55]
    ds_read_b128 a[0:3], v10 offset:0
    v_mfma_f32_16x16x32_bf16 v[56:59], a[56:59], v[88:91], v[56:59]
    v_mfma_f32_16x16x32_bf16 v[60:63], a[56:59], v[92:95], v[60:63]
    ds_read_b128 a[4:7], v10 offset:1024
    v_mfma_f32_16x16x32_bf16 v[76:79], a[60:63], v[92:95], v[76:79]
    v_mfma_f32_16x16x32_bf16 v[72:75], a[60:63], v[88:91], v[72:75]
    ds_read_b128 a[8:11], v10 offset:2048
    v_mfma_f32_16x16x32_bf16 v[68:71], a[60:63], v[84:87], v[68:71]
    v_mfma_f32_16x16x32_bf16 v[64:67], a[60:63], v[80:83], v[64:67]
    ds_read_b128 a[12:15], v10 offset:3072
    s_waitcnt vmcnt(24)
    v_mfma_f32_16x16x32_bf16 v[16:19], a[192:195], v[96:99], v[16:19]
    s_add_u32 s81, s19, 73728
    v_mfma_f32_16x16x32_bf16 v[20:23], a[192:195], v[100:103], v[20:23]
    v_mfma_f32_16x16x32_bf16 v[24:27], a[192:195], v[104:107], v[24:27]
    buffer_load_dwordx4 v[80:83], v2, s[48:51], s81 offen sc1
    v_mfma_f32_16x16x32_bf16 v[28:31], a[192:195], v[108:111], v[28:31]
    v_mfma_f32_16x16x32_bf16 v[44:47], a[196:199], v[108:111], v[44:47]
    buffer_load_dwordx4 v[84:87], v3, s[48:51], s81 offen sc1
    v_mfma_f32_16x16x32_bf16 v[40:43], a[196:199], v[104:107], v[40:43]
    v_mfma_f32_16x16x32_bf16 v[36:39], a[196:199], v[100:103], v[36:39]
    buffer_load_dwordx4 v[88:91], v4, s[48:51], s81 offen sc1
    v_mfma_f32_16x16x32_bf16 v[32:35], a[196:199], v[96:99], v[32:35]
    buffer_load_dwordx4 v[92:95], v5, s[48:51], s81 offen sc1
    v_mfma_f32_16x16x32_bf16 v[48:51], a[200:203], v[96:99], v[48:51]
    v_mfma_f32_16x16x32_bf16 v[52:55], a[200:203], v[100:103], v[52:55]
    ds_read_b128 a[16:19], v10 offset:4096
    v_mfma_f32_16x16x32_bf16 v[56:59], a[200:203], v[104:107], v[56:59]
    v_mfma_f32_16x16x32_bf16 v[60:63], a[200:203], v[108:111], v[60:63]
    ds_read_b128 a[20:23], v10 offset:5120
    v_mfma_f32_16x16x32_bf16 v[76:79], a[204:207], v[108:111], v[76:79]
    v_mfma_f32_16x16x32_bf16 v[72:75], a[204:207], v[104:107], v[72:75]
    ds_read_b128 a[24:27], v10 offset:6144
    v_mfma_f32_16x16x32_bf16 v[68:71], a[204:207], v[100:103], v[68:71]
    v_mfma_f32_16x16x32_bf16 v[64:67], a[204:207], v[96:99], v[64:67]
    ds_read_b128 a[28:31], v10 offset:7168
    s_waitcnt vmcnt(20)
    v_mfma_f32_16x16x32_bf16 v[16:19], a[208:211], v[112:115], v[16:19]
    s_add_u32 s81, s19, 77824
    v_mfma_f32_16x16x32_bf16 v[20:23], a[208:211], v[116:119], v[20:23]
    buffer_load_dwordx4 v[96:99], v2, s[48:51], s81 offen sc1
    v_mfma_f32_16x16x32_bf16 v[24:27], a[208:211], v[120:123], v[24:27]
    buffer_load_dwordx4 v[100:103], v3, s[48:51], s81 offen sc1
    v_mfma_f32_16x16x32_bf16 v[28:31], a[208:211], v[124:127], v[28:31]
    buffer_load_dwordx4 v[104:107], v4, s[48:51], s81 offen sc1
    v_mfma_f32_16x16x32_bf16 v[44:47], a[212:215], v[124:127], v[44:47]
    v_mfma_f32_16x16x32_bf16 v[40:43], a[212:215], v[120:123], v[40:43]
    buffer_load_dwordx4 v[108:111], v5, s[48:51], s81 offen sc1
    v_mfma_f32_16x16x32_bf16 v[36:39], a[212:215], v[116:119], v[36:39]
    s_add_u32 s25, s18, 135168
    v_mfma_f32_16x16x32_bf16 v[32:35], a[212:215], v[112:115], v[32:35]
    buffer_load_dwordx4 a[240:243], v1, s[48:51], s25 offen offset:0 sc1
    v_mfma_f32_16x16x32_bf16 v[48:51], a[216:219], v[112:115], v[48:51]
    buffer_load_dwordx4 a[244:247], v1, s[48:51], s25 offen offset:1024 sc1
    v_mfma_f32_16x16x32_bf16 v[52:55], a[216:219], v[116:119], v[52:55]
    buffer_load_dwordx4 a[248:251], v1, s[48:51], s25 offen offset:2048 sc1
    v_mfma_f32_16x16x32_bf16 v[56:59], a[216:219], v[120:123], v[56:59]
    buffer_load_dwordx4 a[252:255], v1, s[48:51], s25 offen offset:3072 sc1
    v_mfma_f32_16x16x32_bf16 v[60:63], a[216:219], v[124:127], v[60:63]
    ds_read_b128 a[32:35], v11 offset:0
    v_mfma_f32_16x16x32_bf16 v[76:79], a[220:223], v[124:127], v[76:79]
    v_mfma_f32_16x16x32_bf16 v[72:75], a[220:223], v[120:123], v[72:75]
    ds_read_b128 a[36:39], v11 offset:1024
    v_mfma_f32_16x16x32_bf16 v[68:71], a[220:223], v[116:119], v[68:71]
    ds_read_b128 a[40:43], v11 offset:2048
    v_mfma_f32_16x16x32_bf16 v[64:67], a[220:223], v[112:115], v[64:67]
    ds_read_b128 a[44:47], v11 offset:3072
    s_waitcnt vmcnt(24)
    v_mfma_f32_16x16x32_bf16 v[16:19], a[224:227], v[128:131], v[16:19]
    s_add_u32 s81, s19, 81920
    v_mfma_f32_16x16x32_bf16 v[20:23], a[224:227], v[132:135], v[20:23]
    v_mfma_f32_16x16x32_bf16 v[24:27], a[224:227], v[136:139], v[24:27]
    buffer_load_dwordx4 v[112:115], v2, s[48:51], s81 offen sc1
    v_mfma_f32_16x16x32_bf16 v[28:31], a[224:227], v[140:143], v[28:31]
    v_mfma_f32_16x16x32_bf16 v[44:47], a[228:231], v[140:143], v[44:47]
    buffer_load_dwordx4 v[116:119], v3, s[48:51], s81 offen sc1
    v_mfma_f32_16x16x32_bf16 v[40:43], a[228:231], v[136:139], v[40:43]
    v_mfma_f32_16x16x32_bf16 v[36:39], a[228:231], v[132:135], v[36:39]
    buffer_load_dwordx4 v[120:123], v4, s[48:51], s81 offen sc1
    v_mfma_f32_16x16x32_bf16 v[32:35], a[228:231], v[128:131], v[32:35]
    buffer_load_dwordx4 v[124:127], v5, s[48:51], s81 offen sc1
    v_mfma_f32_16x16x32_bf16 v[48:51], a[232:235], v[128:131], v[48:51]
    v_mfma_f32_16x16x32_bf16 v[52:55], a[232:235], v[132:135], v[52:55]
    ds_read_b128 a[48:51], v11 offset:4096
    v_mfma_f32_16x16x32_bf16 v[56:59], a[232:235], v[136:139], v[56:59]
    v_mfma_f32_16x16x32_bf16 v[60:63], a[232:235], v[140:143], v[60:63]
    ds_read_b128 a[52:55], v11 offset:5120
    v_mfma_f32_16x16x32_bf16 v[76:79], a[236:239], v[140:143], v[76:79]
    v_mfma_f32_16x16x32_bf16 v[72:75], a[236:239], v[136:139], v[72:75]
    ds_read_b128 a[56:59], v11 offset:6144
    v_mfma_f32_16x16x32_bf16 v[68:71], a[236:239], v[132:135], v[68:71]
    v_mfma_f32_16x16x32_bf16 v[64:67], a[236:239], v[128:131], v[64:67]
    ds_read_b128 a[60:63], v11 offset:7168
    s_waitcnt vmcnt(24)
    v_mfma_f32_16x16x32_bf16 v[16:19], v[176:179], v[144:147], v[16:19]
    s_add_u32 s81, s19, 86016
    v_mfma_f32_16x16x32_bf16 v[20:23], v[176:179], v[148:151], v[20:23]
    v_mfma_f32_16x16x32_bf16 v[24:27], v[176:179], v[152:155], v[24:27]
    buffer_load_dwordx4 v[128:131], v2, s[48:51], s81 offen sc1
    v_mfma_f32_16x16x32_bf16 v[28:31], v[176:179], v[156:159], v[28:31]
    v_mfma_f32_16x16x32_bf16 v[44:47], v[180:183], v[156:159], v[44:47]
    buffer_load_dwordx4 v[132:135], v3, s[48:51], s81 offen sc1
    v_mfma_f32_16x16x32_bf16 v[40:43], v[180:183], v[152:155], v[40:43]
    v_mfma_f32_16x16x32_bf16 v[36:39], v[180:183], v[148:151], v[36:39]
    buffer_load_dwordx4 v[136:139], v4, s[48:51], s81 offen sc1
    v_mfma_f32_16x16x32_bf16 v[32:35], v[180:183], v[144:147], v[32:35]
    buffer_load_dwordx4 v[140:143], v5, s[48:51], s81 offen sc1
    v_mfma_f32_16x16x32_bf16 v[48:51], v[184:187], v[144:147], v[48:51]
    v_mfma_f32_16x16x32_bf16 v[52:55], v[184:187], v[148:151], v[52:55]
    ds_read_b128 a[192:195], v12 offset:0
    v_mfma_f32_16x16x32_bf16 v[56:59], v[184:187], v[152:155], v[56:59]
    v_mfma_f32_16x16x32_bf16 v[60:63], v[184:187], v[156:159], v[60:63]
    ds_read_b128 a[196:199], v12 offset:1024
    v_mfma_f32_16x16x32_bf16 v[76:79], v[188:191], v[156:159], v[76:79]
    v_mfma_f32_16x16x32_bf16 v[72:75], v[188:191], v[152:155], v[72:75]
    ds_read_b128 a[200:203], v12 offset:2048
    v_mfma_f32_16x16x32_bf16 v[68:71], v[188:191], v[148:151], v[68:71]
    v_mfma_f32_16x16x32_bf16 v[64:67], v[188:191], v[144:147], v[64:67]
    ds_read_b128 a[204:207], v12 offset:3072
    s_waitcnt vmcnt(20)
    v_mfma_f32_16x16x32_bf16 v[16:19], v[192:195], v[160:163], v[16:19]
    s_add_u32 s81, s19, 90112
    v_mfma_f32_16x16x32_bf16 v[20:23], v[192:195], v[164:167], v[20:23]
    buffer_load_dwordx4 v[144:147], v2, s[48:51], s81 offen sc1
    v_mfma_f32_16x16x32_bf16 v[24:27], v[192:195], v[168:171], v[24:27]
    buffer_load_dwordx4 v[148:151], v3, s[48:51], s81 offen sc1
    v_mfma_f32_16x16x32_bf16 v[28:31], v[192:195], v[172:175], v[28:31]
    buffer_load_dwordx4 v[152:155], v4, s[48:51], s81 offen sc1
    v_mfma_f32_16x16x32_bf16 v[44:47], v[196:199], v[172:175], v[44:47]
    v_mfma_f32_16x16x32_bf16 v[40:43], v[196:199], v[168:171], v[40:43]
    buffer_load_dwordx4 v[156:159], v5, s[48:51], s81 offen sc1
    v_mfma_f32_16x16x32_bf16 v[36:39], v[196:199], v[164:167], v[36:39]
    s_add_u32 s25, s18, 139264
    v_mfma_f32_16x16x32_bf16 v[32:35], v[196:199], v[160:163], v[32:35]
    buffer_load_dwordx4 a[64:67], v1, s[48:51], s25 offen offset:0 sc1
    v_mfma_f32_16x16x32_bf16 v[48:51], v[200:203], v[160:163], v[48:51]
    buffer_load_dwordx4 a[68:71], v1, s[48:51], s25 offen offset:1024 sc1
    v_mfma_f32_16x16x32_bf16 v[52:55], v[200:203], v[164:167], v[52:55]
    buffer_load_dwordx4 a[72:75], v1, s[48:51], s25 offen offset:2048 sc1
    v_mfma_f32_16x16x32_bf16 v[56:59], v[200:203], v[168:171], v[56:59]
    buffer_load_dwordx4 a[76:79], v1, s[48:51], s25 offen offset:3072 sc1
    v_mfma_f32_16x16x32_bf16 v[60:63], v[200:203], v[172:175], v[60:63]
    ds_read_b128 a[208:211], v12 offset:4096
    v_mfma_f32_16x16x32_bf16 v[76:79], v[204:207], v[172:175], v[76:79]
    v_mfma_f32_16x16x32_bf16 v[72:75], v[204:207], v[168:171], v[72:75]
    ds_read_b128 a[212:215], v12 offset:5120
    v_mfma_f32_16x16x32_bf16 v[68:71], v[204:207], v[164:167], v[68:71]
    ds_read_b128 a[216:219], v12 offset:6144
    v_mfma_f32_16x16x32_bf16 v[64:67], v[204:207], v[160:163], v[64:67]
    ds_read_b128 a[220:223], v12 offset:7168
    s_waitcnt vmcnt(24)
    v_mfma_f32_16x16x32_bf16 v[16:19], v[208:211], v[80:83], v[16:19]
    v_mfma_f32_16x16x32_bf16 v[20:23], v[208:211], v[84:87], v[20:23]
    s_add_u32 s81, s19, 94208
    v_mfma_f32_16x16x32_bf16 v[24:27], v[208:211], v[88:91], v[24:27]
    v_mfma_f32_16x16x32_bf16 v[28:31], v[208:211], v[92:95], v[28:31]
    v_mfma_f32_16x16x32_bf16 v[44:47], v[212:215], v[92:95], v[44:47]
    buffer_load_dwordx4 v[160:163], v2, s[48:51], s81 offen sc1
    v_mfma_f32_16x16x32_bf16 v[40:43], v[212:215], v[88:91], v[40:43]
    v_mfma_f32_16x16x32_bf16 v[36:39], v[212:215], v[84:87], v[36:39]
    v_mfma_f32_16x16x32_bf16 v[32:35], v[212:215], v[80:83], v[32:35]
    buffer_load_dwordx4 v[164:167], v3, s[48:51], s81 offen sc1
    v_mfma_f32_16x16x32_bf16 v[48:51], v[216:219], v[80:83], v[48:51]
    v_mfma_f32_16x16x32_bf16 v[52:55], v[216:219], v[84:87], v[52:55]
    v_mfma_f32_16x16x32_bf16 v[56:59], v[216:219], v[88:91], v[56:59]
    v_mfma_f32_16x16x32_bf16 v[60:63], v[216:219], v[92:95], v[60:63]
    buffer_load_dwordx4 v[168:171], v4, s[48:51], s81 offen sc1
    v_mfma_f32_16x16x32_bf16 v[76:79], v[220:223], v[92:95], v[76:79]
    v_mfma_f32_16x16x32_bf16 v[72:75], v[220:223], v[88:91], v[72:75]
    v_mfma_f32_16x16x32_bf16 v[68:71], v[220:223], v[84:87], v[68:71]
    buffer_load_dwordx4 v[172:175], v5, s[48:51], s81 offen sc1
    v_mfma_f32_16x16x32_bf16 v[64:67], v[220:223], v[80:83], v[64:67]
    s_waitcnt vmcnt(24)
    v_mfma_f32_16x16x32_bf16 v[16:19], v[224:227], v[96:99], v[16:19]
    v_mfma_f32_16x16x32_bf16 v[20:23], v[224:227], v[100:103], v[20:23]
    s_add_u32 s81, s19, 98304
    v_mfma_f32_16x16x32_bf16 v[24:27], v[224:227], v[104:107], v[24:27]
    v_mfma_f32_16x16x32_bf16 v[28:31], v[224:227], v[108:111], v[28:31]
    v_mfma_f32_16x16x32_bf16 v[44:47], v[228:231], v[108:111], v[44:47]
    buffer_load_dwordx4 v[80:83], v2, s[48:51], s81 offen sc1
    v_mfma_f32_16x16x32_bf16 v[40:43], v[228:231], v[104:107], v[40:43]
    v_mfma_f32_16x16x32_bf16 v[36:39], v[228:231], v[100:103], v[36:39]
    v_mfma_f32_16x16x32_bf16 v[32:35], v[228:231], v[96:99], v[32:35]
    buffer_load_dwordx4 v[84:87], v3, s[48:51], s81 offen sc1
    v_mfma_f32_16x16x32_bf16 v[48:51], v[232:235], v[96:99], v[48:51]
    v_mfma_f32_16x16x32_bf16 v[52:55], v[232:235], v[100:103], v[52:55]
    v_mfma_f32_16x16x32_bf16 v[56:59], v[232:235], v[104:107], v[56:59]
    v_mfma_f32_16x16x32_bf16 v[60:63], v[232:235], v[108:111], v[60:63]
    buffer_load_dwordx4 v[88:91], v4, s[48:51], s81 offen sc1
    v_mfma_f32_16x16x32_bf16 v[76:79], v[236:239], v[108:111], v[76:79]
    v_mfma_f32_16x16x32_bf16 v[72:75], v[236:239], v[104:107], v[72:75]
    v_mfma_f32_16x16x32_bf16 v[68:71], v[236:239], v[100:103], v[68:71]
    buffer_load_dwordx4 v[92:95], v5, s[48:51], s81 offen sc1
    v_mfma_f32_16x16x32_bf16 v[64:67], v[236:239], v[96:99], v[64:67]
    s_waitcnt vmcnt(20)
    v_mfma_f32_16x16x32_bf16 v[16:19], v[240:243], v[112:115], v[16:19]
    s_add_u32 s81, s19, 102400
    v_mfma_f32_16x16x32_bf16 v[20:23], v[240:243], v[116:119], v[20:23]
    v_mfma_f32_16x16x32_bf16 v[24:27], v[240:243], v[120:123], v[24:27]
    buffer_load_dwordx4 v[96:99], v2, s[48:51], s81 offen sc1
    v_mfma_f32_16x16x32_bf16 v[28:31], v[240:243], v[124:127], v[28:31]
    buffer_load_dwordx4 v[100:103], v3, s[48:51], s81 offen sc1
    v_mfma_f32_16x16x32_bf16 v[44:47], v[244:247], v[124:127], v[44:47]
    v_mfma_f32_16x16x32_bf16 v[40:43], v[244:247], v[120:123], v[40:43]
    buffer_load_dwordx4 v[104:107], v4, s[48:51], s81 offen sc1
    v_mfma_f32_16x16x32_bf16 v[36:39], v[244:247], v[116:119], v[36:39]
    v_mfma_f32_16x16x32_bf16 v[32:35], v[244:247], v[112:115], v[32:35]
    buffer_load_dwordx4 v[108:111], v5, s[48:51], s81 offen sc1
    v_mfma_f32_16x16x32_bf16 v[48:51], v[248:251], v[112:115], v[48:51]
    s_add_u32 s25, s18, 143360
    v_mfma_f32_16x16x32_bf16 v[52:55], v[248:251], v[116:119], v[52:55]
    v_mfma_f32_16x16x32_bf16 v[56:59], v[248:251], v[120:123], v[56:59]
    buffer_load_dwordx4 a[80:83], v1, s[48:51], s25 offen offset:0 sc1
    v_mfma_f32_16x16x32_bf16 v[60:63], v[248:251], v[124:127], v[60:63]
    buffer_load_dwordx4 a[84:87], v1, s[48:51], s25 offen offset:1024 sc1
    v_mfma_f32_16x16x32_bf16 v[76:79], v[252:255], v[124:127], v[76:79]
    v_mfma_f32_16x16x32_bf16 v[72:75], v[252:255], v[120:123], v[72:75]
    buffer_load_dwordx4 a[88:91], v1, s[48:51], s25 offen offset:2048 sc1
    v_mfma_f32_16x16x32_bf16 v[68:71], v[252:255], v[116:119], v[68:71]
    v_mfma_f32_16x16x32_bf16 v[64:67], v[252:255], v[112:115], v[64:67]
    buffer_load_dwordx4 a[92:95], v1, s[48:51], s25 offen offset:3072 sc1
    s_waitcnt vmcnt(24) lgkmcnt(0)
    s_barrier
    v_mfma_f32_16x16x32_bf16 v[16:19], a[96:99], v[128:131], v[16:19]
    v_mfma_f32_16x16x32_bf16 v[20:23], a[96:99], v[132:135], v[20:23]
    s_add_u32 s81, s19, 106496
    v_mfma_f32_16x16x32_bf16 v[24:27], a[96:99], v[136:139], v[24:27]
    v_mfma_f32_16x16x32_bf16 v[28:31], a[96:99], v[140:143], v[28:31]
    v_mfma_f32_16x16x32_bf16 v[44:47], a[100:103], v[140:143], v[44:47]
    buffer_load_dwordx4 v[112:115], v2, s[48:51], s81 offen sc1
    v_mfma_f32_16x16x32_bf16 v[40:43], a[100:103], v[136:139], v[40:43]
    v_mfma_f32_16x16x32_bf16 v[36:39], a[100:103], v[132:135], v[36:39]
    v_mfma_f32_16x16x32_bf16 v[32:35], a[100:103], v[128:131], v[32:35]
    buffer_load_dwordx4 v[116:119], v3, s[48:51], s81 offen sc1
    v_mfma_f32_16x16x32_bf16 v[48:51], a[104:107], v[128:131], v[48:51]
    v_mfma_f32_16x16x32_bf16 v[52:55], a[104:107], v[132:135], v[52:55]
    v_mfma_f32_16x16x32_bf16 v[56:59], a[104:107], v[136:139], v[56:59]
    v_mfma_f32_16x16x32_bf16 v[60:63], a[104:107], v[140:143], v[60:63]
    buffer_load_dwordx4 v[120:123], v4, s[48:51], s81 offen sc1
    v_mfma_f32_16x16x32_bf16 v[76:79], a[108:111], v[140:143], v[76:79]
    v_mfma_f32_16x16x32_bf16 v[72:75], a[108:111], v[136:139], v[72:75]
    v_mfma_f32_16x16x32_bf16 v[68:71], a[108:111], v[132:135], v[68:71]
    buffer_load_dwordx4 v[124:127], v5, s[48:51], s81 offen sc1
    v_mfma_f32_16x16x32_bf16 v[64:67], a[108:111], v[128:131], v[64:67]
    s_waitcnt vmcnt(24)
    v_mfma_f32_16x16x32_bf16 v[16:19], a[112:115], v[144:147], v[16:19]
    v_mfma_f32_16x16x32_bf16 v[20:23], a[112:115], v[148:151], v[20:23]
    s_add_u32 s81, s19, 110592
    v_mfma_f32_16x16x32_bf16 v[24:27], a[112:115], v[152:155], v[24:27]
    v_mfma_f32_16x16x32_bf16 v[28:31], a[112:115], v[156:159], v[28:31]
    v_mfma_f32_16x16x32_bf16 v[44:47], a[116:119], v[156:159], v[44:47]
    buffer_load_dwordx4 v[128:131], v2, s[48:51], s81 offen sc1
    v_mfma_f32_16x16x32_bf16 v[40:43], a[116:119], v[152:155], v[40:43]
    v_mfma_f32_16x16x32_bf16 v[36:39], a[116:119], v[148:151], v[36:39]
    v_mfma_f32_16x16x32_bf16 v[32:35], a[116:119], v[144:147], v[32:35]
    buffer_load_dwordx4 v[132:135], v3, s[48:51], s81 offen sc1
    v_mfma_f32_16x16x32_bf16 v[48:51], a[120:123], v[144:147], v[48:51]
    v_mfma_f32_16x16x32_bf16 v[52:55], a[120:123], v[148:151], v[52:55]
    v_mfma_f32_16x16x32_bf16 v[56:59], a[120:123], v[152:155], v[56:59]
    v_mfma_f32_16x16x32_bf16 v[60:63], a[120:123], v[156:159], v[60:63]
    buffer_load_dwordx4 v[136:139], v4, s[48:51], s81 offen sc1
    v_mfma_f32_16x16x32_bf16 v[76:79], a[124:127], v[156:159], v[76:79]
    v_mfma_f32_16x16x32_bf16 v[72:75], a[124:127], v[152:155], v[72:75]
    v_mfma_f32_16x16x32_bf16 v[68:71], a[124:127], v[148:151], v[68:71]
    buffer_load_dwordx4 v[140:143], v5, s[48:51], s81 offen sc1
    v_mfma_f32_16x16x32_bf16 v[64:67], a[124:127], v[144:147], v[64:67]
    s_waitcnt vmcnt(20)
    v_mfma_f32_16x16x32_bf16 v[16:19], a[0:3], v[160:163], v[16:19]
    v_mfma_f32_16x16x32_bf16 v[20:23], a[0:3], v[164:167], v[20:23]
    s_add_u32 s81, s19, 114688
    v_mfma_f32_16x16x32_bf16 v[24:27], a[0:3], v[168:171], v[24:27]
    v_mfma_f32_16x16x32_bf16 v[28:31], a[0:3], v[172:175], v[28:31]
    v_mfma_f32_16x16x32_bf16 v[44:47], a[4:7], v[172:175], v[44:47]
    buffer_load_dwordx4 v[144:147], v2, s[48:51], s81 offen sc1
    v_mfma_f32_16x16x32_bf16 v[40:43], a[4:7], v[168:171], v[40:43]
    v_mfma_f32_16x16x32_bf16 v[36:39], a[4:7], v[164:167], v[36:39]
    v_mfma_f32_16x16x32_bf16 v[32:35], a[4:7], v[160:163], v[32:35]
    buffer_load_dwordx4 v[148:151], v3, s[48:51], s81 offen sc1
    v_mfma_f32_16x16x32_bf16 v[48:51], a[8:11], v[160:163], v[48:51]
    v_mfma_f32_16x16x32_bf16 v[52:55], a[8:11], v[164:167], v[52:55]
    v_mfma_f32_16x16x32_bf16 v[56:59], a[8:11], v[168:171], v[56:59]
    v_mfma_f32_16x16x32_bf16 v[60:63], a[8:11], v[172:175], v[60:63]
    buffer_load_dwordx4 v[152:155], v4, s[48:51], s81 offen sc1
    v_mfma_f32_16x16x32_bf16 v[76:79], a[12:15], v[172:175], v[76:79]
    v_mfma_f32_16x16x32_bf16 v[72:75], a[12:15], v[168:171], v[72:75]
    v_mfma_f32_16x16x32_bf16 v[68:71], a[12:15], v[164:167], v[68:71]
    buffer_load_dwordx4 v[156:159], v5, s[48:51], s81 offen sc1
    v_mfma_f32_16x16x32_bf16 v[64:67], a[12:15], v[160:163], v[64:67]
    s_waitcnt vmcnt(20)
    v_mfma_f32_16x16x32_bf16 v[16:19], a[16:19], v[80:83], v[16:19]
    v_mfma_f32_16x16x32_bf16 v[20:23], a[16:19], v[84:87], v[20:23]
    s_add_u32 s81, s19, 118784
    v_mfma_f32_16x16x32_bf16 v[24:27], a[16:19], v[88:91], v[24:27]
    v_mfma_f32_16x16x32_bf16 v[28:31], a[16:19], v[92:95], v[28:31]
    v_mfma_f32_16x16x32_bf16 v[44:47], a[20:23], v[92:95], v[44:47]
    buffer_load_dwordx4 v[160:163], v2, s[48:51], s81 offen sc1
    v_mfma_f32_16x16x32_bf16 v[40:43], a[20:23], v[88:91], v[40:43]
    v_mfma_f32_16x16x32_bf16 v[36:39], a[20:23], v[84:87], v[36:39]
    v_mfma_f32_16x16x32_bf16 v[32:35], a[20:23], v[80:83], v[32:35]
    buffer_load_dwordx4 v[164:167], v3, s[48:51], s81 offen sc1
    v_mfma_f32_16x16x32_bf16 v[48:51], a[24:27], v[80:83], v[48:51]
    v_mfma_f32_16x16x32_bf16 v[52:55], a[24:27], v[84:87], v[52:55]
    v_mfma_f32_16x16x32_bf16 v[56:59], a[24:27], v[88:91], v[56:59]
    v_mfma_f32_16x16x32_bf16 v[60:63], a[24:27], v[92:95], v[60:63]
    buffer_load_dwordx4 v[168:171], v4, s[48:51], s81 offen sc1
    v_mfma_f32_16x16x32_bf16 v[76:79], a[28:31], v[92:95], v[76:79]
    v_mfma_f32_16x16x32_bf16 v[72:75], a[28:31], v[88:91], v[72:75]
    v_mfma_f32_16x16x32_bf16 v[68:71], a[28:31], v[84:87], v[68:71]
    buffer_load_dwordx4 v[172:175], v5, s[48:51], s81 offen sc1
    v_mfma_f32_16x16x32_bf16 v[64:67], a[28:31], v[80:83], v[64:67]
    s_waitcnt vmcnt(20)
    v_mfma_f32_16x16x32_bf16 v[16:19], a[32:35], v[96:99], v[16:19]
    v_mfma_f32_16x16x32_bf16 v[20:23], a[32:35], v[100:103], v[20:23]
    s_add_u32 s81, s19, 122880
    v_mfma_f32_16x16x32_bf16 v[24:27], a[32:35], v[104:107], v[24:27]
    v_mfma_f32_16x16x32_bf16 v[28:31], a[32:35], v[108:111], v[28:31]
    v_mfma_f32_16x16x32_bf16 v[44:47], a[36:39], v[108:111], v[44:47]
    buffer_load_dwordx4 v[80:83], v2, s[48:51], s81 offen sc1
    v_mfma_f32_16x16x32_bf16 v[40:43], a[36:39], v[104:107], v[40:43]
    v_mfma_f32_16x16x32_bf16 v[36:39], a[36:39], v[100:103], v[36:39]
    v_mfma_f32_16x16x32_bf16 v[32:35], a[36:39], v[96:99], v[32:35]
    buffer_load_dwordx4 v[84:87], v3, s[48:51], s81 offen sc1
    v_mfma_f32_16x16x32_bf16 v[48:51], a[40:43], v[96:99], v[48:51]
    v_mfma_f32_16x16x32_bf16 v[52:55], a[40:43], v[100:103], v[52:55]
    v_mfma_f32_16x16x32_bf16 v[56:59], a[40:43], v[104:107], v[56:59]
    v_mfma_f32_16x16x32_bf16 v[60:63], a[40:43], v[108:111], v[60:63]
    buffer_load_dwordx4 v[88:91], v4, s[48:51], s81 offen sc1
    v_mfma_f32_16x16x32_bf16 v[76:79], a[44:47], v[108:111], v[76:79]
    v_mfma_f32_16x16x32_bf16 v[72:75], a[44:47], v[104:107], v[72:75]
    v_mfma_f32_16x16x32_bf16 v[68:71], a[44:47], v[100:103], v[68:71]
    buffer_load_dwordx4 v[92:95], v5, s[48:51], s81 offen sc1
    v_mfma_f32_16x16x32_bf16 v[64:67], a[44:47], v[96:99], v[64:67]
    s_waitcnt vmcnt(16)
    v_mfma_f32_16x16x32_bf16 v[16:19], a[48:51], v[112:115], v[16:19]
    v_mfma_f32_16x16x32_bf16 v[20:23], a[48:51], v[116:119], v[20:23]
    s_add_u32 s81, s19, 126976
    v_mfma_f32_16x16x32_bf16 v[24:27], a[48:51], v[120:123], v[24:27]
    v_mfma_f32_16x16x32_bf16 v[28:31], a[48:51], v[124:127], v[28:31]
    v_mfma_f32_16x16x32_bf16 v[44:47], a[52:55], v[124:127], v[44:47]
    buffer_load_dwordx4 v[96:99], v2, s[48:51], s81 offen sc1
    v_mfma_f32_16x16x32_bf16 v[40:43], a[52:55], v[120:123], v[40:43]
    v_mfma_f32_16x16x32_bf16 v[36:39], a[52:55], v[116:119], v[36:39]
    v_mfma_f32_16x16x32_bf16 v[32:35], a[52:55], v[112:115], v[32:35]
    buffer_load_dwordx4 v[100:103], v3, s[48:51], s81 offen sc1
    v_mfma_f32_16x16x32_bf16 v[48:51], a[56:59], v[112:115], v[48:51]
    v_mfma_f32_16x16x32_bf16 v[52:55], a[56:59], v[116:119], v[52:55]
    v_mfma_f32_16x16x32_bf16 v[56:59], a[56:59], v[120:123], v[56:59]
    v_mfma_f32_16x16x32_bf16 v[60:63], a[56:59], v[124:127], v[60:63]
    buffer_load_dwordx4 v[104:107], v4, s[48:51], s81 offen sc1
    v_mfma_f32_16x16x32_bf16 v[76:79], a[60:63], v[124:127], v[76:79]
    v_mfma_f32_16x16x32_bf16 v[72:75], a[60:63], v[120:123], v[72:75]
    v_mfma_f32_16x16x32_bf16 v[68:71], a[60:63], v[116:119], v[68:71]
    buffer_load_dwordx4 v[108:111], v5, s[48:51], s81 offen sc1
    v_mfma_f32_16x16x32_bf16 v[64:67], a[60:63], v[112:115], v[64:67]
    s_waitcnt vmcnt(16)
    v_mfma_f32_16x16x32_bf16 v[16:19], a[192:195], v[128:131], v[16:19]
    v_mfma_f32_16x16x32_bf16 v[20:23], a[192:195], v[132:135], v[20:23]
    s_add_u32 s81, s19, 131072
    v_mfma_f32_16x16x32_bf16 v[24:27], a[192:195], v[136:139], v[24:27]
    v_mfma_f32_16x16x32_bf16 v[28:31], a[192:195], v[140:143], v[28:31]
    v_mfma_f32_16x16x32_bf16 v[44:47], a[196:199], v[140:143], v[44:47]
    buffer_load_dwordx4 v[112:115], v2, s[48:51], s81 offen sc1
    v_mfma_f32_16x16x32_bf16 v[40:43], a[196:199], v[136:139], v[40:43]
    v_mfma_f32_16x16x32_bf16 v[36:39], a[196:199], v[132:135], v[36:39]
    v_mfma_f32_16x16x32_bf16 v[32:35], a[196:199], v[128:131], v[32:35]
    buffer_load_dwordx4 v[116:119], v3, s[48:51], s81 offen sc1
    v_mfma_f32_16x16x32_bf16 v[48:51], a[200:203], v[128:131], v[48:51]
    v_mfma_f32_16x16x32_bf16 v[52:55], a[200:203], v[132:135], v[52:55]
    v_mfma_f32_16x16x32_bf16 v[56:59], a[200:203], v[136:139], v[56:59]
    v_mfma_f32_16x16x32_bf16 v[60:63], a[200:203], v[140:143], v[60:63]
    buffer_load_dwordx4 v[120:123], v4, s[48:51], s81 offen sc1
    v_mfma_f32_16x16x32_bf16 v[76:79], a[204:207], v[140:143], v[76:79]
    v_mfma_f32_16x16x32_bf16 v[72:75], a[204:207], v[136:139], v[72:75]
    v_mfma_f32_16x16x32_bf16 v[68:71], a[204:207], v[132:135], v[68:71]
    buffer_load_dwordx4 v[124:127], v5, s[48:51], s81 offen sc1
    v_mfma_f32_16x16x32_bf16 v[64:67], a[204:207], v[128:131], v[64:67]
    s_waitcnt vmcnt(16)
    v_mfma_f32_16x16x32_bf16 v[16:19], a[208:211], v[144:147], v[16:19]
    v_mfma_f32_16x16x32_bf16 v[20:23], a[208:211], v[148:151], v[20:23]
    s_add_u32 s81, s19, 135168
    v_mfma_f32_16x16x32_bf16 v[24:27], a[208:211], v[152:155], v[24:27]
    v_mfma_f32_16x16x32_bf16 v[28:31], a[208:211], v[156:159], v[28:31]
    v_mfma_f32_16x16x32_bf16 v[44:47], a[212:215], v[156:159], v[44:47]
    buffer_load_dwordx4 v[128:131], v2, s[48:51], s81 offen sc1
    v_mfma_f32_16x16x32_bf16 v[40:43], a[212:215], v[152:155], v[40:43]
    v_mfma_f32_16x16x32_bf16 v[36:39], a[212:215], v[148:151], v[36:39]
    v_mfma_f32_16x16x32_bf16 v[32:35], a[212:215], v[144:147], v[32:35]
    buffer_load_dwordx4 v[132:135], v3, s[48:51], s81 offen sc1
    v_mfma_f32_16x16x32_bf16 v[48:51], a[216:219], v[144:147], v[48:51]
    v_mfma_f32_16x16x32_bf16 v[52:55], a[216:219], v[148:151], v[52:55]
    v_mfma_f32_16x16x32_bf16 v[56:59], a[216:219], v[152:155], v[56:59]
    v_mfma_f32_16x16x32_bf16 v[60:63], a[216:219], v[156:159], v[60:63]
    buffer_load_dwordx4 v[136:139], v4, s[48:51], s81 offen sc1
    v_mfma_f32_16x16x32_bf16 v[76:79], a[220:223], v[156:159], v[76:79]
    v_mfma_f32_16x16x32_bf16 v[72:75], a[220:223], v[152:155], v[72:75]
    v_mfma_f32_16x16x32_bf16 v[68:71], a[220:223], v[148:151], v[68:71]
    buffer_load_dwordx4 v[140:143], v5, s[48:51], s81 offen sc1
    v_mfma_f32_16x16x32_bf16 v[64:67], a[220:223], v[144:147], v[64:67]
    s_waitcnt vmcnt(16)
    v_mfma_f32_16x16x32_bf16 v[16:19], a[128:131], v[160:163], v[16:19]
    v_mfma_f32_16x16x32_bf16 v[20:23], a[128:131], v[164:167], v[20:23]
    s_add_u32 s81, s19, 139264
    v_mfma_f32_16x16x32_bf16 v[24:27], a[128:131], v[168:171], v[24:27]
    v_mfma_f32_16x16x32_bf16 v[28:31], a[128:131], v[172:175], v[28:31]
    v_mfma_f32_16x16x32_bf16 v[44:47], a[132:135], v[172:175], v[44:47]
    buffer_load_dwordx4 v[144:147], v2, s[48:51], s81 offen sc1
    v_mfma_f32_16x16x32_bf16 v[40:43], a[132:135], v[168:171], v[40:43]
    v_mfma_f32_16x16x32_bf16 v[36:39], a[132:135], v[164:167], v[36:39]
    v_mfma_f32_16x16x32_bf16 v[32:35], a[132:135], v[160:163], v[32:35]
    buffer_load_dwordx4 v[148:151], v3, s[48:51], s81 offen sc1
    v_mfma_f32_16x16x32_bf16 v[48:51], a[136:139], v[160:163], v[48:51]
    v_mfma_f32_16x16x32_bf16 v[52:55], a[136:139], v[164:167], v[52:55]
    v_mfma_f32_16x16x32_bf16 v[56:59], a[136:139], v[168:171], v[56:59]
    v_mfma_f32_16x16x32_bf16 v[60:63], a[136:139], v[172:175], v[60:63]
    buffer_load_dwordx4 v[152:155], v4, s[48:51], s81 offen sc1
    v_mfma_f32_16x16x32_bf16 v[76:79], a[140:143], v[172:175], v[76:79]
    v_mfma_f32_16x16x32_bf16 v[72:75], a[140:143], v[168:171], v[72:75]
    v_mfma_f32_16x16x32_bf16 v[68:71], a[140:143], v[164:167], v[68:71]
    buffer_load_dwordx4 v[156:159], v5, s[48:51], s81 offen sc1
    v_mfma_f32_16x16x32_bf16 v[64:67], a[140:143], v[160:163], v[64:67]
    s_waitcnt vmcnt(16)
    v_mfma_f32_16x16x32_bf16 v[16:19], a[144:147], v[80:83], v[16:19]
    v_mfma_f32_16x16x32_bf16 v[20:23], a[144:147], v[84:87], v[20:23]
    s_add_u32 s81, s19, 143360
    v_mfma_f32_16x16x32_bf16 v[24:27], a[144:147], v[88:91], v[24:27]
    v_mfma_f32_16x16x32_bf16 v[28:31], a[144:147], v[92:95], v[28:31]
    v_mfma_f32_16x16x32_bf16 v[44:47], a[148:151], v[92:95], v[44:47]
    buffer_load_dwordx4 v[160:163], v2, s[48:51], s81 offen sc1
    v_mfma_f32_16x16x32_bf16 v[40:43], a[148:151], v[88:91], v[40:43]
    v_mfma_f32_16x16x32_bf16 v[36:39], a[148:151], v[84:87], v[36:39]
    v_mfma_f32_16x16x32_bf16 v[32:35], a[148:151], v[80:83], v[32:35]
    buffer_load_dwordx4 v[164:167], v3, s[48:51], s81 offen sc1
    v_mfma_f32_16x16x32_bf16 v[48:51], a[152:155], v[80:83], v[48:51]
    v_mfma_f32_16x16x32_bf16 v[52:55], a[152:155], v[84:87], v[52:55]
    v_mfma_f32_16x16x32_bf16 v[56:59], a[152:155], v[88:91], v[56:59]
    v_mfma_f32_16x16x32_bf16 v[60:63], a[152:155], v[92:95], v[60:63]
    buffer_load_dwordx4 v[168:171], v4, s[48:51], s81 offen sc1
    v_mfma_f32_16x16x32_bf16 v[76:79], a[156:159], v[92:95], v[76:79]
    v_mfma_f32_16x16x32_bf16 v[72:75], a[156:159], v[88:91], v[72:75]
    v_mfma_f32_16x16x32_bf16 v[68:71], a[156:159], v[84:87], v[68:71]
    buffer_load_dwordx4 v[172:175], v5, s[48:51], s81 offen sc1
    v_mfma_f32_16x16x32_bf16 v[64:67], a[156:159], v[80:83], v[64:67]
    s_waitcnt vmcnt(16)
    v_mfma_f32_16x16x32_bf16 v[16:19], a[160:163], v[96:99], v[16:19]
    v_mfma_f32_16x16x32_bf16 v[20:23], a[160:163], v[100:103], v[20:23]
    v_mfma_f32_16x16x32_bf16 v[24:27], a[160:163], v[104:107], v[24:27]
    v_mfma_f32_16x16x32_bf16 v[28:31], a[160:163], v[108:111], v[28:31]
    v_mfma_f32_16x16x32_bf16 v[44:47], a[164:167], v[108:111], v[44:47]
    v_mfma_f32_16x16x32_bf16 v[40:43], a[164:167], v[104:107], v[40:43]
    v_mfma_f32_16x16x32_bf16 v[36:39], a[164:167], v[100:103], v[36:39]
    v_mfma_f32_16x16x32_bf16 v[32:35], a[164:167], v[96:99], v[32:35]
    v_mfma_f32_16x16x32_bf16 v[48:51], a[168:171], v[96:99], v[48:51]
    v_mfma_f32_16x16x32_bf16 v[52:55], a[168:171], v[100:103], v[52:55]
    v_mfma_f32_16x16x32_bf16 v[56:59], a[168:171], v[104:107], v[56:59]
    v_mfma_f32_16x16x32_bf16 v[60:63], a[168:171], v[108:111], v[60:63]
    v_mfma_f32_16x16x32_bf16 v[76:79], a[172:175], v[108:111], v[76:79]
    v_mfma_f32_16x16x32_bf16 v[72:75], a[172:175], v[104:107], v[72:75]
    v_mfma_f32_16x16x32_bf16 v[68:71], a[172:175], v[100:103], v[68:71]
    v_mfma_f32_16x16x32_bf16 v[64:67], a[172:175], v[96:99], v[64:67]
    s_waitcnt vmcnt(12)
    v_mfma_f32_16x16x32_bf16 v[16:19], a[176:179], v[112:115], v[16:19]
    v_mfma_f32_16x16x32_bf16 v[20:23], a[176:179], v[116:119], v[20:23]
    v_mfma_f32_16x16x32_bf16 v[24:27], a[176:179], v[120:123], v[24:27]
    v_mfma_f32_16x16x32_bf16 v[28:31], a[176:179], v[124:127], v[28:31]
    v_mfma_f32_16x16x32_bf16 v[44:47], a[180:183], v[124:127], v[44:47]
    v_mfma_f32_16x16x32_bf16 v[40:43], a[180:183], v[120:123], v[40:43]
    v_mfma_f32_16x16x32_bf16 v[36:39], a[180:183], v[116:119], v[36:39]
    v_mfma_f32_16x16x32_bf16 v[32:35], a[180:183], v[112:115], v[32:35]
    v_mfma_f32_16x16x32_bf16 v[48:51], a[184:187], v[112:115], v[48:51]
    v_mfma_f32_16x16x32_bf16 v[52:55], a[184:187], v[116:119], v[52:55]
    v_mfma_f32_16x16x32_bf16 v[56:59], a[184:187], v[120:123], v[56:59]
    v_mfma_f32_16x16x32_bf16 v[60:63], a[184:187], v[124:127], v[60:63]
    v_mfma_f32_16x16x32_bf16 v[76:79], a[188:191], v[124:127], v[76:79]
    v_mfma_f32_16x16x32_bf16 v[72:75], a[188:191], v[120:123], v[72:75]
    v_mfma_f32_16x16x32_bf16 v[68:71], a[188:191], v[116:119], v[68:71]
    v_mfma_f32_16x16x32_bf16 v[64:67], a[188:191], v[112:115], v[64:67]
    s_waitcnt vmcnt(8)
    v_mfma_f32_16x16x32_bf16 v[16:19], a[240:243], v[128:131], v[16:19]
    v_mfma_f32_16x16x32_bf16 v[20:23], a[240:243], v[132:135], v[20:23]
    v_mfma_f32_16x16x32_bf16 v[24:27], a[240:243], v[136:139], v[24:27]
    v_mfma_f32_16x16x32_bf16 v[28:31], a[240:243], v[140:143], v[28:31]
    v_mfma_f32_16x16x32_bf16 v[44:47], a[244:247], v[140:143], v[44:47]
    v_mfma_f32_16x16x32_bf16 v[40:43], a[244:247], v[136:139], v[40:43]
    v_mfma_f32_16x16x32_bf16 v[36:39], a[244:247], v[132:135], v[36:39]
    v_mfma_f32_16x16x32_bf16 v[32:35], a[244:247], v[128:131], v[32:35]
    v_mfma_f32_16x16x32_bf16 v[48:51], a[248:251], v[128:131], v[48:51]
    v_mfma_f32_16x16x32_bf16 v[52:55], a[248:251], v[132:135], v[52:55]
    v_mfma_f32_16x16x32_bf16 v[56:59], a[248:251], v[136:139], v[56:59]
    v_mfma_f32_16x16x32_bf16 v[60:63], a[248:251], v[140:143], v[60:63]
    v_mfma_f32_16x16x32_bf16 v[76:79], a[252:255], v[140:143], v[76:79]
    v_mfma_f32_16x16x32_bf16 v[72:75], a[252:255], v[136:139], v[72:75]
    v_mfma_f32_16x16x32_bf16 v[68:71], a[252:255], v[132:135], v[68:71]
    v_mfma_f32_16x16x32_bf16 v[64:67], a[252:255], v[128:131], v[64:67]
    s_waitcnt vmcnt(4)
    v_mfma_f32_16x16x32_bf16 v[16:19], a[64:67], v[144:147], v[16:19]
    v_mfma_f32_16x16x32_bf16 v[20:23], a[64:67], v[148:151], v[20:23]
    v_mfma_f32_16x16x32_bf16 v[24:27], a[64:67], v[152:155], v[24:27]
    v_mfma_f32_16x16x32_bf16 v[28:31], a[64:67], v[156:159], v[28:31]
    v_mfma_f32_16x16x32_bf16 v[44:47], a[68:71], v[156:159], v[44:47]
    v_mfma_f32_16x16x32_bf16 v[40:43], a[68:71], v[152:155], v[40:43]
    v_mfma_f32_16x16x32_bf16 v[36:39], a[68:71], v[148:151], v[36:39]
    v_mfma_f32_16x16x32_bf16 v[32:35], a[68:71], v[144:147], v[32:35]
    v_mfma_f32_16x16x32_bf16 v[48:51], a[72:75], v[144:147], v[48:51]
    v_mfma_f32_16x16x32_bf16 v[52:55], a[72:75], v[148:151], v[52:55]
    v_mfma_f32_16x16x32_bf16 v[56:59], a[72:75], v[152:155], v[56:59]
    v_mfma_f32_16x16x32_bf16 v[60:63], a[72:75], v[156:159], v[60:63]
    v_mfma_f32_16x16x32_bf16 v[76:79], a[76:79], v[156:159], v[76:79]
    v_mfma_f32_16x16x32_bf16 v[72:75], a[76:79], v[152:155], v[72:75]
    v_mfma_f32_16x16x32_bf16 v[68:71], a[76:79], v[148:151], v[68:71]
    v_mfma_f32_16x16x32_bf16 v[64:67], a[76:79], v[144:147], v[64:67]
    s_waitcnt vmcnt(0)
    v_mfma_f32_16x16x32_bf16 v[16:19], a[80:83], v[160:163], v[16:19]
    v_mfma_f32_16x16x32_bf16 v[20:23], a[80:83], v[164:167], v[20:23]
    v_mfma_f32_16x16x32_bf16 v[24:27], a[80:83], v[168:171], v[24:27]
    v_mfma_f32_16x16x32_bf16 v[28:31], a[80:83], v[172:175], v[28:31]
    v_mfma_f32_16x16x32_bf16 v[44:47], a[84:87], v[172:175], v[44:47]
    v_mfma_f32_16x16x32_bf16 v[40:43], a[84:87], v[168:171], v[40:43]
    v_mfma_f32_16x16x32_bf16 v[36:39], a[84:87], v[164:167], v[36:39]
    v_mfma_f32_16x16x32_bf16 v[32:35], a[84:87], v[160:163], v[32:35]
    v_mfma_f32_16x16x32_bf16 v[48:51], a[88:91], v[160:163], v[48:51]
    v_mfma_f32_16x16x32_bf16 v[52:55], a[88:91], v[164:167], v[52:55]
    v_mfma_f32_16x16x32_bf16 v[56:59], a[88:91], v[168:171], v[56:59]
    v_mfma_f32_16x16x32_bf16 v[60:63], a[88:91], v[172:175], v[60:63]
    v_mfma_f32_16x16x32_bf16 v[76:79], a[92:95], v[172:175], v[76:79]
    v_mfma_f32_16x16x32_bf16 v[72:75], a[92:95], v[168:171], v[72:75]
    v_mfma_f32_16x16x32_bf16 v[68:71], a[92:95], v[164:167], v[68:71]
    v_mfma_f32_16x16x32_bf16 v[64:67], a[92:95], v[160:163], v[64:67]
    s_mul_i32 s82, s60, 12288
    v_add_u32 v6, s82, v1
    s_xor_b32 s82, s60, 1
    s_mul_i32 s82, s82, 12288
    v_add_u32 v10, s82, v1
    s_xor_b32 s82, s60, 2
    s_mul_i32 s82, s82, 12288
    v_add_u32 v11, s82, v1
    s_xor_b32 s82, s60, 3
    s_mul_i32 s82, s82, 12288
    v_add_u32 v12, s82, v1
    ds_write_b128 v10, v[20:23] offset:0
    ds_write_b128 v10, v[36:39] offset:1024
    ds_write_b128 v10, v[52:55] offset:2048
    ds_write_b128 v10, v[68:71] offset:3072
    ds_write_b128 v11, v[24:27] offset:4096
    ds_write_b128 v11, v[40:43] offset:5120
    ds_write_b128 v11, v[56:59] offset:6144
    ds_write_b128 v11, v[72:75] offset:7168
    ds_write_b128 v12, v[28:31] offset:8192
    ds_write_b128 v12, v[44:47] offset:9216
    ds_write_b128 v12, v[60:63] offset:10240
    ds_write_b128 v12, v[76:79] offset:11264
    v_and_b32 v7, 15, v0
    v_mul_u32_u24 v7, 896, v7
    v_lshrrev_b32 v8, 4, v0
    v_lshl_add_u32 v7, v8, 5, v7
    s_lshl_b32 s81, s16, 2
    s_add_u32 s81, s81, s60
    s_mul_i32 s81, s81, 14336
    s_lshl_b32 s82, s17, 7
    s_add_u32 s81, s81, s82
    s_mov_b64 s[8:9], s[98:99]
    s_mov_b32 s10, 1835008
    s_waitcnt lgkmcnt(0)
    s_barrier
    ds_read_b128 v[80:83], v6 offset:0
    ds_read_b128 v[84:87], v6 offset:1024
    ds_read_b128 v[88:91], v6 offset:2048
    ds_read_b128 v[92:95], v6 offset:3072
    ds_read_b128 v[96:99], v6 offset:4096
    ds_read_b128 v[100:103], v6 offset:5120
    ds_read_b128 v[104:107], v6 offset:6144
    ds_read_b128 v[108:111], v6 offset:7168
    ds_read_b128 v[112:115], v6 offset:8192
    ds_read_b128 v[116:119], v6 offset:9216
    ds_read_b128 v[120:123], v6 offset:10240
    ds_read_b128 v[124:127], v6 offset:11264
    s_waitcnt lgkmcnt(8)
    v_pk_add_f32 v[16:17], v[16:17], v[80:81]
    v_pk_add_f32 v[18:19], v[18:19], v[82:83]
    v_pk_add_f32 v[32:33], v[32:33], v[84:85]
    v_pk_add_f32 v[34:35], v[34:35], v[86:87]
    v_pk_add_f32 v[48:49], v[48:49], v[88:89]
    v_pk_add_f32 v[50:51], v[50:51], v[90:91]
    v_pk_add_f32 v[64:65], v[64:65], v[92:93]
    v_pk_add_f32 v[66:67], v[66:67], v[94:95]
    s_waitcnt lgkmcnt(4)
    v_pk_add_f32 v[16:17], v[16:17], v[96:97]
    v_pk_add_f32 v[18:19], v[18:19], v[98:99]
    v_pk_add_f32 v[32:33], v[32:33], v[100:101]
    v_pk_add_f32 v[34:35], v[34:35], v[102:103]
    v_pk_add_f32 v[48:49], v[48:49], v[104:105]
    v_pk_add_f32 v[50:51], v[50:51], v[106:107]
    v_pk_add_f32 v[64:65], v[64:65], v[108:109]
    v_pk_add_f32 v[66:67], v[66:67], v[110:111]
    s_waitcnt lgkmcnt(0)
    v_pk_add_f32 v[16:17], v[16:17], v[112:113]
    v_pk_add_f32 v[18:19], v[18:19], v[114:115]
    v_pk_add_f32 v[32:33], v[32:33], v[116:117]
    v_pk_add_f32 v[34:35], v[34:35], v[118:119]
    v_pk_add_f32 v[48:49], v[48:49], v[120:121]
    v_pk_add_f32 v[50:51], v[50:51], v[122:123]
    v_pk_add_f32 v[64:65], v[64:65], v[124:125]
    v_pk_add_f32 v[66:67], v[66:67], v[126:127]
    v_cvt_pk_bf16_f32 v144, v16, v32
    v_cvt_pk_bf16_f32 v145, v48, v64
    v_cvt_pk_bf16_f32 v146, v17, v33
    v_cvt_pk_bf16_f32 v147, v49, v65
    v_cvt_pk_bf16_f32 v148, v18, v34
    v_cvt_pk_bf16_f32 v149, v50, v66
    v_cvt_pk_bf16_f32 v150, v19, v35
    v_cvt_pk_bf16_f32 v151, v51, v67
    buffer_store_dwordx4 v[144:147], v7, s[8:11], s81 offen
    buffer_store_dwordx4 v[148:151], v7, s[8:11], s81 offen offset:16
K2_store_36:
F_end_1:
    s_endpgm
CODE_END:
.section .rodata,"a"
.p2align 6
.p2align 6
.amdhsa_kernel gated_mix__compressed_kv_cla__sliding_local_dilated__prompt_kernel
  .amdhsa_next_free_vgpr 512
  .amdhsa_next_free_sgpr 102
  .amdhsa_accum_offset 256
  .amdhsa_group_segment_fixed_size 0
  .amdhsa_kernarg_size 104
  .amdhsa_user_sgpr_count 2
  .amdhsa_user_sgpr_kernarg_segment_ptr 1
  .amdhsa_system_sgpr_workgroup_id_x 1
.end_amdhsa_kernel
```
